```python
import torch

def _softmax(x, axis=-1):
    return torch.softmax(x, dim=axis)

def _gelu(x):
    return torch.nn.functional.gelu(x, approximate='tanh')

def _silu(x):
    return torch.nn.functional.silu(x)

def _sigmoid(x):
    return torch.sigmoid(x)

def _layernorm(x, axis=-1, eps=1e-05):
    m = x.mean(dim=axis, keepdim=True)
    v = x.var(dim=axis, keepdim=True, unbiased=False)
    return (x - m) / torch.sqrt(v + eps)

def _scatter_add(tgt, idx, src, axis=0):
    return tgt.clone().index_add_(axis, idx, src)

def _segment_sum(src, seg, n):
    out = torch.zeros((n,) + src.shape[1:], dtype=src.dtype)
    return out.index_add_(0, seg, src)

def _pad(x, pw):
    flat = tuple((v for pair in reversed(pw) for v in pair))
    return torch.nn.functional.pad(x, flat)
kernel_name = 'gated_mix__memory_aug_recurrent_mem_tr__dense_activation_gelu__prompt'

def setup_inputs():

    _w = lambda a: (lambda t: t.to(torch.bfloat16) if t.is_floating_point() else t)(torch.as_tensor(a))

    def _A_setup():
        B, S, Dm = (1, 2048, 576)
        H, Dh = (32, 128)
        M, seg = (8, 32)
        seg = min(seg, S)
        S = S // seg * seg
        return {'x': _w((lambda *s: torch.randn(*s, dtype=torch.bfloat16) * 0.05)(B, S, Dm)), 'mem0': _w((lambda *s: torch.randn(*s, dtype=torch.bfloat16) * 0.4)(B, M, Dm)), 'Wq': _w((lambda *s: torch.randn(*s, dtype=torch.bfloat16) * 6.4)(Dm, H, Dh) * Dm ** (-0.5)), 'Wk': _w((lambda *s: torch.randn(*s, dtype=torch.bfloat16) * 6.4)(Dm, H, Dh) * Dm ** (-0.5)), 'Wv': _w((lambda *s: torch.randn(*s, dtype=torch.bfloat16) * 0.4)(Dm, H, Dh) * Dm ** (-0.5)), 'Wo': _w((lambda *s: torch.randn(*s, dtype=torch.bfloat16) * 0.4)(H, Dh, Dm) * (H * Dh) ** (-0.5)), 'seg_len': seg}
    _A_in = _A_setup()

    def _B_setup():
        B, S, D, F = (1, 2048, 576, 4608)
        return {'x': _w((lambda *s: torch.randn(*s, dtype=torch.bfloat16) * 0.05)(B, S, D)), 'w1': _w((lambda *s: torch.randn(*s, dtype=torch.bfloat16) * 3.2)(D, F) * D ** (-0.5)), 'b1': _w((lambda *s: torch.randn(*s, dtype=torch.bfloat16) * 3.2)(F) * 0.01), 'w2': _w((lambda *s: torch.randn(*s, dtype=torch.bfloat16) * 0.2)(F, D) * F ** (-0.5)), 'b2': _w((lambda *s: torch.randn(*s, dtype=torch.bfloat16) * 0.4)(D) * 0.01)}
    _B_in = _B_setup()
    return {'A_x': _A_in['x'], 'A_mem0': _A_in['mem0'], 'A_Wq': _A_in['Wq'], 'A_Wk': _A_in['Wk'], 'A_Wv': _A_in['Wv'], 'A_Wo': _A_in['Wo'], 'A_seg_len': _A_in['seg_len'], 'B_x': _B_in['x'], 'B_w1': _B_in['w1'], 'B_b1': _B_in['b1'], 'B_w2': _B_in['w2'], 'B_b2': _B_in['b2'], 'gate_w': _w((lambda *s: torch.randn(*s, dtype=torch.bfloat16) * 0.05)(576) * 16.0)}

def reference(A_x, A_mem0, A_Wq, A_Wk, A_Wv, A_Wo, A_seg_len, B_x, B_w1, B_b1, B_w2, B_b2, gate_w):

    def _A_ref(x, mem0, Wq, Wk, Wv, Wo, seg_len):
        B, S, Dm = x.shape
        H, Dh = (Wq.shape[1], Wq.shape[2])
        M = mem0.shape[1]
        scale = Dh ** (-0.5)
        n_seg = S // seg_len
        L = M + seg_len
        idx = torch.arange(L)
        mask = (idx[:, None] < M) | (idx[:, None] >= idx[None, :])
        mem = mem0
        outs = []
        for s in range(n_seg):
            xs = x[:, s * seg_len:(s + 1) * seg_len, :].clone()
            h = torch.concatenate([mem, xs], axis=1)
            q = torch.einsum('btd,dhe->bhte', h, Wq)
            k = torch.einsum('btd,dhe->bhte', h, Wk)
            v = torch.einsum('btd,dhe->bhte', h, Wv)
            scores = torch.einsum('bhqe,bhke->bhqk', q, k) * scale
            scores = torch.where(mask[None, None], scores, -1000000000.0)
            p = _softmax(scores, axis=-1)
            o = torch.einsum('bhqk,bhke->bhqe', p, v)
            o = torch.einsum('bhte,hed->btd', o, Wo)
            mem = o[:, :M, :].clone()
            outs.append(o[:, M:, :])
        return torch.concatenate(outs, axis=1)

    def _B_ref(x, w1, b1, w2, b2):
        h = torch.einsum('bsd,df->bsf', x, w1) + b1
        h = _gelu(h)
        return torch.einsum('bsf,fd->bsd', h, w2) + b2
    x = A_x
    g = _sigmoid((x * gate_w).sum(-1, keepdims=True))
    a = _A_ref(x, A_mem0, A_Wq, A_Wk, A_Wv, A_Wo, A_seg_len)
    b = _B_ref(x, B_w1, B_b1, B_w2, B_b2)
    return g * a + (1 - g) * b
```

```asm
; @launch grid=(256,1,1) block=(256,1,1) lds=163840
.amdgcn_target "amdgcn-amd-amdhsa--gfx950"
.text
.globl gated_mix__memory_aug_recurrent_mem_tr__dense_activation_gelu__prompt_kernel
.p2align 8
.type gated_mix__memory_aug_recurrent_mem_tr__dense_activation_gelu__prompt_kernel,@function
gated_mix__memory_aug_recurrent_mem_tr__dense_activation_gelu__prompt_kernel:
    s_cmp_ge_u32 s2, 256
    s_cbranch_scc1 Lexit
    s_load_dwordx16 s[64:79], s[0:1], 0
    s_getpc_b64 s[30:31]
Lpc:
    s_bfe_u32 s33, s2, 0x30003
    s_mul_i32 s33, s33, 12288
    s_sub_u32 s33, s33, 4096
    v_lshl_add_u32 v4, v0, 6, s33
    s_mov_b32 s32, Lcode_end-Lpc-4
    v_min_u32 v4, s32, v4
    v_cmp_lt_u32 vcc, 63, v0
    s_and_saveexec_b64 s[34:35], vcc
    s_cbranch_execz Lnopf
    global_load_dword v243, v4, s[30:31]
Lnopf:
    s_mov_b64 exec, s[34:35]
    s_load_dwordx4 s[20:23], s[0:1], 112
    s_waitcnt lgkmcnt(0)
    s_mov_b32 s4, s22
    s_mov_b32 s5, s23
    s_mov_b32 s6, 268435456
    s_mov_b32 s7, 0x00020000
    s_mov_b32 s22, 256
    s_mov_b32 s23, 0x00020000
    s_getreg_b32 s80, hwreg(HW_REG_XCC_ID)
    s_and_b32 s80, s80, 7
    s_getreg_b32 s27, hwreg(HW_REG_XCC_ID)
    s_and_b32 s27, s27, 15
    s_cmp_lg_u32 s27, 0
    s_cselect_b32 s27, 0x10000, 0
    s_mov_b32 s81, 0
    v_mov_b32 v2, 0
Lclaim:
    s_lshl_b32 s31, s80, 2
    s_cmp_eq_u32 s80, 0
    s_cselect_b32 s31, 128, s31
    v_mov_b32 v1, 1
    v_cmp_eq_u32 vcc, 0, v0
    s_and_saveexec_b64 s[32:33], vcc
    s_cbranch_execz Lnoticket
    buffer_atomic_add v1, v2, s[20:23], s31 offen sc0
    s_waitcnt vmcnt(0)
    ds_write_b32 v2, v1
    s_waitcnt lgkmcnt(0)
Lnoticket:
    s_mov_b64 exec, s[32:33]
    s_barrier
    ds_read_b32 v1, v2
    s_waitcnt lgkmcnt(0)
    v_readfirstlane_b32 s28, v1
    s_barrier
    s_cmp_lt_u32 s28, 32
    s_cbranch_scc1 Lclaimed
    s_add_u32 s80, s80, 1
    s_and_b32 s80, s80, 7
    s_add_u32 s81, s81, 1
    s_cmp_lt_u32 s81, 8
    s_cbranch_scc1 Lclaim
    s_branch Lexit
Lclaimed:
    s_cmp_eq_u32 s80, 0
    s_cbranch_scc1 Lchain
    s_sub_u32 s80, s80, 1
    s_mov_b32 s81, s28
    s_lshl_b32 s82, s80, 5
    s_add_u32 s82, s82, s81
    s_mul_i32 s31, s82, 293
    s_lshr_b32 s31, s31, 11
    s_mul_i32 s32, s31, 7
    s_sub_u32 s32, s82, s32
    s_lshl_b32 s33, s31, 3
    s_add_u32 s48, s33, s32
    s_add_u32 s48, s48, 1
    s_sub_u32 s32, s32, 3
    s_lshl_b32 s86, s31, 1
    s_and_b32 s33, s32, 1
    s_add_u32 s86, s86, s33
    s_lshr_b32 s33, s32, 1
    s_lshl_b32 s33, s33, 6
    s_add_u32 s86, s86, s33
    s_cmp_lt_i32 s32, 0
    s_cselect_b32 s86, 9999, s86
    s_mul_i32 s33, s31, 3
    s_add_u32 s33, s33, s32
    s_add_u32 s33, s33, 3
    s_lshl_b32 s34, s31, 2
    s_add_u32 s34, s34, s32
    s_add_u32 s83, s34, 480
    s_add_u32 s35, s34, 208
    s_cmp_ge_u32 s34, 48
    s_cselect_b32 s83, s35, s83
    s_add_u32 s35, s33, 384
    s_lshr_b32 s84, s33, 1
    s_add_u32 s84, s84, 336
    s_bitcmp1_b32 s33, 0
    s_cselect_b32 s84, 9999, s84
    s_cmp_lt_i32 s32, 0
    s_cselect_b32 s83, s35, s83
    s_cselect_b32 s84, s84, 9999
    s_mul_i32 s31, s80, 30
    s_mul_i32 s32, s80, 24
    s_add_u32 s32, s32, 24
    s_cmp_lt_u32 s80, 4
    s_cselect_b32 s31, s31, s32
    s_cselect_b32 s32, 30, 24
    s_sub_u32 s33, 31, s81
    s_add_u32 s85, s31, s33
    s_cmp_lt_u32 s33, s32
    s_cselect_b32 s85, s85, 9999
    s_cmp_lt_u32 s86, 128
    s_cbranch_scc1 Lw_t0
    s_load_dwordx8 s[36:43], s[0:1], 16
    v_lshlrev_b32 v1, 4, v0
    s_sub_u32 s31, s83, 384
    s_mul_i32 s31, s31, 49152
    s_mov_b32 s10, 4718592
    s_mov_b32 s11, 0x00020000
    s_waitcnt lgkmcnt(0)
    s_mov_b32 s8, s42
    s_mov_b32 s9, s43
    s_add_u32 s32, s31, 0
    buffer_load_dwordx4 v[244:247], v1, s[8:11], s32 offen
    s_add_u32 s32, s31, 4096
    buffer_load_dwordx4 v[244:247], v1, s[8:11], s32 offen
    s_add_u32 s32, s31, 8192
    buffer_load_dwordx4 v[244:247], v1, s[8:11], s32 offen
    s_add_u32 s32, s31, 12288
    buffer_load_dwordx4 v[244:247], v1, s[8:11], s32 offen
    s_add_u32 s32, s31, 16384
    buffer_load_dwordx4 v[244:247], v1, s[8:11], s32 offen
    s_add_u32 s32, s31, 20480
    buffer_load_dwordx4 v[244:247], v1, s[8:11], s32 offen
    s_add_u32 s32, s31, 24576
    buffer_load_dwordx4 v[244:247], v1, s[8:11], s32 offen
    s_add_u32 s32, s31, 28672
    buffer_load_dwordx4 v[244:247], v1, s[8:11], s32 offen
    s_add_u32 s32, s31, 32768
    buffer_load_dwordx4 v[244:247], v1, s[8:11], s32 offen
    s_add_u32 s32, s31, 36864
    buffer_load_dwordx4 v[244:247], v1, s[8:11], s32 offen
    s_add_u32 s32, s31, 40960
    buffer_load_dwordx4 v[244:247], v1, s[8:11], s32 offen
    s_add_u32 s32, s31, 45056
    buffer_load_dwordx4 v[244:247], v1, s[8:11], s32 offen
    s_mov_b32 s8, s36
    s_mov_b32 s9, s37
    s_add_u32 s32, s31, 0
    buffer_load_dwordx4 v[244:247], v1, s[8:11], s32 offen
    s_add_u32 s32, s31, 4096
    buffer_load_dwordx4 v[244:247], v1, s[8:11], s32 offen
    s_add_u32 s32, s31, 8192
    buffer_load_dwordx4 v[244:247], v1, s[8:11], s32 offen
    s_add_u32 s32, s31, 12288
    buffer_load_dwordx4 v[244:247], v1, s[8:11], s32 offen
    s_add_u32 s32, s31, 16384
    buffer_load_dwordx4 v[244:247], v1, s[8:11], s32 offen
    s_add_u32 s32, s31, 20480
    buffer_load_dwordx4 v[244:247], v1, s[8:11], s32 offen
    s_add_u32 s32, s31, 24576
    buffer_load_dwordx4 v[244:247], v1, s[8:11], s32 offen
    s_add_u32 s32, s31, 28672
    buffer_load_dwordx4 v[244:247], v1, s[8:11], s32 offen
    s_add_u32 s32, s31, 32768
    buffer_load_dwordx4 v[244:247], v1, s[8:11], s32 offen
    s_add_u32 s32, s31, 36864
    buffer_load_dwordx4 v[244:247], v1, s[8:11], s32 offen
    s_add_u32 s32, s31, 40960
    buffer_load_dwordx4 v[244:247], v1, s[8:11], s32 offen
    s_add_u32 s32, s31, 45056
    buffer_load_dwordx4 v[244:247], v1, s[8:11], s32 offen
Lw_t0:
    s_cmp_ge_u32 s86, 128
    s_cbranch_scc1 Lw_g1
    s_load_dwordx2 s[8:9], s[0:1], 0
    s_load_dwordx4 s[36:39], s[0:1], 24
    v_lshrrev_b32 v1, 6, v0
    s_nop 0
    v_readfirstlane_b32 s29, v1
    v_and_b32 v1, 63, v0
    s_and_b32 s30, s86, 31
    s_bfe_u32 s31, s86, 0x10005
    s_lshr_b32 s32, s86, 6
    s_lshl_b32 s32, s32, 2
    s_add_u32 s32, s32, s29
    s_waitcnt lgkmcnt(0)
    s_cmp_eq_u32 s31, 0
    s_cselect_b32 s12, s36, s38
    s_cselect_b32 s13, s37, s39
    s_mov_b32 s14, 4718592
    s_mov_b32 s15, 0x00020000
    s_mov_b32 s10, 2359296
    s_mov_b32 s11, 0x00020000
    v_lshrrev_b32 v2, 4, v1
    s_and_b32 s33, s29, 1
    s_lshl_b32 s34, s33, 2
    v_or_b32 v3, s34, v2
    v_lshlrev_b32 v3, 1, v3
    v_and_b32 v4, 15, v1
    v_xor_b32 v3, v3, v4
    v_lshlrev_b32 v3, 4, v3
    v_lshl_add_u32 v3, v2, 13, v3
    s_lshl_b32 s33, s33, 1
    s_lshr_b32 s34, s29, 1
    s_add_u32 s33, s33, s34
    s_lshl_b32 s34, s33, 10
    s_lshl_b32 s33, s33, 15
    s_lshl_b32 s35, s30, 8
    s_add_u32 s33, s33, s35
    v_mul_u32_u24 v5, 1152, v4
    v_lshl_add_u32 v5, v2, 4, v5
    s_mul_i32 s35, s32, 36864
    s_add_u32 s40, s35, 18432
    s_add_u32 m0, s34, 0
    s_add_u32 s41, s33, 0
    buffer_load_dwordx4 v3, s[12:15], s41 offen lds
    s_add_u32 m0, s34, 4096
    s_add_u32 s41, s33, 131072
    buffer_load_dwordx4 v3, s[12:15], s41 offen lds
    s_add_u32 m0, s34, 8192
    s_add_u32 s41, s33, 262144
    buffer_load_dwordx4 v3, s[12:15], s41 offen lds
    s_add_u32 m0, s34, 12288
    s_add_u32 s41, s33, 393216
    buffer_load_dwordx4 v3, s[12:15], s41 offen lds
    s_add_u32 m0, s34, 16384
    s_add_u32 s41, s33, 524288
    buffer_load_dwordx4 v3, s[12:15], s41 offen lds
    s_add_u32 m0, s34, 20480
    s_add_u32 s41, s33, 655360
    buffer_load_dwordx4 v3, s[12:15], s41 offen lds
    s_add_u32 m0, s34, 24576
    s_add_u32 s41, s33, 786432
    buffer_load_dwordx4 v3, s[12:15], s41 offen lds
    s_add_u32 m0, s34, 28672
    s_add_u32 s41, s33, 917504
    buffer_load_dwordx4 v3, s[12:15], s41 offen lds
    s_add_u32 m0, s34, 32768
    s_add_u32 s41, s33, 1048576
    buffer_load_dwordx4 v3, s[12:15], s41 offen lds
    s_add_u32 m0, s34, 36864
    s_add_u32 s41, s33, 1179648
    buffer_load_dwordx4 v3, s[12:15], s41 offen lds
    s_add_u32 m0, s34, 40960
    s_add_u32 s41, s33, 1310720
    buffer_load_dwordx4 v3, s[12:15], s41 offen lds
    s_add_u32 m0, s34, 45056
    s_add_u32 s41, s33, 1441792
    buffer_load_dwordx4 v3, s[12:15], s41 offen lds
    buffer_load_dwordx4 v[64:67], v5, s[8:11], s35 offen offset:0
    buffer_load_dwordx4 v[68:71], v5, s[8:11], s40 offen offset:0
    buffer_load_dwordx4 v[72:75], v5, s[8:11], s35 offen offset:64
    buffer_load_dwordx4 v[76:79], v5, s[8:11], s40 offen offset:64
    buffer_load_dwordx4 v[80:83], v5, s[8:11], s35 offen offset:128
    buffer_load_dwordx4 v[84:87], v5, s[8:11], s40 offen offset:128
    buffer_load_dwordx4 v[88:91], v5, s[8:11], s35 offen offset:192
    buffer_load_dwordx4 v[92:95], v5, s[8:11], s40 offen offset:192
    buffer_load_dwordx4 v[96:99], v5, s[8:11], s35 offen offset:256
    buffer_load_dwordx4 v[100:103], v5, s[8:11], s40 offen offset:256
    buffer_load_dwordx4 v[104:107], v5, s[8:11], s35 offen offset:320
    buffer_load_dwordx4 v[108:111], v5, s[8:11], s40 offen offset:320
    buffer_load_dwordx4 v[112:115], v5, s[8:11], s35 offen offset:384
    buffer_load_dwordx4 v[116:119], v5, s[8:11], s40 offen offset:384
    buffer_load_dwordx4 v[120:123], v5, s[8:11], s35 offen offset:448
    buffer_load_dwordx4 v[124:127], v5, s[8:11], s40 offen offset:448
    buffer_load_dwordx4 v[128:131], v5, s[8:11], s35 offen offset:512
    buffer_load_dwordx4 v[132:135], v5, s[8:11], s40 offen offset:512
    s_add_u32 m0, s34, 49152
    s_add_u32 s41, s33, 1572864
    buffer_load_dwordx4 v3, s[12:15], s41 offen lds
    s_add_u32 m0, s34, 53248
    s_add_u32 s41, s33, 1703936
    buffer_load_dwordx4 v3, s[12:15], s41 offen lds
    s_add_u32 m0, s34, 57344
    s_add_u32 s41, s33, 1835008
    buffer_load_dwordx4 v3, s[12:15], s41 offen lds
    s_add_u32 m0, s34, 61440
    s_add_u32 s41, s33, 1966080
    buffer_load_dwordx4 v3, s[12:15], s41 offen lds
    s_add_u32 m0, s34, 65536
    s_add_u32 s41, s33, 2097152
    buffer_load_dwordx4 v3, s[12:15], s41 offen lds
    s_add_u32 m0, s34, 69632
    s_add_u32 s41, s33, 2228224
    buffer_load_dwordx4 v3, s[12:15], s41 offen lds
    s_add_u32 m0, s34, 73728
    s_add_u32 s41, s33, 2359296
    buffer_load_dwordx4 v3, s[12:15], s41 offen lds
    s_add_u32 m0, s34, 77824
    s_add_u32 s41, s33, 2490368
    buffer_load_dwordx4 v3, s[12:15], s41 offen lds
    s_add_u32 m0, s34, 81920
    s_add_u32 s41, s33, 2621440
    buffer_load_dwordx4 v3, s[12:15], s41 offen lds
    s_add_u32 m0, s34, 86016
    s_add_u32 s41, s33, 2752512
    buffer_load_dwordx4 v3, s[12:15], s41 offen lds
    s_add_u32 m0, s34, 90112
    s_add_u32 s41, s33, 2883584
    buffer_load_dwordx4 v3, s[12:15], s41 offen lds
    s_add_u32 m0, s34, 94208
    s_add_u32 s41, s33, 3014656
    buffer_load_dwordx4 v3, s[12:15], s41 offen lds
    buffer_load_dwordx4 v[136:139], v5, s[8:11], s35 offen offset:576
    buffer_load_dwordx4 v[140:143], v5, s[8:11], s40 offen offset:576
    buffer_load_dwordx4 v[144:147], v5, s[8:11], s35 offen offset:640
    buffer_load_dwordx4 v[148:151], v5, s[8:11], s40 offen offset:640
    buffer_load_dwordx4 v[152:155], v5, s[8:11], s35 offen offset:704
    buffer_load_dwordx4 v[156:159], v5, s[8:11], s40 offen offset:704
    buffer_load_dwordx4 v[160:163], v5, s[8:11], s35 offen offset:768
    buffer_load_dwordx4 v[164:167], v5, s[8:11], s40 offen offset:768
    buffer_load_dwordx4 v[168:171], v5, s[8:11], s35 offen offset:832
    buffer_load_dwordx4 v[172:175], v5, s[8:11], s40 offen offset:832
    buffer_load_dwordx4 v[176:179], v5, s[8:11], s35 offen offset:896
    buffer_load_dwordx4 v[180:183], v5, s[8:11], s40 offen offset:896
    buffer_load_dwordx4 v[184:187], v5, s[8:11], s35 offen offset:960
    buffer_load_dwordx4 v[188:191], v5, s[8:11], s40 offen offset:960
    buffer_load_dwordx4 v[192:195], v5, s[8:11], s35 offen offset:1024
    buffer_load_dwordx4 v[196:199], v5, s[8:11], s40 offen offset:1024
    buffer_load_dwordx4 v[200:203], v5, s[8:11], s35 offen offset:1088
    buffer_load_dwordx4 v[204:207], v5, s[8:11], s40 offen offset:1088
    s_add_u32 m0, s34, 98304
    s_add_u32 s41, s33, 3145728
    buffer_load_dwordx4 v3, s[12:15], s41 offen lds
    s_add_u32 m0, s34, 102400
    s_add_u32 s41, s33, 3276800
    buffer_load_dwordx4 v3, s[12:15], s41 offen lds
    s_add_u32 m0, s34, 106496
    s_add_u32 s41, s33, 3407872
    buffer_load_dwordx4 v3, s[12:15], s41 offen lds
    s_add_u32 m0, s34, 110592
    s_add_u32 s41, s33, 3538944
    buffer_load_dwordx4 v3, s[12:15], s41 offen lds
    s_add_u32 m0, s34, 114688
    s_add_u32 s41, s33, 3670016
    buffer_load_dwordx4 v3, s[12:15], s41 offen lds
    s_add_u32 m0, s34, 118784
    s_add_u32 s41, s33, 3801088
    buffer_load_dwordx4 v3, s[12:15], s41 offen lds
    s_add_u32 m0, s34, 122880
    s_add_u32 s41, s33, 3932160
    buffer_load_dwordx4 v3, s[12:15], s41 offen lds
    s_add_u32 m0, s34, 126976
    s_add_u32 s41, s33, 4063232
    buffer_load_dwordx4 v3, s[12:15], s41 offen lds
    s_add_u32 m0, s34, 131072
    s_add_u32 s41, s33, 4194304
    buffer_load_dwordx4 v3, s[12:15], s41 offen lds
    s_add_u32 m0, s34, 135168
    s_add_u32 s41, s33, 4325376
    buffer_load_dwordx4 v3, s[12:15], s41 offen lds
    s_add_u32 m0, s34, 139264
    s_add_u32 s41, s33, 4456448
    buffer_load_dwordx4 v3, s[12:15], s41 offen lds
    s_add_u32 m0, s34, 143360
    s_add_u32 s41, s33, 4587520
    buffer_load_dwordx4 v3, s[12:15], s41 offen lds
    v_bfe_u32 v6, v1, 2, 2
    v_and_b32 v7, 1, v2
    v_lshl_add_u32 v7, v7, 2, v6
    v_lshl_add_u32 v6, v2, 3, v6
    v_lshlrev_b32 v6, 8, v6
    v_and_b32 v8, 3, v1
    v_lshrrev_b32 v9, 1, v8
    v_and_b32 v10, 1, v8
    v_lshlrev_b32 v10, 4, v10
    s_cmp_eq_u32 s31, 1
    s_cselect_b64 vcc, -1, 0
    v_xor_b32 v11, 0, v7
    v_lshl_add_u32 v11, v11, 5, v6
    v_lshl_add_u32 v11, v8, 3, v11
    v_add_u32 v12, 0, v9
    v_xor_b32 v12, v12, v7
    v_lshl_add_u32 v12, v12, 5, v6
    v_add3_u32 v12, v12, v10, 0
    v_cndmask_b32 v16, v12, v11, vcc
    v_xor_b32 v11, 1, v7
    v_lshl_add_u32 v11, v11, 5, v6
    v_lshl_add_u32 v11, v8, 3, v11
    v_add_u32 v12, 0, v9
    v_xor_b32 v12, v12, v7
    v_lshl_add_u32 v12, v12, 5, v6
    v_add3_u32 v12, v12, v10, 8
    v_cndmask_b32 v17, v12, v11, vcc
    v_xor_b32 v11, 2, v7
    v_lshl_add_u32 v11, v11, 5, v6
    v_lshl_add_u32 v11, v8, 3, v11
    v_add_u32 v12, 2, v9
    v_xor_b32 v12, v12, v7
    v_lshl_add_u32 v12, v12, 5, v6
    v_add3_u32 v12, v12, v10, 0
    v_cndmask_b32 v18, v12, v11, vcc
    v_xor_b32 v11, 3, v7
    v_lshl_add_u32 v11, v11, 5, v6
    v_lshl_add_u32 v11, v8, 3, v11
    v_add_u32 v12, 2, v9
    v_xor_b32 v12, v12, v7
    v_lshl_add_u32 v12, v12, 5, v6
    v_add3_u32 v12, v12, v10, 8
    v_cndmask_b32 v19, v12, v11, vcc
    v_xor_b32 v11, 4, v7
    v_lshl_add_u32 v11, v11, 5, v6
    v_lshl_add_u32 v11, v8, 3, v11
    v_add_u32 v12, 4, v9
    v_xor_b32 v12, v12, v7
    v_lshl_add_u32 v12, v12, 5, v6
    v_add3_u32 v12, v12, v10, 0
    v_cndmask_b32 v20, v12, v11, vcc
    v_xor_b32 v11, 5, v7
    v_lshl_add_u32 v11, v11, 5, v6
    v_lshl_add_u32 v11, v8, 3, v11
    v_add_u32 v12, 4, v9
    v_xor_b32 v12, v12, v7
    v_lshl_add_u32 v12, v12, 5, v6
    v_add3_u32 v12, v12, v10, 8
    v_cndmask_b32 v21, v12, v11, vcc
    v_xor_b32 v11, 6, v7
    v_lshl_add_u32 v11, v11, 5, v6
    v_lshl_add_u32 v11, v8, 3, v11
    v_add_u32 v12, 6, v9
    v_xor_b32 v12, v12, v7
    v_lshl_add_u32 v12, v12, 5, v6
    v_add3_u32 v12, v12, v10, 0
    v_cndmask_b32 v22, v12, v11, vcc
    v_xor_b32 v11, 7, v7
    v_lshl_add_u32 v11, v11, 5, v6
    v_lshl_add_u32 v11, v8, 3, v11
    v_add_u32 v12, 6, v9
    v_xor_b32 v12, v12, v7
    v_lshl_add_u32 v12, v12, 5, v6
    v_add3_u32 v12, v12, v10, 8
    v_cndmask_b32 v23, v12, v11, vcc
    v_lshlrev_b32 v1, 4, v1
    s_cbranch_scc1 Lt0V_1
    s_waitcnt vmcnt(42)
    s_barrier
    ds_read_b64_tr_b16 v[208:209], v16 offset:0
    ds_read_b64_tr_b16 v[210:211], v16 offset:1024
    ds_read_b64_tr_b16 v[212:213], v17 offset:0
    ds_read_b64_tr_b16 v[214:215], v17 offset:1024
    ds_read_b64_tr_b16 v[216:217], v18 offset:0
    ds_read_b64_tr_b16 v[218:219], v18 offset:1024
    ds_read_b64_tr_b16 v[220:221], v19 offset:0
    ds_read_b64_tr_b16 v[222:223], v19 offset:1024
    ds_read_b64_tr_b16 v[224:225], v20 offset:0
    ds_read_b64_tr_b16 v[226:227], v20 offset:1024
    ds_read_b64_tr_b16 v[228:229], v21 offset:0
    ds_read_b64_tr_b16 v[230:231], v21 offset:1024
    ds_read_b64_tr_b16 v[232:233], v22 offset:0
    ds_read_b64_tr_b16 v[234:235], v22 offset:1024
    ds_read_b64_tr_b16 v[236:237], v23 offset:0
    ds_read_b64_tr_b16 v[238:239], v23 offset:1024
    s_waitcnt lgkmcnt(0)
    ds_read_b64_tr_b16 v[24:25], v16 offset:8192
    ds_read_b64_tr_b16 v[26:27], v16 offset:9216
    ds_read_b64_tr_b16 v[28:29], v17 offset:8192
    ds_read_b64_tr_b16 v[30:31], v17 offset:9216
    ds_read_b64_tr_b16 v[32:33], v18 offset:8192
    ds_read_b64_tr_b16 v[34:35], v18 offset:9216
    ds_read_b64_tr_b16 v[36:37], v19 offset:8192
    ds_read_b64_tr_b16 v[38:39], v19 offset:9216
    ds_read_b64_tr_b16 v[40:41], v20 offset:8192
    ds_read_b64_tr_b16 v[42:43], v20 offset:9216
    ds_read_b64_tr_b16 v[44:45], v21 offset:8192
    ds_read_b64_tr_b16 v[46:47], v21 offset:9216
    ds_read_b64_tr_b16 v[48:49], v22 offset:8192
    ds_read_b64_tr_b16 v[50:51], v22 offset:9216
    ds_read_b64_tr_b16 v[52:53], v23 offset:8192
    ds_read_b64_tr_b16 v[54:55], v23 offset:9216
    v_mfma_f32_16x16x32_bf16 a[0:3], v[208:211], v[64:67], 0
    v_mfma_f32_16x16x32_bf16 a[4:7], v[212:215], v[64:67], 0
    v_mfma_f32_16x16x32_bf16 a[8:11], v[216:219], v[64:67], 0
    v_mfma_f32_16x16x32_bf16 a[12:15], v[220:223], v[64:67], 0
    v_mfma_f32_16x16x32_bf16 a[16:19], v[224:227], v[64:67], 0
    v_mfma_f32_16x16x32_bf16 a[20:23], v[228:231], v[64:67], 0
    v_mfma_f32_16x16x32_bf16 a[24:27], v[232:235], v[64:67], 0
    v_mfma_f32_16x16x32_bf16 a[28:31], v[236:239], v[64:67], 0
    v_mfma_f32_16x16x32_bf16 a[32:35], v[208:211], v[68:71], 0
    v_mfma_f32_16x16x32_bf16 a[36:39], v[212:215], v[68:71], 0
    v_mfma_f32_16x16x32_bf16 a[40:43], v[216:219], v[68:71], 0
    v_mfma_f32_16x16x32_bf16 a[44:47], v[220:223], v[68:71], 0
    v_mfma_f32_16x16x32_bf16 a[48:51], v[224:227], v[68:71], 0
    v_mfma_f32_16x16x32_bf16 a[52:55], v[228:231], v[68:71], 0
    v_mfma_f32_16x16x32_bf16 a[56:59], v[232:235], v[68:71], 0
    v_mfma_f32_16x16x32_bf16 a[60:63], v[236:239], v[68:71], 0
    s_waitcnt lgkmcnt(0)
    ds_read_b64_tr_b16 v[208:209], v16 offset:16384
    ds_read_b64_tr_b16 v[210:211], v16 offset:17408
    ds_read_b64_tr_b16 v[212:213], v17 offset:16384
    ds_read_b64_tr_b16 v[214:215], v17 offset:17408
    ds_read_b64_tr_b16 v[216:217], v18 offset:16384
    ds_read_b64_tr_b16 v[218:219], v18 offset:17408
    ds_read_b64_tr_b16 v[220:221], v19 offset:16384
    ds_read_b64_tr_b16 v[222:223], v19 offset:17408
    ds_read_b64_tr_b16 v[224:225], v20 offset:16384
    ds_read_b64_tr_b16 v[226:227], v20 offset:17408
    ds_read_b64_tr_b16 v[228:229], v21 offset:16384
    ds_read_b64_tr_b16 v[230:231], v21 offset:17408
    ds_read_b64_tr_b16 v[232:233], v22 offset:16384
    ds_read_b64_tr_b16 v[234:235], v22 offset:17408
    ds_read_b64_tr_b16 v[236:237], v23 offset:16384
    ds_read_b64_tr_b16 v[238:239], v23 offset:17408
    v_mfma_f32_16x16x32_bf16 a[0:3], v[24:27], v[72:75], a[0:3]
    v_mfma_f32_16x16x32_bf16 a[4:7], v[28:31], v[72:75], a[4:7]
    v_mfma_f32_16x16x32_bf16 a[8:11], v[32:35], v[72:75], a[8:11]
    v_mfma_f32_16x16x32_bf16 a[12:15], v[36:39], v[72:75], a[12:15]
    v_mfma_f32_16x16x32_bf16 a[16:19], v[40:43], v[72:75], a[16:19]
    v_mfma_f32_16x16x32_bf16 a[20:23], v[44:47], v[72:75], a[20:23]
    v_mfma_f32_16x16x32_bf16 a[24:27], v[48:51], v[72:75], a[24:27]
    v_mfma_f32_16x16x32_bf16 a[28:31], v[52:55], v[72:75], a[28:31]
    v_mfma_f32_16x16x32_bf16 a[32:35], v[24:27], v[76:79], a[32:35]
    v_mfma_f32_16x16x32_bf16 a[36:39], v[28:31], v[76:79], a[36:39]
    v_mfma_f32_16x16x32_bf16 a[40:43], v[32:35], v[76:79], a[40:43]
    v_mfma_f32_16x16x32_bf16 a[44:47], v[36:39], v[76:79], a[44:47]
    v_mfma_f32_16x16x32_bf16 a[48:51], v[40:43], v[76:79], a[48:51]
    v_mfma_f32_16x16x32_bf16 a[52:55], v[44:47], v[76:79], a[52:55]
    v_mfma_f32_16x16x32_bf16 a[56:59], v[48:51], v[76:79], a[56:59]
    v_mfma_f32_16x16x32_bf16 a[60:63], v[52:55], v[76:79], a[60:63]
    s_waitcnt lgkmcnt(0)
    ds_read_b64_tr_b16 v[24:25], v16 offset:24576
    ds_read_b64_tr_b16 v[26:27], v16 offset:25600
    ds_read_b64_tr_b16 v[28:29], v17 offset:24576
    ds_read_b64_tr_b16 v[30:31], v17 offset:25600
    ds_read_b64_tr_b16 v[32:33], v18 offset:24576
    ds_read_b64_tr_b16 v[34:35], v18 offset:25600
    ds_read_b64_tr_b16 v[36:37], v19 offset:24576
    ds_read_b64_tr_b16 v[38:39], v19 offset:25600
    ds_read_b64_tr_b16 v[40:41], v20 offset:24576
    ds_read_b64_tr_b16 v[42:43], v20 offset:25600
    ds_read_b64_tr_b16 v[44:45], v21 offset:24576
    ds_read_b64_tr_b16 v[46:47], v21 offset:25600
    ds_read_b64_tr_b16 v[48:49], v22 offset:24576
    ds_read_b64_tr_b16 v[50:51], v22 offset:25600
    ds_read_b64_tr_b16 v[52:53], v23 offset:24576
    ds_read_b64_tr_b16 v[54:55], v23 offset:25600
    v_mfma_f32_16x16x32_bf16 a[0:3], v[208:211], v[80:83], a[0:3]
    v_mfma_f32_16x16x32_bf16 a[4:7], v[212:215], v[80:83], a[4:7]
    v_mfma_f32_16x16x32_bf16 a[8:11], v[216:219], v[80:83], a[8:11]
    v_mfma_f32_16x16x32_bf16 a[12:15], v[220:223], v[80:83], a[12:15]
    v_mfma_f32_16x16x32_bf16 a[16:19], v[224:227], v[80:83], a[16:19]
    v_mfma_f32_16x16x32_bf16 a[20:23], v[228:231], v[80:83], a[20:23]
    v_mfma_f32_16x16x32_bf16 a[24:27], v[232:235], v[80:83], a[24:27]
    v_mfma_f32_16x16x32_bf16 a[28:31], v[236:239], v[80:83], a[28:31]
    v_mfma_f32_16x16x32_bf16 a[32:35], v[208:211], v[84:87], a[32:35]
    v_mfma_f32_16x16x32_bf16 a[36:39], v[212:215], v[84:87], a[36:39]
    v_mfma_f32_16x16x32_bf16 a[40:43], v[216:219], v[84:87], a[40:43]
    v_mfma_f32_16x16x32_bf16 a[44:47], v[220:223], v[84:87], a[44:47]
    v_mfma_f32_16x16x32_bf16 a[48:51], v[224:227], v[84:87], a[48:51]
    v_mfma_f32_16x16x32_bf16 a[52:55], v[228:231], v[84:87], a[52:55]
    v_mfma_f32_16x16x32_bf16 a[56:59], v[232:235], v[84:87], a[56:59]
    v_mfma_f32_16x16x32_bf16 a[60:63], v[236:239], v[84:87], a[60:63]
    s_waitcnt lgkmcnt(0)
    ds_read_b64_tr_b16 v[208:209], v16 offset:32768
    ds_read_b64_tr_b16 v[210:211], v16 offset:33792
    ds_read_b64_tr_b16 v[212:213], v17 offset:32768
    ds_read_b64_tr_b16 v[214:215], v17 offset:33792
    ds_read_b64_tr_b16 v[216:217], v18 offset:32768
    ds_read_b64_tr_b16 v[218:219], v18 offset:33792
    ds_read_b64_tr_b16 v[220:221], v19 offset:32768
    ds_read_b64_tr_b16 v[222:223], v19 offset:33792
    ds_read_b64_tr_b16 v[224:225], v20 offset:32768
    ds_read_b64_tr_b16 v[226:227], v20 offset:33792
    ds_read_b64_tr_b16 v[228:229], v21 offset:32768
    ds_read_b64_tr_b16 v[230:231], v21 offset:33792
    ds_read_b64_tr_b16 v[232:233], v22 offset:32768
    ds_read_b64_tr_b16 v[234:235], v22 offset:33792
    ds_read_b64_tr_b16 v[236:237], v23 offset:32768
    ds_read_b64_tr_b16 v[238:239], v23 offset:33792
    v_mfma_f32_16x16x32_bf16 a[0:3], v[24:27], v[88:91], a[0:3]
    v_mfma_f32_16x16x32_bf16 a[4:7], v[28:31], v[88:91], a[4:7]
    v_mfma_f32_16x16x32_bf16 a[8:11], v[32:35], v[88:91], a[8:11]
    v_mfma_f32_16x16x32_bf16 a[12:15], v[36:39], v[88:91], a[12:15]
    v_mfma_f32_16x16x32_bf16 a[16:19], v[40:43], v[88:91], a[16:19]
    v_mfma_f32_16x16x32_bf16 a[20:23], v[44:47], v[88:91], a[20:23]
    v_mfma_f32_16x16x32_bf16 a[24:27], v[48:51], v[88:91], a[24:27]
    v_mfma_f32_16x16x32_bf16 a[28:31], v[52:55], v[88:91], a[28:31]
    v_mfma_f32_16x16x32_bf16 a[32:35], v[24:27], v[92:95], a[32:35]
    v_mfma_f32_16x16x32_bf16 a[36:39], v[28:31], v[92:95], a[36:39]
    v_mfma_f32_16x16x32_bf16 a[40:43], v[32:35], v[92:95], a[40:43]
    v_mfma_f32_16x16x32_bf16 a[44:47], v[36:39], v[92:95], a[44:47]
    v_mfma_f32_16x16x32_bf16 a[48:51], v[40:43], v[92:95], a[48:51]
    v_mfma_f32_16x16x32_bf16 a[52:55], v[44:47], v[92:95], a[52:55]
    v_mfma_f32_16x16x32_bf16 a[56:59], v[48:51], v[92:95], a[56:59]
    v_mfma_f32_16x16x32_bf16 a[60:63], v[52:55], v[92:95], a[60:63]
    s_waitcnt lgkmcnt(0)
    ds_read_b64_tr_b16 v[24:25], v16 offset:40960
    ds_read_b64_tr_b16 v[26:27], v16 offset:41984
    ds_read_b64_tr_b16 v[28:29], v17 offset:40960
    ds_read_b64_tr_b16 v[30:31], v17 offset:41984
    ds_read_b64_tr_b16 v[32:33], v18 offset:40960
    ds_read_b64_tr_b16 v[34:35], v18 offset:41984
    ds_read_b64_tr_b16 v[36:37], v19 offset:40960
    ds_read_b64_tr_b16 v[38:39], v19 offset:41984
    ds_read_b64_tr_b16 v[40:41], v20 offset:40960
    ds_read_b64_tr_b16 v[42:43], v20 offset:41984
    ds_read_b64_tr_b16 v[44:45], v21 offset:40960
    ds_read_b64_tr_b16 v[46:47], v21 offset:41984
    ds_read_b64_tr_b16 v[48:49], v22 offset:40960
    ds_read_b64_tr_b16 v[50:51], v22 offset:41984
    ds_read_b64_tr_b16 v[52:53], v23 offset:40960
    ds_read_b64_tr_b16 v[54:55], v23 offset:41984
    v_mfma_f32_16x16x32_bf16 a[0:3], v[208:211], v[96:99], a[0:3]
    v_mfma_f32_16x16x32_bf16 a[4:7], v[212:215], v[96:99], a[4:7]
    v_mfma_f32_16x16x32_bf16 a[8:11], v[216:219], v[96:99], a[8:11]
    v_mfma_f32_16x16x32_bf16 a[12:15], v[220:223], v[96:99], a[12:15]
    v_mfma_f32_16x16x32_bf16 a[16:19], v[224:227], v[96:99], a[16:19]
    v_mfma_f32_16x16x32_bf16 a[20:23], v[228:231], v[96:99], a[20:23]
    v_mfma_f32_16x16x32_bf16 a[24:27], v[232:235], v[96:99], a[24:27]
    v_mfma_f32_16x16x32_bf16 a[28:31], v[236:239], v[96:99], a[28:31]
    v_mfma_f32_16x16x32_bf16 a[32:35], v[208:211], v[100:103], a[32:35]
    v_mfma_f32_16x16x32_bf16 a[36:39], v[212:215], v[100:103], a[36:39]
    v_mfma_f32_16x16x32_bf16 a[40:43], v[216:219], v[100:103], a[40:43]
    v_mfma_f32_16x16x32_bf16 a[44:47], v[220:223], v[100:103], a[44:47]
    v_mfma_f32_16x16x32_bf16 a[48:51], v[224:227], v[100:103], a[48:51]
    v_mfma_f32_16x16x32_bf16 a[52:55], v[228:231], v[100:103], a[52:55]
    v_mfma_f32_16x16x32_bf16 a[56:59], v[232:235], v[100:103], a[56:59]
    v_mfma_f32_16x16x32_bf16 a[60:63], v[236:239], v[100:103], a[60:63]
    s_waitcnt lgkmcnt(0)
    v_mfma_f32_16x16x32_bf16 a[0:3], v[24:27], v[104:107], a[0:3]
    v_mfma_f32_16x16x32_bf16 a[4:7], v[28:31], v[104:107], a[4:7]
    v_mfma_f32_16x16x32_bf16 a[8:11], v[32:35], v[104:107], a[8:11]
    v_mfma_f32_16x16x32_bf16 a[12:15], v[36:39], v[104:107], a[12:15]
    v_mfma_f32_16x16x32_bf16 a[16:19], v[40:43], v[104:107], a[16:19]
    v_mfma_f32_16x16x32_bf16 a[20:23], v[44:47], v[104:107], a[20:23]
    v_mfma_f32_16x16x32_bf16 a[24:27], v[48:51], v[104:107], a[24:27]
    v_mfma_f32_16x16x32_bf16 a[28:31], v[52:55], v[104:107], a[28:31]
    v_mfma_f32_16x16x32_bf16 a[32:35], v[24:27], v[108:111], a[32:35]
    v_mfma_f32_16x16x32_bf16 a[36:39], v[28:31], v[108:111], a[36:39]
    v_mfma_f32_16x16x32_bf16 a[40:43], v[32:35], v[108:111], a[40:43]
    v_mfma_f32_16x16x32_bf16 a[44:47], v[36:39], v[108:111], a[44:47]
    v_mfma_f32_16x16x32_bf16 a[48:51], v[40:43], v[108:111], a[48:51]
    v_mfma_f32_16x16x32_bf16 a[52:55], v[44:47], v[108:111], a[52:55]
    v_mfma_f32_16x16x32_bf16 a[56:59], v[48:51], v[108:111], a[56:59]
    v_mfma_f32_16x16x32_bf16 a[60:63], v[52:55], v[108:111], a[60:63]
    s_waitcnt vmcnt(12)
    s_barrier
    v_add_u32 v16, 49152, v16
    v_add_u32 v17, 49152, v17
    v_add_u32 v18, 49152, v18
    v_add_u32 v19, 49152, v19
    v_add_u32 v20, 49152, v20
    v_add_u32 v21, 49152, v21
    v_add_u32 v22, 49152, v22
    v_add_u32 v23, 49152, v23
    ds_read_b64_tr_b16 v[208:209], v16 offset:0
    ds_read_b64_tr_b16 v[210:211], v16 offset:1024
    ds_read_b64_tr_b16 v[212:213], v17 offset:0
    ds_read_b64_tr_b16 v[214:215], v17 offset:1024
    ds_read_b64_tr_b16 v[216:217], v18 offset:0
    ds_read_b64_tr_b16 v[218:219], v18 offset:1024
    ds_read_b64_tr_b16 v[220:221], v19 offset:0
    ds_read_b64_tr_b16 v[222:223], v19 offset:1024
    ds_read_b64_tr_b16 v[224:225], v20 offset:0
    ds_read_b64_tr_b16 v[226:227], v20 offset:1024
    ds_read_b64_tr_b16 v[228:229], v21 offset:0
    ds_read_b64_tr_b16 v[230:231], v21 offset:1024
    ds_read_b64_tr_b16 v[232:233], v22 offset:0
    ds_read_b64_tr_b16 v[234:235], v22 offset:1024
    ds_read_b64_tr_b16 v[236:237], v23 offset:0
    ds_read_b64_tr_b16 v[238:239], v23 offset:1024
    s_waitcnt lgkmcnt(0)
    ds_read_b64_tr_b16 v[24:25], v16 offset:8192
    ds_read_b64_tr_b16 v[26:27], v16 offset:9216
    ds_read_b64_tr_b16 v[28:29], v17 offset:8192
    ds_read_b64_tr_b16 v[30:31], v17 offset:9216
    ds_read_b64_tr_b16 v[32:33], v18 offset:8192
    ds_read_b64_tr_b16 v[34:35], v18 offset:9216
    ds_read_b64_tr_b16 v[36:37], v19 offset:8192
    ds_read_b64_tr_b16 v[38:39], v19 offset:9216
    ds_read_b64_tr_b16 v[40:41], v20 offset:8192
    ds_read_b64_tr_b16 v[42:43], v20 offset:9216
    ds_read_b64_tr_b16 v[44:45], v21 offset:8192
    ds_read_b64_tr_b16 v[46:47], v21 offset:9216
    ds_read_b64_tr_b16 v[48:49], v22 offset:8192
    ds_read_b64_tr_b16 v[50:51], v22 offset:9216
    ds_read_b64_tr_b16 v[52:53], v23 offset:8192
    ds_read_b64_tr_b16 v[54:55], v23 offset:9216
    v_mfma_f32_16x16x32_bf16 a[0:3], v[208:211], v[112:115], a[0:3]
    v_mfma_f32_16x16x32_bf16 a[4:7], v[212:215], v[112:115], a[4:7]
    v_mfma_f32_16x16x32_bf16 a[8:11], v[216:219], v[112:115], a[8:11]
    v_mfma_f32_16x16x32_bf16 a[12:15], v[220:223], v[112:115], a[12:15]
    v_mfma_f32_16x16x32_bf16 a[16:19], v[224:227], v[112:115], a[16:19]
    v_mfma_f32_16x16x32_bf16 a[20:23], v[228:231], v[112:115], a[20:23]
    v_mfma_f32_16x16x32_bf16 a[24:27], v[232:235], v[112:115], a[24:27]
    v_mfma_f32_16x16x32_bf16 a[28:31], v[236:239], v[112:115], a[28:31]
    v_mfma_f32_16x16x32_bf16 a[32:35], v[208:211], v[116:119], a[32:35]
    v_mfma_f32_16x16x32_bf16 a[36:39], v[212:215], v[116:119], a[36:39]
    v_mfma_f32_16x16x32_bf16 a[40:43], v[216:219], v[116:119], a[40:43]
    v_mfma_f32_16x16x32_bf16 a[44:47], v[220:223], v[116:119], a[44:47]
    v_mfma_f32_16x16x32_bf16 a[48:51], v[224:227], v[116:119], a[48:51]
    v_mfma_f32_16x16x32_bf16 a[52:55], v[228:231], v[116:119], a[52:55]
    v_mfma_f32_16x16x32_bf16 a[56:59], v[232:235], v[116:119], a[56:59]
    v_mfma_f32_16x16x32_bf16 a[60:63], v[236:239], v[116:119], a[60:63]
    s_waitcnt lgkmcnt(0)
    ds_read_b64_tr_b16 v[208:209], v16 offset:16384
    ds_read_b64_tr_b16 v[210:211], v16 offset:17408
    ds_read_b64_tr_b16 v[212:213], v17 offset:16384
    ds_read_b64_tr_b16 v[214:215], v17 offset:17408
    ds_read_b64_tr_b16 v[216:217], v18 offset:16384
    ds_read_b64_tr_b16 v[218:219], v18 offset:17408
    ds_read_b64_tr_b16 v[220:221], v19 offset:16384
    ds_read_b64_tr_b16 v[222:223], v19 offset:17408
    ds_read_b64_tr_b16 v[224:225], v20 offset:16384
    ds_read_b64_tr_b16 v[226:227], v20 offset:17408
    ds_read_b64_tr_b16 v[228:229], v21 offset:16384
    ds_read_b64_tr_b16 v[230:231], v21 offset:17408
    ds_read_b64_tr_b16 v[232:233], v22 offset:16384
    ds_read_b64_tr_b16 v[234:235], v22 offset:17408
    ds_read_b64_tr_b16 v[236:237], v23 offset:16384
    ds_read_b64_tr_b16 v[238:239], v23 offset:17408
    v_mfma_f32_16x16x32_bf16 a[0:3], v[24:27], v[120:123], a[0:3]
    v_mfma_f32_16x16x32_bf16 a[4:7], v[28:31], v[120:123], a[4:7]
    v_mfma_f32_16x16x32_bf16 a[8:11], v[32:35], v[120:123], a[8:11]
    v_mfma_f32_16x16x32_bf16 a[12:15], v[36:39], v[120:123], a[12:15]
    v_mfma_f32_16x16x32_bf16 a[16:19], v[40:43], v[120:123], a[16:19]
    v_mfma_f32_16x16x32_bf16 a[20:23], v[44:47], v[120:123], a[20:23]
    v_mfma_f32_16x16x32_bf16 a[24:27], v[48:51], v[120:123], a[24:27]
    v_mfma_f32_16x16x32_bf16 a[28:31], v[52:55], v[120:123], a[28:31]
    v_mfma_f32_16x16x32_bf16 a[32:35], v[24:27], v[124:127], a[32:35]
    v_mfma_f32_16x16x32_bf16 a[36:39], v[28:31], v[124:127], a[36:39]
    v_mfma_f32_16x16x32_bf16 a[40:43], v[32:35], v[124:127], a[40:43]
    v_mfma_f32_16x16x32_bf16 a[44:47], v[36:39], v[124:127], a[44:47]
    v_mfma_f32_16x16x32_bf16 a[48:51], v[40:43], v[124:127], a[48:51]
    v_mfma_f32_16x16x32_bf16 a[52:55], v[44:47], v[124:127], a[52:55]
    v_mfma_f32_16x16x32_bf16 a[56:59], v[48:51], v[124:127], a[56:59]
    v_mfma_f32_16x16x32_bf16 a[60:63], v[52:55], v[124:127], a[60:63]
    s_waitcnt lgkmcnt(0)
    ds_read_b64_tr_b16 v[24:25], v16 offset:24576
    ds_read_b64_tr_b16 v[26:27], v16 offset:25600
    ds_read_b64_tr_b16 v[28:29], v17 offset:24576
    ds_read_b64_tr_b16 v[30:31], v17 offset:25600
    ds_read_b64_tr_b16 v[32:33], v18 offset:24576
    ds_read_b64_tr_b16 v[34:35], v18 offset:25600
    ds_read_b64_tr_b16 v[36:37], v19 offset:24576
    ds_read_b64_tr_b16 v[38:39], v19 offset:25600
    ds_read_b64_tr_b16 v[40:41], v20 offset:24576
    ds_read_b64_tr_b16 v[42:43], v20 offset:25600
    ds_read_b64_tr_b16 v[44:45], v21 offset:24576
    ds_read_b64_tr_b16 v[46:47], v21 offset:25600
    ds_read_b64_tr_b16 v[48:49], v22 offset:24576
    ds_read_b64_tr_b16 v[50:51], v22 offset:25600
    ds_read_b64_tr_b16 v[52:53], v23 offset:24576
    ds_read_b64_tr_b16 v[54:55], v23 offset:25600
    v_mfma_f32_16x16x32_bf16 a[0:3], v[208:211], v[128:131], a[0:3]
    v_mfma_f32_16x16x32_bf16 a[4:7], v[212:215], v[128:131], a[4:7]
    v_mfma_f32_16x16x32_bf16 a[8:11], v[216:219], v[128:131], a[8:11]
    v_mfma_f32_16x16x32_bf16 a[12:15], v[220:223], v[128:131], a[12:15]
    v_mfma_f32_16x16x32_bf16 a[16:19], v[224:227], v[128:131], a[16:19]
    v_mfma_f32_16x16x32_bf16 a[20:23], v[228:231], v[128:131], a[20:23]
    v_mfma_f32_16x16x32_bf16 a[24:27], v[232:235], v[128:131], a[24:27]
    v_mfma_f32_16x16x32_bf16 a[28:31], v[236:239], v[128:131], a[28:31]
    v_mfma_f32_16x16x32_bf16 a[32:35], v[208:211], v[132:135], a[32:35]
    v_mfma_f32_16x16x32_bf16 a[36:39], v[212:215], v[132:135], a[36:39]
    v_mfma_f32_16x16x32_bf16 a[40:43], v[216:219], v[132:135], a[40:43]
    v_mfma_f32_16x16x32_bf16 a[44:47], v[220:223], v[132:135], a[44:47]
    v_mfma_f32_16x16x32_bf16 a[48:51], v[224:227], v[132:135], a[48:51]
    v_mfma_f32_16x16x32_bf16 a[52:55], v[228:231], v[132:135], a[52:55]
    v_mfma_f32_16x16x32_bf16 a[56:59], v[232:235], v[132:135], a[56:59]
    v_mfma_f32_16x16x32_bf16 a[60:63], v[236:239], v[132:135], a[60:63]
    s_waitcnt lgkmcnt(0)
    ds_read_b64_tr_b16 v[208:209], v16 offset:32768
    ds_read_b64_tr_b16 v[210:211], v16 offset:33792
    ds_read_b64_tr_b16 v[212:213], v17 offset:32768
    ds_read_b64_tr_b16 v[214:215], v17 offset:33792
    ds_read_b64_tr_b16 v[216:217], v18 offset:32768
    ds_read_b64_tr_b16 v[218:219], v18 offset:33792
    ds_read_b64_tr_b16 v[220:221], v19 offset:32768
    ds_read_b64_tr_b16 v[222:223], v19 offset:33792
    ds_read_b64_tr_b16 v[224:225], v20 offset:32768
    ds_read_b64_tr_b16 v[226:227], v20 offset:33792
    ds_read_b64_tr_b16 v[228:229], v21 offset:32768
    ds_read_b64_tr_b16 v[230:231], v21 offset:33792
    ds_read_b64_tr_b16 v[232:233], v22 offset:32768
    ds_read_b64_tr_b16 v[234:235], v22 offset:33792
    ds_read_b64_tr_b16 v[236:237], v23 offset:32768
    ds_read_b64_tr_b16 v[238:239], v23 offset:33792
    v_mfma_f32_16x16x32_bf16 a[0:3], v[24:27], v[136:139], a[0:3]
    v_mfma_f32_16x16x32_bf16 a[4:7], v[28:31], v[136:139], a[4:7]
    v_mfma_f32_16x16x32_bf16 a[8:11], v[32:35], v[136:139], a[8:11]
    v_mfma_f32_16x16x32_bf16 a[12:15], v[36:39], v[136:139], a[12:15]
    v_mfma_f32_16x16x32_bf16 a[16:19], v[40:43], v[136:139], a[16:19]
    v_mfma_f32_16x16x32_bf16 a[20:23], v[44:47], v[136:139], a[20:23]
    v_mfma_f32_16x16x32_bf16 a[24:27], v[48:51], v[136:139], a[24:27]
    v_mfma_f32_16x16x32_bf16 a[28:31], v[52:55], v[136:139], a[28:31]
    v_mfma_f32_16x16x32_bf16 a[32:35], v[24:27], v[140:143], a[32:35]
    v_mfma_f32_16x16x32_bf16 a[36:39], v[28:31], v[140:143], a[36:39]
    v_mfma_f32_16x16x32_bf16 a[40:43], v[32:35], v[140:143], a[40:43]
    v_mfma_f32_16x16x32_bf16 a[44:47], v[36:39], v[140:143], a[44:47]
    v_mfma_f32_16x16x32_bf16 a[48:51], v[40:43], v[140:143], a[48:51]
    v_mfma_f32_16x16x32_bf16 a[52:55], v[44:47], v[140:143], a[52:55]
    v_mfma_f32_16x16x32_bf16 a[56:59], v[48:51], v[140:143], a[56:59]
    v_mfma_f32_16x16x32_bf16 a[60:63], v[52:55], v[140:143], a[60:63]
    s_waitcnt lgkmcnt(0)
    ds_read_b64_tr_b16 v[24:25], v16 offset:40960
    ds_read_b64_tr_b16 v[26:27], v16 offset:41984
    ds_read_b64_tr_b16 v[28:29], v17 offset:40960
    ds_read_b64_tr_b16 v[30:31], v17 offset:41984
    ds_read_b64_tr_b16 v[32:33], v18 offset:40960
    ds_read_b64_tr_b16 v[34:35], v18 offset:41984
    ds_read_b64_tr_b16 v[36:37], v19 offset:40960
    ds_read_b64_tr_b16 v[38:39], v19 offset:41984
    ds_read_b64_tr_b16 v[40:41], v20 offset:40960
    ds_read_b64_tr_b16 v[42:43], v20 offset:41984
    ds_read_b64_tr_b16 v[44:45], v21 offset:40960
    ds_read_b64_tr_b16 v[46:47], v21 offset:41984
    ds_read_b64_tr_b16 v[48:49], v22 offset:40960
    ds_read_b64_tr_b16 v[50:51], v22 offset:41984
    ds_read_b64_tr_b16 v[52:53], v23 offset:40960
    ds_read_b64_tr_b16 v[54:55], v23 offset:41984
    v_mfma_f32_16x16x32_bf16 a[0:3], v[208:211], v[144:147], a[0:3]
    v_mfma_f32_16x16x32_bf16 a[4:7], v[212:215], v[144:147], a[4:7]
    v_mfma_f32_16x16x32_bf16 a[8:11], v[216:219], v[144:147], a[8:11]
    v_mfma_f32_16x16x32_bf16 a[12:15], v[220:223], v[144:147], a[12:15]
    v_mfma_f32_16x16x32_bf16 a[16:19], v[224:227], v[144:147], a[16:19]
    v_mfma_f32_16x16x32_bf16 a[20:23], v[228:231], v[144:147], a[20:23]
    v_mfma_f32_16x16x32_bf16 a[24:27], v[232:235], v[144:147], a[24:27]
    v_mfma_f32_16x16x32_bf16 a[28:31], v[236:239], v[144:147], a[28:31]
    v_mfma_f32_16x16x32_bf16 a[32:35], v[208:211], v[148:151], a[32:35]
    v_mfma_f32_16x16x32_bf16 a[36:39], v[212:215], v[148:151], a[36:39]
    v_mfma_f32_16x16x32_bf16 a[40:43], v[216:219], v[148:151], a[40:43]
    v_mfma_f32_16x16x32_bf16 a[44:47], v[220:223], v[148:151], a[44:47]
    v_mfma_f32_16x16x32_bf16 a[48:51], v[224:227], v[148:151], a[48:51]
    v_mfma_f32_16x16x32_bf16 a[52:55], v[228:231], v[148:151], a[52:55]
    v_mfma_f32_16x16x32_bf16 a[56:59], v[232:235], v[148:151], a[56:59]
    v_mfma_f32_16x16x32_bf16 a[60:63], v[236:239], v[148:151], a[60:63]
    s_waitcnt lgkmcnt(0)
    v_mfma_f32_16x16x32_bf16 a[0:3], v[24:27], v[152:155], a[0:3]
    v_mfma_f32_16x16x32_bf16 a[4:7], v[28:31], v[152:155], a[4:7]
    v_mfma_f32_16x16x32_bf16 a[8:11], v[32:35], v[152:155], a[8:11]
    v_mfma_f32_16x16x32_bf16 a[12:15], v[36:39], v[152:155], a[12:15]
    v_mfma_f32_16x16x32_bf16 a[16:19], v[40:43], v[152:155], a[16:19]
    v_mfma_f32_16x16x32_bf16 a[20:23], v[44:47], v[152:155], a[20:23]
    v_mfma_f32_16x16x32_bf16 a[24:27], v[48:51], v[152:155], a[24:27]
    v_mfma_f32_16x16x32_bf16 a[28:31], v[52:55], v[152:155], a[28:31]
    v_mfma_f32_16x16x32_bf16 a[32:35], v[24:27], v[156:159], a[32:35]
    v_mfma_f32_16x16x32_bf16 a[36:39], v[28:31], v[156:159], a[36:39]
    v_mfma_f32_16x16x32_bf16 a[40:43], v[32:35], v[156:159], a[40:43]
    v_mfma_f32_16x16x32_bf16 a[44:47], v[36:39], v[156:159], a[44:47]
    v_mfma_f32_16x16x32_bf16 a[48:51], v[40:43], v[156:159], a[48:51]
    v_mfma_f32_16x16x32_bf16 a[52:55], v[44:47], v[156:159], a[52:55]
    v_mfma_f32_16x16x32_bf16 a[56:59], v[48:51], v[156:159], a[56:59]
    v_mfma_f32_16x16x32_bf16 a[60:63], v[52:55], v[156:159], a[60:63]
    s_waitcnt vmcnt(0)
    s_barrier
    v_add_u32 v16, 49152, v16
    v_add_u32 v17, 49152, v17
    v_add_u32 v18, 49152, v18
    v_add_u32 v19, 49152, v19
    v_add_u32 v20, 49152, v20
    v_add_u32 v21, 49152, v21
    v_add_u32 v22, 49152, v22
    v_add_u32 v23, 49152, v23
    ds_read_b64_tr_b16 v[208:209], v16 offset:0
    ds_read_b64_tr_b16 v[210:211], v16 offset:1024
    ds_read_b64_tr_b16 v[212:213], v17 offset:0
    ds_read_b64_tr_b16 v[214:215], v17 offset:1024
    ds_read_b64_tr_b16 v[216:217], v18 offset:0
    ds_read_b64_tr_b16 v[218:219], v18 offset:1024
    ds_read_b64_tr_b16 v[220:221], v19 offset:0
    ds_read_b64_tr_b16 v[222:223], v19 offset:1024
    ds_read_b64_tr_b16 v[224:225], v20 offset:0
    ds_read_b64_tr_b16 v[226:227], v20 offset:1024
    ds_read_b64_tr_b16 v[228:229], v21 offset:0
    ds_read_b64_tr_b16 v[230:231], v21 offset:1024
    ds_read_b64_tr_b16 v[232:233], v22 offset:0
    ds_read_b64_tr_b16 v[234:235], v22 offset:1024
    ds_read_b64_tr_b16 v[236:237], v23 offset:0
    ds_read_b64_tr_b16 v[238:239], v23 offset:1024
    s_waitcnt lgkmcnt(0)
    ds_read_b64_tr_b16 v[24:25], v16 offset:8192
    ds_read_b64_tr_b16 v[26:27], v16 offset:9216
    ds_read_b64_tr_b16 v[28:29], v17 offset:8192
    ds_read_b64_tr_b16 v[30:31], v17 offset:9216
    ds_read_b64_tr_b16 v[32:33], v18 offset:8192
    ds_read_b64_tr_b16 v[34:35], v18 offset:9216
    ds_read_b64_tr_b16 v[36:37], v19 offset:8192
    ds_read_b64_tr_b16 v[38:39], v19 offset:9216
    ds_read_b64_tr_b16 v[40:41], v20 offset:8192
    ds_read_b64_tr_b16 v[42:43], v20 offset:9216
    ds_read_b64_tr_b16 v[44:45], v21 offset:8192
    ds_read_b64_tr_b16 v[46:47], v21 offset:9216
    ds_read_b64_tr_b16 v[48:49], v22 offset:8192
    ds_read_b64_tr_b16 v[50:51], v22 offset:9216
    ds_read_b64_tr_b16 v[52:53], v23 offset:8192
    ds_read_b64_tr_b16 v[54:55], v23 offset:9216
    v_mfma_f32_16x16x32_bf16 a[0:3], v[208:211], v[160:163], a[0:3]
    v_mfma_f32_16x16x32_bf16 a[4:7], v[212:215], v[160:163], a[4:7]
    v_mfma_f32_16x16x32_bf16 a[8:11], v[216:219], v[160:163], a[8:11]
    v_mfma_f32_16x16x32_bf16 a[12:15], v[220:223], v[160:163], a[12:15]
    v_mfma_f32_16x16x32_bf16 a[16:19], v[224:227], v[160:163], a[16:19]
    v_mfma_f32_16x16x32_bf16 a[20:23], v[228:231], v[160:163], a[20:23]
    v_mfma_f32_16x16x32_bf16 a[24:27], v[232:235], v[160:163], a[24:27]
    v_mfma_f32_16x16x32_bf16 a[28:31], v[236:239], v[160:163], a[28:31]
    v_mfma_f32_16x16x32_bf16 a[32:35], v[208:211], v[164:167], a[32:35]
    v_mfma_f32_16x16x32_bf16 a[36:39], v[212:215], v[164:167], a[36:39]
    v_mfma_f32_16x16x32_bf16 a[40:43], v[216:219], v[164:167], a[40:43]
    v_mfma_f32_16x16x32_bf16 a[44:47], v[220:223], v[164:167], a[44:47]
    v_mfma_f32_16x16x32_bf16 a[48:51], v[224:227], v[164:167], a[48:51]
    v_mfma_f32_16x16x32_bf16 a[52:55], v[228:231], v[164:167], a[52:55]
    v_mfma_f32_16x16x32_bf16 a[56:59], v[232:235], v[164:167], a[56:59]
    v_mfma_f32_16x16x32_bf16 a[60:63], v[236:239], v[164:167], a[60:63]
    s_waitcnt lgkmcnt(0)
    ds_read_b64_tr_b16 v[208:209], v16 offset:16384
    ds_read_b64_tr_b16 v[210:211], v16 offset:17408
    ds_read_b64_tr_b16 v[212:213], v17 offset:16384
    ds_read_b64_tr_b16 v[214:215], v17 offset:17408
    ds_read_b64_tr_b16 v[216:217], v18 offset:16384
    ds_read_b64_tr_b16 v[218:219], v18 offset:17408
    ds_read_b64_tr_b16 v[220:221], v19 offset:16384
    ds_read_b64_tr_b16 v[222:223], v19 offset:17408
    ds_read_b64_tr_b16 v[224:225], v20 offset:16384
    ds_read_b64_tr_b16 v[226:227], v20 offset:17408
    ds_read_b64_tr_b16 v[228:229], v21 offset:16384
    ds_read_b64_tr_b16 v[230:231], v21 offset:17408
    ds_read_b64_tr_b16 v[232:233], v22 offset:16384
    ds_read_b64_tr_b16 v[234:235], v22 offset:17408
    ds_read_b64_tr_b16 v[236:237], v23 offset:16384
    ds_read_b64_tr_b16 v[238:239], v23 offset:17408
    v_mfma_f32_16x16x32_bf16 a[0:3], v[24:27], v[168:171], a[0:3]
    v_mfma_f32_16x16x32_bf16 a[4:7], v[28:31], v[168:171], a[4:7]
    v_mfma_f32_16x16x32_bf16 a[8:11], v[32:35], v[168:171], a[8:11]
    v_mfma_f32_16x16x32_bf16 a[12:15], v[36:39], v[168:171], a[12:15]
    v_mfma_f32_16x16x32_bf16 a[16:19], v[40:43], v[168:171], a[16:19]
    v_mfma_f32_16x16x32_bf16 a[20:23], v[44:47], v[168:171], a[20:23]
    v_mfma_f32_16x16x32_bf16 a[24:27], v[48:51], v[168:171], a[24:27]
    v_mfma_f32_16x16x32_bf16 a[28:31], v[52:55], v[168:171], a[28:31]
    v_mfma_f32_16x16x32_bf16 a[32:35], v[24:27], v[172:175], a[32:35]
    v_mfma_f32_16x16x32_bf16 a[36:39], v[28:31], v[172:175], a[36:39]
    v_mfma_f32_16x16x32_bf16 a[40:43], v[32:35], v[172:175], a[40:43]
    v_mfma_f32_16x16x32_bf16 a[44:47], v[36:39], v[172:175], a[44:47]
    v_mfma_f32_16x16x32_bf16 a[48:51], v[40:43], v[172:175], a[48:51]
    v_mfma_f32_16x16x32_bf16 a[52:55], v[44:47], v[172:175], a[52:55]
    v_mfma_f32_16x16x32_bf16 a[56:59], v[48:51], v[172:175], a[56:59]
    v_mfma_f32_16x16x32_bf16 a[60:63], v[52:55], v[172:175], a[60:63]
    s_waitcnt lgkmcnt(0)
    ds_read_b64_tr_b16 v[24:25], v16 offset:24576
    ds_read_b64_tr_b16 v[26:27], v16 offset:25600
    ds_read_b64_tr_b16 v[28:29], v17 offset:24576
    ds_read_b64_tr_b16 v[30:31], v17 offset:25600
    ds_read_b64_tr_b16 v[32:33], v18 offset:24576
    ds_read_b64_tr_b16 v[34:35], v18 offset:25600
    ds_read_b64_tr_b16 v[36:37], v19 offset:24576
    ds_read_b64_tr_b16 v[38:39], v19 offset:25600
    ds_read_b64_tr_b16 v[40:41], v20 offset:24576
    ds_read_b64_tr_b16 v[42:43], v20 offset:25600
    ds_read_b64_tr_b16 v[44:45], v21 offset:24576
    ds_read_b64_tr_b16 v[46:47], v21 offset:25600
    ds_read_b64_tr_b16 v[48:49], v22 offset:24576
    ds_read_b64_tr_b16 v[50:51], v22 offset:25600
    ds_read_b64_tr_b16 v[52:53], v23 offset:24576
    ds_read_b64_tr_b16 v[54:55], v23 offset:25600
    v_mfma_f32_16x16x32_bf16 a[0:3], v[208:211], v[176:179], a[0:3]
    v_mfma_f32_16x16x32_bf16 a[4:7], v[212:215], v[176:179], a[4:7]
    v_mfma_f32_16x16x32_bf16 a[8:11], v[216:219], v[176:179], a[8:11]
    v_mfma_f32_16x16x32_bf16 a[12:15], v[220:223], v[176:179], a[12:15]
    v_mfma_f32_16x16x32_bf16 a[16:19], v[224:227], v[176:179], a[16:19]
    v_mfma_f32_16x16x32_bf16 a[20:23], v[228:231], v[176:179], a[20:23]
    v_mfma_f32_16x16x32_bf16 a[24:27], v[232:235], v[176:179], a[24:27]
    v_mfma_f32_16x16x32_bf16 a[28:31], v[236:239], v[176:179], a[28:31]
    v_mfma_f32_16x16x32_bf16 a[32:35], v[208:211], v[180:183], a[32:35]
    v_mfma_f32_16x16x32_bf16 a[36:39], v[212:215], v[180:183], a[36:39]
    v_mfma_f32_16x16x32_bf16 a[40:43], v[216:219], v[180:183], a[40:43]
    v_mfma_f32_16x16x32_bf16 a[44:47], v[220:223], v[180:183], a[44:47]
    v_mfma_f32_16x16x32_bf16 a[48:51], v[224:227], v[180:183], a[48:51]
    v_mfma_f32_16x16x32_bf16 a[52:55], v[228:231], v[180:183], a[52:55]
    v_mfma_f32_16x16x32_bf16 a[56:59], v[232:235], v[180:183], a[56:59]
    v_mfma_f32_16x16x32_bf16 a[60:63], v[236:239], v[180:183], a[60:63]
    s_waitcnt lgkmcnt(0)
    ds_read_b64_tr_b16 v[208:209], v16 offset:32768
    ds_read_b64_tr_b16 v[210:211], v16 offset:33792
    ds_read_b64_tr_b16 v[212:213], v17 offset:32768
    ds_read_b64_tr_b16 v[214:215], v17 offset:33792
    ds_read_b64_tr_b16 v[216:217], v18 offset:32768
    ds_read_b64_tr_b16 v[218:219], v18 offset:33792
    ds_read_b64_tr_b16 v[220:221], v19 offset:32768
    ds_read_b64_tr_b16 v[222:223], v19 offset:33792
    ds_read_b64_tr_b16 v[224:225], v20 offset:32768
    ds_read_b64_tr_b16 v[226:227], v20 offset:33792
    ds_read_b64_tr_b16 v[228:229], v21 offset:32768
    ds_read_b64_tr_b16 v[230:231], v21 offset:33792
    ds_read_b64_tr_b16 v[232:233], v22 offset:32768
    ds_read_b64_tr_b16 v[234:235], v22 offset:33792
    ds_read_b64_tr_b16 v[236:237], v23 offset:32768
    ds_read_b64_tr_b16 v[238:239], v23 offset:33792
    v_mfma_f32_16x16x32_bf16 a[0:3], v[24:27], v[184:187], a[0:3]
    v_mfma_f32_16x16x32_bf16 a[4:7], v[28:31], v[184:187], a[4:7]
    v_mfma_f32_16x16x32_bf16 a[8:11], v[32:35], v[184:187], a[8:11]
    v_mfma_f32_16x16x32_bf16 a[12:15], v[36:39], v[184:187], a[12:15]
    v_mfma_f32_16x16x32_bf16 a[16:19], v[40:43], v[184:187], a[16:19]
    v_mfma_f32_16x16x32_bf16 a[20:23], v[44:47], v[184:187], a[20:23]
    v_mfma_f32_16x16x32_bf16 a[24:27], v[48:51], v[184:187], a[24:27]
    v_mfma_f32_16x16x32_bf16 a[28:31], v[52:55], v[184:187], a[28:31]
    v_mfma_f32_16x16x32_bf16 a[32:35], v[24:27], v[188:191], a[32:35]
    v_mfma_f32_16x16x32_bf16 a[36:39], v[28:31], v[188:191], a[36:39]
    v_mfma_f32_16x16x32_bf16 a[40:43], v[32:35], v[188:191], a[40:43]
    v_mfma_f32_16x16x32_bf16 a[44:47], v[36:39], v[188:191], a[44:47]
    v_mfma_f32_16x16x32_bf16 a[48:51], v[40:43], v[188:191], a[48:51]
    v_mfma_f32_16x16x32_bf16 a[52:55], v[44:47], v[188:191], a[52:55]
    v_mfma_f32_16x16x32_bf16 a[56:59], v[48:51], v[188:191], a[56:59]
    v_mfma_f32_16x16x32_bf16 a[60:63], v[52:55], v[188:191], a[60:63]
    s_waitcnt lgkmcnt(0)
    ds_read_b64_tr_b16 v[24:25], v16 offset:40960
    ds_read_b64_tr_b16 v[26:27], v16 offset:41984
    ds_read_b64_tr_b16 v[28:29], v17 offset:40960
    ds_read_b64_tr_b16 v[30:31], v17 offset:41984
    ds_read_b64_tr_b16 v[32:33], v18 offset:40960
    ds_read_b64_tr_b16 v[34:35], v18 offset:41984
    ds_read_b64_tr_b16 v[36:37], v19 offset:40960
    ds_read_b64_tr_b16 v[38:39], v19 offset:41984
    ds_read_b64_tr_b16 v[40:41], v20 offset:40960
    ds_read_b64_tr_b16 v[42:43], v20 offset:41984
    ds_read_b64_tr_b16 v[44:45], v21 offset:40960
    ds_read_b64_tr_b16 v[46:47], v21 offset:41984
    ds_read_b64_tr_b16 v[48:49], v22 offset:40960
    ds_read_b64_tr_b16 v[50:51], v22 offset:41984
    ds_read_b64_tr_b16 v[52:53], v23 offset:40960
    ds_read_b64_tr_b16 v[54:55], v23 offset:41984
    v_mfma_f32_16x16x32_bf16 a[0:3], v[208:211], v[192:195], a[0:3]
    v_mfma_f32_16x16x32_bf16 a[4:7], v[212:215], v[192:195], a[4:7]
    v_mfma_f32_16x16x32_bf16 a[8:11], v[216:219], v[192:195], a[8:11]
    v_mfma_f32_16x16x32_bf16 a[12:15], v[220:223], v[192:195], a[12:15]
    v_mfma_f32_16x16x32_bf16 a[16:19], v[224:227], v[192:195], a[16:19]
    v_mfma_f32_16x16x32_bf16 a[20:23], v[228:231], v[192:195], a[20:23]
    v_mfma_f32_16x16x32_bf16 a[24:27], v[232:235], v[192:195], a[24:27]
    v_mfma_f32_16x16x32_bf16 a[28:31], v[236:239], v[192:195], a[28:31]
    v_mfma_f32_16x16x32_bf16 a[32:35], v[208:211], v[196:199], a[32:35]
    v_mfma_f32_16x16x32_bf16 a[36:39], v[212:215], v[196:199], a[36:39]
    v_mfma_f32_16x16x32_bf16 a[40:43], v[216:219], v[196:199], a[40:43]
    v_mfma_f32_16x16x32_bf16 a[44:47], v[220:223], v[196:199], a[44:47]
    v_mfma_f32_16x16x32_bf16 a[48:51], v[224:227], v[196:199], a[48:51]
    v_mfma_f32_16x16x32_bf16 a[52:55], v[228:231], v[196:199], a[52:55]
    v_mfma_f32_16x16x32_bf16 a[56:59], v[232:235], v[196:199], a[56:59]
    v_mfma_f32_16x16x32_bf16 a[60:63], v[236:239], v[196:199], a[60:63]
    s_waitcnt lgkmcnt(0)
    v_mfma_f32_16x16x32_bf16 a[0:3], v[24:27], v[200:203], a[0:3]
    v_mfma_f32_16x16x32_bf16 a[4:7], v[28:31], v[200:203], a[4:7]
    v_mfma_f32_16x16x32_bf16 a[8:11], v[32:35], v[200:203], a[8:11]
    v_mfma_f32_16x16x32_bf16 a[12:15], v[36:39], v[200:203], a[12:15]
    v_mfma_f32_16x16x32_bf16 a[16:19], v[40:43], v[200:203], a[16:19]
    v_mfma_f32_16x16x32_bf16 a[20:23], v[44:47], v[200:203], a[20:23]
    v_mfma_f32_16x16x32_bf16 a[24:27], v[48:51], v[200:203], a[24:27]
    v_mfma_f32_16x16x32_bf16 a[28:31], v[52:55], v[200:203], a[28:31]
    v_mfma_f32_16x16x32_bf16 a[32:35], v[24:27], v[204:207], a[32:35]
    v_mfma_f32_16x16x32_bf16 a[36:39], v[28:31], v[204:207], a[36:39]
    v_mfma_f32_16x16x32_bf16 a[40:43], v[32:35], v[204:207], a[40:43]
    v_mfma_f32_16x16x32_bf16 a[44:47], v[36:39], v[204:207], a[44:47]
    v_mfma_f32_16x16x32_bf16 a[48:51], v[40:43], v[204:207], a[48:51]
    v_mfma_f32_16x16x32_bf16 a[52:55], v[44:47], v[204:207], a[52:55]
    v_mfma_f32_16x16x32_bf16 a[56:59], v[48:51], v[204:207], a[56:59]
    v_mfma_f32_16x16x32_bf16 a[60:63], v[52:55], v[204:207], a[60:63]
    s_mul_i32 s33, s30, 65
    s_add_u32 s33, s33, s32
    s_lshl_b32 s33, s33, 14
    s_add_u32 s33, s33, 16777216
    s_add_u32 s34, s33, 4096
    s_nop 3
    v_accvgpr_read_b32 v64, a0
    v_accvgpr_read_b32 v68, a4
    v_accvgpr_read_b32 v65, a1
    v_accvgpr_read_b32 v69, a5
    v_accvgpr_read_b32 v66, a2
    v_accvgpr_read_b32 v70, a6
    v_accvgpr_read_b32 v67, a3
    v_accvgpr_read_b32 v71, a7
    v_cvt_pk_bf16_f32 v72, v64, v65
    v_cvt_pk_bf16_f32 v73, v66, v67
    v_cvt_pk_bf16_f32 v74, v68, v69
    v_cvt_pk_bf16_f32 v75, v70, v71
    buffer_store_dwordx4 v[72:75], v1, s[4:7], s33 offen offset:0 sc1
    v_accvgpr_read_b32 v76, a8
    v_accvgpr_read_b32 v80, a12
    v_accvgpr_read_b32 v77, a9
    v_accvgpr_read_b32 v81, a13
    v_accvgpr_read_b32 v78, a10
    v_accvgpr_read_b32 v82, a14
    v_accvgpr_read_b32 v79, a11
    v_accvgpr_read_b32 v83, a15
    v_cvt_pk_bf16_f32 v84, v76, v77
    v_cvt_pk_bf16_f32 v85, v78, v79
    v_cvt_pk_bf16_f32 v86, v80, v81
    v_cvt_pk_bf16_f32 v87, v82, v83
    buffer_store_dwordx4 v[84:87], v1, s[4:7], s33 offen offset:1024 sc1
    v_accvgpr_read_b32 v88, a16
    v_accvgpr_read_b32 v92, a20
    v_accvgpr_read_b32 v89, a17
    v_accvgpr_read_b32 v93, a21
    v_accvgpr_read_b32 v90, a18
    v_accvgpr_read_b32 v94, a22
    v_accvgpr_read_b32 v91, a19
    v_accvgpr_read_b32 v95, a23
    v_cvt_pk_bf16_f32 v96, v88, v89
    v_cvt_pk_bf16_f32 v97, v90, v91
    v_cvt_pk_bf16_f32 v98, v92, v93
    v_cvt_pk_bf16_f32 v99, v94, v95
    buffer_store_dwordx4 v[96:99], v1, s[4:7], s33 offen offset:2048 sc1
    v_accvgpr_read_b32 v100, a24
    v_accvgpr_read_b32 v104, a28
    v_accvgpr_read_b32 v101, a25
    v_accvgpr_read_b32 v105, a29
    v_accvgpr_read_b32 v102, a26
    v_accvgpr_read_b32 v106, a30
    v_accvgpr_read_b32 v103, a27
    v_accvgpr_read_b32 v107, a31
    v_cvt_pk_bf16_f32 v108, v100, v101
    v_cvt_pk_bf16_f32 v109, v102, v103
    v_cvt_pk_bf16_f32 v110, v104, v105
    v_cvt_pk_bf16_f32 v111, v106, v107
    buffer_store_dwordx4 v[108:111], v1, s[4:7], s33 offen offset:3072 sc1
    v_accvgpr_read_b32 v112, a32
    v_accvgpr_read_b32 v116, a36
    v_accvgpr_read_b32 v113, a33
    v_accvgpr_read_b32 v117, a37
    v_accvgpr_read_b32 v114, a34
    v_accvgpr_read_b32 v118, a38
    v_accvgpr_read_b32 v115, a35
    v_accvgpr_read_b32 v119, a39
    v_cvt_pk_bf16_f32 v120, v112, v113
    v_cvt_pk_bf16_f32 v121, v114, v115
    v_cvt_pk_bf16_f32 v122, v116, v117
    v_cvt_pk_bf16_f32 v123, v118, v119
    buffer_store_dwordx4 v[120:123], v1, s[4:7], s34 offen offset:0 sc1
    v_accvgpr_read_b32 v124, a40
    v_accvgpr_read_b32 v128, a44
    v_accvgpr_read_b32 v125, a41
    v_accvgpr_read_b32 v129, a45
    v_accvgpr_read_b32 v126, a42
    v_accvgpr_read_b32 v130, a46
    v_accvgpr_read_b32 v127, a43
    v_accvgpr_read_b32 v131, a47
    v_cvt_pk_bf16_f32 v132, v124, v125
    v_cvt_pk_bf16_f32 v133, v126, v127
    v_cvt_pk_bf16_f32 v134, v128, v129
    v_cvt_pk_bf16_f32 v135, v130, v131
    buffer_store_dwordx4 v[132:135], v1, s[4:7], s34 offen offset:1024 sc1
    v_accvgpr_read_b32 v136, a48
    v_accvgpr_read_b32 v140, a52
    v_accvgpr_read_b32 v137, a49
    v_accvgpr_read_b32 v141, a53
    v_accvgpr_read_b32 v138, a50
    v_accvgpr_read_b32 v142, a54
    v_accvgpr_read_b32 v139, a51
    v_accvgpr_read_b32 v143, a55
    v_cvt_pk_bf16_f32 v144, v136, v137
    v_cvt_pk_bf16_f32 v145, v138, v139
    v_cvt_pk_bf16_f32 v146, v140, v141
    v_cvt_pk_bf16_f32 v147, v142, v143
    buffer_store_dwordx4 v[144:147], v1, s[4:7], s34 offen offset:2048 sc1
    v_accvgpr_read_b32 v148, a56
    v_accvgpr_read_b32 v152, a60
    v_accvgpr_read_b32 v149, a57
    v_accvgpr_read_b32 v153, a61
    v_accvgpr_read_b32 v150, a58
    v_accvgpr_read_b32 v154, a62
    v_accvgpr_read_b32 v151, a59
    v_accvgpr_read_b32 v155, a63
    v_cvt_pk_bf16_f32 v156, v148, v149
    v_cvt_pk_bf16_f32 v157, v150, v151
    v_cvt_pk_bf16_f32 v158, v152, v153
    v_cvt_pk_bf16_f32 v159, v154, v155
    buffer_store_dwordx4 v[156:159], v1, s[4:7], s34 offen offset:3072 sc1
    s_branch Lt0E_2
Lt0V_1:
    s_waitcnt vmcnt(42)
    s_barrier
    ds_read_b64_tr_b16 v[208:209], v16 offset:0
    ds_read_b64_tr_b16 v[210:211], v16 offset:1024
    ds_read_b64_tr_b16 v[212:213], v17 offset:0
    ds_read_b64_tr_b16 v[214:215], v17 offset:1024
    ds_read_b64_tr_b16 v[216:217], v18 offset:0
    ds_read_b64_tr_b16 v[218:219], v18 offset:1024
    ds_read_b64_tr_b16 v[220:221], v19 offset:0
    ds_read_b64_tr_b16 v[222:223], v19 offset:1024
    ds_read_b64_tr_b16 v[224:225], v20 offset:0
    ds_read_b64_tr_b16 v[226:227], v20 offset:1024
    ds_read_b64_tr_b16 v[228:229], v21 offset:0
    ds_read_b64_tr_b16 v[230:231], v21 offset:1024
    ds_read_b64_tr_b16 v[232:233], v22 offset:0
    ds_read_b64_tr_b16 v[234:235], v22 offset:1024
    ds_read_b64_tr_b16 v[236:237], v23 offset:0
    ds_read_b64_tr_b16 v[238:239], v23 offset:1024
    s_waitcnt lgkmcnt(0)
    ds_read_b64_tr_b16 v[24:25], v16 offset:8192
    ds_read_b64_tr_b16 v[26:27], v16 offset:9216
    ds_read_b64_tr_b16 v[28:29], v17 offset:8192
    ds_read_b64_tr_b16 v[30:31], v17 offset:9216
    ds_read_b64_tr_b16 v[32:33], v18 offset:8192
    ds_read_b64_tr_b16 v[34:35], v18 offset:9216
    ds_read_b64_tr_b16 v[36:37], v19 offset:8192
    ds_read_b64_tr_b16 v[38:39], v19 offset:9216
    ds_read_b64_tr_b16 v[40:41], v20 offset:8192
    ds_read_b64_tr_b16 v[42:43], v20 offset:9216
    ds_read_b64_tr_b16 v[44:45], v21 offset:8192
    ds_read_b64_tr_b16 v[46:47], v21 offset:9216
    ds_read_b64_tr_b16 v[48:49], v22 offset:8192
    ds_read_b64_tr_b16 v[50:51], v22 offset:9216
    ds_read_b64_tr_b16 v[52:53], v23 offset:8192
    ds_read_b64_tr_b16 v[54:55], v23 offset:9216
    v_mfma_f32_16x16x32_bf16 a[0:3], v[64:67], v[208:211], 0
    v_mfma_f32_16x16x32_bf16 a[4:7], v[64:67], v[212:215], 0
    v_mfma_f32_16x16x32_bf16 a[8:11], v[64:67], v[216:219], 0
    v_mfma_f32_16x16x32_bf16 a[12:15], v[64:67], v[220:223], 0
    v_mfma_f32_16x16x32_bf16 a[16:19], v[64:67], v[224:227], 0
    v_mfma_f32_16x16x32_bf16 a[20:23], v[64:67], v[228:231], 0
    v_mfma_f32_16x16x32_bf16 a[24:27], v[64:67], v[232:235], 0
    v_mfma_f32_16x16x32_bf16 a[28:31], v[64:67], v[236:239], 0
    v_mfma_f32_16x16x32_bf16 a[32:35], v[68:71], v[208:211], 0
    v_mfma_f32_16x16x32_bf16 a[36:39], v[68:71], v[212:215], 0
    v_mfma_f32_16x16x32_bf16 a[40:43], v[68:71], v[216:219], 0
    v_mfma_f32_16x16x32_bf16 a[44:47], v[68:71], v[220:223], 0
    v_mfma_f32_16x16x32_bf16 a[48:51], v[68:71], v[224:227], 0
    v_mfma_f32_16x16x32_bf16 a[52:55], v[68:71], v[228:231], 0
    v_mfma_f32_16x16x32_bf16 a[56:59], v[68:71], v[232:235], 0
    v_mfma_f32_16x16x32_bf16 a[60:63], v[68:71], v[236:239], 0
    s_waitcnt lgkmcnt(0)
    ds_read_b64_tr_b16 v[208:209], v16 offset:16384
    ds_read_b64_tr_b16 v[210:211], v16 offset:17408
    ds_read_b64_tr_b16 v[212:213], v17 offset:16384
    ds_read_b64_tr_b16 v[214:215], v17 offset:17408
    ds_read_b64_tr_b16 v[216:217], v18 offset:16384
    ds_read_b64_tr_b16 v[218:219], v18 offset:17408
    ds_read_b64_tr_b16 v[220:221], v19 offset:16384
    ds_read_b64_tr_b16 v[222:223], v19 offset:17408
    ds_read_b64_tr_b16 v[224:225], v20 offset:16384
    ds_read_b64_tr_b16 v[226:227], v20 offset:17408
    ds_read_b64_tr_b16 v[228:229], v21 offset:16384
    ds_read_b64_tr_b16 v[230:231], v21 offset:17408
    ds_read_b64_tr_b16 v[232:233], v22 offset:16384
    ds_read_b64_tr_b16 v[234:235], v22 offset:17408
    ds_read_b64_tr_b16 v[236:237], v23 offset:16384
    ds_read_b64_tr_b16 v[238:239], v23 offset:17408
    v_mfma_f32_16x16x32_bf16 a[0:3], v[72:75], v[24:27], a[0:3]
    v_mfma_f32_16x16x32_bf16 a[4:7], v[72:75], v[28:31], a[4:7]
    v_mfma_f32_16x16x32_bf16 a[8:11], v[72:75], v[32:35], a[8:11]
    v_mfma_f32_16x16x32_bf16 a[12:15], v[72:75], v[36:39], a[12:15]
    v_mfma_f32_16x16x32_bf16 a[16:19], v[72:75], v[40:43], a[16:19]
    v_mfma_f32_16x16x32_bf16 a[20:23], v[72:75], v[44:47], a[20:23]
    v_mfma_f32_16x16x32_bf16 a[24:27], v[72:75], v[48:51], a[24:27]
    v_mfma_f32_16x16x32_bf16 a[28:31], v[72:75], v[52:55], a[28:31]
    v_mfma_f32_16x16x32_bf16 a[32:35], v[76:79], v[24:27], a[32:35]
    v_mfma_f32_16x16x32_bf16 a[36:39], v[76:79], v[28:31], a[36:39]
    v_mfma_f32_16x16x32_bf16 a[40:43], v[76:79], v[32:35], a[40:43]
    v_mfma_f32_16x16x32_bf16 a[44:47], v[76:79], v[36:39], a[44:47]
    v_mfma_f32_16x16x32_bf16 a[48:51], v[76:79], v[40:43], a[48:51]
    v_mfma_f32_16x16x32_bf16 a[52:55], v[76:79], v[44:47], a[52:55]
    v_mfma_f32_16x16x32_bf16 a[56:59], v[76:79], v[48:51], a[56:59]
    v_mfma_f32_16x16x32_bf16 a[60:63], v[76:79], v[52:55], a[60:63]
    s_waitcnt lgkmcnt(0)
    ds_read_b64_tr_b16 v[24:25], v16 offset:24576
    ds_read_b64_tr_b16 v[26:27], v16 offset:25600
    ds_read_b64_tr_b16 v[28:29], v17 offset:24576
    ds_read_b64_tr_b16 v[30:31], v17 offset:25600
    ds_read_b64_tr_b16 v[32:33], v18 offset:24576
    ds_read_b64_tr_b16 v[34:35], v18 offset:25600
    ds_read_b64_tr_b16 v[36:37], v19 offset:24576
    ds_read_b64_tr_b16 v[38:39], v19 offset:25600
    ds_read_b64_tr_b16 v[40:41], v20 offset:24576
    ds_read_b64_tr_b16 v[42:43], v20 offset:25600
    ds_read_b64_tr_b16 v[44:45], v21 offset:24576
    ds_read_b64_tr_b16 v[46:47], v21 offset:25600
    ds_read_b64_tr_b16 v[48:49], v22 offset:24576
    ds_read_b64_tr_b16 v[50:51], v22 offset:25600
    ds_read_b64_tr_b16 v[52:53], v23 offset:24576
    ds_read_b64_tr_b16 v[54:55], v23 offset:25600
    v_mfma_f32_16x16x32_bf16 a[0:3], v[80:83], v[208:211], a[0:3]
    v_mfma_f32_16x16x32_bf16 a[4:7], v[80:83], v[212:215], a[4:7]
    v_mfma_f32_16x16x32_bf16 a[8:11], v[80:83], v[216:219], a[8:11]
    v_mfma_f32_16x16x32_bf16 a[12:15], v[80:83], v[220:223], a[12:15]
    v_mfma_f32_16x16x32_bf16 a[16:19], v[80:83], v[224:227], a[16:19]
    v_mfma_f32_16x16x32_bf16 a[20:23], v[80:83], v[228:231], a[20:23]
    v_mfma_f32_16x16x32_bf16 a[24:27], v[80:83], v[232:235], a[24:27]
    v_mfma_f32_16x16x32_bf16 a[28:31], v[80:83], v[236:239], a[28:31]
    v_mfma_f32_16x16x32_bf16 a[32:35], v[84:87], v[208:211], a[32:35]
    v_mfma_f32_16x16x32_bf16 a[36:39], v[84:87], v[212:215], a[36:39]
    v_mfma_f32_16x16x32_bf16 a[40:43], v[84:87], v[216:219], a[40:43]
    v_mfma_f32_16x16x32_bf16 a[44:47], v[84:87], v[220:223], a[44:47]
    v_mfma_f32_16x16x32_bf16 a[48:51], v[84:87], v[224:227], a[48:51]
    v_mfma_f32_16x16x32_bf16 a[52:55], v[84:87], v[228:231], a[52:55]
    v_mfma_f32_16x16x32_bf16 a[56:59], v[84:87], v[232:235], a[56:59]
    v_mfma_f32_16x16x32_bf16 a[60:63], v[84:87], v[236:239], a[60:63]
    s_waitcnt lgkmcnt(0)
    ds_read_b64_tr_b16 v[208:209], v16 offset:32768
    ds_read_b64_tr_b16 v[210:211], v16 offset:33792
    ds_read_b64_tr_b16 v[212:213], v17 offset:32768
    ds_read_b64_tr_b16 v[214:215], v17 offset:33792
    ds_read_b64_tr_b16 v[216:217], v18 offset:32768
    ds_read_b64_tr_b16 v[218:219], v18 offset:33792
    ds_read_b64_tr_b16 v[220:221], v19 offset:32768
    ds_read_b64_tr_b16 v[222:223], v19 offset:33792
    ds_read_b64_tr_b16 v[224:225], v20 offset:32768
    ds_read_b64_tr_b16 v[226:227], v20 offset:33792
    ds_read_b64_tr_b16 v[228:229], v21 offset:32768
    ds_read_b64_tr_b16 v[230:231], v21 offset:33792
    ds_read_b64_tr_b16 v[232:233], v22 offset:32768
    ds_read_b64_tr_b16 v[234:235], v22 offset:33792
    ds_read_b64_tr_b16 v[236:237], v23 offset:32768
    ds_read_b64_tr_b16 v[238:239], v23 offset:33792
    v_mfma_f32_16x16x32_bf16 a[0:3], v[88:91], v[24:27], a[0:3]
    v_mfma_f32_16x16x32_bf16 a[4:7], v[88:91], v[28:31], a[4:7]
    v_mfma_f32_16x16x32_bf16 a[8:11], v[88:91], v[32:35], a[8:11]
    v_mfma_f32_16x16x32_bf16 a[12:15], v[88:91], v[36:39], a[12:15]
    v_mfma_f32_16x16x32_bf16 a[16:19], v[88:91], v[40:43], a[16:19]
    v_mfma_f32_16x16x32_bf16 a[20:23], v[88:91], v[44:47], a[20:23]
    v_mfma_f32_16x16x32_bf16 a[24:27], v[88:91], v[48:51], a[24:27]
    v_mfma_f32_16x16x32_bf16 a[28:31], v[88:91], v[52:55], a[28:31]
    v_mfma_f32_16x16x32_bf16 a[32:35], v[92:95], v[24:27], a[32:35]
    v_mfma_f32_16x16x32_bf16 a[36:39], v[92:95], v[28:31], a[36:39]
    v_mfma_f32_16x16x32_bf16 a[40:43], v[92:95], v[32:35], a[40:43]
    v_mfma_f32_16x16x32_bf16 a[44:47], v[92:95], v[36:39], a[44:47]
    v_mfma_f32_16x16x32_bf16 a[48:51], v[92:95], v[40:43], a[48:51]
    v_mfma_f32_16x16x32_bf16 a[52:55], v[92:95], v[44:47], a[52:55]
    v_mfma_f32_16x16x32_bf16 a[56:59], v[92:95], v[48:51], a[56:59]
    v_mfma_f32_16x16x32_bf16 a[60:63], v[92:95], v[52:55], a[60:63]
    s_waitcnt lgkmcnt(0)
    ds_read_b64_tr_b16 v[24:25], v16 offset:40960
    ds_read_b64_tr_b16 v[26:27], v16 offset:41984
    ds_read_b64_tr_b16 v[28:29], v17 offset:40960
    ds_read_b64_tr_b16 v[30:31], v17 offset:41984
    ds_read_b64_tr_b16 v[32:33], v18 offset:40960
    ds_read_b64_tr_b16 v[34:35], v18 offset:41984
    ds_read_b64_tr_b16 v[36:37], v19 offset:40960
    ds_read_b64_tr_b16 v[38:39], v19 offset:41984
    ds_read_b64_tr_b16 v[40:41], v20 offset:40960
    ds_read_b64_tr_b16 v[42:43], v20 offset:41984
    ds_read_b64_tr_b16 v[44:45], v21 offset:40960
    ds_read_b64_tr_b16 v[46:47], v21 offset:41984
    ds_read_b64_tr_b16 v[48:49], v22 offset:40960
    ds_read_b64_tr_b16 v[50:51], v22 offset:41984
    ds_read_b64_tr_b16 v[52:53], v23 offset:40960
    ds_read_b64_tr_b16 v[54:55], v23 offset:41984
    v_mfma_f32_16x16x32_bf16 a[0:3], v[96:99], v[208:211], a[0:3]
    v_mfma_f32_16x16x32_bf16 a[4:7], v[96:99], v[212:215], a[4:7]
    v_mfma_f32_16x16x32_bf16 a[8:11], v[96:99], v[216:219], a[8:11]
    v_mfma_f32_16x16x32_bf16 a[12:15], v[96:99], v[220:223], a[12:15]
    v_mfma_f32_16x16x32_bf16 a[16:19], v[96:99], v[224:227], a[16:19]
    v_mfma_f32_16x16x32_bf16 a[20:23], v[96:99], v[228:231], a[20:23]
    v_mfma_f32_16x16x32_bf16 a[24:27], v[96:99], v[232:235], a[24:27]
    v_mfma_f32_16x16x32_bf16 a[28:31], v[96:99], v[236:239], a[28:31]
    v_mfma_f32_16x16x32_bf16 a[32:35], v[100:103], v[208:211], a[32:35]
    v_mfma_f32_16x16x32_bf16 a[36:39], v[100:103], v[212:215], a[36:39]
    v_mfma_f32_16x16x32_bf16 a[40:43], v[100:103], v[216:219], a[40:43]
    v_mfma_f32_16x16x32_bf16 a[44:47], v[100:103], v[220:223], a[44:47]
    v_mfma_f32_16x16x32_bf16 a[48:51], v[100:103], v[224:227], a[48:51]
    v_mfma_f32_16x16x32_bf16 a[52:55], v[100:103], v[228:231], a[52:55]
    v_mfma_f32_16x16x32_bf16 a[56:59], v[100:103], v[232:235], a[56:59]
    v_mfma_f32_16x16x32_bf16 a[60:63], v[100:103], v[236:239], a[60:63]
    s_waitcnt lgkmcnt(0)
    v_mfma_f32_16x16x32_bf16 a[0:3], v[104:107], v[24:27], a[0:3]
    v_mfma_f32_16x16x32_bf16 a[4:7], v[104:107], v[28:31], a[4:7]
    v_mfma_f32_16x16x32_bf16 a[8:11], v[104:107], v[32:35], a[8:11]
    v_mfma_f32_16x16x32_bf16 a[12:15], v[104:107], v[36:39], a[12:15]
    v_mfma_f32_16x16x32_bf16 a[16:19], v[104:107], v[40:43], a[16:19]
    v_mfma_f32_16x16x32_bf16 a[20:23], v[104:107], v[44:47], a[20:23]
    v_mfma_f32_16x16x32_bf16 a[24:27], v[104:107], v[48:51], a[24:27]
    v_mfma_f32_16x16x32_bf16 a[28:31], v[104:107], v[52:55], a[28:31]
    v_mfma_f32_16x16x32_bf16 a[32:35], v[108:111], v[24:27], a[32:35]
    v_mfma_f32_16x16x32_bf16 a[36:39], v[108:111], v[28:31], a[36:39]
    v_mfma_f32_16x16x32_bf16 a[40:43], v[108:111], v[32:35], a[40:43]
    v_mfma_f32_16x16x32_bf16 a[44:47], v[108:111], v[36:39], a[44:47]
    v_mfma_f32_16x16x32_bf16 a[48:51], v[108:111], v[40:43], a[48:51]
    v_mfma_f32_16x16x32_bf16 a[52:55], v[108:111], v[44:47], a[52:55]
    v_mfma_f32_16x16x32_bf16 a[56:59], v[108:111], v[48:51], a[56:59]
    v_mfma_f32_16x16x32_bf16 a[60:63], v[108:111], v[52:55], a[60:63]
    s_waitcnt vmcnt(12)
    s_barrier
    v_add_u32 v16, 49152, v16
    v_add_u32 v17, 49152, v17
    v_add_u32 v18, 49152, v18
    v_add_u32 v19, 49152, v19
    v_add_u32 v20, 49152, v20
    v_add_u32 v21, 49152, v21
    v_add_u32 v22, 49152, v22
    v_add_u32 v23, 49152, v23
    ds_read_b64_tr_b16 v[208:209], v16 offset:0
    ds_read_b64_tr_b16 v[210:211], v16 offset:1024
    ds_read_b64_tr_b16 v[212:213], v17 offset:0
    ds_read_b64_tr_b16 v[214:215], v17 offset:1024
    ds_read_b64_tr_b16 v[216:217], v18 offset:0
    ds_read_b64_tr_b16 v[218:219], v18 offset:1024
    ds_read_b64_tr_b16 v[220:221], v19 offset:0
    ds_read_b64_tr_b16 v[222:223], v19 offset:1024
    ds_read_b64_tr_b16 v[224:225], v20 offset:0
    ds_read_b64_tr_b16 v[226:227], v20 offset:1024
    ds_read_b64_tr_b16 v[228:229], v21 offset:0
    ds_read_b64_tr_b16 v[230:231], v21 offset:1024
    ds_read_b64_tr_b16 v[232:233], v22 offset:0
    ds_read_b64_tr_b16 v[234:235], v22 offset:1024
    ds_read_b64_tr_b16 v[236:237], v23 offset:0
    ds_read_b64_tr_b16 v[238:239], v23 offset:1024
    s_waitcnt lgkmcnt(0)
    ds_read_b64_tr_b16 v[24:25], v16 offset:8192
    ds_read_b64_tr_b16 v[26:27], v16 offset:9216
    ds_read_b64_tr_b16 v[28:29], v17 offset:8192
    ds_read_b64_tr_b16 v[30:31], v17 offset:9216
    ds_read_b64_tr_b16 v[32:33], v18 offset:8192
    ds_read_b64_tr_b16 v[34:35], v18 offset:9216
    ds_read_b64_tr_b16 v[36:37], v19 offset:8192
    ds_read_b64_tr_b16 v[38:39], v19 offset:9216
    ds_read_b64_tr_b16 v[40:41], v20 offset:8192
    ds_read_b64_tr_b16 v[42:43], v20 offset:9216
    ds_read_b64_tr_b16 v[44:45], v21 offset:8192
    ds_read_b64_tr_b16 v[46:47], v21 offset:9216
    ds_read_b64_tr_b16 v[48:49], v22 offset:8192
    ds_read_b64_tr_b16 v[50:51], v22 offset:9216
    ds_read_b64_tr_b16 v[52:53], v23 offset:8192
    ds_read_b64_tr_b16 v[54:55], v23 offset:9216
    v_mfma_f32_16x16x32_bf16 a[0:3], v[112:115], v[208:211], a[0:3]
    v_mfma_f32_16x16x32_bf16 a[4:7], v[112:115], v[212:215], a[4:7]
    v_mfma_f32_16x16x32_bf16 a[8:11], v[112:115], v[216:219], a[8:11]
    v_mfma_f32_16x16x32_bf16 a[12:15], v[112:115], v[220:223], a[12:15]
    v_mfma_f32_16x16x32_bf16 a[16:19], v[112:115], v[224:227], a[16:19]
    v_mfma_f32_16x16x32_bf16 a[20:23], v[112:115], v[228:231], a[20:23]
    v_mfma_f32_16x16x32_bf16 a[24:27], v[112:115], v[232:235], a[24:27]
    v_mfma_f32_16x16x32_bf16 a[28:31], v[112:115], v[236:239], a[28:31]
    v_mfma_f32_16x16x32_bf16 a[32:35], v[116:119], v[208:211], a[32:35]
    v_mfma_f32_16x16x32_bf16 a[36:39], v[116:119], v[212:215], a[36:39]
    v_mfma_f32_16x16x32_bf16 a[40:43], v[116:119], v[216:219], a[40:43]
    v_mfma_f32_16x16x32_bf16 a[44:47], v[116:119], v[220:223], a[44:47]
    v_mfma_f32_16x16x32_bf16 a[48:51], v[116:119], v[224:227], a[48:51]
    v_mfma_f32_16x16x32_bf16 a[52:55], v[116:119], v[228:231], a[52:55]
    v_mfma_f32_16x16x32_bf16 a[56:59], v[116:119], v[232:235], a[56:59]
    v_mfma_f32_16x16x32_bf16 a[60:63], v[116:119], v[236:239], a[60:63]
    s_waitcnt lgkmcnt(0)
    ds_read_b64_tr_b16 v[208:209], v16 offset:16384
    ds_read_b64_tr_b16 v[210:211], v16 offset:17408
    ds_read_b64_tr_b16 v[212:213], v17 offset:16384
    ds_read_b64_tr_b16 v[214:215], v17 offset:17408
    ds_read_b64_tr_b16 v[216:217], v18 offset:16384
    ds_read_b64_tr_b16 v[218:219], v18 offset:17408
    ds_read_b64_tr_b16 v[220:221], v19 offset:16384
    ds_read_b64_tr_b16 v[222:223], v19 offset:17408
    ds_read_b64_tr_b16 v[224:225], v20 offset:16384
    ds_read_b64_tr_b16 v[226:227], v20 offset:17408
    ds_read_b64_tr_b16 v[228:229], v21 offset:16384
    ds_read_b64_tr_b16 v[230:231], v21 offset:17408
    ds_read_b64_tr_b16 v[232:233], v22 offset:16384
    ds_read_b64_tr_b16 v[234:235], v22 offset:17408
    ds_read_b64_tr_b16 v[236:237], v23 offset:16384
    ds_read_b64_tr_b16 v[238:239], v23 offset:17408
    v_mfma_f32_16x16x32_bf16 a[0:3], v[120:123], v[24:27], a[0:3]
    v_mfma_f32_16x16x32_bf16 a[4:7], v[120:123], v[28:31], a[4:7]
    v_mfma_f32_16x16x32_bf16 a[8:11], v[120:123], v[32:35], a[8:11]
    v_mfma_f32_16x16x32_bf16 a[12:15], v[120:123], v[36:39], a[12:15]
    v_mfma_f32_16x16x32_bf16 a[16:19], v[120:123], v[40:43], a[16:19]
    v_mfma_f32_16x16x32_bf16 a[20:23], v[120:123], v[44:47], a[20:23]
    v_mfma_f32_16x16x32_bf16 a[24:27], v[120:123], v[48:51], a[24:27]
    v_mfma_f32_16x16x32_bf16 a[28:31], v[120:123], v[52:55], a[28:31]
    v_mfma_f32_16x16x32_bf16 a[32:35], v[124:127], v[24:27], a[32:35]
    v_mfma_f32_16x16x32_bf16 a[36:39], v[124:127], v[28:31], a[36:39]
    v_mfma_f32_16x16x32_bf16 a[40:43], v[124:127], v[32:35], a[40:43]
    v_mfma_f32_16x16x32_bf16 a[44:47], v[124:127], v[36:39], a[44:47]
    v_mfma_f32_16x16x32_bf16 a[48:51], v[124:127], v[40:43], a[48:51]
    v_mfma_f32_16x16x32_bf16 a[52:55], v[124:127], v[44:47], a[52:55]
    v_mfma_f32_16x16x32_bf16 a[56:59], v[124:127], v[48:51], a[56:59]
    v_mfma_f32_16x16x32_bf16 a[60:63], v[124:127], v[52:55], a[60:63]
    s_waitcnt lgkmcnt(0)
    ds_read_b64_tr_b16 v[24:25], v16 offset:24576
    ds_read_b64_tr_b16 v[26:27], v16 offset:25600
    ds_read_b64_tr_b16 v[28:29], v17 offset:24576
    ds_read_b64_tr_b16 v[30:31], v17 offset:25600
    ds_read_b64_tr_b16 v[32:33], v18 offset:24576
    ds_read_b64_tr_b16 v[34:35], v18 offset:25600
    ds_read_b64_tr_b16 v[36:37], v19 offset:24576
    ds_read_b64_tr_b16 v[38:39], v19 offset:25600
    ds_read_b64_tr_b16 v[40:41], v20 offset:24576
    ds_read_b64_tr_b16 v[42:43], v20 offset:25600
    ds_read_b64_tr_b16 v[44:45], v21 offset:24576
    ds_read_b64_tr_b16 v[46:47], v21 offset:25600
    ds_read_b64_tr_b16 v[48:49], v22 offset:24576
    ds_read_b64_tr_b16 v[50:51], v22 offset:25600
    ds_read_b64_tr_b16 v[52:53], v23 offset:24576
    ds_read_b64_tr_b16 v[54:55], v23 offset:25600
    v_mfma_f32_16x16x32_bf16 a[0:3], v[128:131], v[208:211], a[0:3]
    v_mfma_f32_16x16x32_bf16 a[4:7], v[128:131], v[212:215], a[4:7]
    v_mfma_f32_16x16x32_bf16 a[8:11], v[128:131], v[216:219], a[8:11]
    v_mfma_f32_16x16x32_bf16 a[12:15], v[128:131], v[220:223], a[12:15]
    v_mfma_f32_16x16x32_bf16 a[16:19], v[128:131], v[224:227], a[16:19]
    v_mfma_f32_16x16x32_bf16 a[20:23], v[128:131], v[228:231], a[20:23]
    v_mfma_f32_16x16x32_bf16 a[24:27], v[128:131], v[232:235], a[24:27]
    v_mfma_f32_16x16x32_bf16 a[28:31], v[128:131], v[236:239], a[28:31]
    v_mfma_f32_16x16x32_bf16 a[32:35], v[132:135], v[208:211], a[32:35]
    v_mfma_f32_16x16x32_bf16 a[36:39], v[132:135], v[212:215], a[36:39]
    v_mfma_f32_16x16x32_bf16 a[40:43], v[132:135], v[216:219], a[40:43]
    v_mfma_f32_16x16x32_bf16 a[44:47], v[132:135], v[220:223], a[44:47]
    v_mfma_f32_16x16x32_bf16 a[48:51], v[132:135], v[224:227], a[48:51]
    v_mfma_f32_16x16x32_bf16 a[52:55], v[132:135], v[228:231], a[52:55]
    v_mfma_f32_16x16x32_bf16 a[56:59], v[132:135], v[232:235], a[56:59]
    v_mfma_f32_16x16x32_bf16 a[60:63], v[132:135], v[236:239], a[60:63]
    s_waitcnt lgkmcnt(0)
    ds_read_b64_tr_b16 v[208:209], v16 offset:32768
    ds_read_b64_tr_b16 v[210:211], v16 offset:33792
    ds_read_b64_tr_b16 v[212:213], v17 offset:32768
    ds_read_b64_tr_b16 v[214:215], v17 offset:33792
    ds_read_b64_tr_b16 v[216:217], v18 offset:32768
    ds_read_b64_tr_b16 v[218:219], v18 offset:33792
    ds_read_b64_tr_b16 v[220:221], v19 offset:32768
    ds_read_b64_tr_b16 v[222:223], v19 offset:33792
    ds_read_b64_tr_b16 v[224:225], v20 offset:32768
    ds_read_b64_tr_b16 v[226:227], v20 offset:33792
    ds_read_b64_tr_b16 v[228:229], v21 offset:32768
    ds_read_b64_tr_b16 v[230:231], v21 offset:33792
    ds_read_b64_tr_b16 v[232:233], v22 offset:32768
    ds_read_b64_tr_b16 v[234:235], v22 offset:33792
    ds_read_b64_tr_b16 v[236:237], v23 offset:32768
    ds_read_b64_tr_b16 v[238:239], v23 offset:33792
    v_mfma_f32_16x16x32_bf16 a[0:3], v[136:139], v[24:27], a[0:3]
    v_mfma_f32_16x16x32_bf16 a[4:7], v[136:139], v[28:31], a[4:7]
    v_mfma_f32_16x16x32_bf16 a[8:11], v[136:139], v[32:35], a[8:11]
    v_mfma_f32_16x16x32_bf16 a[12:15], v[136:139], v[36:39], a[12:15]
    v_mfma_f32_16x16x32_bf16 a[16:19], v[136:139], v[40:43], a[16:19]
    v_mfma_f32_16x16x32_bf16 a[20:23], v[136:139], v[44:47], a[20:23]
    v_mfma_f32_16x16x32_bf16 a[24:27], v[136:139], v[48:51], a[24:27]
    v_mfma_f32_16x16x32_bf16 a[28:31], v[136:139], v[52:55], a[28:31]
    v_mfma_f32_16x16x32_bf16 a[32:35], v[140:143], v[24:27], a[32:35]
    v_mfma_f32_16x16x32_bf16 a[36:39], v[140:143], v[28:31], a[36:39]
    v_mfma_f32_16x16x32_bf16 a[40:43], v[140:143], v[32:35], a[40:43]
    v_mfma_f32_16x16x32_bf16 a[44:47], v[140:143], v[36:39], a[44:47]
    v_mfma_f32_16x16x32_bf16 a[48:51], v[140:143], v[40:43], a[48:51]
    v_mfma_f32_16x16x32_bf16 a[52:55], v[140:143], v[44:47], a[52:55]
    v_mfma_f32_16x16x32_bf16 a[56:59], v[140:143], v[48:51], a[56:59]
    v_mfma_f32_16x16x32_bf16 a[60:63], v[140:143], v[52:55], a[60:63]
    s_waitcnt lgkmcnt(0)
    ds_read_b64_tr_b16 v[24:25], v16 offset:40960
    ds_read_b64_tr_b16 v[26:27], v16 offset:41984
    ds_read_b64_tr_b16 v[28:29], v17 offset:40960
    ds_read_b64_tr_b16 v[30:31], v17 offset:41984
    ds_read_b64_tr_b16 v[32:33], v18 offset:40960
    ds_read_b64_tr_b16 v[34:35], v18 offset:41984
    ds_read_b64_tr_b16 v[36:37], v19 offset:40960
    ds_read_b64_tr_b16 v[38:39], v19 offset:41984
    ds_read_b64_tr_b16 v[40:41], v20 offset:40960
    ds_read_b64_tr_b16 v[42:43], v20 offset:41984
    ds_read_b64_tr_b16 v[44:45], v21 offset:40960
    ds_read_b64_tr_b16 v[46:47], v21 offset:41984
    ds_read_b64_tr_b16 v[48:49], v22 offset:40960
    ds_read_b64_tr_b16 v[50:51], v22 offset:41984
    ds_read_b64_tr_b16 v[52:53], v23 offset:40960
    ds_read_b64_tr_b16 v[54:55], v23 offset:41984
    v_mfma_f32_16x16x32_bf16 a[0:3], v[144:147], v[208:211], a[0:3]
    v_mfma_f32_16x16x32_bf16 a[4:7], v[144:147], v[212:215], a[4:7]
    v_mfma_f32_16x16x32_bf16 a[8:11], v[144:147], v[216:219], a[8:11]
    v_mfma_f32_16x16x32_bf16 a[12:15], v[144:147], v[220:223], a[12:15]
    v_mfma_f32_16x16x32_bf16 a[16:19], v[144:147], v[224:227], a[16:19]
    v_mfma_f32_16x16x32_bf16 a[20:23], v[144:147], v[228:231], a[20:23]
    v_mfma_f32_16x16x32_bf16 a[24:27], v[144:147], v[232:235], a[24:27]
    v_mfma_f32_16x16x32_bf16 a[28:31], v[144:147], v[236:239], a[28:31]
    v_mfma_f32_16x16x32_bf16 a[32:35], v[148:151], v[208:211], a[32:35]
    v_mfma_f32_16x16x32_bf16 a[36:39], v[148:151], v[212:215], a[36:39]
    v_mfma_f32_16x16x32_bf16 a[40:43], v[148:151], v[216:219], a[40:43]
    v_mfma_f32_16x16x32_bf16 a[44:47], v[148:151], v[220:223], a[44:47]
    v_mfma_f32_16x16x32_bf16 a[48:51], v[148:151], v[224:227], a[48:51]
    v_mfma_f32_16x16x32_bf16 a[52:55], v[148:151], v[228:231], a[52:55]
    v_mfma_f32_16x16x32_bf16 a[56:59], v[148:151], v[232:235], a[56:59]
    v_mfma_f32_16x16x32_bf16 a[60:63], v[148:151], v[236:239], a[60:63]
    s_waitcnt lgkmcnt(0)
    v_mfma_f32_16x16x32_bf16 a[0:3], v[152:155], v[24:27], a[0:3]
    v_mfma_f32_16x16x32_bf16 a[4:7], v[152:155], v[28:31], a[4:7]
    v_mfma_f32_16x16x32_bf16 a[8:11], v[152:155], v[32:35], a[8:11]
    v_mfma_f32_16x16x32_bf16 a[12:15], v[152:155], v[36:39], a[12:15]
    v_mfma_f32_16x16x32_bf16 a[16:19], v[152:155], v[40:43], a[16:19]
    v_mfma_f32_16x16x32_bf16 a[20:23], v[152:155], v[44:47], a[20:23]
    v_mfma_f32_16x16x32_bf16 a[24:27], v[152:155], v[48:51], a[24:27]
    v_mfma_f32_16x16x32_bf16 a[28:31], v[152:155], v[52:55], a[28:31]
    v_mfma_f32_16x16x32_bf16 a[32:35], v[156:159], v[24:27], a[32:35]
    v_mfma_f32_16x16x32_bf16 a[36:39], v[156:159], v[28:31], a[36:39]
    v_mfma_f32_16x16x32_bf16 a[40:43], v[156:159], v[32:35], a[40:43]
    v_mfma_f32_16x16x32_bf16 a[44:47], v[156:159], v[36:39], a[44:47]
    v_mfma_f32_16x16x32_bf16 a[48:51], v[156:159], v[40:43], a[48:51]
    v_mfma_f32_16x16x32_bf16 a[52:55], v[156:159], v[44:47], a[52:55]
    v_mfma_f32_16x16x32_bf16 a[56:59], v[156:159], v[48:51], a[56:59]
    v_mfma_f32_16x16x32_bf16 a[60:63], v[156:159], v[52:55], a[60:63]
    s_waitcnt vmcnt(0)
    s_barrier
    v_add_u32 v16, 49152, v16
    v_add_u32 v17, 49152, v17
    v_add_u32 v18, 49152, v18
    v_add_u32 v19, 49152, v19
    v_add_u32 v20, 49152, v20
    v_add_u32 v21, 49152, v21
    v_add_u32 v22, 49152, v22
    v_add_u32 v23, 49152, v23
    ds_read_b64_tr_b16 v[208:209], v16 offset:0
    ds_read_b64_tr_b16 v[210:211], v16 offset:1024
    ds_read_b64_tr_b16 v[212:213], v17 offset:0
    ds_read_b64_tr_b16 v[214:215], v17 offset:1024
    ds_read_b64_tr_b16 v[216:217], v18 offset:0
    ds_read_b64_tr_b16 v[218:219], v18 offset:1024
    ds_read_b64_tr_b16 v[220:221], v19 offset:0
    ds_read_b64_tr_b16 v[222:223], v19 offset:1024
    ds_read_b64_tr_b16 v[224:225], v20 offset:0
    ds_read_b64_tr_b16 v[226:227], v20 offset:1024
    ds_read_b64_tr_b16 v[228:229], v21 offset:0
    ds_read_b64_tr_b16 v[230:231], v21 offset:1024
    ds_read_b64_tr_b16 v[232:233], v22 offset:0
    ds_read_b64_tr_b16 v[234:235], v22 offset:1024
    ds_read_b64_tr_b16 v[236:237], v23 offset:0
    ds_read_b64_tr_b16 v[238:239], v23 offset:1024
    s_waitcnt lgkmcnt(0)
    ds_read_b64_tr_b16 v[24:25], v16 offset:8192
    ds_read_b64_tr_b16 v[26:27], v16 offset:9216
    ds_read_b64_tr_b16 v[28:29], v17 offset:8192
    ds_read_b64_tr_b16 v[30:31], v17 offset:9216
    ds_read_b64_tr_b16 v[32:33], v18 offset:8192
    ds_read_b64_tr_b16 v[34:35], v18 offset:9216
    ds_read_b64_tr_b16 v[36:37], v19 offset:8192
    ds_read_b64_tr_b16 v[38:39], v19 offset:9216
    ds_read_b64_tr_b16 v[40:41], v20 offset:8192
    ds_read_b64_tr_b16 v[42:43], v20 offset:9216
    ds_read_b64_tr_b16 v[44:45], v21 offset:8192
    ds_read_b64_tr_b16 v[46:47], v21 offset:9216
    ds_read_b64_tr_b16 v[48:49], v22 offset:8192
    ds_read_b64_tr_b16 v[50:51], v22 offset:9216
    ds_read_b64_tr_b16 v[52:53], v23 offset:8192
    ds_read_b64_tr_b16 v[54:55], v23 offset:9216
    v_mfma_f32_16x16x32_bf16 a[0:3], v[160:163], v[208:211], a[0:3]
    v_mfma_f32_16x16x32_bf16 a[4:7], v[160:163], v[212:215], a[4:7]
    v_mfma_f32_16x16x32_bf16 a[8:11], v[160:163], v[216:219], a[8:11]
    v_mfma_f32_16x16x32_bf16 a[12:15], v[160:163], v[220:223], a[12:15]
    v_mfma_f32_16x16x32_bf16 a[16:19], v[160:163], v[224:227], a[16:19]
    v_mfma_f32_16x16x32_bf16 a[20:23], v[160:163], v[228:231], a[20:23]
    v_mfma_f32_16x16x32_bf16 a[24:27], v[160:163], v[232:235], a[24:27]
    v_mfma_f32_16x16x32_bf16 a[28:31], v[160:163], v[236:239], a[28:31]
    v_mfma_f32_16x16x32_bf16 a[32:35], v[164:167], v[208:211], a[32:35]
    v_mfma_f32_16x16x32_bf16 a[36:39], v[164:167], v[212:215], a[36:39]
    v_mfma_f32_16x16x32_bf16 a[40:43], v[164:167], v[216:219], a[40:43]
    v_mfma_f32_16x16x32_bf16 a[44:47], v[164:167], v[220:223], a[44:47]
    v_mfma_f32_16x16x32_bf16 a[48:51], v[164:167], v[224:227], a[48:51]
    v_mfma_f32_16x16x32_bf16 a[52:55], v[164:167], v[228:231], a[52:55]
    v_mfma_f32_16x16x32_bf16 a[56:59], v[164:167], v[232:235], a[56:59]
    v_mfma_f32_16x16x32_bf16 a[60:63], v[164:167], v[236:239], a[60:63]
    s_waitcnt lgkmcnt(0)
    ds_read_b64_tr_b16 v[208:209], v16 offset:16384
    ds_read_b64_tr_b16 v[210:211], v16 offset:17408
    ds_read_b64_tr_b16 v[212:213], v17 offset:16384
    ds_read_b64_tr_b16 v[214:215], v17 offset:17408
    ds_read_b64_tr_b16 v[216:217], v18 offset:16384
    ds_read_b64_tr_b16 v[218:219], v18 offset:17408
    ds_read_b64_tr_b16 v[220:221], v19 offset:16384
    ds_read_b64_tr_b16 v[222:223], v19 offset:17408
    ds_read_b64_tr_b16 v[224:225], v20 offset:16384
    ds_read_b64_tr_b16 v[226:227], v20 offset:17408
    ds_read_b64_tr_b16 v[228:229], v21 offset:16384
    ds_read_b64_tr_b16 v[230:231], v21 offset:17408
    ds_read_b64_tr_b16 v[232:233], v22 offset:16384
    ds_read_b64_tr_b16 v[234:235], v22 offset:17408
    ds_read_b64_tr_b16 v[236:237], v23 offset:16384
    ds_read_b64_tr_b16 v[238:239], v23 offset:17408
    v_mfma_f32_16x16x32_bf16 a[0:3], v[168:171], v[24:27], a[0:3]
    v_mfma_f32_16x16x32_bf16 a[4:7], v[168:171], v[28:31], a[4:7]
    v_mfma_f32_16x16x32_bf16 a[8:11], v[168:171], v[32:35], a[8:11]
    v_mfma_f32_16x16x32_bf16 a[12:15], v[168:171], v[36:39], a[12:15]
    v_mfma_f32_16x16x32_bf16 a[16:19], v[168:171], v[40:43], a[16:19]
    v_mfma_f32_16x16x32_bf16 a[20:23], v[168:171], v[44:47], a[20:23]
    v_mfma_f32_16x16x32_bf16 a[24:27], v[168:171], v[48:51], a[24:27]
    v_mfma_f32_16x16x32_bf16 a[28:31], v[168:171], v[52:55], a[28:31]
    v_mfma_f32_16x16x32_bf16 a[32:35], v[172:175], v[24:27], a[32:35]
    v_mfma_f32_16x16x32_bf16 a[36:39], v[172:175], v[28:31], a[36:39]
    v_mfma_f32_16x16x32_bf16 a[40:43], v[172:175], v[32:35], a[40:43]
    v_mfma_f32_16x16x32_bf16 a[44:47], v[172:175], v[36:39], a[44:47]
    v_mfma_f32_16x16x32_bf16 a[48:51], v[172:175], v[40:43], a[48:51]
    v_mfma_f32_16x16x32_bf16 a[52:55], v[172:175], v[44:47], a[52:55]
    v_mfma_f32_16x16x32_bf16 a[56:59], v[172:175], v[48:51], a[56:59]
    v_mfma_f32_16x16x32_bf16 a[60:63], v[172:175], v[52:55], a[60:63]
    s_waitcnt lgkmcnt(0)
    ds_read_b64_tr_b16 v[24:25], v16 offset:24576
    ds_read_b64_tr_b16 v[26:27], v16 offset:25600
    ds_read_b64_tr_b16 v[28:29], v17 offset:24576
    ds_read_b64_tr_b16 v[30:31], v17 offset:25600
    ds_read_b64_tr_b16 v[32:33], v18 offset:24576
    ds_read_b64_tr_b16 v[34:35], v18 offset:25600
    ds_read_b64_tr_b16 v[36:37], v19 offset:24576
    ds_read_b64_tr_b16 v[38:39], v19 offset:25600
    ds_read_b64_tr_b16 v[40:41], v20 offset:24576
    ds_read_b64_tr_b16 v[42:43], v20 offset:25600
    ds_read_b64_tr_b16 v[44:45], v21 offset:24576
    ds_read_b64_tr_b16 v[46:47], v21 offset:25600
    ds_read_b64_tr_b16 v[48:49], v22 offset:24576
    ds_read_b64_tr_b16 v[50:51], v22 offset:25600
    ds_read_b64_tr_b16 v[52:53], v23 offset:24576
    ds_read_b64_tr_b16 v[54:55], v23 offset:25600
    v_mfma_f32_16x16x32_bf16 a[0:3], v[176:179], v[208:211], a[0:3]
    v_mfma_f32_16x16x32_bf16 a[4:7], v[176:179], v[212:215], a[4:7]
    v_mfma_f32_16x16x32_bf16 a[8:11], v[176:179], v[216:219], a[8:11]
    v_mfma_f32_16x16x32_bf16 a[12:15], v[176:179], v[220:223], a[12:15]
    v_mfma_f32_16x16x32_bf16 a[16:19], v[176:179], v[224:227], a[16:19]
    v_mfma_f32_16x16x32_bf16 a[20:23], v[176:179], v[228:231], a[20:23]
    v_mfma_f32_16x16x32_bf16 a[24:27], v[176:179], v[232:235], a[24:27]
    v_mfma_f32_16x16x32_bf16 a[28:31], v[176:179], v[236:239], a[28:31]
    v_mfma_f32_16x16x32_bf16 a[32:35], v[180:183], v[208:211], a[32:35]
    v_mfma_f32_16x16x32_bf16 a[36:39], v[180:183], v[212:215], a[36:39]
    v_mfma_f32_16x16x32_bf16 a[40:43], v[180:183], v[216:219], a[40:43]
    v_mfma_f32_16x16x32_bf16 a[44:47], v[180:183], v[220:223], a[44:47]
    v_mfma_f32_16x16x32_bf16 a[48:51], v[180:183], v[224:227], a[48:51]
    v_mfma_f32_16x16x32_bf16 a[52:55], v[180:183], v[228:231], a[52:55]
    v_mfma_f32_16x16x32_bf16 a[56:59], v[180:183], v[232:235], a[56:59]
    v_mfma_f32_16x16x32_bf16 a[60:63], v[180:183], v[236:239], a[60:63]
    s_waitcnt lgkmcnt(0)
    ds_read_b64_tr_b16 v[208:209], v16 offset:32768
    ds_read_b64_tr_b16 v[210:211], v16 offset:33792
    ds_read_b64_tr_b16 v[212:213], v17 offset:32768
    ds_read_b64_tr_b16 v[214:215], v17 offset:33792
    ds_read_b64_tr_b16 v[216:217], v18 offset:32768
    ds_read_b64_tr_b16 v[218:219], v18 offset:33792
    ds_read_b64_tr_b16 v[220:221], v19 offset:32768
    ds_read_b64_tr_b16 v[222:223], v19 offset:33792
    ds_read_b64_tr_b16 v[224:225], v20 offset:32768
    ds_read_b64_tr_b16 v[226:227], v20 offset:33792
    ds_read_b64_tr_b16 v[228:229], v21 offset:32768
    ds_read_b64_tr_b16 v[230:231], v21 offset:33792
    ds_read_b64_tr_b16 v[232:233], v22 offset:32768
    ds_read_b64_tr_b16 v[234:235], v22 offset:33792
    ds_read_b64_tr_b16 v[236:237], v23 offset:32768
    ds_read_b64_tr_b16 v[238:239], v23 offset:33792
    v_mfma_f32_16x16x32_bf16 a[0:3], v[184:187], v[24:27], a[0:3]
    v_mfma_f32_16x16x32_bf16 a[4:7], v[184:187], v[28:31], a[4:7]
    v_mfma_f32_16x16x32_bf16 a[8:11], v[184:187], v[32:35], a[8:11]
    v_mfma_f32_16x16x32_bf16 a[12:15], v[184:187], v[36:39], a[12:15]
    v_mfma_f32_16x16x32_bf16 a[16:19], v[184:187], v[40:43], a[16:19]
    v_mfma_f32_16x16x32_bf16 a[20:23], v[184:187], v[44:47], a[20:23]
    v_mfma_f32_16x16x32_bf16 a[24:27], v[184:187], v[48:51], a[24:27]
    v_mfma_f32_16x16x32_bf16 a[28:31], v[184:187], v[52:55], a[28:31]
    v_mfma_f32_16x16x32_bf16 a[32:35], v[188:191], v[24:27], a[32:35]
    v_mfma_f32_16x16x32_bf16 a[36:39], v[188:191], v[28:31], a[36:39]
    v_mfma_f32_16x16x32_bf16 a[40:43], v[188:191], v[32:35], a[40:43]
    v_mfma_f32_16x16x32_bf16 a[44:47], v[188:191], v[36:39], a[44:47]
    v_mfma_f32_16x16x32_bf16 a[48:51], v[188:191], v[40:43], a[48:51]
    v_mfma_f32_16x16x32_bf16 a[52:55], v[188:191], v[44:47], a[52:55]
    v_mfma_f32_16x16x32_bf16 a[56:59], v[188:191], v[48:51], a[56:59]
    v_mfma_f32_16x16x32_bf16 a[60:63], v[188:191], v[52:55], a[60:63]
    s_waitcnt lgkmcnt(0)
    ds_read_b64_tr_b16 v[24:25], v16 offset:40960
    ds_read_b64_tr_b16 v[26:27], v16 offset:41984
    ds_read_b64_tr_b16 v[28:29], v17 offset:40960
    ds_read_b64_tr_b16 v[30:31], v17 offset:41984
    ds_read_b64_tr_b16 v[32:33], v18 offset:40960
    ds_read_b64_tr_b16 v[34:35], v18 offset:41984
    ds_read_b64_tr_b16 v[36:37], v19 offset:40960
    ds_read_b64_tr_b16 v[38:39], v19 offset:41984
    ds_read_b64_tr_b16 v[40:41], v20 offset:40960
    ds_read_b64_tr_b16 v[42:43], v20 offset:41984
    ds_read_b64_tr_b16 v[44:45], v21 offset:40960
    ds_read_b64_tr_b16 v[46:47], v21 offset:41984
    ds_read_b64_tr_b16 v[48:49], v22 offset:40960
    ds_read_b64_tr_b16 v[50:51], v22 offset:41984
    ds_read_b64_tr_b16 v[52:53], v23 offset:40960
    ds_read_b64_tr_b16 v[54:55], v23 offset:41984
    v_mfma_f32_16x16x32_bf16 a[0:3], v[192:195], v[208:211], a[0:3]
    v_mfma_f32_16x16x32_bf16 a[4:7], v[192:195], v[212:215], a[4:7]
    v_mfma_f32_16x16x32_bf16 a[8:11], v[192:195], v[216:219], a[8:11]
    v_mfma_f32_16x16x32_bf16 a[12:15], v[192:195], v[220:223], a[12:15]
    v_mfma_f32_16x16x32_bf16 a[16:19], v[192:195], v[224:227], a[16:19]
    v_mfma_f32_16x16x32_bf16 a[20:23], v[192:195], v[228:231], a[20:23]
    v_mfma_f32_16x16x32_bf16 a[24:27], v[192:195], v[232:235], a[24:27]
    v_mfma_f32_16x16x32_bf16 a[28:31], v[192:195], v[236:239], a[28:31]
    v_mfma_f32_16x16x32_bf16 a[32:35], v[196:199], v[208:211], a[32:35]
    v_mfma_f32_16x16x32_bf16 a[36:39], v[196:199], v[212:215], a[36:39]
    v_mfma_f32_16x16x32_bf16 a[40:43], v[196:199], v[216:219], a[40:43]
    v_mfma_f32_16x16x32_bf16 a[44:47], v[196:199], v[220:223], a[44:47]
    v_mfma_f32_16x16x32_bf16 a[48:51], v[196:199], v[224:227], a[48:51]
    v_mfma_f32_16x16x32_bf16 a[52:55], v[196:199], v[228:231], a[52:55]
    v_mfma_f32_16x16x32_bf16 a[56:59], v[196:199], v[232:235], a[56:59]
    v_mfma_f32_16x16x32_bf16 a[60:63], v[196:199], v[236:239], a[60:63]
    s_waitcnt lgkmcnt(0)
    v_mfma_f32_16x16x32_bf16 a[0:3], v[200:203], v[24:27], a[0:3]
    v_mfma_f32_16x16x32_bf16 a[4:7], v[200:203], v[28:31], a[4:7]
    v_mfma_f32_16x16x32_bf16 a[8:11], v[200:203], v[32:35], a[8:11]
    v_mfma_f32_16x16x32_bf16 a[12:15], v[200:203], v[36:39], a[12:15]
    v_mfma_f32_16x16x32_bf16 a[16:19], v[200:203], v[40:43], a[16:19]
    v_mfma_f32_16x16x32_bf16 a[20:23], v[200:203], v[44:47], a[20:23]
    v_mfma_f32_16x16x32_bf16 a[24:27], v[200:203], v[48:51], a[24:27]
    v_mfma_f32_16x16x32_bf16 a[28:31], v[200:203], v[52:55], a[28:31]
    v_mfma_f32_16x16x32_bf16 a[32:35], v[204:207], v[24:27], a[32:35]
    v_mfma_f32_16x16x32_bf16 a[36:39], v[204:207], v[28:31], a[36:39]
    v_mfma_f32_16x16x32_bf16 a[40:43], v[204:207], v[32:35], a[40:43]
    v_mfma_f32_16x16x32_bf16 a[44:47], v[204:207], v[36:39], a[44:47]
    v_mfma_f32_16x16x32_bf16 a[48:51], v[204:207], v[40:43], a[48:51]
    v_mfma_f32_16x16x32_bf16 a[52:55], v[204:207], v[44:47], a[52:55]
    v_mfma_f32_16x16x32_bf16 a[56:59], v[204:207], v[48:51], a[56:59]
    v_mfma_f32_16x16x32_bf16 a[60:63], v[204:207], v[52:55], a[60:63]
    s_mul_i32 s33, s30, 65
    s_add_u32 s33, s33, s32
    s_lshl_b32 s33, s33, 14
    s_add_u32 s33, s33, 16785408
    s_add_u32 s34, s33, 4096
    s_nop 3
    v_accvgpr_read_b32 v64, a0
    v_accvgpr_read_b32 v68, a32
    v_accvgpr_read_b32 v65, a1
    v_accvgpr_read_b32 v69, a33
    v_accvgpr_read_b32 v66, a2
    v_accvgpr_read_b32 v70, a34
    v_accvgpr_read_b32 v67, a3
    v_accvgpr_read_b32 v71, a35
    v_cvt_pk_bf16_f32 v72, v64, v65
    v_cvt_pk_bf16_f32 v73, v66, v67
    v_cvt_pk_bf16_f32 v74, v68, v69
    v_cvt_pk_bf16_f32 v75, v70, v71
    buffer_store_dwordx4 v[72:75], v1, s[4:7], s33 offen offset:0 sc1
    v_accvgpr_read_b32 v76, a4
    v_accvgpr_read_b32 v80, a36
    v_accvgpr_read_b32 v77, a5
    v_accvgpr_read_b32 v81, a37
    v_accvgpr_read_b32 v78, a6
    v_accvgpr_read_b32 v82, a38
    v_accvgpr_read_b32 v79, a7
    v_accvgpr_read_b32 v83, a39
    v_cvt_pk_bf16_f32 v84, v76, v77
    v_cvt_pk_bf16_f32 v85, v78, v79
    v_cvt_pk_bf16_f32 v86, v80, v81
    v_cvt_pk_bf16_f32 v87, v82, v83
    buffer_store_dwordx4 v[84:87], v1, s[4:7], s33 offen offset:1024 sc1
    v_accvgpr_read_b32 v88, a8
    v_accvgpr_read_b32 v92, a40
    v_accvgpr_read_b32 v89, a9
    v_accvgpr_read_b32 v93, a41
    v_accvgpr_read_b32 v90, a10
    v_accvgpr_read_b32 v94, a42
    v_accvgpr_read_b32 v91, a11
    v_accvgpr_read_b32 v95, a43
    v_cvt_pk_bf16_f32 v96, v88, v89
    v_cvt_pk_bf16_f32 v97, v90, v91
    v_cvt_pk_bf16_f32 v98, v92, v93
    v_cvt_pk_bf16_f32 v99, v94, v95
    buffer_store_dwordx4 v[96:99], v1, s[4:7], s33 offen offset:2048 sc1
    v_accvgpr_read_b32 v100, a12
    v_accvgpr_read_b32 v104, a44
    v_accvgpr_read_b32 v101, a13
    v_accvgpr_read_b32 v105, a45
    v_accvgpr_read_b32 v102, a14
    v_accvgpr_read_b32 v106, a46
    v_accvgpr_read_b32 v103, a15
    v_accvgpr_read_b32 v107, a47
    v_cvt_pk_bf16_f32 v108, v100, v101
    v_cvt_pk_bf16_f32 v109, v102, v103
    v_cvt_pk_bf16_f32 v110, v104, v105
    v_cvt_pk_bf16_f32 v111, v106, v107
    buffer_store_dwordx4 v[108:111], v1, s[4:7], s33 offen offset:3072 sc1
    v_accvgpr_read_b32 v112, a16
    v_accvgpr_read_b32 v116, a48
    v_accvgpr_read_b32 v113, a17
    v_accvgpr_read_b32 v117, a49
    v_accvgpr_read_b32 v114, a18
    v_accvgpr_read_b32 v118, a50
    v_accvgpr_read_b32 v115, a19
    v_accvgpr_read_b32 v119, a51
    v_cvt_pk_bf16_f32 v120, v112, v113
    v_cvt_pk_bf16_f32 v121, v114, v115
    v_cvt_pk_bf16_f32 v122, v116, v117
    v_cvt_pk_bf16_f32 v123, v118, v119
    buffer_store_dwordx4 v[120:123], v1, s[4:7], s34 offen offset:0 sc1
    v_accvgpr_read_b32 v124, a20
    v_accvgpr_read_b32 v128, a52
    v_accvgpr_read_b32 v125, a21
    v_accvgpr_read_b32 v129, a53
    v_accvgpr_read_b32 v126, a22
    v_accvgpr_read_b32 v130, a54
    v_accvgpr_read_b32 v127, a23
    v_accvgpr_read_b32 v131, a55
    v_cvt_pk_bf16_f32 v132, v124, v125
    v_cvt_pk_bf16_f32 v133, v126, v127
    v_cvt_pk_bf16_f32 v134, v128, v129
    v_cvt_pk_bf16_f32 v135, v130, v131
    buffer_store_dwordx4 v[132:135], v1, s[4:7], s34 offen offset:1024 sc1
    v_accvgpr_read_b32 v136, a24
    v_accvgpr_read_b32 v140, a56
    v_accvgpr_read_b32 v137, a25
    v_accvgpr_read_b32 v141, a57
    v_accvgpr_read_b32 v138, a26
    v_accvgpr_read_b32 v142, a58
    v_accvgpr_read_b32 v139, a27
    v_accvgpr_read_b32 v143, a59
    v_cvt_pk_bf16_f32 v144, v136, v137
    v_cvt_pk_bf16_f32 v145, v138, v139
    v_cvt_pk_bf16_f32 v146, v140, v141
    v_cvt_pk_bf16_f32 v147, v142, v143
    buffer_store_dwordx4 v[144:147], v1, s[4:7], s34 offen offset:2048 sc1
    v_accvgpr_read_b32 v148, a28
    v_accvgpr_read_b32 v152, a60
    v_accvgpr_read_b32 v149, a29
    v_accvgpr_read_b32 v153, a61
    v_accvgpr_read_b32 v150, a30
    v_accvgpr_read_b32 v154, a62
    v_accvgpr_read_b32 v151, a31
    v_accvgpr_read_b32 v155, a63
    v_cvt_pk_bf16_f32 v156, v148, v149
    v_cvt_pk_bf16_f32 v157, v150, v151
    v_cvt_pk_bf16_f32 v158, v152, v153
    v_cvt_pk_bf16_f32 v159, v154, v155
    buffer_store_dwordx4 v[156:159], v1, s[4:7], s34 offen offset:3072 sc1
Lt0E_2:
    v_mov_b32 v253, 160
    s_mov_b32 s32, 0
Lt0fw:
    buffer_load_dword v252, v253, s[20:23], 0 offen sc1
    s_add_u32 s32, s32, 1
    s_cmp_gt_u32 s32, 1048576
    s_cbranch_scc1 Lexit
    s_waitcnt vmcnt(0)
    v_readfirstlane_b32 s31, v252
    s_and_b32 s31, s31, 0xffff
    s_cmp_lt_u32 s31, 128
    s_cbranch_scc1 Lt0fw
    s_barrier
    s_mov_b32 s78, 65536
    s_cmp_lg_u32 s29, 0
    s_cbranch_scc1 Lw_g1
    v_mov_b32 v254, 1
    v_mov_b32 v253, 0
    s_mov_b64 exec, 1
    buffer_atomic_add v254, v253, s[4:7], s78 offen
    s_mov_b64 exec, -1
Lw_g1:
    s_load_dwordx2 s[8:9], s[0:1], 0
    s_load_dwordx4 s[36:39], s[0:1], 16
    s_load_dwordx2 s[40:41], s[0:1], 32
    s_load_dwordx4 s[44:47], s[0:1], 64
    v_lshrrev_b32 v1, 6, v0
    s_nop 0
    v_readfirstlane_b32 s29, v1
    v_and_b32 v1, 63, v0
    s_waitcnt lgkmcnt(0)
    s_mov_b32 s10, 2359296
    s_mov_b32 s11, 0x00020000
    s_mov_b32 s15, 0x00020000
    s_mov_b32 s16, s46
    s_mov_b32 s17, s47
    s_mov_b32 s18, 9216
    s_mov_b32 s19, 0x00020000
    v_lshrrev_b32 v2, 3, v1
    v_mul_u32_u24 v3, 1152, v2
    v_lshrrev_b32 v4, 4, v1
    s_and_b32 s31, s29, 1
    s_lshl_b32 s31, s31, 2
    v_add_u32 v4, s31, v4
    v_and_b32 v5, 7, v1
    v_xor_b32 v4, v4, v5
    v_lshl_add_u32 v3, v4, 4, v3
    s_mul_i32 s31, s29, 9216
    v_add_u32 v2, s31, v3
    v_lshrrev_b32 v4, 5, v1
    s_lshl_b32 s31, s29, 1
    v_or_b32 v5, s31, v4
    v_lshlrev_b32 v5, 1, v5
    v_and_b32 v6, 31, v1
    v_xor_b32 v5, v5, v6
    v_lshlrev_b32 v5, 4, v5
    s_and_b32 s31, s29, 1
    s_lshr_b32 s32, s29, 1
    s_lshl_b32 s32, s32, 2
    s_add_u32 s31, s31, s32
    s_lshl_b32 s31, s31, 1
    v_add_u32 v4, s31, v4
    v_lshl_add_u32 v3, v4, 13, v5
    v_mul_u32_u24 v4, 9216, v4
    v_add_u32 v4, v4, v5
    s_lshl_b32 s33, s31, 9
    s_lshl_b32 s34, s29, 10
    v_and_b32 v6, 15, v1
    v_lshrrev_b32 v7, 4, v1
    v_lshrrev_b32 v8, 1, v6
    v_xor_b32 v8, v8, v7
    v_lshlrev_b32 v8, 4, v8
    v_lshl_add_u32 v8, v6, 7, v8
    s_lshr_b32 s31, s29, 1
    s_lshl_b32 s31, s31, 14
    v_add_u32 v5, s31, v8
    v_xor_b32 v6, 64, v5
    v_bfe_u32 v8, v1, 2, 2
    v_and_b32 v9, 1, v7
    v_lshl_add_u32 v9, v9, 2, v8
    v_lshl_add_u32 v8, v7, 3, v8
    v_lshlrev_b32 v8, 9, v8
    s_and_b32 s31, s29, 1
    s_lshl_b32 s31, s31, 8
    s_add_u32 s31, s31, 32768
    v_add_u32 v8, s31, v8
    v_and_b32 v10, 3, v1
    v_xor_b32 v11, 0, v9
    v_lshl_add_u32 v11, v11, 5, v8
    v_lshl_add_u32 v16, v10, 3, v11
    v_xor_b32 v11, 1, v9
    v_lshl_add_u32 v11, v11, 5, v8
    v_lshl_add_u32 v17, v10, 3, v11
    v_xor_b32 v11, 2, v9
    v_lshl_add_u32 v11, v11, 5, v8
    v_lshl_add_u32 v18, v10, 3, v11
    v_xor_b32 v11, 3, v9
    v_lshl_add_u32 v11, v11, 5, v8
    v_lshl_add_u32 v19, v10, 3, v11
    v_xor_b32 v11, 4, v9
    v_lshl_add_u32 v11, v11, 5, v8
    v_lshl_add_u32 v20, v10, 3, v11
    v_xor_b32 v11, 5, v9
    v_lshl_add_u32 v11, v11, 5, v8
    v_lshl_add_u32 v21, v10, 3, v11
    v_xor_b32 v11, 6, v9
    v_lshl_add_u32 v11, v11, 5, v8
    v_lshl_add_u32 v22, v10, 3, v11
    v_xor_b32 v11, 7, v9
    v_lshl_add_u32 v11, v11, 5, v8
    v_lshl_add_u32 v23, v10, 3, v11
    v_lshrrev_b32 v12, 1, v10
    v_and_b32 v13, 1, v10
    v_lshlrev_b32 v13, 4, v13
    v_add_u32 v11, 0, v12
    v_xor_b32 v11, v11, v9
    v_lshl_add_u32 v11, v11, 5, v8
    v_add_u32 v11, v11, v13
    v_add_u32 v24, 0, v11
    v_add_u32 v11, 0, v12
    v_xor_b32 v11, v11, v9
    v_lshl_add_u32 v11, v11, 5, v8
    v_add_u32 v11, v11, v13
    v_add_u32 v25, 8, v11
    v_add_u32 v11, 2, v12
    v_xor_b32 v11, v11, v9
    v_lshl_add_u32 v11, v11, 5, v8
    v_add_u32 v11, v11, v13
    v_add_u32 v26, 0, v11
    v_add_u32 v11, 2, v12
    v_xor_b32 v11, v11, v9
    v_lshl_add_u32 v11, v11, 5, v8
    v_add_u32 v11, v11, v13
    v_add_u32 v27, 8, v11
    v_add_u32 v11, 4, v12
    v_xor_b32 v11, v11, v9
    v_lshl_add_u32 v11, v11, 5, v8
    v_add_u32 v11, v11, v13
    v_add_u32 v28, 0, v11
    v_add_u32 v11, 4, v12
    v_xor_b32 v11, v11, v9
    v_lshl_add_u32 v11, v11, 5, v8
    v_add_u32 v11, v11, v13
    v_add_u32 v29, 8, v11
    v_add_u32 v11, 6, v12
    v_xor_b32 v11, v11, v9
    v_lshl_add_u32 v11, v11, 5, v8
    v_add_u32 v11, v11, v13
    v_add_u32 v30, 0, v11
    v_add_u32 v11, 6, v12
    v_xor_b32 v11, v11, v9
    v_lshl_add_u32 v11, v11, 5, v8
    v_add_u32 v11, v11, v13
    v_add_u32 v31, 8, v11
    v_lshlrev_b32 v7, 4, v7
    v_lshlrev_b32 v1, 4, v1
    s_mov_b32 s78, 2146435072
    s_and_b32 s60, s48, 7
    s_lshr_b32 s59, s48, 3
    s_mul_i32 s56, s60, 294912
    s_lshr_b32 s58, s59, 4
    s_min_u32 s58, s58, 3
    s_lshl_b32 s31, s58, 4
    s_sub_u32 s59, s59, s31
    s_lshl_b32 s57, s59, 9
    s_cmp_eq_u32 s58, 0
    s_cselect_b32 s12, s38, s40
    s_cselect_b32 s13, s39, s41
    s_cmp_eq_u32 s58, 2
    s_cselect_b32 s12, s36, s12
    s_cselect_b32 s13, s37, s13
    s_cmp_eq_u32 s58, 3
    s_cselect_b32 s12, s44, s12
    s_cselect_b32 s13, s45, s13
    s_movk_i32 s35, 8192
    s_cselect_b32 s35, 9216, s35
    s_mul_i32 s14, s35, 576
    s_cselect_b64 vcc, -1, 0
    v_cndmask_b32 v8, v3, v4, vcc
    s_mov_b32 s62, s56
    s_mov_b32 s63, s57
    s_add_u32 m0, s34, 0
    s_add_u32 s31, s62, 0
    buffer_load_dwordx4 v2, s[8:11], s31 offen lds
    s_add_u32 m0, s34, 4096
    s_add_u32 s31, s62, 36864
    buffer_load_dwordx4 v2, s[8:11], s31 offen lds
    s_add_u32 m0, s34, 8192
    s_add_u32 s31, s62, 73728
    buffer_load_dwordx4 v2, s[8:11], s31 offen lds
    s_add_u32 m0, s34, 12288
    s_add_u32 s31, s62, 110592
    buffer_load_dwordx4 v2, s[8:11], s31 offen lds
    s_add_u32 m0, s34, 16384
    s_add_u32 s31, s62, 147456
    buffer_load_dwordx4 v2, s[8:11], s31 offen lds
    s_add_u32 m0, s34, 20480
    s_add_u32 s31, s62, 184320
    buffer_load_dwordx4 v2, s[8:11], s31 offen lds
    s_add_u32 m0, s34, 24576
    s_add_u32 s31, s62, 221184
    buffer_load_dwordx4 v2, s[8:11], s31 offen lds
    s_add_u32 m0, s34, 28672
    s_add_u32 s31, s62, 258048
    buffer_load_dwordx4 v2, s[8:11], s31 offen lds
    s_add_u32 m0, s33, 32768
    s_mul_i32 s31, s35, 0
    s_add_u32 s31, s31, s63
    buffer_load_dwordx4 v8, s[12:15], s31 offen lds
    s_add_u32 m0, s33, 34816
    s_mul_i32 s31, s35, 4
    s_add_u32 s31, s31, s63
    buffer_load_dwordx4 v8, s[12:15], s31 offen lds
    s_add_u32 m0, s33, 40960
    s_mul_i32 s31, s35, 16
    s_add_u32 s31, s31, s63
    buffer_load_dwordx4 v8, s[12:15], s31 offen lds
    s_add_u32 m0, s33, 43008
    s_mul_i32 s31, s35, 20
    s_add_u32 s31, s31, s63
    buffer_load_dwordx4 v8, s[12:15], s31 offen lds
    s_add_u32 m0, s33, 49152
    s_mul_i32 s31, s35, 32
    s_add_u32 s31, s31, s63
    buffer_load_dwordx4 v8, s[12:15], s31 offen lds
    s_add_u32 m0, s33, 51200
    s_mul_i32 s31, s35, 36
    s_add_u32 s31, s31, s63
    buffer_load_dwordx4 v8, s[12:15], s31 offen lds
    s_add_u32 m0, s33, 57344
    s_mul_i32 s31, s35, 48
    s_add_u32 s31, s31, s63
    buffer_load_dwordx4 v8, s[12:15], s31 offen lds
    s_add_u32 m0, s33, 59392
    s_mul_i32 s31, s35, 52
    s_add_u32 s31, s31, s63
    buffer_load_dwordx4 v8, s[12:15], s31 offen lds
    s_add_u32 s62, s62, 128
    s_lshl_b32 s31, s35, 6
    s_add_u32 s63, s63, s31
    s_add_u32 m0, s34, 65536
    s_add_u32 s31, s62, 0
    buffer_load_dwordx4 v2, s[8:11], s31 offen lds
    s_add_u32 m0, s34, 69632
    s_add_u32 s31, s62, 36864
    buffer_load_dwordx4 v2, s[8:11], s31 offen lds
    s_add_u32 m0, s34, 73728
    s_add_u32 s31, s62, 73728
    buffer_load_dwordx4 v2, s[8:11], s31 offen lds
    s_add_u32 m0, s34, 77824
    s_add_u32 s31, s62, 110592
    buffer_load_dwordx4 v2, s[8:11], s31 offen lds
    s_add_u32 m0, s34, 81920
    s_add_u32 s31, s62, 147456
    buffer_load_dwordx4 v2, s[8:11], s31 offen lds
    s_add_u32 m0, s34, 86016
    s_add_u32 s31, s62, 184320
    buffer_load_dwordx4 v2, s[8:11], s31 offen lds
    s_add_u32 m0, s34, 90112
    s_add_u32 s31, s62, 221184
    buffer_load_dwordx4 v2, s[8:11], s31 offen lds
    s_add_u32 m0, s34, 94208
    s_add_u32 s31, s62, 258048
    buffer_load_dwordx4 v2, s[8:11], s31 offen lds
    s_add_u32 m0, s33, 98304
    s_mul_i32 s31, s35, 0
    s_add_u32 s31, s31, s63
    buffer_load_dwordx4 v8, s[12:15], s31 offen lds
    s_add_u32 m0, s33, 100352
    s_mul_i32 s31, s35, 4
    s_add_u32 s31, s31, s63
    buffer_load_dwordx4 v8, s[12:15], s31 offen lds
    s_add_u32 m0, s33, 106496
    s_mul_i32 s31, s35, 16
    s_add_u32 s31, s31, s63
    buffer_load_dwordx4 v8, s[12:15], s31 offen lds
    s_add_u32 m0, s33, 108544
    s_mul_i32 s31, s35, 20
    s_add_u32 s31, s31, s63
    buffer_load_dwordx4 v8, s[12:15], s31 offen lds
    s_add_u32 m0, s33, 114688
    s_mul_i32 s31, s35, 32
    s_add_u32 s31, s31, s63
    buffer_load_dwordx4 v8, s[12:15], s31 offen lds
    s_add_u32 m0, s33, 116736
    s_mul_i32 s31, s35, 36
    s_add_u32 s31, s31, s63
    buffer_load_dwordx4 v8, s[12:15], s31 offen lds
    s_add_u32 m0, s33, 122880
    s_mul_i32 s31, s35, 48
    s_add_u32 s31, s31, s63
    buffer_load_dwordx4 v8, s[12:15], s31 offen lds
    s_add_u32 m0, s33, 124928
    s_mul_i32 s31, s35, 52
    s_add_u32 s31, s31, s63
    buffer_load_dwordx4 v8, s[12:15], s31 offen lds
    s_add_u32 s62, s62, 128
    s_lshl_b32 s31, s35, 6
    s_add_u32 s63, s63, s31
    s_waitcnt vmcnt(16)
Lg1_task:
    s_mov_b32 s50, s56
    s_mov_b32 s51, s57
    s_mov_b32 s52, s58
    s_mov_b32 s53, s59
    s_mov_b32 s54, s60
    s_cmp_eq_u32 s52, 1
    s_cselect_b64 vcc, -1, 0
    v_mov_b32 v32, v5
    v_mov_b32 v33, v6
    v_cndmask_b32 v34, v24, v16, vcc
    v_cndmask_b32 v35, v25, v17, vcc
    v_cndmask_b32 v36, v26, v18, vcc
    v_cndmask_b32 v37, v27, v19, vcc
    v_cndmask_b32 v38, v28, v20, vcc
    v_cndmask_b32 v39, v29, v21, vcc
    v_cndmask_b32 v40, v30, v22, vcc
    v_cndmask_b32 v41, v31, v23, vcc
    s_barrier
    ds_read_b128 v[64:67], v32 offset:0
    ds_read_b64_tr_b16 v[128:129], v34 offset:0
    ds_read_b64_tr_b16 v[130:131], v34 offset:2048
    ds_read_b64_tr_b16 v[132:133], v35 offset:0
    ds_read_b64_tr_b16 v[134:135], v35 offset:2048
    ds_read_b64_tr_b16 v[136:137], v36 offset:0
    ds_read_b64_tr_b16 v[138:139], v36 offset:2048
    ds_read_b64_tr_b16 v[140:141], v37 offset:0
    ds_read_b64_tr_b16 v[142:143], v37 offset:2048
    ds_read_b64_tr_b16 v[144:145], v38 offset:0
    ds_read_b64_tr_b16 v[146:147], v38 offset:2048
    ds_read_b64_tr_b16 v[148:149], v39 offset:0
    ds_read_b64_tr_b16 v[150:151], v39 offset:2048
    ds_read_b64_tr_b16 v[152:153], v40 offset:0
    ds_read_b64_tr_b16 v[154:155], v40 offset:2048
    ds_read_b64_tr_b16 v[156:157], v41 offset:0
    ds_read_b64_tr_b16 v[158:159], v41 offset:2048
    ds_read_b128 v[68:71], v32 offset:2048
    ds_read_b128 v[72:75], v32 offset:4096
    ds_read_b128 v[76:79], v32 offset:6144
    ds_read_b128 v[80:83], v32 offset:8192
    ds_read_b128 v[84:87], v32 offset:10240
    ds_read_b128 v[88:91], v32 offset:12288
    ds_read_b128 v[92:95], v32 offset:14336
    s_mov_b32 s64, 0
    s_cmp_eq_u32 s52, 1
    s_cbranch_scc1 Lg1_N
Lg1_T:
    s_waitcnt lgkmcnt(0)
    v_mfma_f32_16x16x32_bf16 a[0:3], v[128:131], v[64:67], 0
    ds_read_b128 v[96:99], v33 offset:0
    v_mfma_f32_16x16x32_bf16 a[4:7], v[132:135], v[64:67], 0
    ds_read_b64_tr_b16 v[160:161], v34 offset:16384
    v_mfma_f32_16x16x32_bf16 a[8:11], v[136:139], v[64:67], 0
    ds_read_b64_tr_b16 v[162:163], v34 offset:18432
    v_mfma_f32_16x16x32_bf16 a[12:15], v[140:143], v[64:67], 0
    ds_read_b64_tr_b16 v[164:165], v35 offset:16384
    v_mfma_f32_16x16x32_bf16 a[16:19], v[144:147], v[64:67], 0
    ds_read_b64_tr_b16 v[166:167], v35 offset:18432
    v_mfma_f32_16x16x32_bf16 a[20:23], v[148:151], v[64:67], 0
    ds_read_b64_tr_b16 v[168:169], v36 offset:16384
    v_mfma_f32_16x16x32_bf16 a[24:27], v[152:155], v[64:67], 0
    ds_read_b64_tr_b16 v[170:171], v36 offset:18432
    v_mfma_f32_16x16x32_bf16 a[28:31], v[156:159], v[64:67], 0
    ds_read_b64_tr_b16 v[172:173], v37 offset:16384
    v_mfma_f32_16x16x32_bf16 a[32:35], v[128:131], v[68:71], 0
    ds_read_b64_tr_b16 v[174:175], v37 offset:18432
    v_mfma_f32_16x16x32_bf16 a[36:39], v[132:135], v[68:71], 0
    ds_read_b64_tr_b16 v[176:177], v38 offset:16384
    v_mfma_f32_16x16x32_bf16 a[40:43], v[136:139], v[68:71], 0
    ds_read_b64_tr_b16 v[178:179], v38 offset:18432
    v_mfma_f32_16x16x32_bf16 a[44:47], v[140:143], v[68:71], 0
    ds_read_b64_tr_b16 v[180:181], v39 offset:16384
    v_mfma_f32_16x16x32_bf16 a[48:51], v[144:147], v[68:71], 0
    ds_read_b64_tr_b16 v[182:183], v39 offset:18432
    v_mfma_f32_16x16x32_bf16 a[52:55], v[148:151], v[68:71], 0
    ds_read_b64_tr_b16 v[184:185], v40 offset:16384
    v_mfma_f32_16x16x32_bf16 a[56:59], v[152:155], v[68:71], 0
    ds_read_b64_tr_b16 v[186:187], v40 offset:18432
    v_mfma_f32_16x16x32_bf16 a[60:63], v[156:159], v[68:71], 0
    ds_read_b64_tr_b16 v[188:189], v41 offset:16384
    v_mfma_f32_16x16x32_bf16 a[64:67], v[128:131], v[72:75], 0
    ds_read_b64_tr_b16 v[190:191], v41 offset:18432
    v_mfma_f32_16x16x32_bf16 a[68:71], v[132:135], v[72:75], 0
    ds_read_b128 v[100:103], v33 offset:2048
    v_mfma_f32_16x16x32_bf16 a[72:75], v[136:139], v[72:75], 0
    ds_read_b128 v[104:107], v33 offset:4096
    v_mfma_f32_16x16x32_bf16 a[76:79], v[140:143], v[72:75], 0
    ds_read_b128 v[108:111], v33 offset:6144
    v_mfma_f32_16x16x32_bf16 a[80:83], v[144:147], v[72:75], 0
    ds_read_b128 v[112:115], v33 offset:8192
    v_mfma_f32_16x16x32_bf16 a[84:87], v[148:151], v[72:75], 0
    ds_read_b128 v[116:119], v33 offset:10240
    v_mfma_f32_16x16x32_bf16 a[88:91], v[152:155], v[72:75], 0
    ds_read_b128 v[120:123], v33 offset:12288
    v_mfma_f32_16x16x32_bf16 a[92:95], v[156:159], v[72:75], 0
    ds_read_b128 v[124:127], v33 offset:14336
    v_mfma_f32_16x16x32_bf16 a[96:99], v[128:131], v[76:79], 0
    v_mfma_f32_16x16x32_bf16 a[100:103], v[132:135], v[76:79], 0
    v_mfma_f32_16x16x32_bf16 a[104:107], v[136:139], v[76:79], 0
    v_mfma_f32_16x16x32_bf16 a[108:111], v[140:143], v[76:79], 0
    v_mfma_f32_16x16x32_bf16 a[112:115], v[144:147], v[76:79], 0
    v_mfma_f32_16x16x32_bf16 a[116:119], v[148:151], v[76:79], 0
    v_mfma_f32_16x16x32_bf16 a[120:123], v[152:155], v[76:79], 0
    v_mfma_f32_16x16x32_bf16 a[124:127], v[156:159], v[76:79], 0
    v_mfma_f32_16x16x32_bf16 a[128:131], v[128:131], v[80:83], 0
    v_mfma_f32_16x16x32_bf16 a[132:135], v[132:135], v[80:83], 0
    v_mfma_f32_16x16x32_bf16 a[136:139], v[136:139], v[80:83], 0
    v_mfma_f32_16x16x32_bf16 a[140:143], v[140:143], v[80:83], 0
    v_mfma_f32_16x16x32_bf16 a[144:147], v[144:147], v[80:83], 0
    v_mfma_f32_16x16x32_bf16 a[148:151], v[148:151], v[80:83], 0
    v_mfma_f32_16x16x32_bf16 a[152:155], v[152:155], v[80:83], 0
    v_mfma_f32_16x16x32_bf16 a[156:159], v[156:159], v[80:83], 0
    v_mfma_f32_16x16x32_bf16 a[160:163], v[128:131], v[84:87], 0
    v_mfma_f32_16x16x32_bf16 a[164:167], v[132:135], v[84:87], 0
    v_mfma_f32_16x16x32_bf16 a[168:171], v[136:139], v[84:87], 0
    v_mfma_f32_16x16x32_bf16 a[172:175], v[140:143], v[84:87], 0
    v_mfma_f32_16x16x32_bf16 a[176:179], v[144:147], v[84:87], 0
    v_mfma_f32_16x16x32_bf16 a[180:183], v[148:151], v[84:87], 0
    v_mfma_f32_16x16x32_bf16 a[184:187], v[152:155], v[84:87], 0
    v_mfma_f32_16x16x32_bf16 a[188:191], v[156:159], v[84:87], 0
    v_mfma_f32_16x16x32_bf16 a[192:195], v[128:131], v[88:91], 0
    v_mfma_f32_16x16x32_bf16 a[196:199], v[132:135], v[88:91], 0
    v_mfma_f32_16x16x32_bf16 a[200:203], v[136:139], v[88:91], 0
    v_mfma_f32_16x16x32_bf16 a[204:207], v[140:143], v[88:91], 0
    v_mfma_f32_16x16x32_bf16 a[208:211], v[144:147], v[88:91], 0
    v_mfma_f32_16x16x32_bf16 a[212:215], v[148:151], v[88:91], 0
    v_mfma_f32_16x16x32_bf16 a[216:219], v[152:155], v[88:91], 0
    v_mfma_f32_16x16x32_bf16 a[220:223], v[156:159], v[88:91], 0
    v_mfma_f32_16x16x32_bf16 a[224:227], v[128:131], v[92:95], 0
    v_mfma_f32_16x16x32_bf16 a[228:231], v[132:135], v[92:95], 0
    v_mfma_f32_16x16x32_bf16 a[232:235], v[136:139], v[92:95], 0
    v_mfma_f32_16x16x32_bf16 a[236:239], v[140:143], v[92:95], 0
    v_mfma_f32_16x16x32_bf16 a[240:243], v[144:147], v[92:95], 0
    v_mfma_f32_16x16x32_bf16 a[244:247], v[148:151], v[92:95], 0
    v_mfma_f32_16x16x32_bf16 a[248:251], v[152:155], v[92:95], 0
    v_mfma_f32_16x16x32_bf16 a[252:255], v[156:159], v[92:95], 0
    s_branch Lg1_T_mid
Lg1_T_top:
    s_waitcnt lgkmcnt(0)
    v_mfma_f32_16x16x32_bf16 a[0:3], v[128:131], v[64:67], a[0:3]
    ds_read_b128 v[96:99], v33 offset:0
    v_mfma_f32_16x16x32_bf16 a[4:7], v[132:135], v[64:67], a[4:7]
    ds_read_b64_tr_b16 v[160:161], v34 offset:16384
    v_mfma_f32_16x16x32_bf16 a[8:11], v[136:139], v[64:67], a[8:11]
    ds_read_b64_tr_b16 v[162:163], v34 offset:18432
    v_mfma_f32_16x16x32_bf16 a[12:15], v[140:143], v[64:67], a[12:15]
    ds_read_b64_tr_b16 v[164:165], v35 offset:16384
    v_mfma_f32_16x16x32_bf16 a[16:19], v[144:147], v[64:67], a[16:19]
    ds_read_b64_tr_b16 v[166:167], v35 offset:18432
    v_mfma_f32_16x16x32_bf16 a[20:23], v[148:151], v[64:67], a[20:23]
    ds_read_b64_tr_b16 v[168:169], v36 offset:16384
    v_mfma_f32_16x16x32_bf16 a[24:27], v[152:155], v[64:67], a[24:27]
    ds_read_b64_tr_b16 v[170:171], v36 offset:18432
    v_mfma_f32_16x16x32_bf16 a[28:31], v[156:159], v[64:67], a[28:31]
    ds_read_b64_tr_b16 v[172:173], v37 offset:16384
    v_mfma_f32_16x16x32_bf16 a[32:35], v[128:131], v[68:71], a[32:35]
    ds_read_b64_tr_b16 v[174:175], v37 offset:18432
    v_mfma_f32_16x16x32_bf16 a[36:39], v[132:135], v[68:71], a[36:39]
    ds_read_b64_tr_b16 v[176:177], v38 offset:16384
    v_mfma_f32_16x16x32_bf16 a[40:43], v[136:139], v[68:71], a[40:43]
    ds_read_b64_tr_b16 v[178:179], v38 offset:18432
    v_mfma_f32_16x16x32_bf16 a[44:47], v[140:143], v[68:71], a[44:47]
    ds_read_b64_tr_b16 v[180:181], v39 offset:16384
    v_mfma_f32_16x16x32_bf16 a[48:51], v[144:147], v[68:71], a[48:51]
    ds_read_b64_tr_b16 v[182:183], v39 offset:18432
    v_mfma_f32_16x16x32_bf16 a[52:55], v[148:151], v[68:71], a[52:55]
    ds_read_b64_tr_b16 v[184:185], v40 offset:16384
    v_mfma_f32_16x16x32_bf16 a[56:59], v[152:155], v[68:71], a[56:59]
    ds_read_b64_tr_b16 v[186:187], v40 offset:18432
    v_mfma_f32_16x16x32_bf16 a[60:63], v[156:159], v[68:71], a[60:63]
    ds_read_b64_tr_b16 v[188:189], v41 offset:16384
    v_mfma_f32_16x16x32_bf16 a[64:67], v[128:131], v[72:75], a[64:67]
    ds_read_b64_tr_b16 v[190:191], v41 offset:18432
    v_mfma_f32_16x16x32_bf16 a[68:71], v[132:135], v[72:75], a[68:71]
    ds_read_b128 v[100:103], v33 offset:2048
    v_mfma_f32_16x16x32_bf16 a[72:75], v[136:139], v[72:75], a[72:75]
    ds_read_b128 v[104:107], v33 offset:4096
    v_mfma_f32_16x16x32_bf16 a[76:79], v[140:143], v[72:75], a[76:79]
    ds_read_b128 v[108:111], v33 offset:6144
    v_mfma_f32_16x16x32_bf16 a[80:83], v[144:147], v[72:75], a[80:83]
    ds_read_b128 v[112:115], v33 offset:8192
    v_mfma_f32_16x16x32_bf16 a[84:87], v[148:151], v[72:75], a[84:87]
    ds_read_b128 v[116:119], v33 offset:10240
    v_mfma_f32_16x16x32_bf16 a[88:91], v[152:155], v[72:75], a[88:91]
    ds_read_b128 v[120:123], v33 offset:12288
    v_mfma_f32_16x16x32_bf16 a[92:95], v[156:159], v[72:75], a[92:95]
    ds_read_b128 v[124:127], v33 offset:14336
    v_mfma_f32_16x16x32_bf16 a[96:99], v[128:131], v[76:79], a[96:99]
    v_mfma_f32_16x16x32_bf16 a[100:103], v[132:135], v[76:79], a[100:103]
    v_mfma_f32_16x16x32_bf16 a[104:107], v[136:139], v[76:79], a[104:107]
    v_mfma_f32_16x16x32_bf16 a[108:111], v[140:143], v[76:79], a[108:111]
    v_mfma_f32_16x16x32_bf16 a[112:115], v[144:147], v[76:79], a[112:115]
    v_mfma_f32_16x16x32_bf16 a[116:119], v[148:151], v[76:79], a[116:119]
    v_mfma_f32_16x16x32_bf16 a[120:123], v[152:155], v[76:79], a[120:123]
    v_mfma_f32_16x16x32_bf16 a[124:127], v[156:159], v[76:79], a[124:127]
    v_mfma_f32_16x16x32_bf16 a[128:131], v[128:131], v[80:83], a[128:131]
    v_mfma_f32_16x16x32_bf16 a[132:135], v[132:135], v[80:83], a[132:135]
    v_mfma_f32_16x16x32_bf16 a[136:139], v[136:139], v[80:83], a[136:139]
    v_mfma_f32_16x16x32_bf16 a[140:143], v[140:143], v[80:83], a[140:143]
    v_mfma_f32_16x16x32_bf16 a[144:147], v[144:147], v[80:83], a[144:147]
    v_mfma_f32_16x16x32_bf16 a[148:151], v[148:151], v[80:83], a[148:151]
    v_mfma_f32_16x16x32_bf16 a[152:155], v[152:155], v[80:83], a[152:155]
    v_mfma_f32_16x16x32_bf16 a[156:159], v[156:159], v[80:83], a[156:159]
    v_mfma_f32_16x16x32_bf16 a[160:163], v[128:131], v[84:87], a[160:163]
    v_mfma_f32_16x16x32_bf16 a[164:167], v[132:135], v[84:87], a[164:167]
    v_mfma_f32_16x16x32_bf16 a[168:171], v[136:139], v[84:87], a[168:171]
    v_mfma_f32_16x16x32_bf16 a[172:175], v[140:143], v[84:87], a[172:175]
    v_mfma_f32_16x16x32_bf16 a[176:179], v[144:147], v[84:87], a[176:179]
    v_mfma_f32_16x16x32_bf16 a[180:183], v[148:151], v[84:87], a[180:183]
    v_mfma_f32_16x16x32_bf16 a[184:187], v[152:155], v[84:87], a[184:187]
    v_mfma_f32_16x16x32_bf16 a[188:191], v[156:159], v[84:87], a[188:191]
    v_mfma_f32_16x16x32_bf16 a[192:195], v[128:131], v[88:91], a[192:195]
    v_mfma_f32_16x16x32_bf16 a[196:199], v[132:135], v[88:91], a[196:199]
    v_mfma_f32_16x16x32_bf16 a[200:203], v[136:139], v[88:91], a[200:203]
    v_mfma_f32_16x16x32_bf16 a[204:207], v[140:143], v[88:91], a[204:207]
    v_mfma_f32_16x16x32_bf16 a[208:211], v[144:147], v[88:91], a[208:211]
    v_mfma_f32_16x16x32_bf16 a[212:215], v[148:151], v[88:91], a[212:215]
    v_mfma_f32_16x16x32_bf16 a[216:219], v[152:155], v[88:91], a[216:219]
    v_mfma_f32_16x16x32_bf16 a[220:223], v[156:159], v[88:91], a[220:223]
    v_mfma_f32_16x16x32_bf16 a[224:227], v[128:131], v[92:95], a[224:227]
    v_mfma_f32_16x16x32_bf16 a[228:231], v[132:135], v[92:95], a[228:231]
    v_mfma_f32_16x16x32_bf16 a[232:235], v[136:139], v[92:95], a[232:235]
    v_mfma_f32_16x16x32_bf16 a[236:239], v[140:143], v[92:95], a[236:239]
    v_mfma_f32_16x16x32_bf16 a[240:243], v[144:147], v[92:95], a[240:243]
    v_mfma_f32_16x16x32_bf16 a[244:247], v[148:151], v[92:95], a[244:247]
    v_mfma_f32_16x16x32_bf16 a[248:251], v[152:155], v[92:95], a[248:251]
    v_mfma_f32_16x16x32_bf16 a[252:255], v[156:159], v[92:95], a[252:255]
Lg1_T_mid:
    s_cmp_eq_u32 s64, 8
    s_cbranch_scc1 Lg1_T_last
    s_waitcnt vmcnt(0) lgkmcnt(0)
    s_barrier
    s_or_b32 s31, s64, s29
    s_cbranch_scc0 Lg1_T_flag
Lg1_T_flagged:
    s_and_b32 s32, s64, 1
    s_lshl_b32 s32, s32, 16
    s_add_u32 s65, s34, s32
    s_add_u32 s66, s33, s32
    s_cmp_ge_u32 s64, 7
    s_cselect_b32 s67, 2146435072, s62
    s_cselect_b32 s68, 2146435072, s63
    v_mfma_f32_16x16x32_bf16 a[0:3], v[160:163], v[96:99], a[0:3]
    s_add_u32 m0, s65, 0
    s_add_u32 s31, s67, 0
    buffer_load_dwordx4 v2, s[8:11], s31 offen lds
    v_mfma_f32_16x16x32_bf16 a[4:7], v[164:167], v[96:99], a[4:7]
    v_xor_b32 v32, 0x10000, v32
    v_mfma_f32_16x16x32_bf16 a[8:11], v[168:171], v[96:99], a[8:11]
    v_xor_b32 v33, 0x10000, v33
    v_mfma_f32_16x16x32_bf16 a[12:15], v[172:175], v[96:99], a[12:15]
    v_xor_b32 v34, 0x10000, v34
    v_mfma_f32_16x16x32_bf16 a[16:19], v[176:179], v[96:99], a[16:19]
    s_add_u32 m0, s65, 4096
    s_add_u32 s31, s67, 36864
    buffer_load_dwordx4 v2, s[8:11], s31 offen lds
    v_mfma_f32_16x16x32_bf16 a[20:23], v[180:183], v[96:99], a[20:23]
    v_xor_b32 v35, 0x10000, v35
    v_mfma_f32_16x16x32_bf16 a[24:27], v[184:187], v[96:99], a[24:27]
    v_xor_b32 v36, 0x10000, v36
    v_mfma_f32_16x16x32_bf16 a[28:31], v[188:191], v[96:99], a[28:31]
    v_xor_b32 v37, 0x10000, v37
    v_mfma_f32_16x16x32_bf16 a[32:35], v[160:163], v[100:103], a[32:35]
    s_add_u32 m0, s65, 8192
    s_add_u32 s31, s67, 73728
    buffer_load_dwordx4 v2, s[8:11], s31 offen lds
    v_mfma_f32_16x16x32_bf16 a[36:39], v[164:167], v[100:103], a[36:39]
    v_xor_b32 v38, 0x10000, v38
    v_mfma_f32_16x16x32_bf16 a[40:43], v[168:171], v[100:103], a[40:43]
    v_xor_b32 v39, 0x10000, v39
    v_mfma_f32_16x16x32_bf16 a[44:47], v[172:175], v[100:103], a[44:47]
    v_xor_b32 v40, 0x10000, v40
    v_mfma_f32_16x16x32_bf16 a[48:51], v[176:179], v[100:103], a[48:51]
    s_add_u32 m0, s65, 12288
    s_add_u32 s31, s67, 110592
    buffer_load_dwordx4 v2, s[8:11], s31 offen lds
    v_mfma_f32_16x16x32_bf16 a[52:55], v[180:183], v[100:103], a[52:55]
    v_xor_b32 v41, 0x10000, v41
    v_mfma_f32_16x16x32_bf16 a[56:59], v[184:187], v[100:103], a[56:59]
    ds_read_b128 v[64:67], v32 offset:0
    v_mfma_f32_16x16x32_bf16 a[60:63], v[188:191], v[100:103], a[60:63]
    ds_read_b64_tr_b16 v[128:129], v34 offset:0
    v_mfma_f32_16x16x32_bf16 a[64:67], v[160:163], v[104:107], a[64:67]
    s_add_u32 m0, s65, 16384
    s_add_u32 s31, s67, 147456
    buffer_load_dwordx4 v2, s[8:11], s31 offen lds
    v_mfma_f32_16x16x32_bf16 a[68:71], v[164:167], v[104:107], a[68:71]
    ds_read_b64_tr_b16 v[130:131], v34 offset:2048
    v_mfma_f32_16x16x32_bf16 a[72:75], v[168:171], v[104:107], a[72:75]
    ds_read_b64_tr_b16 v[132:133], v35 offset:0
    v_mfma_f32_16x16x32_bf16 a[76:79], v[172:175], v[104:107], a[76:79]
    ds_read_b64_tr_b16 v[134:135], v35 offset:2048
    v_mfma_f32_16x16x32_bf16 a[80:83], v[176:179], v[104:107], a[80:83]
    s_add_u32 m0, s65, 20480
    s_add_u32 s31, s67, 184320
    buffer_load_dwordx4 v2, s[8:11], s31 offen lds
    v_mfma_f32_16x16x32_bf16 a[84:87], v[180:183], v[104:107], a[84:87]
    ds_read_b64_tr_b16 v[136:137], v36 offset:0
    v_mfma_f32_16x16x32_bf16 a[88:91], v[184:187], v[104:107], a[88:91]
    ds_read_b64_tr_b16 v[138:139], v36 offset:2048
    v_mfma_f32_16x16x32_bf16 a[92:95], v[188:191], v[104:107], a[92:95]
    ds_read_b64_tr_b16 v[140:141], v37 offset:0
    v_mfma_f32_16x16x32_bf16 a[96:99], v[160:163], v[108:111], a[96:99]
    s_add_u32 m0, s65, 24576
    s_add_u32 s31, s67, 221184
    buffer_load_dwordx4 v2, s[8:11], s31 offen lds
    v_mfma_f32_16x16x32_bf16 a[100:103], v[164:167], v[108:111], a[100:103]
    ds_read_b64_tr_b16 v[142:143], v37 offset:2048
    v_mfma_f32_16x16x32_bf16 a[104:107], v[168:171], v[108:111], a[104:107]
    ds_read_b64_tr_b16 v[144:145], v38 offset:0
    v_mfma_f32_16x16x32_bf16 a[108:111], v[172:175], v[108:111], a[108:111]
    ds_read_b64_tr_b16 v[146:147], v38 offset:2048
    v_mfma_f32_16x16x32_bf16 a[112:115], v[176:179], v[108:111], a[112:115]
    s_add_u32 m0, s65, 28672
    s_add_u32 s31, s67, 258048
    buffer_load_dwordx4 v2, s[8:11], s31 offen lds
    v_mfma_f32_16x16x32_bf16 a[116:119], v[180:183], v[108:111], a[116:119]
    ds_read_b64_tr_b16 v[148:149], v39 offset:0
    v_mfma_f32_16x16x32_bf16 a[120:123], v[184:187], v[108:111], a[120:123]
    ds_read_b64_tr_b16 v[150:151], v39 offset:2048
    v_mfma_f32_16x16x32_bf16 a[124:127], v[188:191], v[108:111], a[124:127]
    ds_read_b64_tr_b16 v[152:153], v40 offset:0
    v_mfma_f32_16x16x32_bf16 a[128:131], v[160:163], v[112:115], a[128:131]
    s_add_u32 m0, s66, 32768
    s_mul_i32 s31, s35, 0
    s_add_u32 s31, s31, s68
    buffer_load_dwordx4 v8, s[12:15], s31 offen lds
    v_mfma_f32_16x16x32_bf16 a[132:135], v[164:167], v[112:115], a[132:135]
    ds_read_b64_tr_b16 v[154:155], v40 offset:2048
    v_mfma_f32_16x16x32_bf16 a[136:139], v[168:171], v[112:115], a[136:139]
    ds_read_b64_tr_b16 v[156:157], v41 offset:0
    v_mfma_f32_16x16x32_bf16 a[140:143], v[172:175], v[112:115], a[140:143]
    ds_read_b64_tr_b16 v[158:159], v41 offset:2048
    v_mfma_f32_16x16x32_bf16 a[144:147], v[176:179], v[112:115], a[144:147]
    s_add_u32 m0, s66, 34816
    s_mul_i32 s31, s35, 4
    s_add_u32 s31, s31, s68
    buffer_load_dwordx4 v8, s[12:15], s31 offen lds
    v_mfma_f32_16x16x32_bf16 a[148:151], v[180:183], v[112:115], a[148:151]
    ds_read_b128 v[68:71], v32 offset:2048
    v_mfma_f32_16x16x32_bf16 a[152:155], v[184:187], v[112:115], a[152:155]
    ds_read_b128 v[72:75], v32 offset:4096
    v_mfma_f32_16x16x32_bf16 a[156:159], v[188:191], v[112:115], a[156:159]
    ds_read_b128 v[76:79], v32 offset:6144
    v_mfma_f32_16x16x32_bf16 a[160:163], v[160:163], v[116:119], a[160:163]
    s_add_u32 m0, s66, 40960
    s_mul_i32 s31, s35, 16
    s_add_u32 s31, s31, s68
    buffer_load_dwordx4 v8, s[12:15], s31 offen lds
    v_mfma_f32_16x16x32_bf16 a[164:167], v[164:167], v[116:119], a[164:167]
    ds_read_b128 v[80:83], v32 offset:8192
    v_mfma_f32_16x16x32_bf16 a[168:171], v[168:171], v[116:119], a[168:171]
    ds_read_b128 v[84:87], v32 offset:10240
    v_mfma_f32_16x16x32_bf16 a[172:175], v[172:175], v[116:119], a[172:175]
    ds_read_b128 v[88:91], v32 offset:12288
    v_mfma_f32_16x16x32_bf16 a[176:179], v[176:179], v[116:119], a[176:179]
    s_add_u32 m0, s66, 43008
    s_mul_i32 s31, s35, 20
    s_add_u32 s31, s31, s68
    buffer_load_dwordx4 v8, s[12:15], s31 offen lds
    v_mfma_f32_16x16x32_bf16 a[180:183], v[180:183], v[116:119], a[180:183]
    ds_read_b128 v[92:95], v32 offset:14336
    v_mfma_f32_16x16x32_bf16 a[184:187], v[184:187], v[116:119], a[184:187]
    v_mfma_f32_16x16x32_bf16 a[188:191], v[188:191], v[116:119], a[188:191]
    v_mfma_f32_16x16x32_bf16 a[192:195], v[160:163], v[120:123], a[192:195]
    s_add_u32 m0, s66, 49152
    s_mul_i32 s31, s35, 32
    s_add_u32 s31, s31, s68
    buffer_load_dwordx4 v8, s[12:15], s31 offen lds
    v_mfma_f32_16x16x32_bf16 a[196:199], v[164:167], v[120:123], a[196:199]
    v_mfma_f32_16x16x32_bf16 a[200:203], v[168:171], v[120:123], a[200:203]
    v_mfma_f32_16x16x32_bf16 a[204:207], v[172:175], v[120:123], a[204:207]
    v_mfma_f32_16x16x32_bf16 a[208:211], v[176:179], v[120:123], a[208:211]
    s_add_u32 m0, s66, 51200
    s_mul_i32 s31, s35, 36
    s_add_u32 s31, s31, s68
    buffer_load_dwordx4 v8, s[12:15], s31 offen lds
    v_mfma_f32_16x16x32_bf16 a[212:215], v[180:183], v[120:123], a[212:215]
    v_mfma_f32_16x16x32_bf16 a[216:219], v[184:187], v[120:123], a[216:219]
    v_mfma_f32_16x16x32_bf16 a[220:223], v[188:191], v[120:123], a[220:223]
    v_mfma_f32_16x16x32_bf16 a[224:227], v[160:163], v[124:127], a[224:227]
    s_add_u32 m0, s66, 57344
    s_mul_i32 s31, s35, 48
    s_add_u32 s31, s31, s68
    buffer_load_dwordx4 v8, s[12:15], s31 offen lds
    v_mfma_f32_16x16x32_bf16 a[228:231], v[164:167], v[124:127], a[228:231]
    v_mfma_f32_16x16x32_bf16 a[232:235], v[168:171], v[124:127], a[232:235]
    v_mfma_f32_16x16x32_bf16 a[236:239], v[172:175], v[124:127], a[236:239]
    v_mfma_f32_16x16x32_bf16 a[240:243], v[176:179], v[124:127], a[240:243]
    s_add_u32 m0, s66, 59392
    s_mul_i32 s31, s35, 52
    s_add_u32 s31, s31, s68
    buffer_load_dwordx4 v8, s[12:15], s31 offen lds
    v_mfma_f32_16x16x32_bf16 a[244:247], v[180:183], v[124:127], a[244:247]
    v_mfma_f32_16x16x32_bf16 a[248:251], v[184:187], v[124:127], a[248:251]
    v_mfma_f32_16x16x32_bf16 a[252:255], v[188:191], v[124:127], a[252:255]
    s_add_u32 s62, s62, 128
    s_lshl_b32 s31, s35, 6
    s_add_u32 s63, s63, s31
    s_add_u32 s64, s64, 1
    s_branch Lg1_T_top
Lg1_T_last:
    s_waitcnt vmcnt(0) lgkmcnt(0)
    s_barrier
    v_mfma_f32_16x16x32_bf16 a[0:3], v[160:163], v[96:99], a[0:3]
    v_mfma_f32_16x16x32_bf16 a[4:7], v[164:167], v[96:99], a[4:7]
    v_mfma_f32_16x16x32_bf16 a[8:11], v[168:171], v[96:99], a[8:11]
    v_mfma_f32_16x16x32_bf16 a[12:15], v[172:175], v[96:99], a[12:15]
    v_mfma_f32_16x16x32_bf16 a[16:19], v[176:179], v[96:99], a[16:19]
    v_mfma_f32_16x16x32_bf16 a[20:23], v[180:183], v[96:99], a[20:23]
    v_mfma_f32_16x16x32_bf16 a[24:27], v[184:187], v[96:99], a[24:27]
    v_mfma_f32_16x16x32_bf16 a[28:31], v[188:191], v[96:99], a[28:31]
    v_mfma_f32_16x16x32_bf16 a[32:35], v[160:163], v[100:103], a[32:35]
    v_mfma_f32_16x16x32_bf16 a[36:39], v[164:167], v[100:103], a[36:39]
    v_mfma_f32_16x16x32_bf16 a[40:43], v[168:171], v[100:103], a[40:43]
    v_mfma_f32_16x16x32_bf16 a[44:47], v[172:175], v[100:103], a[44:47]
    v_mfma_f32_16x16x32_bf16 a[48:51], v[176:179], v[100:103], a[48:51]
    v_mfma_f32_16x16x32_bf16 a[52:55], v[180:183], v[100:103], a[52:55]
    v_mfma_f32_16x16x32_bf16 a[56:59], v[184:187], v[100:103], a[56:59]
    v_mfma_f32_16x16x32_bf16 a[60:63], v[188:191], v[100:103], a[60:63]
    v_mfma_f32_16x16x32_bf16 a[64:67], v[160:163], v[104:107], a[64:67]
    v_mfma_f32_16x16x32_bf16 a[68:71], v[164:167], v[104:107], a[68:71]
    v_mfma_f32_16x16x32_bf16 a[72:75], v[168:171], v[104:107], a[72:75]
    v_mfma_f32_16x16x32_bf16 a[76:79], v[172:175], v[104:107], a[76:79]
    v_mfma_f32_16x16x32_bf16 a[80:83], v[176:179], v[104:107], a[80:83]
    v_mfma_f32_16x16x32_bf16 a[84:87], v[180:183], v[104:107], a[84:87]
    v_mfma_f32_16x16x32_bf16 a[88:91], v[184:187], v[104:107], a[88:91]
    v_mfma_f32_16x16x32_bf16 a[92:95], v[188:191], v[104:107], a[92:95]
    v_mfma_f32_16x16x32_bf16 a[96:99], v[160:163], v[108:111], a[96:99]
    v_mfma_f32_16x16x32_bf16 a[100:103], v[164:167], v[108:111], a[100:103]
    v_mfma_f32_16x16x32_bf16 a[104:107], v[168:171], v[108:111], a[104:107]
    v_mfma_f32_16x16x32_bf16 a[108:111], v[172:175], v[108:111], a[108:111]
    v_mfma_f32_16x16x32_bf16 a[112:115], v[176:179], v[108:111], a[112:115]
    v_mfma_f32_16x16x32_bf16 a[116:119], v[180:183], v[108:111], a[116:119]
    v_mfma_f32_16x16x32_bf16 a[120:123], v[184:187], v[108:111], a[120:123]
    v_mfma_f32_16x16x32_bf16 a[124:127], v[188:191], v[108:111], a[124:127]
    v_mfma_f32_16x16x32_bf16 a[128:131], v[160:163], v[112:115], a[128:131]
    v_mfma_f32_16x16x32_bf16 a[132:135], v[164:167], v[112:115], a[132:135]
    v_mfma_f32_16x16x32_bf16 a[136:139], v[168:171], v[112:115], a[136:139]
    v_mfma_f32_16x16x32_bf16 a[140:143], v[172:175], v[112:115], a[140:143]
    v_mfma_f32_16x16x32_bf16 a[144:147], v[176:179], v[112:115], a[144:147]
    v_mfma_f32_16x16x32_bf16 a[148:151], v[180:183], v[112:115], a[148:151]
    v_mfma_f32_16x16x32_bf16 a[152:155], v[184:187], v[112:115], a[152:155]
    v_mfma_f32_16x16x32_bf16 a[156:159], v[188:191], v[112:115], a[156:159]
    v_mfma_f32_16x16x32_bf16 a[160:163], v[160:163], v[116:119], a[160:163]
    v_mfma_f32_16x16x32_bf16 a[164:167], v[164:167], v[116:119], a[164:167]
    v_mfma_f32_16x16x32_bf16 a[168:171], v[168:171], v[116:119], a[168:171]
    v_mfma_f32_16x16x32_bf16 a[172:175], v[172:175], v[116:119], a[172:175]
    v_mfma_f32_16x16x32_bf16 a[176:179], v[176:179], v[116:119], a[176:179]
    v_mfma_f32_16x16x32_bf16 a[180:183], v[180:183], v[116:119], a[180:183]
    v_mfma_f32_16x16x32_bf16 a[184:187], v[184:187], v[116:119], a[184:187]
    v_mfma_f32_16x16x32_bf16 a[188:191], v[188:191], v[116:119], a[188:191]
    v_mfma_f32_16x16x32_bf16 a[192:195], v[160:163], v[120:123], a[192:195]
    v_mfma_f32_16x16x32_bf16 a[196:199], v[164:167], v[120:123], a[196:199]
    v_mfma_f32_16x16x32_bf16 a[200:203], v[168:171], v[120:123], a[200:203]
    v_mfma_f32_16x16x32_bf16 a[204:207], v[172:175], v[120:123], a[204:207]
    v_mfma_f32_16x16x32_bf16 a[208:211], v[176:179], v[120:123], a[208:211]
    v_mfma_f32_16x16x32_bf16 a[212:215], v[180:183], v[120:123], a[212:215]
    v_mfma_f32_16x16x32_bf16 a[216:219], v[184:187], v[120:123], a[216:219]
    v_mfma_f32_16x16x32_bf16 a[220:223], v[188:191], v[120:123], a[220:223]
    v_mfma_f32_16x16x32_bf16 a[224:227], v[160:163], v[124:127], a[224:227]
    v_mfma_f32_16x16x32_bf16 a[228:231], v[164:167], v[124:127], a[228:231]
    v_mfma_f32_16x16x32_bf16 a[232:235], v[168:171], v[124:127], a[232:235]
    v_mfma_f32_16x16x32_bf16 a[236:239], v[172:175], v[124:127], a[236:239]
    v_mfma_f32_16x16x32_bf16 a[240:243], v[176:179], v[124:127], a[240:243]
    v_mfma_f32_16x16x32_bf16 a[244:247], v[180:183], v[124:127], a[244:247]
    v_mfma_f32_16x16x32_bf16 a[248:251], v[184:187], v[124:127], a[248:251]
    v_mfma_f32_16x16x32_bf16 a[252:255], v[188:191], v[124:127], a[252:255]
    s_branch Lg1_epi
Lg1_T_flag:
    v_mov_b32 v254, 4
    v_mov_b32 v253, 0
    s_mov_b64 exec, 1
    buffer_atomic_add v254, v253, s[4:7], s78 offen
    s_mov_b64 exec, -1
    s_branch Lg1_T_flagged
Lg1_N:
    s_waitcnt lgkmcnt(0)
    v_mfma_f32_16x16x32_bf16 a[0:3], v[64:67], v[128:131], 0
    ds_read_b128 v[96:99], v33 offset:0
    v_mfma_f32_16x16x32_bf16 a[4:7], v[64:67], v[132:135], 0
    ds_read_b64_tr_b16 v[160:161], v34 offset:16384
    v_mfma_f32_16x16x32_bf16 a[8:11], v[64:67], v[136:139], 0
    ds_read_b64_tr_b16 v[162:163], v34 offset:18432
    v_mfma_f32_16x16x32_bf16 a[12:15], v[64:67], v[140:143], 0
    ds_read_b64_tr_b16 v[164:165], v35 offset:16384
    v_mfma_f32_16x16x32_bf16 a[16:19], v[64:67], v[144:147], 0
    ds_read_b64_tr_b16 v[166:167], v35 offset:18432
    v_mfma_f32_16x16x32_bf16 a[20:23], v[64:67], v[148:151], 0
    ds_read_b64_tr_b16 v[168:169], v36 offset:16384
    v_mfma_f32_16x16x32_bf16 a[24:27], v[64:67], v[152:155], 0
    ds_read_b64_tr_b16 v[170:171], v36 offset:18432
    v_mfma_f32_16x16x32_bf16 a[28:31], v[64:67], v[156:159], 0
    ds_read_b64_tr_b16 v[172:173], v37 offset:16384
    v_mfma_f32_16x16x32_bf16 a[32:35], v[68:71], v[128:131], 0
    ds_read_b64_tr_b16 v[174:175], v37 offset:18432
    v_mfma_f32_16x16x32_bf16 a[36:39], v[68:71], v[132:135], 0
    ds_read_b64_tr_b16 v[176:177], v38 offset:16384
    v_mfma_f32_16x16x32_bf16 a[40:43], v[68:71], v[136:139], 0
    ds_read_b64_tr_b16 v[178:179], v38 offset:18432
    v_mfma_f32_16x16x32_bf16 a[44:47], v[68:71], v[140:143], 0
    ds_read_b64_tr_b16 v[180:181], v39 offset:16384
    v_mfma_f32_16x16x32_bf16 a[48:51], v[68:71], v[144:147], 0
    ds_read_b64_tr_b16 v[182:183], v39 offset:18432
    v_mfma_f32_16x16x32_bf16 a[52:55], v[68:71], v[148:151], 0
    ds_read_b64_tr_b16 v[184:185], v40 offset:16384
    v_mfma_f32_16x16x32_bf16 a[56:59], v[68:71], v[152:155], 0
    ds_read_b64_tr_b16 v[186:187], v40 offset:18432
    v_mfma_f32_16x16x32_bf16 a[60:63], v[68:71], v[156:159], 0
    ds_read_b64_tr_b16 v[188:189], v41 offset:16384
    v_mfma_f32_16x16x32_bf16 a[64:67], v[72:75], v[128:131], 0
    ds_read_b64_tr_b16 v[190:191], v41 offset:18432
    v_mfma_f32_16x16x32_bf16 a[68:71], v[72:75], v[132:135], 0
    ds_read_b128 v[100:103], v33 offset:2048
    v_mfma_f32_16x16x32_bf16 a[72:75], v[72:75], v[136:139], 0
    ds_read_b128 v[104:107], v33 offset:4096
    v_mfma_f32_16x16x32_bf16 a[76:79], v[72:75], v[140:143], 0
    ds_read_b128 v[108:111], v33 offset:6144
    v_mfma_f32_16x16x32_bf16 a[80:83], v[72:75], v[144:147], 0
    ds_read_b128 v[112:115], v33 offset:8192
    v_mfma_f32_16x16x32_bf16 a[84:87], v[72:75], v[148:151], 0
    ds_read_b128 v[116:119], v33 offset:10240
    v_mfma_f32_16x16x32_bf16 a[88:91], v[72:75], v[152:155], 0
    ds_read_b128 v[120:123], v33 offset:12288
    v_mfma_f32_16x16x32_bf16 a[92:95], v[72:75], v[156:159], 0
    ds_read_b128 v[124:127], v33 offset:14336
    v_mfma_f32_16x16x32_bf16 a[96:99], v[76:79], v[128:131], 0
    v_mfma_f32_16x16x32_bf16 a[100:103], v[76:79], v[132:135], 0
    v_mfma_f32_16x16x32_bf16 a[104:107], v[76:79], v[136:139], 0
    v_mfma_f32_16x16x32_bf16 a[108:111], v[76:79], v[140:143], 0
    v_mfma_f32_16x16x32_bf16 a[112:115], v[76:79], v[144:147], 0
    v_mfma_f32_16x16x32_bf16 a[116:119], v[76:79], v[148:151], 0
    v_mfma_f32_16x16x32_bf16 a[120:123], v[76:79], v[152:155], 0
    v_mfma_f32_16x16x32_bf16 a[124:127], v[76:79], v[156:159], 0
    v_mfma_f32_16x16x32_bf16 a[128:131], v[80:83], v[128:131], 0
    v_mfma_f32_16x16x32_bf16 a[132:135], v[80:83], v[132:135], 0
    v_mfma_f32_16x16x32_bf16 a[136:139], v[80:83], v[136:139], 0
    v_mfma_f32_16x16x32_bf16 a[140:143], v[80:83], v[140:143], 0
    v_mfma_f32_16x16x32_bf16 a[144:147], v[80:83], v[144:147], 0
    v_mfma_f32_16x16x32_bf16 a[148:151], v[80:83], v[148:151], 0
    v_mfma_f32_16x16x32_bf16 a[152:155], v[80:83], v[152:155], 0
    v_mfma_f32_16x16x32_bf16 a[156:159], v[80:83], v[156:159], 0
    v_mfma_f32_16x16x32_bf16 a[160:163], v[84:87], v[128:131], 0
    v_mfma_f32_16x16x32_bf16 a[164:167], v[84:87], v[132:135], 0
    v_mfma_f32_16x16x32_bf16 a[168:171], v[84:87], v[136:139], 0
    v_mfma_f32_16x16x32_bf16 a[172:175], v[84:87], v[140:143], 0
    v_mfma_f32_16x16x32_bf16 a[176:179], v[84:87], v[144:147], 0
    v_mfma_f32_16x16x32_bf16 a[180:183], v[84:87], v[148:151], 0
    v_mfma_f32_16x16x32_bf16 a[184:187], v[84:87], v[152:155], 0
    v_mfma_f32_16x16x32_bf16 a[188:191], v[84:87], v[156:159], 0
    v_mfma_f32_16x16x32_bf16 a[192:195], v[88:91], v[128:131], 0
    v_mfma_f32_16x16x32_bf16 a[196:199], v[88:91], v[132:135], 0
    v_mfma_f32_16x16x32_bf16 a[200:203], v[88:91], v[136:139], 0
    v_mfma_f32_16x16x32_bf16 a[204:207], v[88:91], v[140:143], 0
    v_mfma_f32_16x16x32_bf16 a[208:211], v[88:91], v[144:147], 0
    v_mfma_f32_16x16x32_bf16 a[212:215], v[88:91], v[148:151], 0
    v_mfma_f32_16x16x32_bf16 a[216:219], v[88:91], v[152:155], 0
    v_mfma_f32_16x16x32_bf16 a[220:223], v[88:91], v[156:159], 0
    v_mfma_f32_16x16x32_bf16 a[224:227], v[92:95], v[128:131], 0
    v_mfma_f32_16x16x32_bf16 a[228:231], v[92:95], v[132:135], 0
    v_mfma_f32_16x16x32_bf16 a[232:235], v[92:95], v[136:139], 0
    v_mfma_f32_16x16x32_bf16 a[236:239], v[92:95], v[140:143], 0
    v_mfma_f32_16x16x32_bf16 a[240:243], v[92:95], v[144:147], 0
    v_mfma_f32_16x16x32_bf16 a[244:247], v[92:95], v[148:151], 0
    v_mfma_f32_16x16x32_bf16 a[248:251], v[92:95], v[152:155], 0
    v_mfma_f32_16x16x32_bf16 a[252:255], v[92:95], v[156:159], 0
    s_branch Lg1_N_mid
Lg1_N_top:
    s_waitcnt lgkmcnt(0)
    v_mfma_f32_16x16x32_bf16 a[0:3], v[64:67], v[128:131], a[0:3]
    ds_read_b128 v[96:99], v33 offset:0
    v_mfma_f32_16x16x32_bf16 a[4:7], v[64:67], v[132:135], a[4:7]
    ds_read_b64_tr_b16 v[160:161], v34 offset:16384
    v_mfma_f32_16x16x32_bf16 a[8:11], v[64:67], v[136:139], a[8:11]
    ds_read_b64_tr_b16 v[162:163], v34 offset:18432
    v_mfma_f32_16x16x32_bf16 a[12:15], v[64:67], v[140:143], a[12:15]
    ds_read_b64_tr_b16 v[164:165], v35 offset:16384
    v_mfma_f32_16x16x32_bf16 a[16:19], v[64:67], v[144:147], a[16:19]
    ds_read_b64_tr_b16 v[166:167], v35 offset:18432
    v_mfma_f32_16x16x32_bf16 a[20:23], v[64:67], v[148:151], a[20:23]
    ds_read_b64_tr_b16 v[168:169], v36 offset:16384
    v_mfma_f32_16x16x32_bf16 a[24:27], v[64:67], v[152:155], a[24:27]
    ds_read_b64_tr_b16 v[170:171], v36 offset:18432
    v_mfma_f32_16x16x32_bf16 a[28:31], v[64:67], v[156:159], a[28:31]
    ds_read_b64_tr_b16 v[172:173], v37 offset:16384
    v_mfma_f32_16x16x32_bf16 a[32:35], v[68:71], v[128:131], a[32:35]
    ds_read_b64_tr_b16 v[174:175], v37 offset:18432
    v_mfma_f32_16x16x32_bf16 a[36:39], v[68:71], v[132:135], a[36:39]
    ds_read_b64_tr_b16 v[176:177], v38 offset:16384
    v_mfma_f32_16x16x32_bf16 a[40:43], v[68:71], v[136:139], a[40:43]
    ds_read_b64_tr_b16 v[178:179], v38 offset:18432
    v_mfma_f32_16x16x32_bf16 a[44:47], v[68:71], v[140:143], a[44:47]
    ds_read_b64_tr_b16 v[180:181], v39 offset:16384
    v_mfma_f32_16x16x32_bf16 a[48:51], v[68:71], v[144:147], a[48:51]
    ds_read_b64_tr_b16 v[182:183], v39 offset:18432
    v_mfma_f32_16x16x32_bf16 a[52:55], v[68:71], v[148:151], a[52:55]
    ds_read_b64_tr_b16 v[184:185], v40 offset:16384
    v_mfma_f32_16x16x32_bf16 a[56:59], v[68:71], v[152:155], a[56:59]
    ds_read_b64_tr_b16 v[186:187], v40 offset:18432
    v_mfma_f32_16x16x32_bf16 a[60:63], v[68:71], v[156:159], a[60:63]
    ds_read_b64_tr_b16 v[188:189], v41 offset:16384
    v_mfma_f32_16x16x32_bf16 a[64:67], v[72:75], v[128:131], a[64:67]
    ds_read_b64_tr_b16 v[190:191], v41 offset:18432
    v_mfma_f32_16x16x32_bf16 a[68:71], v[72:75], v[132:135], a[68:71]
    ds_read_b128 v[100:103], v33 offset:2048
    v_mfma_f32_16x16x32_bf16 a[72:75], v[72:75], v[136:139], a[72:75]
    ds_read_b128 v[104:107], v33 offset:4096
    v_mfma_f32_16x16x32_bf16 a[76:79], v[72:75], v[140:143], a[76:79]
    ds_read_b128 v[108:111], v33 offset:6144
    v_mfma_f32_16x16x32_bf16 a[80:83], v[72:75], v[144:147], a[80:83]
    ds_read_b128 v[112:115], v33 offset:8192
    v_mfma_f32_16x16x32_bf16 a[84:87], v[72:75], v[148:151], a[84:87]
    ds_read_b128 v[116:119], v33 offset:10240
    v_mfma_f32_16x16x32_bf16 a[88:91], v[72:75], v[152:155], a[88:91]
    ds_read_b128 v[120:123], v33 offset:12288
    v_mfma_f32_16x16x32_bf16 a[92:95], v[72:75], v[156:159], a[92:95]
    ds_read_b128 v[124:127], v33 offset:14336
    v_mfma_f32_16x16x32_bf16 a[96:99], v[76:79], v[128:131], a[96:99]
    v_mfma_f32_16x16x32_bf16 a[100:103], v[76:79], v[132:135], a[100:103]
    v_mfma_f32_16x16x32_bf16 a[104:107], v[76:79], v[136:139], a[104:107]
    v_mfma_f32_16x16x32_bf16 a[108:111], v[76:79], v[140:143], a[108:111]
    v_mfma_f32_16x16x32_bf16 a[112:115], v[76:79], v[144:147], a[112:115]
    v_mfma_f32_16x16x32_bf16 a[116:119], v[76:79], v[148:151], a[116:119]
    v_mfma_f32_16x16x32_bf16 a[120:123], v[76:79], v[152:155], a[120:123]
    v_mfma_f32_16x16x32_bf16 a[124:127], v[76:79], v[156:159], a[124:127]
    v_mfma_f32_16x16x32_bf16 a[128:131], v[80:83], v[128:131], a[128:131]
    v_mfma_f32_16x16x32_bf16 a[132:135], v[80:83], v[132:135], a[132:135]
    v_mfma_f32_16x16x32_bf16 a[136:139], v[80:83], v[136:139], a[136:139]
    v_mfma_f32_16x16x32_bf16 a[140:143], v[80:83], v[140:143], a[140:143]
    v_mfma_f32_16x16x32_bf16 a[144:147], v[80:83], v[144:147], a[144:147]
    v_mfma_f32_16x16x32_bf16 a[148:151], v[80:83], v[148:151], a[148:151]
    v_mfma_f32_16x16x32_bf16 a[152:155], v[80:83], v[152:155], a[152:155]
    v_mfma_f32_16x16x32_bf16 a[156:159], v[80:83], v[156:159], a[156:159]
    v_mfma_f32_16x16x32_bf16 a[160:163], v[84:87], v[128:131], a[160:163]
    v_mfma_f32_16x16x32_bf16 a[164:167], v[84:87], v[132:135], a[164:167]
    v_mfma_f32_16x16x32_bf16 a[168:171], v[84:87], v[136:139], a[168:171]
    v_mfma_f32_16x16x32_bf16 a[172:175], v[84:87], v[140:143], a[172:175]
    v_mfma_f32_16x16x32_bf16 a[176:179], v[84:87], v[144:147], a[176:179]
    v_mfma_f32_16x16x32_bf16 a[180:183], v[84:87], v[148:151], a[180:183]
    v_mfma_f32_16x16x32_bf16 a[184:187], v[84:87], v[152:155], a[184:187]
    v_mfma_f32_16x16x32_bf16 a[188:191], v[84:87], v[156:159], a[188:191]
    v_mfma_f32_16x16x32_bf16 a[192:195], v[88:91], v[128:131], a[192:195]
    v_mfma_f32_16x16x32_bf16 a[196:199], v[88:91], v[132:135], a[196:199]
    v_mfma_f32_16x16x32_bf16 a[200:203], v[88:91], v[136:139], a[200:203]
    v_mfma_f32_16x16x32_bf16 a[204:207], v[88:91], v[140:143], a[204:207]
    v_mfma_f32_16x16x32_bf16 a[208:211], v[88:91], v[144:147], a[208:211]
    v_mfma_f32_16x16x32_bf16 a[212:215], v[88:91], v[148:151], a[212:215]
    v_mfma_f32_16x16x32_bf16 a[216:219], v[88:91], v[152:155], a[216:219]
    v_mfma_f32_16x16x32_bf16 a[220:223], v[88:91], v[156:159], a[220:223]
    v_mfma_f32_16x16x32_bf16 a[224:227], v[92:95], v[128:131], a[224:227]
    v_mfma_f32_16x16x32_bf16 a[228:231], v[92:95], v[132:135], a[228:231]
    v_mfma_f32_16x16x32_bf16 a[232:235], v[92:95], v[136:139], a[232:235]
    v_mfma_f32_16x16x32_bf16 a[236:239], v[92:95], v[140:143], a[236:239]
    v_mfma_f32_16x16x32_bf16 a[240:243], v[92:95], v[144:147], a[240:243]
    v_mfma_f32_16x16x32_bf16 a[244:247], v[92:95], v[148:151], a[244:247]
    v_mfma_f32_16x16x32_bf16 a[248:251], v[92:95], v[152:155], a[248:251]
    v_mfma_f32_16x16x32_bf16 a[252:255], v[92:95], v[156:159], a[252:255]
Lg1_N_mid:
    s_cmp_eq_u32 s64, 8
    s_cbranch_scc1 Lg1_N_last
    s_waitcnt vmcnt(0) lgkmcnt(0)
    s_barrier
    s_or_b32 s31, s64, s29
    s_cbranch_scc0 Lg1_N_flag
Lg1_N_flagged:
    s_and_b32 s32, s64, 1
    s_lshl_b32 s32, s32, 16
    s_add_u32 s65, s34, s32
    s_add_u32 s66, s33, s32
    s_cmp_ge_u32 s64, 7
    s_cselect_b32 s67, 2146435072, s62
    s_cselect_b32 s68, 2146435072, s63
    v_mfma_f32_16x16x32_bf16 a[0:3], v[96:99], v[160:163], a[0:3]
    s_add_u32 m0, s65, 0
    s_add_u32 s31, s67, 0
    buffer_load_dwordx4 v2, s[8:11], s31 offen lds
    v_mfma_f32_16x16x32_bf16 a[4:7], v[96:99], v[164:167], a[4:7]
    v_xor_b32 v32, 0x10000, v32
    v_mfma_f32_16x16x32_bf16 a[8:11], v[96:99], v[168:171], a[8:11]
    v_xor_b32 v33, 0x10000, v33
    v_mfma_f32_16x16x32_bf16 a[12:15], v[96:99], v[172:175], a[12:15]
    v_xor_b32 v34, 0x10000, v34
    v_mfma_f32_16x16x32_bf16 a[16:19], v[96:99], v[176:179], a[16:19]
    s_add_u32 m0, s65, 4096
    s_add_u32 s31, s67, 36864
    buffer_load_dwordx4 v2, s[8:11], s31 offen lds
    v_mfma_f32_16x16x32_bf16 a[20:23], v[96:99], v[180:183], a[20:23]
    v_xor_b32 v35, 0x10000, v35
    v_mfma_f32_16x16x32_bf16 a[24:27], v[96:99], v[184:187], a[24:27]
    v_xor_b32 v36, 0x10000, v36
    v_mfma_f32_16x16x32_bf16 a[28:31], v[96:99], v[188:191], a[28:31]
    v_xor_b32 v37, 0x10000, v37
    v_mfma_f32_16x16x32_bf16 a[32:35], v[100:103], v[160:163], a[32:35]
    s_add_u32 m0, s65, 8192
    s_add_u32 s31, s67, 73728
    buffer_load_dwordx4 v2, s[8:11], s31 offen lds
    v_mfma_f32_16x16x32_bf16 a[36:39], v[100:103], v[164:167], a[36:39]
    v_xor_b32 v38, 0x10000, v38
    v_mfma_f32_16x16x32_bf16 a[40:43], v[100:103], v[168:171], a[40:43]
    v_xor_b32 v39, 0x10000, v39
    v_mfma_f32_16x16x32_bf16 a[44:47], v[100:103], v[172:175], a[44:47]
    v_xor_b32 v40, 0x10000, v40
    v_mfma_f32_16x16x32_bf16 a[48:51], v[100:103], v[176:179], a[48:51]
    s_add_u32 m0, s65, 12288
    s_add_u32 s31, s67, 110592
    buffer_load_dwordx4 v2, s[8:11], s31 offen lds
    v_mfma_f32_16x16x32_bf16 a[52:55], v[100:103], v[180:183], a[52:55]
    v_xor_b32 v41, 0x10000, v41
    v_mfma_f32_16x16x32_bf16 a[56:59], v[100:103], v[184:187], a[56:59]
    ds_read_b128 v[64:67], v32 offset:0
    v_mfma_f32_16x16x32_bf16 a[60:63], v[100:103], v[188:191], a[60:63]
    ds_read_b64_tr_b16 v[128:129], v34 offset:0
    v_mfma_f32_16x16x32_bf16 a[64:67], v[104:107], v[160:163], a[64:67]
    s_add_u32 m0, s65, 16384
    s_add_u32 s31, s67, 147456
    buffer_load_dwordx4 v2, s[8:11], s31 offen lds
    v_mfma_f32_16x16x32_bf16 a[68:71], v[104:107], v[164:167], a[68:71]
    ds_read_b64_tr_b16 v[130:131], v34 offset:2048
    v_mfma_f32_16x16x32_bf16 a[72:75], v[104:107], v[168:171], a[72:75]
    ds_read_b64_tr_b16 v[132:133], v35 offset:0
    v_mfma_f32_16x16x32_bf16 a[76:79], v[104:107], v[172:175], a[76:79]
    ds_read_b64_tr_b16 v[134:135], v35 offset:2048
    v_mfma_f32_16x16x32_bf16 a[80:83], v[104:107], v[176:179], a[80:83]
    s_add_u32 m0, s65, 20480
    s_add_u32 s31, s67, 184320
    buffer_load_dwordx4 v2, s[8:11], s31 offen lds
    v_mfma_f32_16x16x32_bf16 a[84:87], v[104:107], v[180:183], a[84:87]
    ds_read_b64_tr_b16 v[136:137], v36 offset:0
    v_mfma_f32_16x16x32_bf16 a[88:91], v[104:107], v[184:187], a[88:91]
    ds_read_b64_tr_b16 v[138:139], v36 offset:2048
    v_mfma_f32_16x16x32_bf16 a[92:95], v[104:107], v[188:191], a[92:95]
    ds_read_b64_tr_b16 v[140:141], v37 offset:0
    v_mfma_f32_16x16x32_bf16 a[96:99], v[108:111], v[160:163], a[96:99]
    s_add_u32 m0, s65, 24576
    s_add_u32 s31, s67, 221184
    buffer_load_dwordx4 v2, s[8:11], s31 offen lds
    v_mfma_f32_16x16x32_bf16 a[100:103], v[108:111], v[164:167], a[100:103]
    ds_read_b64_tr_b16 v[142:143], v37 offset:2048
    v_mfma_f32_16x16x32_bf16 a[104:107], v[108:111], v[168:171], a[104:107]
    ds_read_b64_tr_b16 v[144:145], v38 offset:0
    v_mfma_f32_16x16x32_bf16 a[108:111], v[108:111], v[172:175], a[108:111]
    ds_read_b64_tr_b16 v[146:147], v38 offset:2048
    v_mfma_f32_16x16x32_bf16 a[112:115], v[108:111], v[176:179], a[112:115]
    s_add_u32 m0, s65, 28672
    s_add_u32 s31, s67, 258048
    buffer_load_dwordx4 v2, s[8:11], s31 offen lds
    v_mfma_f32_16x16x32_bf16 a[116:119], v[108:111], v[180:183], a[116:119]
    ds_read_b64_tr_b16 v[148:149], v39 offset:0
    v_mfma_f32_16x16x32_bf16 a[120:123], v[108:111], v[184:187], a[120:123]
    ds_read_b64_tr_b16 v[150:151], v39 offset:2048
    v_mfma_f32_16x16x32_bf16 a[124:127], v[108:111], v[188:191], a[124:127]
    ds_read_b64_tr_b16 v[152:153], v40 offset:0
    v_mfma_f32_16x16x32_bf16 a[128:131], v[112:115], v[160:163], a[128:131]
    s_add_u32 m0, s66, 32768
    s_mul_i32 s31, s35, 0
    s_add_u32 s31, s31, s68
    buffer_load_dwordx4 v8, s[12:15], s31 offen lds
    v_mfma_f32_16x16x32_bf16 a[132:135], v[112:115], v[164:167], a[132:135]
    ds_read_b64_tr_b16 v[154:155], v40 offset:2048
    v_mfma_f32_16x16x32_bf16 a[136:139], v[112:115], v[168:171], a[136:139]
    ds_read_b64_tr_b16 v[156:157], v41 offset:0
    v_mfma_f32_16x16x32_bf16 a[140:143], v[112:115], v[172:175], a[140:143]
    ds_read_b64_tr_b16 v[158:159], v41 offset:2048
    v_mfma_f32_16x16x32_bf16 a[144:147], v[112:115], v[176:179], a[144:147]
    s_add_u32 m0, s66, 34816
    s_mul_i32 s31, s35, 4
    s_add_u32 s31, s31, s68
    buffer_load_dwordx4 v8, s[12:15], s31 offen lds
    v_mfma_f32_16x16x32_bf16 a[148:151], v[112:115], v[180:183], a[148:151]
    ds_read_b128 v[68:71], v32 offset:2048
    v_mfma_f32_16x16x32_bf16 a[152:155], v[112:115], v[184:187], a[152:155]
    ds_read_b128 v[72:75], v32 offset:4096
    v_mfma_f32_16x16x32_bf16 a[156:159], v[112:115], v[188:191], a[156:159]
    ds_read_b128 v[76:79], v32 offset:6144
    v_mfma_f32_16x16x32_bf16 a[160:163], v[116:119], v[160:163], a[160:163]
    s_add_u32 m0, s66, 40960
    s_mul_i32 s31, s35, 16
    s_add_u32 s31, s31, s68
    buffer_load_dwordx4 v8, s[12:15], s31 offen lds
    v_mfma_f32_16x16x32_bf16 a[164:167], v[116:119], v[164:167], a[164:167]
    ds_read_b128 v[80:83], v32 offset:8192
    v_mfma_f32_16x16x32_bf16 a[168:171], v[116:119], v[168:171], a[168:171]
    ds_read_b128 v[84:87], v32 offset:10240
    v_mfma_f32_16x16x32_bf16 a[172:175], v[116:119], v[172:175], a[172:175]
    ds_read_b128 v[88:91], v32 offset:12288
    v_mfma_f32_16x16x32_bf16 a[176:179], v[116:119], v[176:179], a[176:179]
    s_add_u32 m0, s66, 43008
    s_mul_i32 s31, s35, 20
    s_add_u32 s31, s31, s68
    buffer_load_dwordx4 v8, s[12:15], s31 offen lds
    v_mfma_f32_16x16x32_bf16 a[180:183], v[116:119], v[180:183], a[180:183]
    ds_read_b128 v[92:95], v32 offset:14336
    v_mfma_f32_16x16x32_bf16 a[184:187], v[116:119], v[184:187], a[184:187]
    v_mfma_f32_16x16x32_bf16 a[188:191], v[116:119], v[188:191], a[188:191]
    v_mfma_f32_16x16x32_bf16 a[192:195], v[120:123], v[160:163], a[192:195]
    s_add_u32 m0, s66, 49152
    s_mul_i32 s31, s35, 32
    s_add_u32 s31, s31, s68
    buffer_load_dwordx4 v8, s[12:15], s31 offen lds
    v_mfma_f32_16x16x32_bf16 a[196:199], v[120:123], v[164:167], a[196:199]
    v_mfma_f32_16x16x32_bf16 a[200:203], v[120:123], v[168:171], a[200:203]
    v_mfma_f32_16x16x32_bf16 a[204:207], v[120:123], v[172:175], a[204:207]
    v_mfma_f32_16x16x32_bf16 a[208:211], v[120:123], v[176:179], a[208:211]
    s_add_u32 m0, s66, 51200
    s_mul_i32 s31, s35, 36
    s_add_u32 s31, s31, s68
    buffer_load_dwordx4 v8, s[12:15], s31 offen lds
    v_mfma_f32_16x16x32_bf16 a[212:215], v[120:123], v[180:183], a[212:215]
    v_mfma_f32_16x16x32_bf16 a[216:219], v[120:123], v[184:187], a[216:219]
    v_mfma_f32_16x16x32_bf16 a[220:223], v[120:123], v[188:191], a[220:223]
    v_mfma_f32_16x16x32_bf16 a[224:227], v[124:127], v[160:163], a[224:227]
    s_add_u32 m0, s66, 57344
    s_mul_i32 s31, s35, 48
    s_add_u32 s31, s31, s68
    buffer_load_dwordx4 v8, s[12:15], s31 offen lds
    v_mfma_f32_16x16x32_bf16 a[228:231], v[124:127], v[164:167], a[228:231]
    v_mfma_f32_16x16x32_bf16 a[232:235], v[124:127], v[168:171], a[232:235]
    v_mfma_f32_16x16x32_bf16 a[236:239], v[124:127], v[172:175], a[236:239]
    v_mfma_f32_16x16x32_bf16 a[240:243], v[124:127], v[176:179], a[240:243]
    s_add_u32 m0, s66, 59392
    s_mul_i32 s31, s35, 52
    s_add_u32 s31, s31, s68
    buffer_load_dwordx4 v8, s[12:15], s31 offen lds
    v_mfma_f32_16x16x32_bf16 a[244:247], v[124:127], v[180:183], a[244:247]
    v_mfma_f32_16x16x32_bf16 a[248:251], v[124:127], v[184:187], a[248:251]
    v_mfma_f32_16x16x32_bf16 a[252:255], v[124:127], v[188:191], a[252:255]
    s_add_u32 s62, s62, 128
    s_lshl_b32 s31, s35, 6
    s_add_u32 s63, s63, s31
    s_add_u32 s64, s64, 1
    s_branch Lg1_N_top
Lg1_N_last:
    s_waitcnt vmcnt(0) lgkmcnt(0)
    s_barrier
    v_mfma_f32_16x16x32_bf16 a[0:3], v[96:99], v[160:163], a[0:3]
    v_mfma_f32_16x16x32_bf16 a[4:7], v[96:99], v[164:167], a[4:7]
    v_mfma_f32_16x16x32_bf16 a[8:11], v[96:99], v[168:171], a[8:11]
    v_mfma_f32_16x16x32_bf16 a[12:15], v[96:99], v[172:175], a[12:15]
    v_mfma_f32_16x16x32_bf16 a[16:19], v[96:99], v[176:179], a[16:19]
    v_mfma_f32_16x16x32_bf16 a[20:23], v[96:99], v[180:183], a[20:23]
    v_mfma_f32_16x16x32_bf16 a[24:27], v[96:99], v[184:187], a[24:27]
    v_mfma_f32_16x16x32_bf16 a[28:31], v[96:99], v[188:191], a[28:31]
    v_mfma_f32_16x16x32_bf16 a[32:35], v[100:103], v[160:163], a[32:35]
    v_mfma_f32_16x16x32_bf16 a[36:39], v[100:103], v[164:167], a[36:39]
    v_mfma_f32_16x16x32_bf16 a[40:43], v[100:103], v[168:171], a[40:43]
    v_mfma_f32_16x16x32_bf16 a[44:47], v[100:103], v[172:175], a[44:47]
    v_mfma_f32_16x16x32_bf16 a[48:51], v[100:103], v[176:179], a[48:51]
    v_mfma_f32_16x16x32_bf16 a[52:55], v[100:103], v[180:183], a[52:55]
    v_mfma_f32_16x16x32_bf16 a[56:59], v[100:103], v[184:187], a[56:59]
    v_mfma_f32_16x16x32_bf16 a[60:63], v[100:103], v[188:191], a[60:63]
    v_mfma_f32_16x16x32_bf16 a[64:67], v[104:107], v[160:163], a[64:67]
    v_mfma_f32_16x16x32_bf16 a[68:71], v[104:107], v[164:167], a[68:71]
    v_mfma_f32_16x16x32_bf16 a[72:75], v[104:107], v[168:171], a[72:75]
    v_mfma_f32_16x16x32_bf16 a[76:79], v[104:107], v[172:175], a[76:79]
    v_mfma_f32_16x16x32_bf16 a[80:83], v[104:107], v[176:179], a[80:83]
    v_mfma_f32_16x16x32_bf16 a[84:87], v[104:107], v[180:183], a[84:87]
    v_mfma_f32_16x16x32_bf16 a[88:91], v[104:107], v[184:187], a[88:91]
    v_mfma_f32_16x16x32_bf16 a[92:95], v[104:107], v[188:191], a[92:95]
    v_mfma_f32_16x16x32_bf16 a[96:99], v[108:111], v[160:163], a[96:99]
    v_mfma_f32_16x16x32_bf16 a[100:103], v[108:111], v[164:167], a[100:103]
    v_mfma_f32_16x16x32_bf16 a[104:107], v[108:111], v[168:171], a[104:107]
    v_mfma_f32_16x16x32_bf16 a[108:111], v[108:111], v[172:175], a[108:111]
    v_mfma_f32_16x16x32_bf16 a[112:115], v[108:111], v[176:179], a[112:115]
    v_mfma_f32_16x16x32_bf16 a[116:119], v[108:111], v[180:183], a[116:119]
    v_mfma_f32_16x16x32_bf16 a[120:123], v[108:111], v[184:187], a[120:123]
    v_mfma_f32_16x16x32_bf16 a[124:127], v[108:111], v[188:191], a[124:127]
    v_mfma_f32_16x16x32_bf16 a[128:131], v[112:115], v[160:163], a[128:131]
    v_mfma_f32_16x16x32_bf16 a[132:135], v[112:115], v[164:167], a[132:135]
    v_mfma_f32_16x16x32_bf16 a[136:139], v[112:115], v[168:171], a[136:139]
    v_mfma_f32_16x16x32_bf16 a[140:143], v[112:115], v[172:175], a[140:143]
    v_mfma_f32_16x16x32_bf16 a[144:147], v[112:115], v[176:179], a[144:147]
    v_mfma_f32_16x16x32_bf16 a[148:151], v[112:115], v[180:183], a[148:151]
    v_mfma_f32_16x16x32_bf16 a[152:155], v[112:115], v[184:187], a[152:155]
    v_mfma_f32_16x16x32_bf16 a[156:159], v[112:115], v[188:191], a[156:159]
    v_mfma_f32_16x16x32_bf16 a[160:163], v[116:119], v[160:163], a[160:163]
    v_mfma_f32_16x16x32_bf16 a[164:167], v[116:119], v[164:167], a[164:167]
    v_mfma_f32_16x16x32_bf16 a[168:171], v[116:119], v[168:171], a[168:171]
    v_mfma_f32_16x16x32_bf16 a[172:175], v[116:119], v[172:175], a[172:175]
    v_mfma_f32_16x16x32_bf16 a[176:179], v[116:119], v[176:179], a[176:179]
    v_mfma_f32_16x16x32_bf16 a[180:183], v[116:119], v[180:183], a[180:183]
    v_mfma_f32_16x16x32_bf16 a[184:187], v[116:119], v[184:187], a[184:187]
    v_mfma_f32_16x16x32_bf16 a[188:191], v[116:119], v[188:191], a[188:191]
    v_mfma_f32_16x16x32_bf16 a[192:195], v[120:123], v[160:163], a[192:195]
    v_mfma_f32_16x16x32_bf16 a[196:199], v[120:123], v[164:167], a[196:199]
    v_mfma_f32_16x16x32_bf16 a[200:203], v[120:123], v[168:171], a[200:203]
    v_mfma_f32_16x16x32_bf16 a[204:207], v[120:123], v[172:175], a[204:207]
    v_mfma_f32_16x16x32_bf16 a[208:211], v[120:123], v[176:179], a[208:211]
    v_mfma_f32_16x16x32_bf16 a[212:215], v[120:123], v[180:183], a[212:215]
    v_mfma_f32_16x16x32_bf16 a[216:219], v[120:123], v[184:187], a[216:219]
    v_mfma_f32_16x16x32_bf16 a[220:223], v[120:123], v[188:191], a[220:223]
    v_mfma_f32_16x16x32_bf16 a[224:227], v[124:127], v[160:163], a[224:227]
    v_mfma_f32_16x16x32_bf16 a[228:231], v[124:127], v[164:167], a[228:231]
    v_mfma_f32_16x16x32_bf16 a[232:235], v[124:127], v[168:171], a[232:235]
    v_mfma_f32_16x16x32_bf16 a[236:239], v[124:127], v[172:175], a[236:239]
    v_mfma_f32_16x16x32_bf16 a[240:243], v[124:127], v[176:179], a[240:243]
    v_mfma_f32_16x16x32_bf16 a[244:247], v[124:127], v[180:183], a[244:247]
    v_mfma_f32_16x16x32_bf16 a[248:251], v[124:127], v[184:187], a[248:251]
    v_mfma_f32_16x16x32_bf16 a[252:255], v[124:127], v[188:191], a[252:255]
    s_branch Lg1_epi
Lg1_N_flag:
    v_mov_b32 v254, 4
    v_mov_b32 v253, 0
    s_mov_b64 exec, 1
    buffer_atomic_add v254, v253, s[4:7], s78 offen
    s_mov_b64 exec, -1
    s_branch Lg1_N_flagged
Lg1_epi:
    s_mov_b32 s48, s83
    s_mov_b32 s83, s84
    s_mov_b32 s84, 9999
    s_cmp_ge_u32 s48, 528
    s_cbranch_scc1 Lg1_nonext
    s_and_b32 s60, s48, 7
    s_lshr_b32 s59, s48, 3
    s_mul_i32 s56, s60, 294912
    s_lshr_b32 s58, s59, 4
    s_min_u32 s58, s58, 3
    s_lshl_b32 s31, s58, 4
    s_sub_u32 s59, s59, s31
    s_lshl_b32 s57, s59, 9
    s_cmp_eq_u32 s58, 0
    s_cselect_b32 s12, s38, s40
    s_cselect_b32 s13, s39, s41
    s_cmp_eq_u32 s58, 2
    s_cselect_b32 s12, s36, s12
    s_cselect_b32 s13, s37, s13
    s_cmp_eq_u32 s58, 3
    s_cselect_b32 s12, s44, s12
    s_cselect_b32 s13, s45, s13
    s_movk_i32 s35, 8192
    s_cselect_b32 s35, 9216, s35
    s_mul_i32 s14, s35, 576
    s_cselect_b64 vcc, -1, 0
    v_cndmask_b32 v8, v3, v4, vcc
    s_mov_b32 s62, s56
    s_mov_b32 s63, s57
    s_add_u32 m0, s34, 0
    s_add_u32 s31, s62, 0
    buffer_load_dwordx4 v2, s[8:11], s31 offen lds
    s_add_u32 m0, s34, 4096
    s_add_u32 s31, s62, 36864
    buffer_load_dwordx4 v2, s[8:11], s31 offen lds
    s_add_u32 m0, s34, 8192
    s_add_u32 s31, s62, 73728
    buffer_load_dwordx4 v2, s[8:11], s31 offen lds
    s_add_u32 m0, s34, 12288
    s_add_u32 s31, s62, 110592
    buffer_load_dwordx4 v2, s[8:11], s31 offen lds
    s_add_u32 m0, s34, 16384
    s_add_u32 s31, s62, 147456
    buffer_load_dwordx4 v2, s[8:11], s31 offen lds
    s_add_u32 m0, s34, 20480
    s_add_u32 s31, s62, 184320
    buffer_load_dwordx4 v2, s[8:11], s31 offen lds
    s_add_u32 m0, s34, 24576
    s_add_u32 s31, s62, 221184
    buffer_load_dwordx4 v2, s[8:11], s31 offen lds
    s_add_u32 m0, s34, 28672
    s_add_u32 s31, s62, 258048
    buffer_load_dwordx4 v2, s[8:11], s31 offen lds
    s_add_u32 m0, s33, 32768
    s_mul_i32 s31, s35, 0
    s_add_u32 s31, s31, s63
    buffer_load_dwordx4 v8, s[12:15], s31 offen lds
    s_add_u32 m0, s33, 34816
    s_mul_i32 s31, s35, 4
    s_add_u32 s31, s31, s63
    buffer_load_dwordx4 v8, s[12:15], s31 offen lds
    s_add_u32 m0, s33, 40960
    s_mul_i32 s31, s35, 16
    s_add_u32 s31, s31, s63
    buffer_load_dwordx4 v8, s[12:15], s31 offen lds
    s_add_u32 m0, s33, 43008
    s_mul_i32 s31, s35, 20
    s_add_u32 s31, s31, s63
    buffer_load_dwordx4 v8, s[12:15], s31 offen lds
    s_add_u32 m0, s33, 49152
    s_mul_i32 s31, s35, 32
    s_add_u32 s31, s31, s63
    buffer_load_dwordx4 v8, s[12:15], s31 offen lds
    s_add_u32 m0, s33, 51200
    s_mul_i32 s31, s35, 36
    s_add_u32 s31, s31, s63
    buffer_load_dwordx4 v8, s[12:15], s31 offen lds
    s_add_u32 m0, s33, 57344
    s_mul_i32 s31, s35, 48
    s_add_u32 s31, s31, s63
    buffer_load_dwordx4 v8, s[12:15], s31 offen lds
    s_add_u32 m0, s33, 59392
    s_mul_i32 s31, s35, 52
    s_add_u32 s31, s31, s63
    buffer_load_dwordx4 v8, s[12:15], s31 offen lds
    s_add_u32 s62, s62, 128
    s_lshl_b32 s31, s35, 6
    s_add_u32 s63, s63, s31
    s_add_u32 m0, s34, 65536
    s_add_u32 s31, s62, 0
    buffer_load_dwordx4 v2, s[8:11], s31 offen lds
    s_add_u32 m0, s34, 69632
    s_add_u32 s31, s62, 36864
    buffer_load_dwordx4 v2, s[8:11], s31 offen lds
    s_add_u32 m0, s34, 73728
    s_add_u32 s31, s62, 73728
    buffer_load_dwordx4 v2, s[8:11], s31 offen lds
    s_add_u32 m0, s34, 77824
    s_add_u32 s31, s62, 110592
    buffer_load_dwordx4 v2, s[8:11], s31 offen lds
    s_add_u32 m0, s34, 81920
    s_add_u32 s31, s62, 147456
    buffer_load_dwordx4 v2, s[8:11], s31 offen lds
    s_add_u32 m0, s34, 86016
    s_add_u32 s31, s62, 184320
    buffer_load_dwordx4 v2, s[8:11], s31 offen lds
    s_add_u32 m0, s34, 90112
    s_add_u32 s31, s62, 221184
    buffer_load_dwordx4 v2, s[8:11], s31 offen lds
    s_add_u32 m0, s34, 94208
    s_add_u32 s31, s62, 258048
    buffer_load_dwordx4 v2, s[8:11], s31 offen lds
    s_add_u32 m0, s33, 98304
    s_mul_i32 s31, s35, 0
    s_add_u32 s31, s31, s63
    buffer_load_dwordx4 v8, s[12:15], s31 offen lds
    s_add_u32 m0, s33, 100352
    s_mul_i32 s31, s35, 4
    s_add_u32 s31, s31, s63
    buffer_load_dwordx4 v8, s[12:15], s31 offen lds
    s_add_u32 m0, s33, 106496
    s_mul_i32 s31, s35, 16
    s_add_u32 s31, s31, s63
    buffer_load_dwordx4 v8, s[12:15], s31 offen lds
    s_add_u32 m0, s33, 108544
    s_mul_i32 s31, s35, 20
    s_add_u32 s31, s31, s63
    buffer_load_dwordx4 v8, s[12:15], s31 offen lds
    s_add_u32 m0, s33, 114688
    s_mul_i32 s31, s35, 32
    s_add_u32 s31, s31, s63
    buffer_load_dwordx4 v8, s[12:15], s31 offen lds
    s_add_u32 m0, s33, 116736
    s_mul_i32 s31, s35, 36
    s_add_u32 s31, s31, s63
    buffer_load_dwordx4 v8, s[12:15], s31 offen lds
    s_add_u32 m0, s33, 122880
    s_mul_i32 s31, s35, 48
    s_add_u32 s31, s31, s63
    buffer_load_dwordx4 v8, s[12:15], s31 offen lds
    s_add_u32 m0, s33, 124928
    s_mul_i32 s31, s35, 52
    s_add_u32 s31, s31, s63
    buffer_load_dwordx4 v8, s[12:15], s31 offen lds
    s_add_u32 s62, s62, 128
    s_lshl_b32 s31, s35, 6
    s_add_u32 s63, s63, s31
Lg1_nonext:
    v_mov_b32 v253, 160
    buffer_load_dword v252, v253, s[20:23], 0 offen sc1
    s_lshr_b32 s69, s29, 1
    s_and_b32 s70, s29, 1
    s_lshl_b32 s31, s54, 3
    s_lshl_b32 s32, s69, 2
    s_add_u32 s71, s31, s32
    s_lshl_b32 s72, s53, 1
    s_add_u32 s72, s72, s70
    s_cmp_eq_u32 s52, 3
    s_cbranch_scc1 Lg1_epiH
    s_cmp_eq_u32 s52, 1
    s_cbranch_scc1 Lg1_epiV
    s_mul_i32 s31, s72, 65
    s_add_u32 s31, s31, s71
    s_cmp_eq_u32 s52, 0
    s_cselect_b32 s32, 14, 13
    s_lshl_b32 s73, s31, s32
    s_mov_b32 s31, 52428800
    s_cmp_eq_u32 s52, 0
    s_cselect_b32 s31, 16777216, s31
    s_add_u32 s73, s73, s31
    s_lshl_b32 s74, 1, s32
    v_accvgpr_read_b32 v192, a0
    v_accvgpr_read_b32 v193, a1
    v_accvgpr_read_b32 v194, a2
    v_accvgpr_read_b32 v195, a3
    v_accvgpr_read_b32 v196, a4
    v_accvgpr_read_b32 v197, a5
    v_accvgpr_read_b32 v198, a6
    v_accvgpr_read_b32 v199, a7
    v_cvt_pk_bf16_f32 v200, v192, v193
    v_cvt_pk_bf16_f32 v201, v194, v195
    v_cvt_pk_bf16_f32 v202, v196, v197
    v_cvt_pk_bf16_f32 v203, v198, v199
    buffer_store_dwordx4 v[200:203], v1, s[4:7], s73 offen offset:0 sc1
    v_accvgpr_read_b32 v192, a8
    v_accvgpr_read_b32 v193, a9
    v_accvgpr_read_b32 v194, a10
    v_accvgpr_read_b32 v195, a11
    v_accvgpr_read_b32 v196, a12
    v_accvgpr_read_b32 v197, a13
    v_accvgpr_read_b32 v198, a14
    v_accvgpr_read_b32 v199, a15
    v_cvt_pk_bf16_f32 v204, v192, v193
    v_cvt_pk_bf16_f32 v205, v194, v195
    v_cvt_pk_bf16_f32 v206, v196, v197
    v_cvt_pk_bf16_f32 v207, v198, v199
    buffer_store_dwordx4 v[204:207], v1, s[4:7], s73 offen offset:1024 sc1
    v_accvgpr_read_b32 v192, a16
    v_accvgpr_read_b32 v193, a17
    v_accvgpr_read_b32 v194, a18
    v_accvgpr_read_b32 v195, a19
    v_accvgpr_read_b32 v196, a20
    v_accvgpr_read_b32 v197, a21
    v_accvgpr_read_b32 v198, a22
    v_accvgpr_read_b32 v199, a23
    v_cvt_pk_bf16_f32 v208, v192, v193
    v_cvt_pk_bf16_f32 v209, v194, v195
    v_cvt_pk_bf16_f32 v210, v196, v197
    v_cvt_pk_bf16_f32 v211, v198, v199
    buffer_store_dwordx4 v[208:211], v1, s[4:7], s73 offen offset:2048 sc1
    v_accvgpr_read_b32 v192, a24
    v_accvgpr_read_b32 v193, a25
    v_accvgpr_read_b32 v194, a26
    v_accvgpr_read_b32 v195, a27
    v_accvgpr_read_b32 v196, a28
    v_accvgpr_read_b32 v197, a29
    v_accvgpr_read_b32 v198, a30
    v_accvgpr_read_b32 v199, a31
    v_cvt_pk_bf16_f32 v212, v192, v193
    v_cvt_pk_bf16_f32 v213, v194, v195
    v_cvt_pk_bf16_f32 v214, v196, v197
    v_cvt_pk_bf16_f32 v215, v198, v199
    buffer_store_dwordx4 v[212:215], v1, s[4:7], s73 offen offset:3072 sc1
    v_accvgpr_read_b32 v192, a32
    v_accvgpr_read_b32 v193, a33
    v_accvgpr_read_b32 v194, a34
    v_accvgpr_read_b32 v195, a35
    v_accvgpr_read_b32 v196, a36
    v_accvgpr_read_b32 v197, a37
    v_accvgpr_read_b32 v198, a38
    v_accvgpr_read_b32 v199, a39
    v_cvt_pk_bf16_f32 v200, v192, v193
    v_cvt_pk_bf16_f32 v201, v194, v195
    v_cvt_pk_bf16_f32 v202, v196, v197
    v_cvt_pk_bf16_f32 v203, v198, v199
    s_add_u32 s31, s73, 4096
    buffer_store_dwordx4 v[200:203], v1, s[4:7], s31 offen offset:0 sc1
    v_accvgpr_read_b32 v192, a40
    v_accvgpr_read_b32 v193, a41
    v_accvgpr_read_b32 v194, a42
    v_accvgpr_read_b32 v195, a43
    v_accvgpr_read_b32 v196, a44
    v_accvgpr_read_b32 v197, a45
    v_accvgpr_read_b32 v198, a46
    v_accvgpr_read_b32 v199, a47
    v_cvt_pk_bf16_f32 v204, v192, v193
    v_cvt_pk_bf16_f32 v205, v194, v195
    v_cvt_pk_bf16_f32 v206, v196, v197
    v_cvt_pk_bf16_f32 v207, v198, v199
    buffer_store_dwordx4 v[204:207], v1, s[4:7], s31 offen offset:1024 sc1
    v_accvgpr_read_b32 v192, a48
    v_accvgpr_read_b32 v193, a49
    v_accvgpr_read_b32 v194, a50
    v_accvgpr_read_b32 v195, a51
    v_accvgpr_read_b32 v196, a52
    v_accvgpr_read_b32 v197, a53
    v_accvgpr_read_b32 v198, a54
    v_accvgpr_read_b32 v199, a55
    v_cvt_pk_bf16_f32 v208, v192, v193
    v_cvt_pk_bf16_f32 v209, v194, v195
    v_cvt_pk_bf16_f32 v210, v196, v197
    v_cvt_pk_bf16_f32 v211, v198, v199
    buffer_store_dwordx4 v[208:211], v1, s[4:7], s31 offen offset:2048 sc1
    v_accvgpr_read_b32 v192, a56
    v_accvgpr_read_b32 v193, a57
    v_accvgpr_read_b32 v194, a58
    v_accvgpr_read_b32 v195, a59
    v_accvgpr_read_b32 v196, a60
    v_accvgpr_read_b32 v197, a61
    v_accvgpr_read_b32 v198, a62
    v_accvgpr_read_b32 v199, a63
    v_cvt_pk_bf16_f32 v212, v192, v193
    v_cvt_pk_bf16_f32 v213, v194, v195
    v_cvt_pk_bf16_f32 v214, v196, v197
    v_cvt_pk_bf16_f32 v215, v198, v199
    buffer_store_dwordx4 v[212:215], v1, s[4:7], s31 offen offset:3072 sc1
    s_add_u32 s73, s73, s74
    v_accvgpr_read_b32 v192, a64
    v_accvgpr_read_b32 v193, a65
    v_accvgpr_read_b32 v194, a66
    v_accvgpr_read_b32 v195, a67
    v_accvgpr_read_b32 v196, a68
    v_accvgpr_read_b32 v197, a69
    v_accvgpr_read_b32 v198, a70
    v_accvgpr_read_b32 v199, a71
    v_cvt_pk_bf16_f32 v200, v192, v193
    v_cvt_pk_bf16_f32 v201, v194, v195
    v_cvt_pk_bf16_f32 v202, v196, v197
    v_cvt_pk_bf16_f32 v203, v198, v199
    buffer_store_dwordx4 v[200:203], v1, s[4:7], s73 offen offset:0 sc1
    v_accvgpr_read_b32 v192, a72
    v_accvgpr_read_b32 v193, a73
    v_accvgpr_read_b32 v194, a74
    v_accvgpr_read_b32 v195, a75
    v_accvgpr_read_b32 v196, a76
    v_accvgpr_read_b32 v197, a77
    v_accvgpr_read_b32 v198, a78
    v_accvgpr_read_b32 v199, a79
    v_cvt_pk_bf16_f32 v204, v192, v193
    v_cvt_pk_bf16_f32 v205, v194, v195
    v_cvt_pk_bf16_f32 v206, v196, v197
    v_cvt_pk_bf16_f32 v207, v198, v199
    buffer_store_dwordx4 v[204:207], v1, s[4:7], s73 offen offset:1024 sc1
    v_accvgpr_read_b32 v192, a80
    v_accvgpr_read_b32 v193, a81
    v_accvgpr_read_b32 v194, a82
    v_accvgpr_read_b32 v195, a83
    v_accvgpr_read_b32 v196, a84
    v_accvgpr_read_b32 v197, a85
    v_accvgpr_read_b32 v198, a86
    v_accvgpr_read_b32 v199, a87
    v_cvt_pk_bf16_f32 v208, v192, v193
    v_cvt_pk_bf16_f32 v209, v194, v195
    v_cvt_pk_bf16_f32 v210, v196, v197
    v_cvt_pk_bf16_f32 v211, v198, v199
    buffer_store_dwordx4 v[208:211], v1, s[4:7], s73 offen offset:2048 sc1
    v_accvgpr_read_b32 v192, a88
    v_accvgpr_read_b32 v193, a89
    v_accvgpr_read_b32 v194, a90
    v_accvgpr_read_b32 v195, a91
    v_accvgpr_read_b32 v196, a92
    v_accvgpr_read_b32 v197, a93
    v_accvgpr_read_b32 v198, a94
    v_accvgpr_read_b32 v199, a95
    v_cvt_pk_bf16_f32 v212, v192, v193
    v_cvt_pk_bf16_f32 v213, v194, v195
    v_cvt_pk_bf16_f32 v214, v196, v197
    v_cvt_pk_bf16_f32 v215, v198, v199
    buffer_store_dwordx4 v[212:215], v1, s[4:7], s73 offen offset:3072 sc1
    v_accvgpr_read_b32 v192, a96
    v_accvgpr_read_b32 v193, a97
    v_accvgpr_read_b32 v194, a98
    v_accvgpr_read_b32 v195, a99
    v_accvgpr_read_b32 v196, a100
    v_accvgpr_read_b32 v197, a101
    v_accvgpr_read_b32 v198, a102
    v_accvgpr_read_b32 v199, a103
    v_cvt_pk_bf16_f32 v200, v192, v193
    v_cvt_pk_bf16_f32 v201, v194, v195
    v_cvt_pk_bf16_f32 v202, v196, v197
    v_cvt_pk_bf16_f32 v203, v198, v199
    s_add_u32 s31, s73, 4096
    buffer_store_dwordx4 v[200:203], v1, s[4:7], s31 offen offset:0 sc1
    v_accvgpr_read_b32 v192, a104
    v_accvgpr_read_b32 v193, a105
    v_accvgpr_read_b32 v194, a106
    v_accvgpr_read_b32 v195, a107
    v_accvgpr_read_b32 v196, a108
    v_accvgpr_read_b32 v197, a109
    v_accvgpr_read_b32 v198, a110
    v_accvgpr_read_b32 v199, a111
    v_cvt_pk_bf16_f32 v204, v192, v193
    v_cvt_pk_bf16_f32 v205, v194, v195
    v_cvt_pk_bf16_f32 v206, v196, v197
    v_cvt_pk_bf16_f32 v207, v198, v199
    buffer_store_dwordx4 v[204:207], v1, s[4:7], s31 offen offset:1024 sc1
    v_accvgpr_read_b32 v192, a112
    v_accvgpr_read_b32 v193, a113
    v_accvgpr_read_b32 v194, a114
    v_accvgpr_read_b32 v195, a115
    v_accvgpr_read_b32 v196, a116
    v_accvgpr_read_b32 v197, a117
    v_accvgpr_read_b32 v198, a118
    v_accvgpr_read_b32 v199, a119
    v_cvt_pk_bf16_f32 v208, v192, v193
    v_cvt_pk_bf16_f32 v209, v194, v195
    v_cvt_pk_bf16_f32 v210, v196, v197
    v_cvt_pk_bf16_f32 v211, v198, v199
    buffer_store_dwordx4 v[208:211], v1, s[4:7], s31 offen offset:2048 sc1
    v_accvgpr_read_b32 v192, a120
    v_accvgpr_read_b32 v193, a121
    v_accvgpr_read_b32 v194, a122
    v_accvgpr_read_b32 v195, a123
    v_accvgpr_read_b32 v196, a124
    v_accvgpr_read_b32 v197, a125
    v_accvgpr_read_b32 v198, a126
    v_accvgpr_read_b32 v199, a127
    v_cvt_pk_bf16_f32 v212, v192, v193
    v_cvt_pk_bf16_f32 v213, v194, v195
    v_cvt_pk_bf16_f32 v214, v196, v197
    v_cvt_pk_bf16_f32 v215, v198, v199
    buffer_store_dwordx4 v[212:215], v1, s[4:7], s31 offen offset:3072 sc1
    s_add_u32 s73, s73, s74
    v_accvgpr_read_b32 v192, a128
    v_accvgpr_read_b32 v193, a129
    v_accvgpr_read_b32 v194, a130
    v_accvgpr_read_b32 v195, a131
    v_accvgpr_read_b32 v196, a132
    v_accvgpr_read_b32 v197, a133
    v_accvgpr_read_b32 v198, a134
    v_accvgpr_read_b32 v199, a135
    v_cvt_pk_bf16_f32 v200, v192, v193
    v_cvt_pk_bf16_f32 v201, v194, v195
    v_cvt_pk_bf16_f32 v202, v196, v197
    v_cvt_pk_bf16_f32 v203, v198, v199
    buffer_store_dwordx4 v[200:203], v1, s[4:7], s73 offen offset:0 sc1
    v_accvgpr_read_b32 v192, a136
    v_accvgpr_read_b32 v193, a137
    v_accvgpr_read_b32 v194, a138
    v_accvgpr_read_b32 v195, a139
    v_accvgpr_read_b32 v196, a140
    v_accvgpr_read_b32 v197, a141
    v_accvgpr_read_b32 v198, a142
    v_accvgpr_read_b32 v199, a143
    v_cvt_pk_bf16_f32 v204, v192, v193
    v_cvt_pk_bf16_f32 v205, v194, v195
    v_cvt_pk_bf16_f32 v206, v196, v197
    v_cvt_pk_bf16_f32 v207, v198, v199
    buffer_store_dwordx4 v[204:207], v1, s[4:7], s73 offen offset:1024 sc1
    v_accvgpr_read_b32 v192, a144
    v_accvgpr_read_b32 v193, a145
    v_accvgpr_read_b32 v194, a146
    v_accvgpr_read_b32 v195, a147
    v_accvgpr_read_b32 v196, a148
    v_accvgpr_read_b32 v197, a149
    v_accvgpr_read_b32 v198, a150
    v_accvgpr_read_b32 v199, a151
    v_cvt_pk_bf16_f32 v208, v192, v193
    v_cvt_pk_bf16_f32 v209, v194, v195
    v_cvt_pk_bf16_f32 v210, v196, v197
    v_cvt_pk_bf16_f32 v211, v198, v199
    buffer_store_dwordx4 v[208:211], v1, s[4:7], s73 offen offset:2048 sc1
    v_accvgpr_read_b32 v192, a152
    v_accvgpr_read_b32 v193, a153
    v_accvgpr_read_b32 v194, a154
    v_accvgpr_read_b32 v195, a155
    v_accvgpr_read_b32 v196, a156
    v_accvgpr_read_b32 v197, a157
    v_accvgpr_read_b32 v198, a158
    v_accvgpr_read_b32 v199, a159
    v_cvt_pk_bf16_f32 v212, v192, v193
    v_cvt_pk_bf16_f32 v213, v194, v195
    v_cvt_pk_bf16_f32 v214, v196, v197
    v_cvt_pk_bf16_f32 v215, v198, v199
    buffer_store_dwordx4 v[212:215], v1, s[4:7], s73 offen offset:3072 sc1
    v_accvgpr_read_b32 v192, a160
    v_accvgpr_read_b32 v193, a161
    v_accvgpr_read_b32 v194, a162
    v_accvgpr_read_b32 v195, a163
    v_accvgpr_read_b32 v196, a164
    v_accvgpr_read_b32 v197, a165
    v_accvgpr_read_b32 v198, a166
    v_accvgpr_read_b32 v199, a167
    v_cvt_pk_bf16_f32 v200, v192, v193
    v_cvt_pk_bf16_f32 v201, v194, v195
    v_cvt_pk_bf16_f32 v202, v196, v197
    v_cvt_pk_bf16_f32 v203, v198, v199
    s_add_u32 s31, s73, 4096
    buffer_store_dwordx4 v[200:203], v1, s[4:7], s31 offen offset:0 sc1
    v_accvgpr_read_b32 v192, a168
    v_accvgpr_read_b32 v193, a169
    v_accvgpr_read_b32 v194, a170
    v_accvgpr_read_b32 v195, a171
    v_accvgpr_read_b32 v196, a172
    v_accvgpr_read_b32 v197, a173
    v_accvgpr_read_b32 v198, a174
    v_accvgpr_read_b32 v199, a175
    v_cvt_pk_bf16_f32 v204, v192, v193
    v_cvt_pk_bf16_f32 v205, v194, v195
    v_cvt_pk_bf16_f32 v206, v196, v197
    v_cvt_pk_bf16_f32 v207, v198, v199
    buffer_store_dwordx4 v[204:207], v1, s[4:7], s31 offen offset:1024 sc1
    v_accvgpr_read_b32 v192, a176
    v_accvgpr_read_b32 v193, a177
    v_accvgpr_read_b32 v194, a178
    v_accvgpr_read_b32 v195, a179
    v_accvgpr_read_b32 v196, a180
    v_accvgpr_read_b32 v197, a181
    v_accvgpr_read_b32 v198, a182
    v_accvgpr_read_b32 v199, a183
    v_cvt_pk_bf16_f32 v208, v192, v193
    v_cvt_pk_bf16_f32 v209, v194, v195
    v_cvt_pk_bf16_f32 v210, v196, v197
    v_cvt_pk_bf16_f32 v211, v198, v199
    buffer_store_dwordx4 v[208:211], v1, s[4:7], s31 offen offset:2048 sc1
    v_accvgpr_read_b32 v192, a184
    v_accvgpr_read_b32 v193, a185
    v_accvgpr_read_b32 v194, a186
    v_accvgpr_read_b32 v195, a187
    v_accvgpr_read_b32 v196, a188
    v_accvgpr_read_b32 v197, a189
    v_accvgpr_read_b32 v198, a190
    v_accvgpr_read_b32 v199, a191
    v_cvt_pk_bf16_f32 v212, v192, v193
    v_cvt_pk_bf16_f32 v213, v194, v195
    v_cvt_pk_bf16_f32 v214, v196, v197
    v_cvt_pk_bf16_f32 v215, v198, v199
    buffer_store_dwordx4 v[212:215], v1, s[4:7], s31 offen offset:3072 sc1
    s_add_u32 s73, s73, s74
    v_accvgpr_read_b32 v192, a192
    v_accvgpr_read_b32 v193, a193
    v_accvgpr_read_b32 v194, a194
    v_accvgpr_read_b32 v195, a195
    v_accvgpr_read_b32 v196, a196
    v_accvgpr_read_b32 v197, a197
    v_accvgpr_read_b32 v198, a198
    v_accvgpr_read_b32 v199, a199
    v_cvt_pk_bf16_f32 v200, v192, v193
    v_cvt_pk_bf16_f32 v201, v194, v195
    v_cvt_pk_bf16_f32 v202, v196, v197
    v_cvt_pk_bf16_f32 v203, v198, v199
    buffer_store_dwordx4 v[200:203], v1, s[4:7], s73 offen offset:0 sc1
    v_accvgpr_read_b32 v192, a200
    v_accvgpr_read_b32 v193, a201
    v_accvgpr_read_b32 v194, a202
    v_accvgpr_read_b32 v195, a203
    v_accvgpr_read_b32 v196, a204
    v_accvgpr_read_b32 v197, a205
    v_accvgpr_read_b32 v198, a206
    v_accvgpr_read_b32 v199, a207
    v_cvt_pk_bf16_f32 v204, v192, v193
    v_cvt_pk_bf16_f32 v205, v194, v195
    v_cvt_pk_bf16_f32 v206, v196, v197
    v_cvt_pk_bf16_f32 v207, v198, v199
    buffer_store_dwordx4 v[204:207], v1, s[4:7], s73 offen offset:1024 sc1
    v_accvgpr_read_b32 v192, a208
    v_accvgpr_read_b32 v193, a209
    v_accvgpr_read_b32 v194, a210
    v_accvgpr_read_b32 v195, a211
    v_accvgpr_read_b32 v196, a212
    v_accvgpr_read_b32 v197, a213
    v_accvgpr_read_b32 v198, a214
    v_accvgpr_read_b32 v199, a215
    v_cvt_pk_bf16_f32 v208, v192, v193
    v_cvt_pk_bf16_f32 v209, v194, v195
    v_cvt_pk_bf16_f32 v210, v196, v197
    v_cvt_pk_bf16_f32 v211, v198, v199
    buffer_store_dwordx4 v[208:211], v1, s[4:7], s73 offen offset:2048 sc1
    v_accvgpr_read_b32 v192, a216
    v_accvgpr_read_b32 v193, a217
    v_accvgpr_read_b32 v194, a218
    v_accvgpr_read_b32 v195, a219
    v_accvgpr_read_b32 v196, a220
    v_accvgpr_read_b32 v197, a221
    v_accvgpr_read_b32 v198, a222
    v_accvgpr_read_b32 v199, a223
    v_cvt_pk_bf16_f32 v212, v192, v193
    v_cvt_pk_bf16_f32 v213, v194, v195
    v_cvt_pk_bf16_f32 v214, v196, v197
    v_cvt_pk_bf16_f32 v215, v198, v199
    buffer_store_dwordx4 v[212:215], v1, s[4:7], s73 offen offset:3072 sc1
    v_accvgpr_read_b32 v192, a224
    v_accvgpr_read_b32 v193, a225
    v_accvgpr_read_b32 v194, a226
    v_accvgpr_read_b32 v195, a227
    v_accvgpr_read_b32 v196, a228
    v_accvgpr_read_b32 v197, a229
    v_accvgpr_read_b32 v198, a230
    v_accvgpr_read_b32 v199, a231
    v_cvt_pk_bf16_f32 v200, v192, v193
    v_cvt_pk_bf16_f32 v201, v194, v195
    v_cvt_pk_bf16_f32 v202, v196, v197
    v_cvt_pk_bf16_f32 v203, v198, v199
    s_add_u32 s31, s73, 4096
    buffer_store_dwordx4 v[200:203], v1, s[4:7], s31 offen offset:0 sc1
    v_accvgpr_read_b32 v192, a232
    v_accvgpr_read_b32 v193, a233
    v_accvgpr_read_b32 v194, a234
    v_accvgpr_read_b32 v195, a235
    v_accvgpr_read_b32 v196, a236
    v_accvgpr_read_b32 v197, a237
    v_accvgpr_read_b32 v198, a238
    v_accvgpr_read_b32 v199, a239
    v_cvt_pk_bf16_f32 v204, v192, v193
    v_cvt_pk_bf16_f32 v205, v194, v195
    v_cvt_pk_bf16_f32 v206, v196, v197
    v_cvt_pk_bf16_f32 v207, v198, v199
    buffer_store_dwordx4 v[204:207], v1, s[4:7], s31 offen offset:1024 sc1
    v_accvgpr_read_b32 v192, a240
    v_accvgpr_read_b32 v193, a241
    v_accvgpr_read_b32 v194, a242
    v_accvgpr_read_b32 v195, a243
    v_accvgpr_read_b32 v196, a244
    v_accvgpr_read_b32 v197, a245
    v_accvgpr_read_b32 v198, a246
    v_accvgpr_read_b32 v199, a247
    v_cvt_pk_bf16_f32 v208, v192, v193
    v_cvt_pk_bf16_f32 v209, v194, v195
    v_cvt_pk_bf16_f32 v210, v196, v197
    v_cvt_pk_bf16_f32 v211, v198, v199
    buffer_store_dwordx4 v[208:211], v1, s[4:7], s31 offen offset:2048 sc1
    v_accvgpr_read_b32 v192, a248
    v_accvgpr_read_b32 v193, a249
    v_accvgpr_read_b32 v194, a250
    v_accvgpr_read_b32 v195, a251
    v_accvgpr_read_b32 v196, a252
    v_accvgpr_read_b32 v197, a253
    v_accvgpr_read_b32 v198, a254
    v_accvgpr_read_b32 v199, a255
    v_cvt_pk_bf16_f32 v212, v192, v193
    v_cvt_pk_bf16_f32 v213, v194, v195
    v_cvt_pk_bf16_f32 v214, v196, v197
    v_cvt_pk_bf16_f32 v215, v198, v199
    buffer_store_dwordx4 v[212:215], v1, s[4:7], s31 offen offset:3072 sc1
    s_add_u32 s73, s73, s74
    s_branch Lg1_epi_done
Lg1_epiV:
    s_mul_i32 s31, s72, 65
    s_add_u32 s31, s31, s71
    s_lshl_b32 s73, s31, 14
    s_add_u32 s73, s73, 16785408
    v_accvgpr_read_b32 v192, a0
    v_accvgpr_read_b32 v193, a1
    v_accvgpr_read_b32 v194, a2
    v_accvgpr_read_b32 v195, a3
    v_accvgpr_read_b32 v196, a32
    v_accvgpr_read_b32 v197, a33
    v_accvgpr_read_b32 v198, a34
    v_accvgpr_read_b32 v199, a35
    v_cvt_pk_bf16_f32 v200, v192, v193
    v_cvt_pk_bf16_f32 v201, v194, v195
    v_cvt_pk_bf16_f32 v202, v196, v197
    v_cvt_pk_bf16_f32 v203, v198, v199
    buffer_store_dwordx4 v[200:203], v1, s[4:7], s73 offen offset:0 sc1
    v_accvgpr_read_b32 v192, a4
    v_accvgpr_read_b32 v193, a5
    v_accvgpr_read_b32 v194, a6
    v_accvgpr_read_b32 v195, a7
    v_accvgpr_read_b32 v196, a36
    v_accvgpr_read_b32 v197, a37
    v_accvgpr_read_b32 v198, a38
    v_accvgpr_read_b32 v199, a39
    v_cvt_pk_bf16_f32 v204, v192, v193
    v_cvt_pk_bf16_f32 v205, v194, v195
    v_cvt_pk_bf16_f32 v206, v196, v197
    v_cvt_pk_bf16_f32 v207, v198, v199
    buffer_store_dwordx4 v[204:207], v1, s[4:7], s73 offen offset:1024 sc1
    v_accvgpr_read_b32 v192, a8
    v_accvgpr_read_b32 v193, a9
    v_accvgpr_read_b32 v194, a10
    v_accvgpr_read_b32 v195, a11
    v_accvgpr_read_b32 v196, a40
    v_accvgpr_read_b32 v197, a41
    v_accvgpr_read_b32 v198, a42
    v_accvgpr_read_b32 v199, a43
    v_cvt_pk_bf16_f32 v208, v192, v193
    v_cvt_pk_bf16_f32 v209, v194, v195
    v_cvt_pk_bf16_f32 v210, v196, v197
    v_cvt_pk_bf16_f32 v211, v198, v199
    buffer_store_dwordx4 v[208:211], v1, s[4:7], s73 offen offset:2048 sc1
    v_accvgpr_read_b32 v192, a12
    v_accvgpr_read_b32 v193, a13
    v_accvgpr_read_b32 v194, a14
    v_accvgpr_read_b32 v195, a15
    v_accvgpr_read_b32 v196, a44
    v_accvgpr_read_b32 v197, a45
    v_accvgpr_read_b32 v198, a46
    v_accvgpr_read_b32 v199, a47
    v_cvt_pk_bf16_f32 v212, v192, v193
    v_cvt_pk_bf16_f32 v213, v194, v195
    v_cvt_pk_bf16_f32 v214, v196, v197
    v_cvt_pk_bf16_f32 v215, v198, v199
    buffer_store_dwordx4 v[212:215], v1, s[4:7], s73 offen offset:3072 sc1
    v_accvgpr_read_b32 v192, a16
    v_accvgpr_read_b32 v193, a17
    v_accvgpr_read_b32 v194, a18
    v_accvgpr_read_b32 v195, a19
    v_accvgpr_read_b32 v196, a48
    v_accvgpr_read_b32 v197, a49
    v_accvgpr_read_b32 v198, a50
    v_accvgpr_read_b32 v199, a51
    v_cvt_pk_bf16_f32 v200, v192, v193
    v_cvt_pk_bf16_f32 v201, v194, v195
    v_cvt_pk_bf16_f32 v202, v196, v197
    v_cvt_pk_bf16_f32 v203, v198, v199
    s_add_u32 s31, s73, 4096
    buffer_store_dwordx4 v[200:203], v1, s[4:7], s31 offen offset:0 sc1
    v_accvgpr_read_b32 v192, a20
    v_accvgpr_read_b32 v193, a21
    v_accvgpr_read_b32 v194, a22
    v_accvgpr_read_b32 v195, a23
    v_accvgpr_read_b32 v196, a52
    v_accvgpr_read_b32 v197, a53
    v_accvgpr_read_b32 v198, a54
    v_accvgpr_read_b32 v199, a55
    v_cvt_pk_bf16_f32 v204, v192, v193
    v_cvt_pk_bf16_f32 v205, v194, v195
    v_cvt_pk_bf16_f32 v206, v196, v197
    v_cvt_pk_bf16_f32 v207, v198, v199
    buffer_store_dwordx4 v[204:207], v1, s[4:7], s31 offen offset:1024 sc1
    v_accvgpr_read_b32 v192, a24
    v_accvgpr_read_b32 v193, a25
    v_accvgpr_read_b32 v194, a26
    v_accvgpr_read_b32 v195, a27
    v_accvgpr_read_b32 v196, a56
    v_accvgpr_read_b32 v197, a57
    v_accvgpr_read_b32 v198, a58
    v_accvgpr_read_b32 v199, a59
    v_cvt_pk_bf16_f32 v208, v192, v193
    v_cvt_pk_bf16_f32 v209, v194, v195
    v_cvt_pk_bf16_f32 v210, v196, v197
    v_cvt_pk_bf16_f32 v211, v198, v199
    buffer_store_dwordx4 v[208:211], v1, s[4:7], s31 offen offset:2048 sc1
    v_accvgpr_read_b32 v192, a28
    v_accvgpr_read_b32 v193, a29
    v_accvgpr_read_b32 v194, a30
    v_accvgpr_read_b32 v195, a31
    v_accvgpr_read_b32 v196, a60
    v_accvgpr_read_b32 v197, a61
    v_accvgpr_read_b32 v198, a62
    v_accvgpr_read_b32 v199, a63
    v_cvt_pk_bf16_f32 v212, v192, v193
    v_cvt_pk_bf16_f32 v213, v194, v195
    v_cvt_pk_bf16_f32 v214, v196, v197
    v_cvt_pk_bf16_f32 v215, v198, v199
    buffer_store_dwordx4 v[212:215], v1, s[4:7], s31 offen offset:3072 sc1
    s_add_u32 s73, s73, 16384
    v_accvgpr_read_b32 v192, a64
    v_accvgpr_read_b32 v193, a65
    v_accvgpr_read_b32 v194, a66
    v_accvgpr_read_b32 v195, a67
    v_accvgpr_read_b32 v196, a96
    v_accvgpr_read_b32 v197, a97
    v_accvgpr_read_b32 v198, a98
    v_accvgpr_read_b32 v199, a99
    v_cvt_pk_bf16_f32 v200, v192, v193
    v_cvt_pk_bf16_f32 v201, v194, v195
    v_cvt_pk_bf16_f32 v202, v196, v197
    v_cvt_pk_bf16_f32 v203, v198, v199
    buffer_store_dwordx4 v[200:203], v1, s[4:7], s73 offen offset:0 sc1
    v_accvgpr_read_b32 v192, a68
    v_accvgpr_read_b32 v193, a69
    v_accvgpr_read_b32 v194, a70
    v_accvgpr_read_b32 v195, a71
    v_accvgpr_read_b32 v196, a100
    v_accvgpr_read_b32 v197, a101
    v_accvgpr_read_b32 v198, a102
    v_accvgpr_read_b32 v199, a103
    v_cvt_pk_bf16_f32 v204, v192, v193
    v_cvt_pk_bf16_f32 v205, v194, v195
    v_cvt_pk_bf16_f32 v206, v196, v197
    v_cvt_pk_bf16_f32 v207, v198, v199
    buffer_store_dwordx4 v[204:207], v1, s[4:7], s73 offen offset:1024 sc1
    v_accvgpr_read_b32 v192, a72
    v_accvgpr_read_b32 v193, a73
    v_accvgpr_read_b32 v194, a74
    v_accvgpr_read_b32 v195, a75
    v_accvgpr_read_b32 v196, a104
    v_accvgpr_read_b32 v197, a105
    v_accvgpr_read_b32 v198, a106
    v_accvgpr_read_b32 v199, a107
    v_cvt_pk_bf16_f32 v208, v192, v193
    v_cvt_pk_bf16_f32 v209, v194, v195
    v_cvt_pk_bf16_f32 v210, v196, v197
    v_cvt_pk_bf16_f32 v211, v198, v199
    buffer_store_dwordx4 v[208:211], v1, s[4:7], s73 offen offset:2048 sc1
    v_accvgpr_read_b32 v192, a76
    v_accvgpr_read_b32 v193, a77
    v_accvgpr_read_b32 v194, a78
    v_accvgpr_read_b32 v195, a79
    v_accvgpr_read_b32 v196, a108
    v_accvgpr_read_b32 v197, a109
    v_accvgpr_read_b32 v198, a110
    v_accvgpr_read_b32 v199, a111
    v_cvt_pk_bf16_f32 v212, v192, v193
    v_cvt_pk_bf16_f32 v213, v194, v195
    v_cvt_pk_bf16_f32 v214, v196, v197
    v_cvt_pk_bf16_f32 v215, v198, v199
    buffer_store_dwordx4 v[212:215], v1, s[4:7], s73 offen offset:3072 sc1
    v_accvgpr_read_b32 v192, a80
    v_accvgpr_read_b32 v193, a81
    v_accvgpr_read_b32 v194, a82
    v_accvgpr_read_b32 v195, a83
    v_accvgpr_read_b32 v196, a112
    v_accvgpr_read_b32 v197, a113
    v_accvgpr_read_b32 v198, a114
    v_accvgpr_read_b32 v199, a115
    v_cvt_pk_bf16_f32 v200, v192, v193
    v_cvt_pk_bf16_f32 v201, v194, v195
    v_cvt_pk_bf16_f32 v202, v196, v197
    v_cvt_pk_bf16_f32 v203, v198, v199
    s_add_u32 s31, s73, 4096
    buffer_store_dwordx4 v[200:203], v1, s[4:7], s31 offen offset:0 sc1
    v_accvgpr_read_b32 v192, a84
    v_accvgpr_read_b32 v193, a85
    v_accvgpr_read_b32 v194, a86
    v_accvgpr_read_b32 v195, a87
    v_accvgpr_read_b32 v196, a116
    v_accvgpr_read_b32 v197, a117
    v_accvgpr_read_b32 v198, a118
    v_accvgpr_read_b32 v199, a119
    v_cvt_pk_bf16_f32 v204, v192, v193
    v_cvt_pk_bf16_f32 v205, v194, v195
    v_cvt_pk_bf16_f32 v206, v196, v197
    v_cvt_pk_bf16_f32 v207, v198, v199
    buffer_store_dwordx4 v[204:207], v1, s[4:7], s31 offen offset:1024 sc1
    v_accvgpr_read_b32 v192, a88
    v_accvgpr_read_b32 v193, a89
    v_accvgpr_read_b32 v194, a90
    v_accvgpr_read_b32 v195, a91
    v_accvgpr_read_b32 v196, a120
    v_accvgpr_read_b32 v197, a121
    v_accvgpr_read_b32 v198, a122
    v_accvgpr_read_b32 v199, a123
    v_cvt_pk_bf16_f32 v208, v192, v193
    v_cvt_pk_bf16_f32 v209, v194, v195
    v_cvt_pk_bf16_f32 v210, v196, v197
    v_cvt_pk_bf16_f32 v211, v198, v199
    buffer_store_dwordx4 v[208:211], v1, s[4:7], s31 offen offset:2048 sc1
    v_accvgpr_read_b32 v192, a92
    v_accvgpr_read_b32 v193, a93
    v_accvgpr_read_b32 v194, a94
    v_accvgpr_read_b32 v195, a95
    v_accvgpr_read_b32 v196, a124
    v_accvgpr_read_b32 v197, a125
    v_accvgpr_read_b32 v198, a126
    v_accvgpr_read_b32 v199, a127
    v_cvt_pk_bf16_f32 v212, v192, v193
    v_cvt_pk_bf16_f32 v213, v194, v195
    v_cvt_pk_bf16_f32 v214, v196, v197
    v_cvt_pk_bf16_f32 v215, v198, v199
    buffer_store_dwordx4 v[212:215], v1, s[4:7], s31 offen offset:3072 sc1
    s_add_u32 s73, s73, 16384
    v_accvgpr_read_b32 v192, a128
    v_accvgpr_read_b32 v193, a129
    v_accvgpr_read_b32 v194, a130
    v_accvgpr_read_b32 v195, a131
    v_accvgpr_read_b32 v196, a160
    v_accvgpr_read_b32 v197, a161
    v_accvgpr_read_b32 v198, a162
    v_accvgpr_read_b32 v199, a163
    v_cvt_pk_bf16_f32 v200, v192, v193
    v_cvt_pk_bf16_f32 v201, v194, v195
    v_cvt_pk_bf16_f32 v202, v196, v197
    v_cvt_pk_bf16_f32 v203, v198, v199
    buffer_store_dwordx4 v[200:203], v1, s[4:7], s73 offen offset:0 sc1
    v_accvgpr_read_b32 v192, a132
    v_accvgpr_read_b32 v193, a133
    v_accvgpr_read_b32 v194, a134
    v_accvgpr_read_b32 v195, a135
    v_accvgpr_read_b32 v196, a164
    v_accvgpr_read_b32 v197, a165
    v_accvgpr_read_b32 v198, a166
    v_accvgpr_read_b32 v199, a167
    v_cvt_pk_bf16_f32 v204, v192, v193
    v_cvt_pk_bf16_f32 v205, v194, v195
    v_cvt_pk_bf16_f32 v206, v196, v197
    v_cvt_pk_bf16_f32 v207, v198, v199
    buffer_store_dwordx4 v[204:207], v1, s[4:7], s73 offen offset:1024 sc1
    v_accvgpr_read_b32 v192, a136
    v_accvgpr_read_b32 v193, a137
    v_accvgpr_read_b32 v194, a138
    v_accvgpr_read_b32 v195, a139
    v_accvgpr_read_b32 v196, a168
    v_accvgpr_read_b32 v197, a169
    v_accvgpr_read_b32 v198, a170
    v_accvgpr_read_b32 v199, a171
    v_cvt_pk_bf16_f32 v208, v192, v193
    v_cvt_pk_bf16_f32 v209, v194, v195
    v_cvt_pk_bf16_f32 v210, v196, v197
    v_cvt_pk_bf16_f32 v211, v198, v199
    buffer_store_dwordx4 v[208:211], v1, s[4:7], s73 offen offset:2048 sc1
    v_accvgpr_read_b32 v192, a140
    v_accvgpr_read_b32 v193, a141
    v_accvgpr_read_b32 v194, a142
    v_accvgpr_read_b32 v195, a143
    v_accvgpr_read_b32 v196, a172
    v_accvgpr_read_b32 v197, a173
    v_accvgpr_read_b32 v198, a174
    v_accvgpr_read_b32 v199, a175
    v_cvt_pk_bf16_f32 v212, v192, v193
    v_cvt_pk_bf16_f32 v213, v194, v195
    v_cvt_pk_bf16_f32 v214, v196, v197
    v_cvt_pk_bf16_f32 v215, v198, v199
    buffer_store_dwordx4 v[212:215], v1, s[4:7], s73 offen offset:3072 sc1
    v_accvgpr_read_b32 v192, a144
    v_accvgpr_read_b32 v193, a145
    v_accvgpr_read_b32 v194, a146
    v_accvgpr_read_b32 v195, a147
    v_accvgpr_read_b32 v196, a176
    v_accvgpr_read_b32 v197, a177
    v_accvgpr_read_b32 v198, a178
    v_accvgpr_read_b32 v199, a179
    v_cvt_pk_bf16_f32 v200, v192, v193
    v_cvt_pk_bf16_f32 v201, v194, v195
    v_cvt_pk_bf16_f32 v202, v196, v197
    v_cvt_pk_bf16_f32 v203, v198, v199
    s_add_u32 s31, s73, 4096
    buffer_store_dwordx4 v[200:203], v1, s[4:7], s31 offen offset:0 sc1
    v_accvgpr_read_b32 v192, a148
    v_accvgpr_read_b32 v193, a149
    v_accvgpr_read_b32 v194, a150
    v_accvgpr_read_b32 v195, a151
    v_accvgpr_read_b32 v196, a180
    v_accvgpr_read_b32 v197, a181
    v_accvgpr_read_b32 v198, a182
    v_accvgpr_read_b32 v199, a183
    v_cvt_pk_bf16_f32 v204, v192, v193
    v_cvt_pk_bf16_f32 v205, v194, v195
    v_cvt_pk_bf16_f32 v206, v196, v197
    v_cvt_pk_bf16_f32 v207, v198, v199
    buffer_store_dwordx4 v[204:207], v1, s[4:7], s31 offen offset:1024 sc1
    v_accvgpr_read_b32 v192, a152
    v_accvgpr_read_b32 v193, a153
    v_accvgpr_read_b32 v194, a154
    v_accvgpr_read_b32 v195, a155
    v_accvgpr_read_b32 v196, a184
    v_accvgpr_read_b32 v197, a185
    v_accvgpr_read_b32 v198, a186
    v_accvgpr_read_b32 v199, a187
    v_cvt_pk_bf16_f32 v208, v192, v193
    v_cvt_pk_bf16_f32 v209, v194, v195
    v_cvt_pk_bf16_f32 v210, v196, v197
    v_cvt_pk_bf16_f32 v211, v198, v199
    buffer_store_dwordx4 v[208:211], v1, s[4:7], s31 offen offset:2048 sc1
    v_accvgpr_read_b32 v192, a156
    v_accvgpr_read_b32 v193, a157
    v_accvgpr_read_b32 v194, a158
    v_accvgpr_read_b32 v195, a159
    v_accvgpr_read_b32 v196, a188
    v_accvgpr_read_b32 v197, a189
    v_accvgpr_read_b32 v198, a190
    v_accvgpr_read_b32 v199, a191
    v_cvt_pk_bf16_f32 v212, v192, v193
    v_cvt_pk_bf16_f32 v213, v194, v195
    v_cvt_pk_bf16_f32 v214, v196, v197
    v_cvt_pk_bf16_f32 v215, v198, v199
    buffer_store_dwordx4 v[212:215], v1, s[4:7], s31 offen offset:3072 sc1
    s_add_u32 s73, s73, 16384
    v_accvgpr_read_b32 v192, a192
    v_accvgpr_read_b32 v193, a193
    v_accvgpr_read_b32 v194, a194
    v_accvgpr_read_b32 v195, a195
    v_accvgpr_read_b32 v196, a224
    v_accvgpr_read_b32 v197, a225
    v_accvgpr_read_b32 v198, a226
    v_accvgpr_read_b32 v199, a227
    v_cvt_pk_bf16_f32 v200, v192, v193
    v_cvt_pk_bf16_f32 v201, v194, v195
    v_cvt_pk_bf16_f32 v202, v196, v197
    v_cvt_pk_bf16_f32 v203, v198, v199
    buffer_store_dwordx4 v[200:203], v1, s[4:7], s73 offen offset:0 sc1
    v_accvgpr_read_b32 v192, a196
    v_accvgpr_read_b32 v193, a197
    v_accvgpr_read_b32 v194, a198
    v_accvgpr_read_b32 v195, a199
    v_accvgpr_read_b32 v196, a228
    v_accvgpr_read_b32 v197, a229
    v_accvgpr_read_b32 v198, a230
    v_accvgpr_read_b32 v199, a231
    v_cvt_pk_bf16_f32 v204, v192, v193
    v_cvt_pk_bf16_f32 v205, v194, v195
    v_cvt_pk_bf16_f32 v206, v196, v197
    v_cvt_pk_bf16_f32 v207, v198, v199
    buffer_store_dwordx4 v[204:207], v1, s[4:7], s73 offen offset:1024 sc1
    v_accvgpr_read_b32 v192, a200
    v_accvgpr_read_b32 v193, a201
    v_accvgpr_read_b32 v194, a202
    v_accvgpr_read_b32 v195, a203
    v_accvgpr_read_b32 v196, a232
    v_accvgpr_read_b32 v197, a233
    v_accvgpr_read_b32 v198, a234
    v_accvgpr_read_b32 v199, a235
    v_cvt_pk_bf16_f32 v208, v192, v193
    v_cvt_pk_bf16_f32 v209, v194, v195
    v_cvt_pk_bf16_f32 v210, v196, v197
    v_cvt_pk_bf16_f32 v211, v198, v199
    buffer_store_dwordx4 v[208:211], v1, s[4:7], s73 offen offset:2048 sc1
    v_accvgpr_read_b32 v192, a204
    v_accvgpr_read_b32 v193, a205
    v_accvgpr_read_b32 v194, a206
    v_accvgpr_read_b32 v195, a207
    v_accvgpr_read_b32 v196, a236
    v_accvgpr_read_b32 v197, a237
    v_accvgpr_read_b32 v198, a238
    v_accvgpr_read_b32 v199, a239
    v_cvt_pk_bf16_f32 v212, v192, v193
    v_cvt_pk_bf16_f32 v213, v194, v195
    v_cvt_pk_bf16_f32 v214, v196, v197
    v_cvt_pk_bf16_f32 v215, v198, v199
    buffer_store_dwordx4 v[212:215], v1, s[4:7], s73 offen offset:3072 sc1
    v_accvgpr_read_b32 v192, a208
    v_accvgpr_read_b32 v193, a209
    v_accvgpr_read_b32 v194, a210
    v_accvgpr_read_b32 v195, a211
    v_accvgpr_read_b32 v196, a240
    v_accvgpr_read_b32 v197, a241
    v_accvgpr_read_b32 v198, a242
    v_accvgpr_read_b32 v199, a243
    v_cvt_pk_bf16_f32 v200, v192, v193
    v_cvt_pk_bf16_f32 v201, v194, v195
    v_cvt_pk_bf16_f32 v202, v196, v197
    v_cvt_pk_bf16_f32 v203, v198, v199
    s_add_u32 s31, s73, 4096
    buffer_store_dwordx4 v[200:203], v1, s[4:7], s31 offen offset:0 sc1
    v_accvgpr_read_b32 v192, a212
    v_accvgpr_read_b32 v193, a213
    v_accvgpr_read_b32 v194, a214
    v_accvgpr_read_b32 v195, a215
    v_accvgpr_read_b32 v196, a244
    v_accvgpr_read_b32 v197, a245
    v_accvgpr_read_b32 v198, a246
    v_accvgpr_read_b32 v199, a247
    v_cvt_pk_bf16_f32 v204, v192, v193
    v_cvt_pk_bf16_f32 v205, v194, v195
    v_cvt_pk_bf16_f32 v206, v196, v197
    v_cvt_pk_bf16_f32 v207, v198, v199
    buffer_store_dwordx4 v[204:207], v1, s[4:7], s31 offen offset:1024 sc1
    v_accvgpr_read_b32 v192, a216
    v_accvgpr_read_b32 v193, a217
    v_accvgpr_read_b32 v194, a218
    v_accvgpr_read_b32 v195, a219
    v_accvgpr_read_b32 v196, a248
    v_accvgpr_read_b32 v197, a249
    v_accvgpr_read_b32 v198, a250
    v_accvgpr_read_b32 v199, a251
    v_cvt_pk_bf16_f32 v208, v192, v193
    v_cvt_pk_bf16_f32 v209, v194, v195
    v_cvt_pk_bf16_f32 v210, v196, v197
    v_cvt_pk_bf16_f32 v211, v198, v199
    buffer_store_dwordx4 v[208:211], v1, s[4:7], s31 offen offset:2048 sc1
    v_accvgpr_read_b32 v192, a220
    v_accvgpr_read_b32 v193, a221
    v_accvgpr_read_b32 v194, a222
    v_accvgpr_read_b32 v195, a223
    v_accvgpr_read_b32 v196, a252
    v_accvgpr_read_b32 v197, a253
    v_accvgpr_read_b32 v198, a254
    v_accvgpr_read_b32 v199, a255
    v_cvt_pk_bf16_f32 v212, v192, v193
    v_cvt_pk_bf16_f32 v213, v194, v195
    v_cvt_pk_bf16_f32 v214, v196, v197
    v_cvt_pk_bf16_f32 v215, v198, v199
    buffer_store_dwordx4 v[212:215], v1, s[4:7], s31 offen offset:3072 sc1
    s_add_u32 s73, s73, 16384
    s_branch Lg1_epi_done
Lg1_epiH:
    s_lshl_b32 s31, s72, 8
    buffer_load_dwordx4 v[200:203], v7, s[16:19], s31 offen offset:0
    buffer_load_dwordx4 v[204:207], v7, s[16:19], s31 offen offset:64
    buffer_load_dwordx4 v[208:211], v7, s[16:19], s31 offen offset:128
    buffer_load_dwordx4 v[212:215], v7, s[16:19], s31 offen offset:192
    s_mul_i32 s73, s71, 294912
    s_lshl_b32 s31, s72, 12
    s_add_u32 s73, s73, s31
    s_add_u32 s73, s73, 90177536
    s_mov_b32 s76, 0xbdd2d3e8
    s_mov_b32 s77, 0xbdd2d3e8
    v_mov_b32 v248, 0xc0135761
    v_mov_b32 v249, 0xc0135761
    s_waitcnt vmcnt(0)
    v_lshlrev_b32 v216, 16, v200
    v_and_b32 v217, 0xffff0000, v200
    v_lshlrev_b32 v218, 16, v201
    v_and_b32 v219, 0xffff0000, v201
    v_lshlrev_b32 v220, 16, v202
    v_and_b32 v221, 0xffff0000, v202
    v_lshlrev_b32 v222, 16, v203
    v_and_b32 v223, 0xffff0000, v203
    v_lshlrev_b32 v224, 16, v204
    v_and_b32 v225, 0xffff0000, v204
    v_lshlrev_b32 v226, 16, v205
    v_and_b32 v227, 0xffff0000, v205
    v_lshlrev_b32 v228, 16, v206
    v_and_b32 v229, 0xffff0000, v206
    v_lshlrev_b32 v230, 16, v207
    v_and_b32 v231, 0xffff0000, v207
    v_lshlrev_b32 v232, 16, v208
    v_and_b32 v233, 0xffff0000, v208
    v_lshlrev_b32 v234, 16, v209
    v_and_b32 v235, 0xffff0000, v209
    v_lshlrev_b32 v236, 16, v210
    v_and_b32 v237, 0xffff0000, v210
    v_lshlrev_b32 v238, 16, v211
    v_and_b32 v239, 0xffff0000, v211
    v_lshlrev_b32 v240, 16, v212
    v_and_b32 v241, 0xffff0000, v212
    v_lshlrev_b32 v242, 16, v213
    v_and_b32 v243, 0xffff0000, v213
    v_lshlrev_b32 v244, 16, v214
    v_and_b32 v245, 0xffff0000, v214
    v_lshlrev_b32 v246, 16, v215
    v_and_b32 v247, 0xffff0000, v215
    v_accvgpr_read_b32 v192, a0
    v_accvgpr_read_b32 v193, a1
    v_accvgpr_read_b32 v194, a2
    v_accvgpr_read_b32 v195, a3
    v_accvgpr_read_b32 v196, a4
    v_accvgpr_read_b32 v197, a5
    v_accvgpr_read_b32 v198, a6
    v_accvgpr_read_b32 v199, a7
    v_pk_add_f32 v[192:193], v[192:193], v[216:217]
    v_pk_add_f32 v[194:195], v[194:195], v[218:219]
    v_pk_add_f32 v[196:197], v[196:197], v[220:221]
    v_pk_add_f32 v[198:199], v[198:199], v[222:223]
    v_pk_mul_f32 v[176:177], v[192:193], v[192:193]
    v_pk_mul_f32 v[178:179], v[194:195], v[194:195]
    v_pk_mul_f32 v[180:181], v[196:197], v[196:197]
    v_pk_mul_f32 v[182:183], v[198:199], v[198:199]
    v_pk_fma_f32 v[176:177], v[176:177], s[76:77], v[248:249]
    v_pk_fma_f32 v[178:179], v[178:179], s[76:77], v[248:249]
    v_pk_fma_f32 v[180:181], v[180:181], s[76:77], v[248:249]
    v_pk_fma_f32 v[182:183], v[182:183], s[76:77], v[248:249]
    v_pk_mul_f32 v[176:177], v[176:177], v[192:193]
    v_pk_mul_f32 v[178:179], v[178:179], v[194:195]
    v_pk_mul_f32 v[180:181], v[180:181], v[196:197]
    v_pk_mul_f32 v[182:183], v[182:183], v[198:199]
    v_exp_f32 v176, v176
    v_exp_f32 v177, v177
    v_exp_f32 v178, v178
    v_exp_f32 v179, v179
    v_exp_f32 v180, v180
    v_exp_f32 v181, v181
    v_exp_f32 v182, v182
    v_exp_f32 v183, v183
    v_pk_add_f32 v[176:177], v[176:177], 1.0 op_sel_hi:[1,0]
    v_pk_add_f32 v[178:179], v[178:179], 1.0 op_sel_hi:[1,0]
    v_pk_add_f32 v[180:181], v[180:181], 1.0 op_sel_hi:[1,0]
    v_pk_add_f32 v[182:183], v[182:183], 1.0 op_sel_hi:[1,0]
    v_rcp_f32 v176, v176
    v_rcp_f32 v177, v177
    v_rcp_f32 v178, v178
    v_rcp_f32 v179, v179
    v_rcp_f32 v180, v180
    v_rcp_f32 v181, v181
    v_rcp_f32 v182, v182
    v_rcp_f32 v183, v183
    v_pk_mul_f32 v[192:193], v[192:193], v[176:177]
    v_pk_mul_f32 v[194:195], v[194:195], v[178:179]
    v_pk_mul_f32 v[196:197], v[196:197], v[180:181]
    v_pk_mul_f32 v[198:199], v[198:199], v[182:183]
    v_cvt_pk_bf16_f32 v200, v192, v193
    v_cvt_pk_bf16_f32 v201, v194, v195
    v_cvt_pk_bf16_f32 v202, v196, v197
    v_cvt_pk_bf16_f32 v203, v198, v199
    buffer_store_dwordx4 v[200:203], v1, s[4:7], s73 offen offset:0 sc1
    v_accvgpr_read_b32 v192, a8
    v_accvgpr_read_b32 v193, a9
    v_accvgpr_read_b32 v194, a10
    v_accvgpr_read_b32 v195, a11
    v_accvgpr_read_b32 v196, a12
    v_accvgpr_read_b32 v197, a13
    v_accvgpr_read_b32 v198, a14
    v_accvgpr_read_b32 v199, a15
    v_pk_add_f32 v[192:193], v[192:193], v[224:225]
    v_pk_add_f32 v[194:195], v[194:195], v[226:227]
    v_pk_add_f32 v[196:197], v[196:197], v[228:229]
    v_pk_add_f32 v[198:199], v[198:199], v[230:231]
    v_pk_mul_f32 v[176:177], v[192:193], v[192:193]
    v_pk_mul_f32 v[178:179], v[194:195], v[194:195]
    v_pk_mul_f32 v[180:181], v[196:197], v[196:197]
    v_pk_mul_f32 v[182:183], v[198:199], v[198:199]
    v_pk_fma_f32 v[176:177], v[176:177], s[76:77], v[248:249]
    v_pk_fma_f32 v[178:179], v[178:179], s[76:77], v[248:249]
    v_pk_fma_f32 v[180:181], v[180:181], s[76:77], v[248:249]
    v_pk_fma_f32 v[182:183], v[182:183], s[76:77], v[248:249]
    v_pk_mul_f32 v[176:177], v[176:177], v[192:193]
    v_pk_mul_f32 v[178:179], v[178:179], v[194:195]
    v_pk_mul_f32 v[180:181], v[180:181], v[196:197]
    v_pk_mul_f32 v[182:183], v[182:183], v[198:199]
    v_exp_f32 v176, v176
    v_exp_f32 v177, v177
    v_exp_f32 v178, v178
    v_exp_f32 v179, v179
    v_exp_f32 v180, v180
    v_exp_f32 v181, v181
    v_exp_f32 v182, v182
    v_exp_f32 v183, v183
    v_pk_add_f32 v[176:177], v[176:177], 1.0 op_sel_hi:[1,0]
    v_pk_add_f32 v[178:179], v[178:179], 1.0 op_sel_hi:[1,0]
    v_pk_add_f32 v[180:181], v[180:181], 1.0 op_sel_hi:[1,0]
    v_pk_add_f32 v[182:183], v[182:183], 1.0 op_sel_hi:[1,0]
    v_rcp_f32 v176, v176
    v_rcp_f32 v177, v177
    v_rcp_f32 v178, v178
    v_rcp_f32 v179, v179
    v_rcp_f32 v180, v180
    v_rcp_f32 v181, v181
    v_rcp_f32 v182, v182
    v_rcp_f32 v183, v183
    v_pk_mul_f32 v[192:193], v[192:193], v[176:177]
    v_pk_mul_f32 v[194:195], v[194:195], v[178:179]
    v_pk_mul_f32 v[196:197], v[196:197], v[180:181]
    v_pk_mul_f32 v[198:199], v[198:199], v[182:183]
    v_cvt_pk_bf16_f32 v204, v192, v193
    v_cvt_pk_bf16_f32 v205, v194, v195
    v_cvt_pk_bf16_f32 v206, v196, v197
    v_cvt_pk_bf16_f32 v207, v198, v199
    buffer_store_dwordx4 v[204:207], v1, s[4:7], s73 offen offset:1024 sc1
    v_accvgpr_read_b32 v192, a16
    v_accvgpr_read_b32 v193, a17
    v_accvgpr_read_b32 v194, a18
    v_accvgpr_read_b32 v195, a19
    v_accvgpr_read_b32 v196, a20
    v_accvgpr_read_b32 v197, a21
    v_accvgpr_read_b32 v198, a22
    v_accvgpr_read_b32 v199, a23
    v_pk_add_f32 v[192:193], v[192:193], v[232:233]
    v_pk_add_f32 v[194:195], v[194:195], v[234:235]
    v_pk_add_f32 v[196:197], v[196:197], v[236:237]
    v_pk_add_f32 v[198:199], v[198:199], v[238:239]
    v_pk_mul_f32 v[176:177], v[192:193], v[192:193]
    v_pk_mul_f32 v[178:179], v[194:195], v[194:195]
    v_pk_mul_f32 v[180:181], v[196:197], v[196:197]
    v_pk_mul_f32 v[182:183], v[198:199], v[198:199]
    v_pk_fma_f32 v[176:177], v[176:177], s[76:77], v[248:249]
    v_pk_fma_f32 v[178:179], v[178:179], s[76:77], v[248:249]
    v_pk_fma_f32 v[180:181], v[180:181], s[76:77], v[248:249]
    v_pk_fma_f32 v[182:183], v[182:183], s[76:77], v[248:249]
    v_pk_mul_f32 v[176:177], v[176:177], v[192:193]
    v_pk_mul_f32 v[178:179], v[178:179], v[194:195]
    v_pk_mul_f32 v[180:181], v[180:181], v[196:197]
    v_pk_mul_f32 v[182:183], v[182:183], v[198:199]
    v_exp_f32 v176, v176
    v_exp_f32 v177, v177
    v_exp_f32 v178, v178
    v_exp_f32 v179, v179
    v_exp_f32 v180, v180
    v_exp_f32 v181, v181
    v_exp_f32 v182, v182
    v_exp_f32 v183, v183
    v_pk_add_f32 v[176:177], v[176:177], 1.0 op_sel_hi:[1,0]
    v_pk_add_f32 v[178:179], v[178:179], 1.0 op_sel_hi:[1,0]
    v_pk_add_f32 v[180:181], v[180:181], 1.0 op_sel_hi:[1,0]
    v_pk_add_f32 v[182:183], v[182:183], 1.0 op_sel_hi:[1,0]
    v_rcp_f32 v176, v176
    v_rcp_f32 v177, v177
    v_rcp_f32 v178, v178
    v_rcp_f32 v179, v179
    v_rcp_f32 v180, v180
    v_rcp_f32 v181, v181
    v_rcp_f32 v182, v182
    v_rcp_f32 v183, v183
    v_pk_mul_f32 v[192:193], v[192:193], v[176:177]
    v_pk_mul_f32 v[194:195], v[194:195], v[178:179]
    v_pk_mul_f32 v[196:197], v[196:197], v[180:181]
    v_pk_mul_f32 v[198:199], v[198:199], v[182:183]
    v_cvt_pk_bf16_f32 v208, v192, v193
    v_cvt_pk_bf16_f32 v209, v194, v195
    v_cvt_pk_bf16_f32 v210, v196, v197
    v_cvt_pk_bf16_f32 v211, v198, v199
    buffer_store_dwordx4 v[208:211], v1, s[4:7], s73 offen offset:2048 sc1
    v_accvgpr_read_b32 v192, a24
    v_accvgpr_read_b32 v193, a25
    v_accvgpr_read_b32 v194, a26
    v_accvgpr_read_b32 v195, a27
    v_accvgpr_read_b32 v196, a28
    v_accvgpr_read_b32 v197, a29
    v_accvgpr_read_b32 v198, a30
    v_accvgpr_read_b32 v199, a31
    v_pk_add_f32 v[192:193], v[192:193], v[240:241]
    v_pk_add_f32 v[194:195], v[194:195], v[242:243]
    v_pk_add_f32 v[196:197], v[196:197], v[244:245]
    v_pk_add_f32 v[198:199], v[198:199], v[246:247]
    v_pk_mul_f32 v[176:177], v[192:193], v[192:193]
    v_pk_mul_f32 v[178:179], v[194:195], v[194:195]
    v_pk_mul_f32 v[180:181], v[196:197], v[196:197]
    v_pk_mul_f32 v[182:183], v[198:199], v[198:199]
    v_pk_fma_f32 v[176:177], v[176:177], s[76:77], v[248:249]
    v_pk_fma_f32 v[178:179], v[178:179], s[76:77], v[248:249]
    v_pk_fma_f32 v[180:181], v[180:181], s[76:77], v[248:249]
    v_pk_fma_f32 v[182:183], v[182:183], s[76:77], v[248:249]
    v_pk_mul_f32 v[176:177], v[176:177], v[192:193]
    v_pk_mul_f32 v[178:179], v[178:179], v[194:195]
    v_pk_mul_f32 v[180:181], v[180:181], v[196:197]
    v_pk_mul_f32 v[182:183], v[182:183], v[198:199]
    v_exp_f32 v176, v176
    v_exp_f32 v177, v177
    v_exp_f32 v178, v178
    v_exp_f32 v179, v179
    v_exp_f32 v180, v180
    v_exp_f32 v181, v181
    v_exp_f32 v182, v182
    v_exp_f32 v183, v183
    v_pk_add_f32 v[176:177], v[176:177], 1.0 op_sel_hi:[1,0]
    v_pk_add_f32 v[178:179], v[178:179], 1.0 op_sel_hi:[1,0]
    v_pk_add_f32 v[180:181], v[180:181], 1.0 op_sel_hi:[1,0]
    v_pk_add_f32 v[182:183], v[182:183], 1.0 op_sel_hi:[1,0]
    v_rcp_f32 v176, v176
    v_rcp_f32 v177, v177
    v_rcp_f32 v178, v178
    v_rcp_f32 v179, v179
    v_rcp_f32 v180, v180
    v_rcp_f32 v181, v181
    v_rcp_f32 v182, v182
    v_rcp_f32 v183, v183
    v_pk_mul_f32 v[192:193], v[192:193], v[176:177]
    v_pk_mul_f32 v[194:195], v[194:195], v[178:179]
    v_pk_mul_f32 v[196:197], v[196:197], v[180:181]
    v_pk_mul_f32 v[198:199], v[198:199], v[182:183]
    v_cvt_pk_bf16_f32 v212, v192, v193
    v_cvt_pk_bf16_f32 v213, v194, v195
    v_cvt_pk_bf16_f32 v214, v196, v197
    v_cvt_pk_bf16_f32 v215, v198, v199
    buffer_store_dwordx4 v[212:215], v1, s[4:7], s73 offen offset:3072 sc1
    s_add_u32 s73, s73, 147456
    v_accvgpr_read_b32 v192, a32
    v_accvgpr_read_b32 v193, a33
    v_accvgpr_read_b32 v194, a34
    v_accvgpr_read_b32 v195, a35
    v_accvgpr_read_b32 v196, a36
    v_accvgpr_read_b32 v197, a37
    v_accvgpr_read_b32 v198, a38
    v_accvgpr_read_b32 v199, a39
    v_pk_add_f32 v[192:193], v[192:193], v[216:217]
    v_pk_add_f32 v[194:195], v[194:195], v[218:219]
    v_pk_add_f32 v[196:197], v[196:197], v[220:221]
    v_pk_add_f32 v[198:199], v[198:199], v[222:223]
    v_pk_mul_f32 v[176:177], v[192:193], v[192:193]
    v_pk_mul_f32 v[178:179], v[194:195], v[194:195]
    v_pk_mul_f32 v[180:181], v[196:197], v[196:197]
    v_pk_mul_f32 v[182:183], v[198:199], v[198:199]
    v_pk_fma_f32 v[176:177], v[176:177], s[76:77], v[248:249]
    v_pk_fma_f32 v[178:179], v[178:179], s[76:77], v[248:249]
    v_pk_fma_f32 v[180:181], v[180:181], s[76:77], v[248:249]
    v_pk_fma_f32 v[182:183], v[182:183], s[76:77], v[248:249]
    v_pk_mul_f32 v[176:177], v[176:177], v[192:193]
    v_pk_mul_f32 v[178:179], v[178:179], v[194:195]
    v_pk_mul_f32 v[180:181], v[180:181], v[196:197]
    v_pk_mul_f32 v[182:183], v[182:183], v[198:199]
    v_exp_f32 v176, v176
    v_exp_f32 v177, v177
    v_exp_f32 v178, v178
    v_exp_f32 v179, v179
    v_exp_f32 v180, v180
    v_exp_f32 v181, v181
    v_exp_f32 v182, v182
    v_exp_f32 v183, v183
    v_pk_add_f32 v[176:177], v[176:177], 1.0 op_sel_hi:[1,0]
    v_pk_add_f32 v[178:179], v[178:179], 1.0 op_sel_hi:[1,0]
    v_pk_add_f32 v[180:181], v[180:181], 1.0 op_sel_hi:[1,0]
    v_pk_add_f32 v[182:183], v[182:183], 1.0 op_sel_hi:[1,0]
    v_rcp_f32 v176, v176
    v_rcp_f32 v177, v177
    v_rcp_f32 v178, v178
    v_rcp_f32 v179, v179
    v_rcp_f32 v180, v180
    v_rcp_f32 v181, v181
    v_rcp_f32 v182, v182
    v_rcp_f32 v183, v183
    v_pk_mul_f32 v[192:193], v[192:193], v[176:177]
    v_pk_mul_f32 v[194:195], v[194:195], v[178:179]
    v_pk_mul_f32 v[196:197], v[196:197], v[180:181]
    v_pk_mul_f32 v[198:199], v[198:199], v[182:183]
    v_cvt_pk_bf16_f32 v200, v192, v193
    v_cvt_pk_bf16_f32 v201, v194, v195
    v_cvt_pk_bf16_f32 v202, v196, v197
    v_cvt_pk_bf16_f32 v203, v198, v199
    buffer_store_dwordx4 v[200:203], v1, s[4:7], s73 offen offset:0 sc1
    v_accvgpr_read_b32 v192, a40
    v_accvgpr_read_b32 v193, a41
    v_accvgpr_read_b32 v194, a42
    v_accvgpr_read_b32 v195, a43
    v_accvgpr_read_b32 v196, a44
    v_accvgpr_read_b32 v197, a45
    v_accvgpr_read_b32 v198, a46
    v_accvgpr_read_b32 v199, a47
    v_pk_add_f32 v[192:193], v[192:193], v[224:225]
    v_pk_add_f32 v[194:195], v[194:195], v[226:227]
    v_pk_add_f32 v[196:197], v[196:197], v[228:229]
    v_pk_add_f32 v[198:199], v[198:199], v[230:231]
    v_pk_mul_f32 v[176:177], v[192:193], v[192:193]
    v_pk_mul_f32 v[178:179], v[194:195], v[194:195]
    v_pk_mul_f32 v[180:181], v[196:197], v[196:197]
    v_pk_mul_f32 v[182:183], v[198:199], v[198:199]
    v_pk_fma_f32 v[176:177], v[176:177], s[76:77], v[248:249]
    v_pk_fma_f32 v[178:179], v[178:179], s[76:77], v[248:249]
    v_pk_fma_f32 v[180:181], v[180:181], s[76:77], v[248:249]
    v_pk_fma_f32 v[182:183], v[182:183], s[76:77], v[248:249]
    v_pk_mul_f32 v[176:177], v[176:177], v[192:193]
    v_pk_mul_f32 v[178:179], v[178:179], v[194:195]
    v_pk_mul_f32 v[180:181], v[180:181], v[196:197]
    v_pk_mul_f32 v[182:183], v[182:183], v[198:199]
    v_exp_f32 v176, v176
    v_exp_f32 v177, v177
    v_exp_f32 v178, v178
    v_exp_f32 v179, v179
    v_exp_f32 v180, v180
    v_exp_f32 v181, v181
    v_exp_f32 v182, v182
    v_exp_f32 v183, v183
    v_pk_add_f32 v[176:177], v[176:177], 1.0 op_sel_hi:[1,0]
    v_pk_add_f32 v[178:179], v[178:179], 1.0 op_sel_hi:[1,0]
    v_pk_add_f32 v[180:181], v[180:181], 1.0 op_sel_hi:[1,0]
    v_pk_add_f32 v[182:183], v[182:183], 1.0 op_sel_hi:[1,0]
    v_rcp_f32 v176, v176
    v_rcp_f32 v177, v177
    v_rcp_f32 v178, v178
    v_rcp_f32 v179, v179
    v_rcp_f32 v180, v180
    v_rcp_f32 v181, v181
    v_rcp_f32 v182, v182
    v_rcp_f32 v183, v183
    v_pk_mul_f32 v[192:193], v[192:193], v[176:177]
    v_pk_mul_f32 v[194:195], v[194:195], v[178:179]
    v_pk_mul_f32 v[196:197], v[196:197], v[180:181]
    v_pk_mul_f32 v[198:199], v[198:199], v[182:183]
    v_cvt_pk_bf16_f32 v204, v192, v193
    v_cvt_pk_bf16_f32 v205, v194, v195
    v_cvt_pk_bf16_f32 v206, v196, v197
    v_cvt_pk_bf16_f32 v207, v198, v199
    buffer_store_dwordx4 v[204:207], v1, s[4:7], s73 offen offset:1024 sc1
    v_accvgpr_read_b32 v192, a48
    v_accvgpr_read_b32 v193, a49
    v_accvgpr_read_b32 v194, a50
    v_accvgpr_read_b32 v195, a51
    v_accvgpr_read_b32 v196, a52
    v_accvgpr_read_b32 v197, a53
    v_accvgpr_read_b32 v198, a54
    v_accvgpr_read_b32 v199, a55
    v_pk_add_f32 v[192:193], v[192:193], v[232:233]
    v_pk_add_f32 v[194:195], v[194:195], v[234:235]
    v_pk_add_f32 v[196:197], v[196:197], v[236:237]
    v_pk_add_f32 v[198:199], v[198:199], v[238:239]
    v_pk_mul_f32 v[176:177], v[192:193], v[192:193]
    v_pk_mul_f32 v[178:179], v[194:195], v[194:195]
    v_pk_mul_f32 v[180:181], v[196:197], v[196:197]
    v_pk_mul_f32 v[182:183], v[198:199], v[198:199]
    v_pk_fma_f32 v[176:177], v[176:177], s[76:77], v[248:249]
    v_pk_fma_f32 v[178:179], v[178:179], s[76:77], v[248:249]
    v_pk_fma_f32 v[180:181], v[180:181], s[76:77], v[248:249]
    v_pk_fma_f32 v[182:183], v[182:183], s[76:77], v[248:249]
    v_pk_mul_f32 v[176:177], v[176:177], v[192:193]
    v_pk_mul_f32 v[178:179], v[178:179], v[194:195]
    v_pk_mul_f32 v[180:181], v[180:181], v[196:197]
    v_pk_mul_f32 v[182:183], v[182:183], v[198:199]
    v_exp_f32 v176, v176
    v_exp_f32 v177, v177
    v_exp_f32 v178, v178
    v_exp_f32 v179, v179
    v_exp_f32 v180, v180
    v_exp_f32 v181, v181
    v_exp_f32 v182, v182
    v_exp_f32 v183, v183
    v_pk_add_f32 v[176:177], v[176:177], 1.0 op_sel_hi:[1,0]
    v_pk_add_f32 v[178:179], v[178:179], 1.0 op_sel_hi:[1,0]
    v_pk_add_f32 v[180:181], v[180:181], 1.0 op_sel_hi:[1,0]
    v_pk_add_f32 v[182:183], v[182:183], 1.0 op_sel_hi:[1,0]
    v_rcp_f32 v176, v176
    v_rcp_f32 v177, v177
    v_rcp_f32 v178, v178
    v_rcp_f32 v179, v179
    v_rcp_f32 v180, v180
    v_rcp_f32 v181, v181
    v_rcp_f32 v182, v182
    v_rcp_f32 v183, v183
    v_pk_mul_f32 v[192:193], v[192:193], v[176:177]
    v_pk_mul_f32 v[194:195], v[194:195], v[178:179]
    v_pk_mul_f32 v[196:197], v[196:197], v[180:181]
    v_pk_mul_f32 v[198:199], v[198:199], v[182:183]
    v_cvt_pk_bf16_f32 v208, v192, v193
    v_cvt_pk_bf16_f32 v209, v194, v195
    v_cvt_pk_bf16_f32 v210, v196, v197
    v_cvt_pk_bf16_f32 v211, v198, v199
    buffer_store_dwordx4 v[208:211], v1, s[4:7], s73 offen offset:2048 sc1
    v_accvgpr_read_b32 v192, a56
    v_accvgpr_read_b32 v193, a57
    v_accvgpr_read_b32 v194, a58
    v_accvgpr_read_b32 v195, a59
    v_accvgpr_read_b32 v196, a60
    v_accvgpr_read_b32 v197, a61
    v_accvgpr_read_b32 v198, a62
    v_accvgpr_read_b32 v199, a63
    v_pk_add_f32 v[192:193], v[192:193], v[240:241]
    v_pk_add_f32 v[194:195], v[194:195], v[242:243]
    v_pk_add_f32 v[196:197], v[196:197], v[244:245]
    v_pk_add_f32 v[198:199], v[198:199], v[246:247]
    v_pk_mul_f32 v[176:177], v[192:193], v[192:193]
    v_pk_mul_f32 v[178:179], v[194:195], v[194:195]
    v_pk_mul_f32 v[180:181], v[196:197], v[196:197]
    v_pk_mul_f32 v[182:183], v[198:199], v[198:199]
    v_pk_fma_f32 v[176:177], v[176:177], s[76:77], v[248:249]
    v_pk_fma_f32 v[178:179], v[178:179], s[76:77], v[248:249]
    v_pk_fma_f32 v[180:181], v[180:181], s[76:77], v[248:249]
    v_pk_fma_f32 v[182:183], v[182:183], s[76:77], v[248:249]
    v_pk_mul_f32 v[176:177], v[176:177], v[192:193]
    v_pk_mul_f32 v[178:179], v[178:179], v[194:195]
    v_pk_mul_f32 v[180:181], v[180:181], v[196:197]
    v_pk_mul_f32 v[182:183], v[182:183], v[198:199]
    v_exp_f32 v176, v176
    v_exp_f32 v177, v177
    v_exp_f32 v178, v178
    v_exp_f32 v179, v179
    v_exp_f32 v180, v180
    v_exp_f32 v181, v181
    v_exp_f32 v182, v182
    v_exp_f32 v183, v183
    v_pk_add_f32 v[176:177], v[176:177], 1.0 op_sel_hi:[1,0]
    v_pk_add_f32 v[178:179], v[178:179], 1.0 op_sel_hi:[1,0]
    v_pk_add_f32 v[180:181], v[180:181], 1.0 op_sel_hi:[1,0]
    v_pk_add_f32 v[182:183], v[182:183], 1.0 op_sel_hi:[1,0]
    v_rcp_f32 v176, v176
    v_rcp_f32 v177, v177
    v_rcp_f32 v178, v178
    v_rcp_f32 v179, v179
    v_rcp_f32 v180, v180
    v_rcp_f32 v181, v181
    v_rcp_f32 v182, v182
    v_rcp_f32 v183, v183
    v_pk_mul_f32 v[192:193], v[192:193], v[176:177]
    v_pk_mul_f32 v[194:195], v[194:195], v[178:179]
    v_pk_mul_f32 v[196:197], v[196:197], v[180:181]
    v_pk_mul_f32 v[198:199], v[198:199], v[182:183]
    v_cvt_pk_bf16_f32 v212, v192, v193
    v_cvt_pk_bf16_f32 v213, v194, v195
    v_cvt_pk_bf16_f32 v214, v196, v197
    v_cvt_pk_bf16_f32 v215, v198, v199
    buffer_store_dwordx4 v[212:215], v1, s[4:7], s73 offen offset:3072 sc1
    s_add_u32 s73, s73, 147456
    v_accvgpr_read_b32 v192, a64
    v_accvgpr_read_b32 v193, a65
    v_accvgpr_read_b32 v194, a66
    v_accvgpr_read_b32 v195, a67
    v_accvgpr_read_b32 v196, a68
    v_accvgpr_read_b32 v197, a69
    v_accvgpr_read_b32 v198, a70
    v_accvgpr_read_b32 v199, a71
    v_pk_add_f32 v[192:193], v[192:193], v[216:217]
    v_pk_add_f32 v[194:195], v[194:195], v[218:219]
    v_pk_add_f32 v[196:197], v[196:197], v[220:221]
    v_pk_add_f32 v[198:199], v[198:199], v[222:223]
    v_pk_mul_f32 v[176:177], v[192:193], v[192:193]
    v_pk_mul_f32 v[178:179], v[194:195], v[194:195]
    v_pk_mul_f32 v[180:181], v[196:197], v[196:197]
    v_pk_mul_f32 v[182:183], v[198:199], v[198:199]
    v_pk_fma_f32 v[176:177], v[176:177], s[76:77], v[248:249]
    v_pk_fma_f32 v[178:179], v[178:179], s[76:77], v[248:249]
    v_pk_fma_f32 v[180:181], v[180:181], s[76:77], v[248:249]
    v_pk_fma_f32 v[182:183], v[182:183], s[76:77], v[248:249]
    v_pk_mul_f32 v[176:177], v[176:177], v[192:193]
    v_pk_mul_f32 v[178:179], v[178:179], v[194:195]
    v_pk_mul_f32 v[180:181], v[180:181], v[196:197]
    v_pk_mul_f32 v[182:183], v[182:183], v[198:199]
    v_exp_f32 v176, v176
    v_exp_f32 v177, v177
    v_exp_f32 v178, v178
    v_exp_f32 v179, v179
    v_exp_f32 v180, v180
    v_exp_f32 v181, v181
    v_exp_f32 v182, v182
    v_exp_f32 v183, v183
    v_pk_add_f32 v[176:177], v[176:177], 1.0 op_sel_hi:[1,0]
    v_pk_add_f32 v[178:179], v[178:179], 1.0 op_sel_hi:[1,0]
    v_pk_add_f32 v[180:181], v[180:181], 1.0 op_sel_hi:[1,0]
    v_pk_add_f32 v[182:183], v[182:183], 1.0 op_sel_hi:[1,0]
    v_rcp_f32 v176, v176
    v_rcp_f32 v177, v177
    v_rcp_f32 v178, v178
    v_rcp_f32 v179, v179
    v_rcp_f32 v180, v180
    v_rcp_f32 v181, v181
    v_rcp_f32 v182, v182
    v_rcp_f32 v183, v183
    v_pk_mul_f32 v[192:193], v[192:193], v[176:177]
    v_pk_mul_f32 v[194:195], v[194:195], v[178:179]
    v_pk_mul_f32 v[196:197], v[196:197], v[180:181]
    v_pk_mul_f32 v[198:199], v[198:199], v[182:183]
    v_cvt_pk_bf16_f32 v200, v192, v193
    v_cvt_pk_bf16_f32 v201, v194, v195
    v_cvt_pk_bf16_f32 v202, v196, v197
    v_cvt_pk_bf16_f32 v203, v198, v199
    buffer_store_dwordx4 v[200:203], v1, s[4:7], s73 offen offset:0 sc1
    v_accvgpr_read_b32 v192, a72
    v_accvgpr_read_b32 v193, a73
    v_accvgpr_read_b32 v194, a74
    v_accvgpr_read_b32 v195, a75
    v_accvgpr_read_b32 v196, a76
    v_accvgpr_read_b32 v197, a77
    v_accvgpr_read_b32 v198, a78
    v_accvgpr_read_b32 v199, a79
    v_pk_add_f32 v[192:193], v[192:193], v[224:225]
    v_pk_add_f32 v[194:195], v[194:195], v[226:227]
    v_pk_add_f32 v[196:197], v[196:197], v[228:229]
    v_pk_add_f32 v[198:199], v[198:199], v[230:231]
    v_pk_mul_f32 v[176:177], v[192:193], v[192:193]
    v_pk_mul_f32 v[178:179], v[194:195], v[194:195]
    v_pk_mul_f32 v[180:181], v[196:197], v[196:197]
    v_pk_mul_f32 v[182:183], v[198:199], v[198:199]
    v_pk_fma_f32 v[176:177], v[176:177], s[76:77], v[248:249]
    v_pk_fma_f32 v[178:179], v[178:179], s[76:77], v[248:249]
    v_pk_fma_f32 v[180:181], v[180:181], s[76:77], v[248:249]
    v_pk_fma_f32 v[182:183], v[182:183], s[76:77], v[248:249]
    v_pk_mul_f32 v[176:177], v[176:177], v[192:193]
    v_pk_mul_f32 v[178:179], v[178:179], v[194:195]
    v_pk_mul_f32 v[180:181], v[180:181], v[196:197]
    v_pk_mul_f32 v[182:183], v[182:183], v[198:199]
    v_exp_f32 v176, v176
    v_exp_f32 v177, v177
    v_exp_f32 v178, v178
    v_exp_f32 v179, v179
    v_exp_f32 v180, v180
    v_exp_f32 v181, v181
    v_exp_f32 v182, v182
    v_exp_f32 v183, v183
    v_pk_add_f32 v[176:177], v[176:177], 1.0 op_sel_hi:[1,0]
    v_pk_add_f32 v[178:179], v[178:179], 1.0 op_sel_hi:[1,0]
    v_pk_add_f32 v[180:181], v[180:181], 1.0 op_sel_hi:[1,0]
    v_pk_add_f32 v[182:183], v[182:183], 1.0 op_sel_hi:[1,0]
    v_rcp_f32 v176, v176
    v_rcp_f32 v177, v177
    v_rcp_f32 v178, v178
    v_rcp_f32 v179, v179
    v_rcp_f32 v180, v180
    v_rcp_f32 v181, v181
    v_rcp_f32 v182, v182
    v_rcp_f32 v183, v183
    v_pk_mul_f32 v[192:193], v[192:193], v[176:177]
    v_pk_mul_f32 v[194:195], v[194:195], v[178:179]
    v_pk_mul_f32 v[196:197], v[196:197], v[180:181]
    v_pk_mul_f32 v[198:199], v[198:199], v[182:183]
    v_cvt_pk_bf16_f32 v204, v192, v193
    v_cvt_pk_bf16_f32 v205, v194, v195
    v_cvt_pk_bf16_f32 v206, v196, v197
    v_cvt_pk_bf16_f32 v207, v198, v199
    buffer_store_dwordx4 v[204:207], v1, s[4:7], s73 offen offset:1024 sc1
    v_accvgpr_read_b32 v192, a80
    v_accvgpr_read_b32 v193, a81
    v_accvgpr_read_b32 v194, a82
    v_accvgpr_read_b32 v195, a83
    v_accvgpr_read_b32 v196, a84
    v_accvgpr_read_b32 v197, a85
    v_accvgpr_read_b32 v198, a86
    v_accvgpr_read_b32 v199, a87
    v_pk_add_f32 v[192:193], v[192:193], v[232:233]
    v_pk_add_f32 v[194:195], v[194:195], v[234:235]
    v_pk_add_f32 v[196:197], v[196:197], v[236:237]
    v_pk_add_f32 v[198:199], v[198:199], v[238:239]
    v_pk_mul_f32 v[176:177], v[192:193], v[192:193]
    v_pk_mul_f32 v[178:179], v[194:195], v[194:195]
    v_pk_mul_f32 v[180:181], v[196:197], v[196:197]
    v_pk_mul_f32 v[182:183], v[198:199], v[198:199]
    v_pk_fma_f32 v[176:177], v[176:177], s[76:77], v[248:249]
    v_pk_fma_f32 v[178:179], v[178:179], s[76:77], v[248:249]
    v_pk_fma_f32 v[180:181], v[180:181], s[76:77], v[248:249]
    v_pk_fma_f32 v[182:183], v[182:183], s[76:77], v[248:249]
    v_pk_mul_f32 v[176:177], v[176:177], v[192:193]
    v_pk_mul_f32 v[178:179], v[178:179], v[194:195]
    v_pk_mul_f32 v[180:181], v[180:181], v[196:197]
    v_pk_mul_f32 v[182:183], v[182:183], v[198:199]
    v_exp_f32 v176, v176
    v_exp_f32 v177, v177
    v_exp_f32 v178, v178
    v_exp_f32 v179, v179
    v_exp_f32 v180, v180
    v_exp_f32 v181, v181
    v_exp_f32 v182, v182
    v_exp_f32 v183, v183
    v_pk_add_f32 v[176:177], v[176:177], 1.0 op_sel_hi:[1,0]
    v_pk_add_f32 v[178:179], v[178:179], 1.0 op_sel_hi:[1,0]
    v_pk_add_f32 v[180:181], v[180:181], 1.0 op_sel_hi:[1,0]
    v_pk_add_f32 v[182:183], v[182:183], 1.0 op_sel_hi:[1,0]
    v_rcp_f32 v176, v176
    v_rcp_f32 v177, v177
    v_rcp_f32 v178, v178
    v_rcp_f32 v179, v179
    v_rcp_f32 v180, v180
    v_rcp_f32 v181, v181
    v_rcp_f32 v182, v182
    v_rcp_f32 v183, v183
    v_pk_mul_f32 v[192:193], v[192:193], v[176:177]
    v_pk_mul_f32 v[194:195], v[194:195], v[178:179]
    v_pk_mul_f32 v[196:197], v[196:197], v[180:181]
    v_pk_mul_f32 v[198:199], v[198:199], v[182:183]
    v_cvt_pk_bf16_f32 v208, v192, v193
    v_cvt_pk_bf16_f32 v209, v194, v195
    v_cvt_pk_bf16_f32 v210, v196, v197
    v_cvt_pk_bf16_f32 v211, v198, v199
    buffer_store_dwordx4 v[208:211], v1, s[4:7], s73 offen offset:2048 sc1
    v_accvgpr_read_b32 v192, a88
    v_accvgpr_read_b32 v193, a89
    v_accvgpr_read_b32 v194, a90
    v_accvgpr_read_b32 v195, a91
    v_accvgpr_read_b32 v196, a92
    v_accvgpr_read_b32 v197, a93
    v_accvgpr_read_b32 v198, a94
    v_accvgpr_read_b32 v199, a95
    v_pk_add_f32 v[192:193], v[192:193], v[240:241]
    v_pk_add_f32 v[194:195], v[194:195], v[242:243]
    v_pk_add_f32 v[196:197], v[196:197], v[244:245]
    v_pk_add_f32 v[198:199], v[198:199], v[246:247]
    v_pk_mul_f32 v[176:177], v[192:193], v[192:193]
    v_pk_mul_f32 v[178:179], v[194:195], v[194:195]
    v_pk_mul_f32 v[180:181], v[196:197], v[196:197]
    v_pk_mul_f32 v[182:183], v[198:199], v[198:199]
    v_pk_fma_f32 v[176:177], v[176:177], s[76:77], v[248:249]
    v_pk_fma_f32 v[178:179], v[178:179], s[76:77], v[248:249]
    v_pk_fma_f32 v[180:181], v[180:181], s[76:77], v[248:249]
    v_pk_fma_f32 v[182:183], v[182:183], s[76:77], v[248:249]
    v_pk_mul_f32 v[176:177], v[176:177], v[192:193]
    v_pk_mul_f32 v[178:179], v[178:179], v[194:195]
    v_pk_mul_f32 v[180:181], v[180:181], v[196:197]
    v_pk_mul_f32 v[182:183], v[182:183], v[198:199]
    v_exp_f32 v176, v176
    v_exp_f32 v177, v177
    v_exp_f32 v178, v178
    v_exp_f32 v179, v179
    v_exp_f32 v180, v180
    v_exp_f32 v181, v181
    v_exp_f32 v182, v182
    v_exp_f32 v183, v183
    v_pk_add_f32 v[176:177], v[176:177], 1.0 op_sel_hi:[1,0]
    v_pk_add_f32 v[178:179], v[178:179], 1.0 op_sel_hi:[1,0]
    v_pk_add_f32 v[180:181], v[180:181], 1.0 op_sel_hi:[1,0]
    v_pk_add_f32 v[182:183], v[182:183], 1.0 op_sel_hi:[1,0]
    v_rcp_f32 v176, v176
    v_rcp_f32 v177, v177
    v_rcp_f32 v178, v178
    v_rcp_f32 v179, v179
    v_rcp_f32 v180, v180
    v_rcp_f32 v181, v181
    v_rcp_f32 v182, v182
    v_rcp_f32 v183, v183
    v_pk_mul_f32 v[192:193], v[192:193], v[176:177]
    v_pk_mul_f32 v[194:195], v[194:195], v[178:179]
    v_pk_mul_f32 v[196:197], v[196:197], v[180:181]
    v_pk_mul_f32 v[198:199], v[198:199], v[182:183]
    v_cvt_pk_bf16_f32 v212, v192, v193
    v_cvt_pk_bf16_f32 v213, v194, v195
    v_cvt_pk_bf16_f32 v214, v196, v197
    v_cvt_pk_bf16_f32 v215, v198, v199
    buffer_store_dwordx4 v[212:215], v1, s[4:7], s73 offen offset:3072 sc1
    s_add_u32 s73, s73, 147456
    v_accvgpr_read_b32 v192, a96
    v_accvgpr_read_b32 v193, a97
    v_accvgpr_read_b32 v194, a98
    v_accvgpr_read_b32 v195, a99
    v_accvgpr_read_b32 v196, a100
    v_accvgpr_read_b32 v197, a101
    v_accvgpr_read_b32 v198, a102
    v_accvgpr_read_b32 v199, a103
    v_pk_add_f32 v[192:193], v[192:193], v[216:217]
    v_pk_add_f32 v[194:195], v[194:195], v[218:219]
    v_pk_add_f32 v[196:197], v[196:197], v[220:221]
    v_pk_add_f32 v[198:199], v[198:199], v[222:223]
    v_pk_mul_f32 v[176:177], v[192:193], v[192:193]
    v_pk_mul_f32 v[178:179], v[194:195], v[194:195]
    v_pk_mul_f32 v[180:181], v[196:197], v[196:197]
    v_pk_mul_f32 v[182:183], v[198:199], v[198:199]
    v_pk_fma_f32 v[176:177], v[176:177], s[76:77], v[248:249]
    v_pk_fma_f32 v[178:179], v[178:179], s[76:77], v[248:249]
    v_pk_fma_f32 v[180:181], v[180:181], s[76:77], v[248:249]
    v_pk_fma_f32 v[182:183], v[182:183], s[76:77], v[248:249]
    v_pk_mul_f32 v[176:177], v[176:177], v[192:193]
    v_pk_mul_f32 v[178:179], v[178:179], v[194:195]
    v_pk_mul_f32 v[180:181], v[180:181], v[196:197]
    v_pk_mul_f32 v[182:183], v[182:183], v[198:199]
    v_exp_f32 v176, v176
    v_exp_f32 v177, v177
    v_exp_f32 v178, v178
    v_exp_f32 v179, v179
    v_exp_f32 v180, v180
    v_exp_f32 v181, v181
    v_exp_f32 v182, v182
    v_exp_f32 v183, v183
    v_pk_add_f32 v[176:177], v[176:177], 1.0 op_sel_hi:[1,0]
    v_pk_add_f32 v[178:179], v[178:179], 1.0 op_sel_hi:[1,0]
    v_pk_add_f32 v[180:181], v[180:181], 1.0 op_sel_hi:[1,0]
    v_pk_add_f32 v[182:183], v[182:183], 1.0 op_sel_hi:[1,0]
    v_rcp_f32 v176, v176
    v_rcp_f32 v177, v177
    v_rcp_f32 v178, v178
    v_rcp_f32 v179, v179
    v_rcp_f32 v180, v180
    v_rcp_f32 v181, v181
    v_rcp_f32 v182, v182
    v_rcp_f32 v183, v183
    v_pk_mul_f32 v[192:193], v[192:193], v[176:177]
    v_pk_mul_f32 v[194:195], v[194:195], v[178:179]
    v_pk_mul_f32 v[196:197], v[196:197], v[180:181]
    v_pk_mul_f32 v[198:199], v[198:199], v[182:183]
    v_cvt_pk_bf16_f32 v200, v192, v193
    v_cvt_pk_bf16_f32 v201, v194, v195
    v_cvt_pk_bf16_f32 v202, v196, v197
    v_cvt_pk_bf16_f32 v203, v198, v199
    buffer_store_dwordx4 v[200:203], v1, s[4:7], s73 offen offset:0 sc1
    v_accvgpr_read_b32 v192, a104
    v_accvgpr_read_b32 v193, a105
    v_accvgpr_read_b32 v194, a106
    v_accvgpr_read_b32 v195, a107
    v_accvgpr_read_b32 v196, a108
    v_accvgpr_read_b32 v197, a109
    v_accvgpr_read_b32 v198, a110
    v_accvgpr_read_b32 v199, a111
    v_pk_add_f32 v[192:193], v[192:193], v[224:225]
    v_pk_add_f32 v[194:195], v[194:195], v[226:227]
    v_pk_add_f32 v[196:197], v[196:197], v[228:229]
    v_pk_add_f32 v[198:199], v[198:199], v[230:231]
    v_pk_mul_f32 v[176:177], v[192:193], v[192:193]
    v_pk_mul_f32 v[178:179], v[194:195], v[194:195]
    v_pk_mul_f32 v[180:181], v[196:197], v[196:197]
    v_pk_mul_f32 v[182:183], v[198:199], v[198:199]
    v_pk_fma_f32 v[176:177], v[176:177], s[76:77], v[248:249]
    v_pk_fma_f32 v[178:179], v[178:179], s[76:77], v[248:249]
    v_pk_fma_f32 v[180:181], v[180:181], s[76:77], v[248:249]
    v_pk_fma_f32 v[182:183], v[182:183], s[76:77], v[248:249]
    v_pk_mul_f32 v[176:177], v[176:177], v[192:193]
    v_pk_mul_f32 v[178:179], v[178:179], v[194:195]
    v_pk_mul_f32 v[180:181], v[180:181], v[196:197]
    v_pk_mul_f32 v[182:183], v[182:183], v[198:199]
    v_exp_f32 v176, v176
    v_exp_f32 v177, v177
    v_exp_f32 v178, v178
    v_exp_f32 v179, v179
    v_exp_f32 v180, v180
    v_exp_f32 v181, v181
    v_exp_f32 v182, v182
    v_exp_f32 v183, v183
    v_pk_add_f32 v[176:177], v[176:177], 1.0 op_sel_hi:[1,0]
    v_pk_add_f32 v[178:179], v[178:179], 1.0 op_sel_hi:[1,0]
    v_pk_add_f32 v[180:181], v[180:181], 1.0 op_sel_hi:[1,0]
    v_pk_add_f32 v[182:183], v[182:183], 1.0 op_sel_hi:[1,0]
    v_rcp_f32 v176, v176
    v_rcp_f32 v177, v177
    v_rcp_f32 v178, v178
    v_rcp_f32 v179, v179
    v_rcp_f32 v180, v180
    v_rcp_f32 v181, v181
    v_rcp_f32 v182, v182
    v_rcp_f32 v183, v183
    v_pk_mul_f32 v[192:193], v[192:193], v[176:177]
    v_pk_mul_f32 v[194:195], v[194:195], v[178:179]
    v_pk_mul_f32 v[196:197], v[196:197], v[180:181]
    v_pk_mul_f32 v[198:199], v[198:199], v[182:183]
    v_cvt_pk_bf16_f32 v204, v192, v193
    v_cvt_pk_bf16_f32 v205, v194, v195
    v_cvt_pk_bf16_f32 v206, v196, v197
    v_cvt_pk_bf16_f32 v207, v198, v199
    buffer_store_dwordx4 v[204:207], v1, s[4:7], s73 offen offset:1024 sc1
    v_accvgpr_read_b32 v192, a112
    v_accvgpr_read_b32 v193, a113
    v_accvgpr_read_b32 v194, a114
    v_accvgpr_read_b32 v195, a115
    v_accvgpr_read_b32 v196, a116
    v_accvgpr_read_b32 v197, a117
    v_accvgpr_read_b32 v198, a118
    v_accvgpr_read_b32 v199, a119
    v_pk_add_f32 v[192:193], v[192:193], v[232:233]
    v_pk_add_f32 v[194:195], v[194:195], v[234:235]
    v_pk_add_f32 v[196:197], v[196:197], v[236:237]
    v_pk_add_f32 v[198:199], v[198:199], v[238:239]
    v_pk_mul_f32 v[176:177], v[192:193], v[192:193]
    v_pk_mul_f32 v[178:179], v[194:195], v[194:195]
    v_pk_mul_f32 v[180:181], v[196:197], v[196:197]
    v_pk_mul_f32 v[182:183], v[198:199], v[198:199]
    v_pk_fma_f32 v[176:177], v[176:177], s[76:77], v[248:249]
    v_pk_fma_f32 v[178:179], v[178:179], s[76:77], v[248:249]
    v_pk_fma_f32 v[180:181], v[180:181], s[76:77], v[248:249]
    v_pk_fma_f32 v[182:183], v[182:183], s[76:77], v[248:249]
    v_pk_mul_f32 v[176:177], v[176:177], v[192:193]
    v_pk_mul_f32 v[178:179], v[178:179], v[194:195]
    v_pk_mul_f32 v[180:181], v[180:181], v[196:197]
    v_pk_mul_f32 v[182:183], v[182:183], v[198:199]
    v_exp_f32 v176, v176
    v_exp_f32 v177, v177
    v_exp_f32 v178, v178
    v_exp_f32 v179, v179
    v_exp_f32 v180, v180
    v_exp_f32 v181, v181
    v_exp_f32 v182, v182
    v_exp_f32 v183, v183
    v_pk_add_f32 v[176:177], v[176:177], 1.0 op_sel_hi:[1,0]
    v_pk_add_f32 v[178:179], v[178:179], 1.0 op_sel_hi:[1,0]
    v_pk_add_f32 v[180:181], v[180:181], 1.0 op_sel_hi:[1,0]
    v_pk_add_f32 v[182:183], v[182:183], 1.0 op_sel_hi:[1,0]
    v_rcp_f32 v176, v176
    v_rcp_f32 v177, v177
    v_rcp_f32 v178, v178
    v_rcp_f32 v179, v179
    v_rcp_f32 v180, v180
    v_rcp_f32 v181, v181
    v_rcp_f32 v182, v182
    v_rcp_f32 v183, v183
    v_pk_mul_f32 v[192:193], v[192:193], v[176:177]
    v_pk_mul_f32 v[194:195], v[194:195], v[178:179]
    v_pk_mul_f32 v[196:197], v[196:197], v[180:181]
    v_pk_mul_f32 v[198:199], v[198:199], v[182:183]
    v_cvt_pk_bf16_f32 v208, v192, v193
    v_cvt_pk_bf16_f32 v209, v194, v195
    v_cvt_pk_bf16_f32 v210, v196, v197
    v_cvt_pk_bf16_f32 v211, v198, v199
    buffer_store_dwordx4 v[208:211], v1, s[4:7], s73 offen offset:2048 sc1
    v_accvgpr_read_b32 v192, a120
    v_accvgpr_read_b32 v193, a121
    v_accvgpr_read_b32 v194, a122
    v_accvgpr_read_b32 v195, a123
    v_accvgpr_read_b32 v196, a124
    v_accvgpr_read_b32 v197, a125
    v_accvgpr_read_b32 v198, a126
    v_accvgpr_read_b32 v199, a127
    v_pk_add_f32 v[192:193], v[192:193], v[240:241]
    v_pk_add_f32 v[194:195], v[194:195], v[242:243]
    v_pk_add_f32 v[196:197], v[196:197], v[244:245]
    v_pk_add_f32 v[198:199], v[198:199], v[246:247]
    v_pk_mul_f32 v[176:177], v[192:193], v[192:193]
    v_pk_mul_f32 v[178:179], v[194:195], v[194:195]
    v_pk_mul_f32 v[180:181], v[196:197], v[196:197]
    v_pk_mul_f32 v[182:183], v[198:199], v[198:199]
    v_pk_fma_f32 v[176:177], v[176:177], s[76:77], v[248:249]
    v_pk_fma_f32 v[178:179], v[178:179], s[76:77], v[248:249]
    v_pk_fma_f32 v[180:181], v[180:181], s[76:77], v[248:249]
    v_pk_fma_f32 v[182:183], v[182:183], s[76:77], v[248:249]
    v_pk_mul_f32 v[176:177], v[176:177], v[192:193]
    v_pk_mul_f32 v[178:179], v[178:179], v[194:195]
    v_pk_mul_f32 v[180:181], v[180:181], v[196:197]
    v_pk_mul_f32 v[182:183], v[182:183], v[198:199]
    v_exp_f32 v176, v176
    v_exp_f32 v177, v177
    v_exp_f32 v178, v178
    v_exp_f32 v179, v179
    v_exp_f32 v180, v180
    v_exp_f32 v181, v181
    v_exp_f32 v182, v182
    v_exp_f32 v183, v183
    v_pk_add_f32 v[176:177], v[176:177], 1.0 op_sel_hi:[1,0]
    v_pk_add_f32 v[178:179], v[178:179], 1.0 op_sel_hi:[1,0]
    v_pk_add_f32 v[180:181], v[180:181], 1.0 op_sel_hi:[1,0]
    v_pk_add_f32 v[182:183], v[182:183], 1.0 op_sel_hi:[1,0]
    v_rcp_f32 v176, v176
    v_rcp_f32 v177, v177
    v_rcp_f32 v178, v178
    v_rcp_f32 v179, v179
    v_rcp_f32 v180, v180
    v_rcp_f32 v181, v181
    v_rcp_f32 v182, v182
    v_rcp_f32 v183, v183
    v_pk_mul_f32 v[192:193], v[192:193], v[176:177]
    v_pk_mul_f32 v[194:195], v[194:195], v[178:179]
    v_pk_mul_f32 v[196:197], v[196:197], v[180:181]
    v_pk_mul_f32 v[198:199], v[198:199], v[182:183]
    v_cvt_pk_bf16_f32 v212, v192, v193
    v_cvt_pk_bf16_f32 v213, v194, v195
    v_cvt_pk_bf16_f32 v214, v196, v197
    v_cvt_pk_bf16_f32 v215, v198, v199
    buffer_store_dwordx4 v[212:215], v1, s[4:7], s73 offen offset:3072 sc1
    s_add_u32 s73, s73, 147456
    v_accvgpr_read_b32 v192, a128
    v_accvgpr_read_b32 v193, a129
    v_accvgpr_read_b32 v194, a130
    v_accvgpr_read_b32 v195, a131
    v_accvgpr_read_b32 v196, a132
    v_accvgpr_read_b32 v197, a133
    v_accvgpr_read_b32 v198, a134
    v_accvgpr_read_b32 v199, a135
    v_pk_add_f32 v[192:193], v[192:193], v[216:217]
    v_pk_add_f32 v[194:195], v[194:195], v[218:219]
    v_pk_add_f32 v[196:197], v[196:197], v[220:221]
    v_pk_add_f32 v[198:199], v[198:199], v[222:223]
    v_pk_mul_f32 v[176:177], v[192:193], v[192:193]
    v_pk_mul_f32 v[178:179], v[194:195], v[194:195]
    v_pk_mul_f32 v[180:181], v[196:197], v[196:197]
    v_pk_mul_f32 v[182:183], v[198:199], v[198:199]
    v_pk_fma_f32 v[176:177], v[176:177], s[76:77], v[248:249]
    v_pk_fma_f32 v[178:179], v[178:179], s[76:77], v[248:249]
    v_pk_fma_f32 v[180:181], v[180:181], s[76:77], v[248:249]
    v_pk_fma_f32 v[182:183], v[182:183], s[76:77], v[248:249]
    v_pk_mul_f32 v[176:177], v[176:177], v[192:193]
    v_pk_mul_f32 v[178:179], v[178:179], v[194:195]
    v_pk_mul_f32 v[180:181], v[180:181], v[196:197]
    v_pk_mul_f32 v[182:183], v[182:183], v[198:199]
    v_exp_f32 v176, v176
    v_exp_f32 v177, v177
    v_exp_f32 v178, v178
    v_exp_f32 v179, v179
    v_exp_f32 v180, v180
    v_exp_f32 v181, v181
    v_exp_f32 v182, v182
    v_exp_f32 v183, v183
    v_pk_add_f32 v[176:177], v[176:177], 1.0 op_sel_hi:[1,0]
    v_pk_add_f32 v[178:179], v[178:179], 1.0 op_sel_hi:[1,0]
    v_pk_add_f32 v[180:181], v[180:181], 1.0 op_sel_hi:[1,0]
    v_pk_add_f32 v[182:183], v[182:183], 1.0 op_sel_hi:[1,0]
    v_rcp_f32 v176, v176
    v_rcp_f32 v177, v177
    v_rcp_f32 v178, v178
    v_rcp_f32 v179, v179
    v_rcp_f32 v180, v180
    v_rcp_f32 v181, v181
    v_rcp_f32 v182, v182
    v_rcp_f32 v183, v183
    v_pk_mul_f32 v[192:193], v[192:193], v[176:177]
    v_pk_mul_f32 v[194:195], v[194:195], v[178:179]
    v_pk_mul_f32 v[196:197], v[196:197], v[180:181]
    v_pk_mul_f32 v[198:199], v[198:199], v[182:183]
    v_cvt_pk_bf16_f32 v200, v192, v193
    v_cvt_pk_bf16_f32 v201, v194, v195
    v_cvt_pk_bf16_f32 v202, v196, v197
    v_cvt_pk_bf16_f32 v203, v198, v199
    buffer_store_dwordx4 v[200:203], v1, s[4:7], s73 offen offset:0 sc1
    v_accvgpr_read_b32 v192, a136
    v_accvgpr_read_b32 v193, a137
    v_accvgpr_read_b32 v194, a138
    v_accvgpr_read_b32 v195, a139
    v_accvgpr_read_b32 v196, a140
    v_accvgpr_read_b32 v197, a141
    v_accvgpr_read_b32 v198, a142
    v_accvgpr_read_b32 v199, a143
    v_pk_add_f32 v[192:193], v[192:193], v[224:225]
    v_pk_add_f32 v[194:195], v[194:195], v[226:227]
    v_pk_add_f32 v[196:197], v[196:197], v[228:229]
    v_pk_add_f32 v[198:199], v[198:199], v[230:231]
    v_pk_mul_f32 v[176:177], v[192:193], v[192:193]
    v_pk_mul_f32 v[178:179], v[194:195], v[194:195]
    v_pk_mul_f32 v[180:181], v[196:197], v[196:197]
    v_pk_mul_f32 v[182:183], v[198:199], v[198:199]
    v_pk_fma_f32 v[176:177], v[176:177], s[76:77], v[248:249]
    v_pk_fma_f32 v[178:179], v[178:179], s[76:77], v[248:249]
    v_pk_fma_f32 v[180:181], v[180:181], s[76:77], v[248:249]
    v_pk_fma_f32 v[182:183], v[182:183], s[76:77], v[248:249]
    v_pk_mul_f32 v[176:177], v[176:177], v[192:193]
    v_pk_mul_f32 v[178:179], v[178:179], v[194:195]
    v_pk_mul_f32 v[180:181], v[180:181], v[196:197]
    v_pk_mul_f32 v[182:183], v[182:183], v[198:199]
    v_exp_f32 v176, v176
    v_exp_f32 v177, v177
    v_exp_f32 v178, v178
    v_exp_f32 v179, v179
    v_exp_f32 v180, v180
    v_exp_f32 v181, v181
    v_exp_f32 v182, v182
    v_exp_f32 v183, v183
    v_pk_add_f32 v[176:177], v[176:177], 1.0 op_sel_hi:[1,0]
    v_pk_add_f32 v[178:179], v[178:179], 1.0 op_sel_hi:[1,0]
    v_pk_add_f32 v[180:181], v[180:181], 1.0 op_sel_hi:[1,0]
    v_pk_add_f32 v[182:183], v[182:183], 1.0 op_sel_hi:[1,0]
    v_rcp_f32 v176, v176
    v_rcp_f32 v177, v177
    v_rcp_f32 v178, v178
    v_rcp_f32 v179, v179
    v_rcp_f32 v180, v180
    v_rcp_f32 v181, v181
    v_rcp_f32 v182, v182
    v_rcp_f32 v183, v183
    v_pk_mul_f32 v[192:193], v[192:193], v[176:177]
    v_pk_mul_f32 v[194:195], v[194:195], v[178:179]
    v_pk_mul_f32 v[196:197], v[196:197], v[180:181]
    v_pk_mul_f32 v[198:199], v[198:199], v[182:183]
    v_cvt_pk_bf16_f32 v204, v192, v193
    v_cvt_pk_bf16_f32 v205, v194, v195
    v_cvt_pk_bf16_f32 v206, v196, v197
    v_cvt_pk_bf16_f32 v207, v198, v199
    buffer_store_dwordx4 v[204:207], v1, s[4:7], s73 offen offset:1024 sc1
    v_accvgpr_read_b32 v192, a144
    v_accvgpr_read_b32 v193, a145
    v_accvgpr_read_b32 v194, a146
    v_accvgpr_read_b32 v195, a147
    v_accvgpr_read_b32 v196, a148
    v_accvgpr_read_b32 v197, a149
    v_accvgpr_read_b32 v198, a150
    v_accvgpr_read_b32 v199, a151
    v_pk_add_f32 v[192:193], v[192:193], v[232:233]
    v_pk_add_f32 v[194:195], v[194:195], v[234:235]
    v_pk_add_f32 v[196:197], v[196:197], v[236:237]
    v_pk_add_f32 v[198:199], v[198:199], v[238:239]
    v_pk_mul_f32 v[176:177], v[192:193], v[192:193]
    v_pk_mul_f32 v[178:179], v[194:195], v[194:195]
    v_pk_mul_f32 v[180:181], v[196:197], v[196:197]
    v_pk_mul_f32 v[182:183], v[198:199], v[198:199]
    v_pk_fma_f32 v[176:177], v[176:177], s[76:77], v[248:249]
    v_pk_fma_f32 v[178:179], v[178:179], s[76:77], v[248:249]
    v_pk_fma_f32 v[180:181], v[180:181], s[76:77], v[248:249]
    v_pk_fma_f32 v[182:183], v[182:183], s[76:77], v[248:249]
    v_pk_mul_f32 v[176:177], v[176:177], v[192:193]
    v_pk_mul_f32 v[178:179], v[178:179], v[194:195]
    v_pk_mul_f32 v[180:181], v[180:181], v[196:197]
    v_pk_mul_f32 v[182:183], v[182:183], v[198:199]
    v_exp_f32 v176, v176
    v_exp_f32 v177, v177
    v_exp_f32 v178, v178
    v_exp_f32 v179, v179
    v_exp_f32 v180, v180
    v_exp_f32 v181, v181
    v_exp_f32 v182, v182
    v_exp_f32 v183, v183
    v_pk_add_f32 v[176:177], v[176:177], 1.0 op_sel_hi:[1,0]
    v_pk_add_f32 v[178:179], v[178:179], 1.0 op_sel_hi:[1,0]
    v_pk_add_f32 v[180:181], v[180:181], 1.0 op_sel_hi:[1,0]
    v_pk_add_f32 v[182:183], v[182:183], 1.0 op_sel_hi:[1,0]
    v_rcp_f32 v176, v176
    v_rcp_f32 v177, v177
    v_rcp_f32 v178, v178
    v_rcp_f32 v179, v179
    v_rcp_f32 v180, v180
    v_rcp_f32 v181, v181
    v_rcp_f32 v182, v182
    v_rcp_f32 v183, v183
    v_pk_mul_f32 v[192:193], v[192:193], v[176:177]
    v_pk_mul_f32 v[194:195], v[194:195], v[178:179]
    v_pk_mul_f32 v[196:197], v[196:197], v[180:181]
    v_pk_mul_f32 v[198:199], v[198:199], v[182:183]
    v_cvt_pk_bf16_f32 v208, v192, v193
    v_cvt_pk_bf16_f32 v209, v194, v195
    v_cvt_pk_bf16_f32 v210, v196, v197
    v_cvt_pk_bf16_f32 v211, v198, v199
    buffer_store_dwordx4 v[208:211], v1, s[4:7], s73 offen offset:2048 sc1
    v_accvgpr_read_b32 v192, a152
    v_accvgpr_read_b32 v193, a153
    v_accvgpr_read_b32 v194, a154
    v_accvgpr_read_b32 v195, a155
    v_accvgpr_read_b32 v196, a156
    v_accvgpr_read_b32 v197, a157
    v_accvgpr_read_b32 v198, a158
    v_accvgpr_read_b32 v199, a159
    v_pk_add_f32 v[192:193], v[192:193], v[240:241]
    v_pk_add_f32 v[194:195], v[194:195], v[242:243]
    v_pk_add_f32 v[196:197], v[196:197], v[244:245]
    v_pk_add_f32 v[198:199], v[198:199], v[246:247]
    v_pk_mul_f32 v[176:177], v[192:193], v[192:193]
    v_pk_mul_f32 v[178:179], v[194:195], v[194:195]
    v_pk_mul_f32 v[180:181], v[196:197], v[196:197]
    v_pk_mul_f32 v[182:183], v[198:199], v[198:199]
    v_pk_fma_f32 v[176:177], v[176:177], s[76:77], v[248:249]
    v_pk_fma_f32 v[178:179], v[178:179], s[76:77], v[248:249]
    v_pk_fma_f32 v[180:181], v[180:181], s[76:77], v[248:249]
    v_pk_fma_f32 v[182:183], v[182:183], s[76:77], v[248:249]
    v_pk_mul_f32 v[176:177], v[176:177], v[192:193]
    v_pk_mul_f32 v[178:179], v[178:179], v[194:195]
    v_pk_mul_f32 v[180:181], v[180:181], v[196:197]
    v_pk_mul_f32 v[182:183], v[182:183], v[198:199]
    v_exp_f32 v176, v176
    v_exp_f32 v177, v177
    v_exp_f32 v178, v178
    v_exp_f32 v179, v179
    v_exp_f32 v180, v180
    v_exp_f32 v181, v181
    v_exp_f32 v182, v182
    v_exp_f32 v183, v183
    v_pk_add_f32 v[176:177], v[176:177], 1.0 op_sel_hi:[1,0]
    v_pk_add_f32 v[178:179], v[178:179], 1.0 op_sel_hi:[1,0]
    v_pk_add_f32 v[180:181], v[180:181], 1.0 op_sel_hi:[1,0]
    v_pk_add_f32 v[182:183], v[182:183], 1.0 op_sel_hi:[1,0]
    v_rcp_f32 v176, v176
    v_rcp_f32 v177, v177
    v_rcp_f32 v178, v178
    v_rcp_f32 v179, v179
    v_rcp_f32 v180, v180
    v_rcp_f32 v181, v181
    v_rcp_f32 v182, v182
    v_rcp_f32 v183, v183
    v_pk_mul_f32 v[192:193], v[192:193], v[176:177]
    v_pk_mul_f32 v[194:195], v[194:195], v[178:179]
    v_pk_mul_f32 v[196:197], v[196:197], v[180:181]
    v_pk_mul_f32 v[198:199], v[198:199], v[182:183]
    v_cvt_pk_bf16_f32 v212, v192, v193
    v_cvt_pk_bf16_f32 v213, v194, v195
    v_cvt_pk_bf16_f32 v214, v196, v197
    v_cvt_pk_bf16_f32 v215, v198, v199
    buffer_store_dwordx4 v[212:215], v1, s[4:7], s73 offen offset:3072 sc1
    s_add_u32 s73, s73, 147456
    v_accvgpr_read_b32 v192, a160
    v_accvgpr_read_b32 v193, a161
    v_accvgpr_read_b32 v194, a162
    v_accvgpr_read_b32 v195, a163
    v_accvgpr_read_b32 v196, a164
    v_accvgpr_read_b32 v197, a165
    v_accvgpr_read_b32 v198, a166
    v_accvgpr_read_b32 v199, a167
    v_pk_add_f32 v[192:193], v[192:193], v[216:217]
    v_pk_add_f32 v[194:195], v[194:195], v[218:219]
    v_pk_add_f32 v[196:197], v[196:197], v[220:221]
    v_pk_add_f32 v[198:199], v[198:199], v[222:223]
    v_pk_mul_f32 v[176:177], v[192:193], v[192:193]
    v_pk_mul_f32 v[178:179], v[194:195], v[194:195]
    v_pk_mul_f32 v[180:181], v[196:197], v[196:197]
    v_pk_mul_f32 v[182:183], v[198:199], v[198:199]
    v_pk_fma_f32 v[176:177], v[176:177], s[76:77], v[248:249]
    v_pk_fma_f32 v[178:179], v[178:179], s[76:77], v[248:249]
    v_pk_fma_f32 v[180:181], v[180:181], s[76:77], v[248:249]
    v_pk_fma_f32 v[182:183], v[182:183], s[76:77], v[248:249]
    v_pk_mul_f32 v[176:177], v[176:177], v[192:193]
    v_pk_mul_f32 v[178:179], v[178:179], v[194:195]
    v_pk_mul_f32 v[180:181], v[180:181], v[196:197]
    v_pk_mul_f32 v[182:183], v[182:183], v[198:199]
    v_exp_f32 v176, v176
    v_exp_f32 v177, v177
    v_exp_f32 v178, v178
    v_exp_f32 v179, v179
    v_exp_f32 v180, v180
    v_exp_f32 v181, v181
    v_exp_f32 v182, v182
    v_exp_f32 v183, v183
    v_pk_add_f32 v[176:177], v[176:177], 1.0 op_sel_hi:[1,0]
    v_pk_add_f32 v[178:179], v[178:179], 1.0 op_sel_hi:[1,0]
    v_pk_add_f32 v[180:181], v[180:181], 1.0 op_sel_hi:[1,0]
    v_pk_add_f32 v[182:183], v[182:183], 1.0 op_sel_hi:[1,0]
    v_rcp_f32 v176, v176
    v_rcp_f32 v177, v177
    v_rcp_f32 v178, v178
    v_rcp_f32 v179, v179
    v_rcp_f32 v180, v180
    v_rcp_f32 v181, v181
    v_rcp_f32 v182, v182
    v_rcp_f32 v183, v183
    v_pk_mul_f32 v[192:193], v[192:193], v[176:177]
    v_pk_mul_f32 v[194:195], v[194:195], v[178:179]
    v_pk_mul_f32 v[196:197], v[196:197], v[180:181]
    v_pk_mul_f32 v[198:199], v[198:199], v[182:183]
    v_cvt_pk_bf16_f32 v200, v192, v193
    v_cvt_pk_bf16_f32 v201, v194, v195
    v_cvt_pk_bf16_f32 v202, v196, v197
    v_cvt_pk_bf16_f32 v203, v198, v199
    buffer_store_dwordx4 v[200:203], v1, s[4:7], s73 offen offset:0 sc1
    v_accvgpr_read_b32 v192, a168
    v_accvgpr_read_b32 v193, a169
    v_accvgpr_read_b32 v194, a170
    v_accvgpr_read_b32 v195, a171
    v_accvgpr_read_b32 v196, a172
    v_accvgpr_read_b32 v197, a173
    v_accvgpr_read_b32 v198, a174
    v_accvgpr_read_b32 v199, a175
    v_pk_add_f32 v[192:193], v[192:193], v[224:225]
    v_pk_add_f32 v[194:195], v[194:195], v[226:227]
    v_pk_add_f32 v[196:197], v[196:197], v[228:229]
    v_pk_add_f32 v[198:199], v[198:199], v[230:231]
    v_pk_mul_f32 v[176:177], v[192:193], v[192:193]
    v_pk_mul_f32 v[178:179], v[194:195], v[194:195]
    v_pk_mul_f32 v[180:181], v[196:197], v[196:197]
    v_pk_mul_f32 v[182:183], v[198:199], v[198:199]
    v_pk_fma_f32 v[176:177], v[176:177], s[76:77], v[248:249]
    v_pk_fma_f32 v[178:179], v[178:179], s[76:77], v[248:249]
    v_pk_fma_f32 v[180:181], v[180:181], s[76:77], v[248:249]
    v_pk_fma_f32 v[182:183], v[182:183], s[76:77], v[248:249]
    v_pk_mul_f32 v[176:177], v[176:177], v[192:193]
    v_pk_mul_f32 v[178:179], v[178:179], v[194:195]
    v_pk_mul_f32 v[180:181], v[180:181], v[196:197]
    v_pk_mul_f32 v[182:183], v[182:183], v[198:199]
    v_exp_f32 v176, v176
    v_exp_f32 v177, v177
    v_exp_f32 v178, v178
    v_exp_f32 v179, v179
    v_exp_f32 v180, v180
    v_exp_f32 v181, v181
    v_exp_f32 v182, v182
    v_exp_f32 v183, v183
    v_pk_add_f32 v[176:177], v[176:177], 1.0 op_sel_hi:[1,0]
    v_pk_add_f32 v[178:179], v[178:179], 1.0 op_sel_hi:[1,0]
    v_pk_add_f32 v[180:181], v[180:181], 1.0 op_sel_hi:[1,0]
    v_pk_add_f32 v[182:183], v[182:183], 1.0 op_sel_hi:[1,0]
    v_rcp_f32 v176, v176
    v_rcp_f32 v177, v177
    v_rcp_f32 v178, v178
    v_rcp_f32 v179, v179
    v_rcp_f32 v180, v180
    v_rcp_f32 v181, v181
    v_rcp_f32 v182, v182
    v_rcp_f32 v183, v183
    v_pk_mul_f32 v[192:193], v[192:193], v[176:177]
    v_pk_mul_f32 v[194:195], v[194:195], v[178:179]
    v_pk_mul_f32 v[196:197], v[196:197], v[180:181]
    v_pk_mul_f32 v[198:199], v[198:199], v[182:183]
    v_cvt_pk_bf16_f32 v204, v192, v193
    v_cvt_pk_bf16_f32 v205, v194, v195
    v_cvt_pk_bf16_f32 v206, v196, v197
    v_cvt_pk_bf16_f32 v207, v198, v199
    buffer_store_dwordx4 v[204:207], v1, s[4:7], s73 offen offset:1024 sc1
    v_accvgpr_read_b32 v192, a176
    v_accvgpr_read_b32 v193, a177
    v_accvgpr_read_b32 v194, a178
    v_accvgpr_read_b32 v195, a179
    v_accvgpr_read_b32 v196, a180
    v_accvgpr_read_b32 v197, a181
    v_accvgpr_read_b32 v198, a182
    v_accvgpr_read_b32 v199, a183
    v_pk_add_f32 v[192:193], v[192:193], v[232:233]
    v_pk_add_f32 v[194:195], v[194:195], v[234:235]
    v_pk_add_f32 v[196:197], v[196:197], v[236:237]
    v_pk_add_f32 v[198:199], v[198:199], v[238:239]
    v_pk_mul_f32 v[176:177], v[192:193], v[192:193]
    v_pk_mul_f32 v[178:179], v[194:195], v[194:195]
    v_pk_mul_f32 v[180:181], v[196:197], v[196:197]
    v_pk_mul_f32 v[182:183], v[198:199], v[198:199]
    v_pk_fma_f32 v[176:177], v[176:177], s[76:77], v[248:249]
    v_pk_fma_f32 v[178:179], v[178:179], s[76:77], v[248:249]
    v_pk_fma_f32 v[180:181], v[180:181], s[76:77], v[248:249]
    v_pk_fma_f32 v[182:183], v[182:183], s[76:77], v[248:249]
    v_pk_mul_f32 v[176:177], v[176:177], v[192:193]
    v_pk_mul_f32 v[178:179], v[178:179], v[194:195]
    v_pk_mul_f32 v[180:181], v[180:181], v[196:197]
    v_pk_mul_f32 v[182:183], v[182:183], v[198:199]
    v_exp_f32 v176, v176
    v_exp_f32 v177, v177
    v_exp_f32 v178, v178
    v_exp_f32 v179, v179
    v_exp_f32 v180, v180
    v_exp_f32 v181, v181
    v_exp_f32 v182, v182
    v_exp_f32 v183, v183
    v_pk_add_f32 v[176:177], v[176:177], 1.0 op_sel_hi:[1,0]
    v_pk_add_f32 v[178:179], v[178:179], 1.0 op_sel_hi:[1,0]
    v_pk_add_f32 v[180:181], v[180:181], 1.0 op_sel_hi:[1,0]
    v_pk_add_f32 v[182:183], v[182:183], 1.0 op_sel_hi:[1,0]
    v_rcp_f32 v176, v176
    v_rcp_f32 v177, v177
    v_rcp_f32 v178, v178
    v_rcp_f32 v179, v179
    v_rcp_f32 v180, v180
    v_rcp_f32 v181, v181
    v_rcp_f32 v182, v182
    v_rcp_f32 v183, v183
    v_pk_mul_f32 v[192:193], v[192:193], v[176:177]
    v_pk_mul_f32 v[194:195], v[194:195], v[178:179]
    v_pk_mul_f32 v[196:197], v[196:197], v[180:181]
    v_pk_mul_f32 v[198:199], v[198:199], v[182:183]
    v_cvt_pk_bf16_f32 v208, v192, v193
    v_cvt_pk_bf16_f32 v209, v194, v195
    v_cvt_pk_bf16_f32 v210, v196, v197
    v_cvt_pk_bf16_f32 v211, v198, v199
    buffer_store_dwordx4 v[208:211], v1, s[4:7], s73 offen offset:2048 sc1
    v_accvgpr_read_b32 v192, a184
    v_accvgpr_read_b32 v193, a185
    v_accvgpr_read_b32 v194, a186
    v_accvgpr_read_b32 v195, a187
    v_accvgpr_read_b32 v196, a188
    v_accvgpr_read_b32 v197, a189
    v_accvgpr_read_b32 v198, a190
    v_accvgpr_read_b32 v199, a191
    v_pk_add_f32 v[192:193], v[192:193], v[240:241]
    v_pk_add_f32 v[194:195], v[194:195], v[242:243]
    v_pk_add_f32 v[196:197], v[196:197], v[244:245]
    v_pk_add_f32 v[198:199], v[198:199], v[246:247]
    v_pk_mul_f32 v[176:177], v[192:193], v[192:193]
    v_pk_mul_f32 v[178:179], v[194:195], v[194:195]
    v_pk_mul_f32 v[180:181], v[196:197], v[196:197]
    v_pk_mul_f32 v[182:183], v[198:199], v[198:199]
    v_pk_fma_f32 v[176:177], v[176:177], s[76:77], v[248:249]
    v_pk_fma_f32 v[178:179], v[178:179], s[76:77], v[248:249]
    v_pk_fma_f32 v[180:181], v[180:181], s[76:77], v[248:249]
    v_pk_fma_f32 v[182:183], v[182:183], s[76:77], v[248:249]
    v_pk_mul_f32 v[176:177], v[176:177], v[192:193]
    v_pk_mul_f32 v[178:179], v[178:179], v[194:195]
    v_pk_mul_f32 v[180:181], v[180:181], v[196:197]
    v_pk_mul_f32 v[182:183], v[182:183], v[198:199]
    v_exp_f32 v176, v176
    v_exp_f32 v177, v177
    v_exp_f32 v178, v178
    v_exp_f32 v179, v179
    v_exp_f32 v180, v180
    v_exp_f32 v181, v181
    v_exp_f32 v182, v182
    v_exp_f32 v183, v183
    v_pk_add_f32 v[176:177], v[176:177], 1.0 op_sel_hi:[1,0]
    v_pk_add_f32 v[178:179], v[178:179], 1.0 op_sel_hi:[1,0]
    v_pk_add_f32 v[180:181], v[180:181], 1.0 op_sel_hi:[1,0]
    v_pk_add_f32 v[182:183], v[182:183], 1.0 op_sel_hi:[1,0]
    v_rcp_f32 v176, v176
    v_rcp_f32 v177, v177
    v_rcp_f32 v178, v178
    v_rcp_f32 v179, v179
    v_rcp_f32 v180, v180
    v_rcp_f32 v181, v181
    v_rcp_f32 v182, v182
    v_rcp_f32 v183, v183
    v_pk_mul_f32 v[192:193], v[192:193], v[176:177]
    v_pk_mul_f32 v[194:195], v[194:195], v[178:179]
    v_pk_mul_f32 v[196:197], v[196:197], v[180:181]
    v_pk_mul_f32 v[198:199], v[198:199], v[182:183]
    v_cvt_pk_bf16_f32 v212, v192, v193
    v_cvt_pk_bf16_f32 v213, v194, v195
    v_cvt_pk_bf16_f32 v214, v196, v197
    v_cvt_pk_bf16_f32 v215, v198, v199
    buffer_store_dwordx4 v[212:215], v1, s[4:7], s73 offen offset:3072 sc1
    s_add_u32 s73, s73, 147456
    v_accvgpr_read_b32 v192, a192
    v_accvgpr_read_b32 v193, a193
    v_accvgpr_read_b32 v194, a194
    v_accvgpr_read_b32 v195, a195
    v_accvgpr_read_b32 v196, a196
    v_accvgpr_read_b32 v197, a197
    v_accvgpr_read_b32 v198, a198
    v_accvgpr_read_b32 v199, a199
    v_pk_add_f32 v[192:193], v[192:193], v[216:217]
    v_pk_add_f32 v[194:195], v[194:195], v[218:219]
    v_pk_add_f32 v[196:197], v[196:197], v[220:221]
    v_pk_add_f32 v[198:199], v[198:199], v[222:223]
    v_pk_mul_f32 v[176:177], v[192:193], v[192:193]
    v_pk_mul_f32 v[178:179], v[194:195], v[194:195]
    v_pk_mul_f32 v[180:181], v[196:197], v[196:197]
    v_pk_mul_f32 v[182:183], v[198:199], v[198:199]
    v_pk_fma_f32 v[176:177], v[176:177], s[76:77], v[248:249]
    v_pk_fma_f32 v[178:179], v[178:179], s[76:77], v[248:249]
    v_pk_fma_f32 v[180:181], v[180:181], s[76:77], v[248:249]
    v_pk_fma_f32 v[182:183], v[182:183], s[76:77], v[248:249]
    v_pk_mul_f32 v[176:177], v[176:177], v[192:193]
    v_pk_mul_f32 v[178:179], v[178:179], v[194:195]
    v_pk_mul_f32 v[180:181], v[180:181], v[196:197]
    v_pk_mul_f32 v[182:183], v[182:183], v[198:199]
    v_exp_f32 v176, v176
    v_exp_f32 v177, v177
    v_exp_f32 v178, v178
    v_exp_f32 v179, v179
    v_exp_f32 v180, v180
    v_exp_f32 v181, v181
    v_exp_f32 v182, v182
    v_exp_f32 v183, v183
    v_pk_add_f32 v[176:177], v[176:177], 1.0 op_sel_hi:[1,0]
    v_pk_add_f32 v[178:179], v[178:179], 1.0 op_sel_hi:[1,0]
    v_pk_add_f32 v[180:181], v[180:181], 1.0 op_sel_hi:[1,0]
    v_pk_add_f32 v[182:183], v[182:183], 1.0 op_sel_hi:[1,0]
    v_rcp_f32 v176, v176
    v_rcp_f32 v177, v177
    v_rcp_f32 v178, v178
    v_rcp_f32 v179, v179
    v_rcp_f32 v180, v180
    v_rcp_f32 v181, v181
    v_rcp_f32 v182, v182
    v_rcp_f32 v183, v183
    v_pk_mul_f32 v[192:193], v[192:193], v[176:177]
    v_pk_mul_f32 v[194:195], v[194:195], v[178:179]
    v_pk_mul_f32 v[196:197], v[196:197], v[180:181]
    v_pk_mul_f32 v[198:199], v[198:199], v[182:183]
    v_cvt_pk_bf16_f32 v200, v192, v193
    v_cvt_pk_bf16_f32 v201, v194, v195
    v_cvt_pk_bf16_f32 v202, v196, v197
    v_cvt_pk_bf16_f32 v203, v198, v199
    buffer_store_dwordx4 v[200:203], v1, s[4:7], s73 offen offset:0 sc1
    v_accvgpr_read_b32 v192, a200
    v_accvgpr_read_b32 v193, a201
    v_accvgpr_read_b32 v194, a202
    v_accvgpr_read_b32 v195, a203
    v_accvgpr_read_b32 v196, a204
    v_accvgpr_read_b32 v197, a205
    v_accvgpr_read_b32 v198, a206
    v_accvgpr_read_b32 v199, a207
    v_pk_add_f32 v[192:193], v[192:193], v[224:225]
    v_pk_add_f32 v[194:195], v[194:195], v[226:227]
    v_pk_add_f32 v[196:197], v[196:197], v[228:229]
    v_pk_add_f32 v[198:199], v[198:199], v[230:231]
    v_pk_mul_f32 v[176:177], v[192:193], v[192:193]
    v_pk_mul_f32 v[178:179], v[194:195], v[194:195]
    v_pk_mul_f32 v[180:181], v[196:197], v[196:197]
    v_pk_mul_f32 v[182:183], v[198:199], v[198:199]
    v_pk_fma_f32 v[176:177], v[176:177], s[76:77], v[248:249]
    v_pk_fma_f32 v[178:179], v[178:179], s[76:77], v[248:249]
    v_pk_fma_f32 v[180:181], v[180:181], s[76:77], v[248:249]
    v_pk_fma_f32 v[182:183], v[182:183], s[76:77], v[248:249]
    v_pk_mul_f32 v[176:177], v[176:177], v[192:193]
    v_pk_mul_f32 v[178:179], v[178:179], v[194:195]
    v_pk_mul_f32 v[180:181], v[180:181], v[196:197]
    v_pk_mul_f32 v[182:183], v[182:183], v[198:199]
    v_exp_f32 v176, v176
    v_exp_f32 v177, v177
    v_exp_f32 v178, v178
    v_exp_f32 v179, v179
    v_exp_f32 v180, v180
    v_exp_f32 v181, v181
    v_exp_f32 v182, v182
    v_exp_f32 v183, v183
    v_pk_add_f32 v[176:177], v[176:177], 1.0 op_sel_hi:[1,0]
    v_pk_add_f32 v[178:179], v[178:179], 1.0 op_sel_hi:[1,0]
    v_pk_add_f32 v[180:181], v[180:181], 1.0 op_sel_hi:[1,0]
    v_pk_add_f32 v[182:183], v[182:183], 1.0 op_sel_hi:[1,0]
    v_rcp_f32 v176, v176
    v_rcp_f32 v177, v177
    v_rcp_f32 v178, v178
    v_rcp_f32 v179, v179
    v_rcp_f32 v180, v180
    v_rcp_f32 v181, v181
    v_rcp_f32 v182, v182
    v_rcp_f32 v183, v183
    v_pk_mul_f32 v[192:193], v[192:193], v[176:177]
    v_pk_mul_f32 v[194:195], v[194:195], v[178:179]
    v_pk_mul_f32 v[196:197], v[196:197], v[180:181]
    v_pk_mul_f32 v[198:199], v[198:199], v[182:183]
    v_cvt_pk_bf16_f32 v204, v192, v193
    v_cvt_pk_bf16_f32 v205, v194, v195
    v_cvt_pk_bf16_f32 v206, v196, v197
    v_cvt_pk_bf16_f32 v207, v198, v199
    buffer_store_dwordx4 v[204:207], v1, s[4:7], s73 offen offset:1024 sc1
    v_accvgpr_read_b32 v192, a208
    v_accvgpr_read_b32 v193, a209
    v_accvgpr_read_b32 v194, a210
    v_accvgpr_read_b32 v195, a211
    v_accvgpr_read_b32 v196, a212
    v_accvgpr_read_b32 v197, a213
    v_accvgpr_read_b32 v198, a214
    v_accvgpr_read_b32 v199, a215
    v_pk_add_f32 v[192:193], v[192:193], v[232:233]
    v_pk_add_f32 v[194:195], v[194:195], v[234:235]
    v_pk_add_f32 v[196:197], v[196:197], v[236:237]
    v_pk_add_f32 v[198:199], v[198:199], v[238:239]
    v_pk_mul_f32 v[176:177], v[192:193], v[192:193]
    v_pk_mul_f32 v[178:179], v[194:195], v[194:195]
    v_pk_mul_f32 v[180:181], v[196:197], v[196:197]
    v_pk_mul_f32 v[182:183], v[198:199], v[198:199]
    v_pk_fma_f32 v[176:177], v[176:177], s[76:77], v[248:249]
    v_pk_fma_f32 v[178:179], v[178:179], s[76:77], v[248:249]
    v_pk_fma_f32 v[180:181], v[180:181], s[76:77], v[248:249]
    v_pk_fma_f32 v[182:183], v[182:183], s[76:77], v[248:249]
    v_pk_mul_f32 v[176:177], v[176:177], v[192:193]
    v_pk_mul_f32 v[178:179], v[178:179], v[194:195]
    v_pk_mul_f32 v[180:181], v[180:181], v[196:197]
    v_pk_mul_f32 v[182:183], v[182:183], v[198:199]
    v_exp_f32 v176, v176
    v_exp_f32 v177, v177
    v_exp_f32 v178, v178
    v_exp_f32 v179, v179
    v_exp_f32 v180, v180
    v_exp_f32 v181, v181
    v_exp_f32 v182, v182
    v_exp_f32 v183, v183
    v_pk_add_f32 v[176:177], v[176:177], 1.0 op_sel_hi:[1,0]
    v_pk_add_f32 v[178:179], v[178:179], 1.0 op_sel_hi:[1,0]
    v_pk_add_f32 v[180:181], v[180:181], 1.0 op_sel_hi:[1,0]
    v_pk_add_f32 v[182:183], v[182:183], 1.0 op_sel_hi:[1,0]
    v_rcp_f32 v176, v176
    v_rcp_f32 v177, v177
    v_rcp_f32 v178, v178
    v_rcp_f32 v179, v179
    v_rcp_f32 v180, v180
    v_rcp_f32 v181, v181
    v_rcp_f32 v182, v182
    v_rcp_f32 v183, v183
    v_pk_mul_f32 v[192:193], v[192:193], v[176:177]
    v_pk_mul_f32 v[194:195], v[194:195], v[178:179]
    v_pk_mul_f32 v[196:197], v[196:197], v[180:181]
    v_pk_mul_f32 v[198:199], v[198:199], v[182:183]
    v_cvt_pk_bf16_f32 v208, v192, v193
    v_cvt_pk_bf16_f32 v209, v194, v195
    v_cvt_pk_bf16_f32 v210, v196, v197
    v_cvt_pk_bf16_f32 v211, v198, v199
    buffer_store_dwordx4 v[208:211], v1, s[4:7], s73 offen offset:2048 sc1
    v_accvgpr_read_b32 v192, a216
    v_accvgpr_read_b32 v193, a217
    v_accvgpr_read_b32 v194, a218
    v_accvgpr_read_b32 v195, a219
    v_accvgpr_read_b32 v196, a220
    v_accvgpr_read_b32 v197, a221
    v_accvgpr_read_b32 v198, a222
    v_accvgpr_read_b32 v199, a223
    v_pk_add_f32 v[192:193], v[192:193], v[240:241]
    v_pk_add_f32 v[194:195], v[194:195], v[242:243]
    v_pk_add_f32 v[196:197], v[196:197], v[244:245]
    v_pk_add_f32 v[198:199], v[198:199], v[246:247]
    v_pk_mul_f32 v[176:177], v[192:193], v[192:193]
    v_pk_mul_f32 v[178:179], v[194:195], v[194:195]
    v_pk_mul_f32 v[180:181], v[196:197], v[196:197]
    v_pk_mul_f32 v[182:183], v[198:199], v[198:199]
    v_pk_fma_f32 v[176:177], v[176:177], s[76:77], v[248:249]
    v_pk_fma_f32 v[178:179], v[178:179], s[76:77], v[248:249]
    v_pk_fma_f32 v[180:181], v[180:181], s[76:77], v[248:249]
    v_pk_fma_f32 v[182:183], v[182:183], s[76:77], v[248:249]
    v_pk_mul_f32 v[176:177], v[176:177], v[192:193]
    v_pk_mul_f32 v[178:179], v[178:179], v[194:195]
    v_pk_mul_f32 v[180:181], v[180:181], v[196:197]
    v_pk_mul_f32 v[182:183], v[182:183], v[198:199]
    v_exp_f32 v176, v176
    v_exp_f32 v177, v177
    v_exp_f32 v178, v178
    v_exp_f32 v179, v179
    v_exp_f32 v180, v180
    v_exp_f32 v181, v181
    v_exp_f32 v182, v182
    v_exp_f32 v183, v183
    v_pk_add_f32 v[176:177], v[176:177], 1.0 op_sel_hi:[1,0]
    v_pk_add_f32 v[178:179], v[178:179], 1.0 op_sel_hi:[1,0]
    v_pk_add_f32 v[180:181], v[180:181], 1.0 op_sel_hi:[1,0]
    v_pk_add_f32 v[182:183], v[182:183], 1.0 op_sel_hi:[1,0]
    v_rcp_f32 v176, v176
    v_rcp_f32 v177, v177
    v_rcp_f32 v178, v178
    v_rcp_f32 v179, v179
    v_rcp_f32 v180, v180
    v_rcp_f32 v181, v181
    v_rcp_f32 v182, v182
    v_rcp_f32 v183, v183
    v_pk_mul_f32 v[192:193], v[192:193], v[176:177]
    v_pk_mul_f32 v[194:195], v[194:195], v[178:179]
    v_pk_mul_f32 v[196:197], v[196:197], v[180:181]
    v_pk_mul_f32 v[198:199], v[198:199], v[182:183]
    v_cvt_pk_bf16_f32 v212, v192, v193
    v_cvt_pk_bf16_f32 v213, v194, v195
    v_cvt_pk_bf16_f32 v214, v196, v197
    v_cvt_pk_bf16_f32 v215, v198, v199
    buffer_store_dwordx4 v[212:215], v1, s[4:7], s73 offen offset:3072 sc1
    s_add_u32 s73, s73, 147456
    v_accvgpr_read_b32 v192, a224
    v_accvgpr_read_b32 v193, a225
    v_accvgpr_read_b32 v194, a226
    v_accvgpr_read_b32 v195, a227
    v_accvgpr_read_b32 v196, a228
    v_accvgpr_read_b32 v197, a229
    v_accvgpr_read_b32 v198, a230
    v_accvgpr_read_b32 v199, a231
    v_pk_add_f32 v[192:193], v[192:193], v[216:217]
    v_pk_add_f32 v[194:195], v[194:195], v[218:219]
    v_pk_add_f32 v[196:197], v[196:197], v[220:221]
    v_pk_add_f32 v[198:199], v[198:199], v[222:223]
    v_pk_mul_f32 v[176:177], v[192:193], v[192:193]
    v_pk_mul_f32 v[178:179], v[194:195], v[194:195]
    v_pk_mul_f32 v[180:181], v[196:197], v[196:197]
    v_pk_mul_f32 v[182:183], v[198:199], v[198:199]
    v_pk_fma_f32 v[176:177], v[176:177], s[76:77], v[248:249]
    v_pk_fma_f32 v[178:179], v[178:179], s[76:77], v[248:249]
    v_pk_fma_f32 v[180:181], v[180:181], s[76:77], v[248:249]
    v_pk_fma_f32 v[182:183], v[182:183], s[76:77], v[248:249]
    v_pk_mul_f32 v[176:177], v[176:177], v[192:193]
    v_pk_mul_f32 v[178:179], v[178:179], v[194:195]
    v_pk_mul_f32 v[180:181], v[180:181], v[196:197]
    v_pk_mul_f32 v[182:183], v[182:183], v[198:199]
    v_exp_f32 v176, v176
    v_exp_f32 v177, v177
    v_exp_f32 v178, v178
    v_exp_f32 v179, v179
    v_exp_f32 v180, v180
    v_exp_f32 v181, v181
    v_exp_f32 v182, v182
    v_exp_f32 v183, v183
    v_pk_add_f32 v[176:177], v[176:177], 1.0 op_sel_hi:[1,0]
    v_pk_add_f32 v[178:179], v[178:179], 1.0 op_sel_hi:[1,0]
    v_pk_add_f32 v[180:181], v[180:181], 1.0 op_sel_hi:[1,0]
    v_pk_add_f32 v[182:183], v[182:183], 1.0 op_sel_hi:[1,0]
    v_rcp_f32 v176, v176
    v_rcp_f32 v177, v177
    v_rcp_f32 v178, v178
    v_rcp_f32 v179, v179
    v_rcp_f32 v180, v180
    v_rcp_f32 v181, v181
    v_rcp_f32 v182, v182
    v_rcp_f32 v183, v183
    v_pk_mul_f32 v[192:193], v[192:193], v[176:177]
    v_pk_mul_f32 v[194:195], v[194:195], v[178:179]
    v_pk_mul_f32 v[196:197], v[196:197], v[180:181]
    v_pk_mul_f32 v[198:199], v[198:199], v[182:183]
    v_cvt_pk_bf16_f32 v200, v192, v193
    v_cvt_pk_bf16_f32 v201, v194, v195
    v_cvt_pk_bf16_f32 v202, v196, v197
    v_cvt_pk_bf16_f32 v203, v198, v199
    buffer_store_dwordx4 v[200:203], v1, s[4:7], s73 offen offset:0 sc1
    v_accvgpr_read_b32 v192, a232
    v_accvgpr_read_b32 v193, a233
    v_accvgpr_read_b32 v194, a234
    v_accvgpr_read_b32 v195, a235
    v_accvgpr_read_b32 v196, a236
    v_accvgpr_read_b32 v197, a237
    v_accvgpr_read_b32 v198, a238
    v_accvgpr_read_b32 v199, a239
    v_pk_add_f32 v[192:193], v[192:193], v[224:225]
    v_pk_add_f32 v[194:195], v[194:195], v[226:227]
    v_pk_add_f32 v[196:197], v[196:197], v[228:229]
    v_pk_add_f32 v[198:199], v[198:199], v[230:231]
    v_pk_mul_f32 v[176:177], v[192:193], v[192:193]
    v_pk_mul_f32 v[178:179], v[194:195], v[194:195]
    v_pk_mul_f32 v[180:181], v[196:197], v[196:197]
    v_pk_mul_f32 v[182:183], v[198:199], v[198:199]
    v_pk_fma_f32 v[176:177], v[176:177], s[76:77], v[248:249]
    v_pk_fma_f32 v[178:179], v[178:179], s[76:77], v[248:249]
    v_pk_fma_f32 v[180:181], v[180:181], s[76:77], v[248:249]
    v_pk_fma_f32 v[182:183], v[182:183], s[76:77], v[248:249]
    v_pk_mul_f32 v[176:177], v[176:177], v[192:193]
    v_pk_mul_f32 v[178:179], v[178:179], v[194:195]
    v_pk_mul_f32 v[180:181], v[180:181], v[196:197]
    v_pk_mul_f32 v[182:183], v[182:183], v[198:199]
    v_exp_f32 v176, v176
    v_exp_f32 v177, v177
    v_exp_f32 v178, v178
    v_exp_f32 v179, v179
    v_exp_f32 v180, v180
    v_exp_f32 v181, v181
    v_exp_f32 v182, v182
    v_exp_f32 v183, v183
    v_pk_add_f32 v[176:177], v[176:177], 1.0 op_sel_hi:[1,0]
    v_pk_add_f32 v[178:179], v[178:179], 1.0 op_sel_hi:[1,0]
    v_pk_add_f32 v[180:181], v[180:181], 1.0 op_sel_hi:[1,0]
    v_pk_add_f32 v[182:183], v[182:183], 1.0 op_sel_hi:[1,0]
    v_rcp_f32 v176, v176
    v_rcp_f32 v177, v177
    v_rcp_f32 v178, v178
    v_rcp_f32 v179, v179
    v_rcp_f32 v180, v180
    v_rcp_f32 v181, v181
    v_rcp_f32 v182, v182
    v_rcp_f32 v183, v183
    v_pk_mul_f32 v[192:193], v[192:193], v[176:177]
    v_pk_mul_f32 v[194:195], v[194:195], v[178:179]
    v_pk_mul_f32 v[196:197], v[196:197], v[180:181]
    v_pk_mul_f32 v[198:199], v[198:199], v[182:183]
    v_cvt_pk_bf16_f32 v204, v192, v193
    v_cvt_pk_bf16_f32 v205, v194, v195
    v_cvt_pk_bf16_f32 v206, v196, v197
    v_cvt_pk_bf16_f32 v207, v198, v199
    buffer_store_dwordx4 v[204:207], v1, s[4:7], s73 offen offset:1024 sc1
    v_accvgpr_read_b32 v192, a240
    v_accvgpr_read_b32 v193, a241
    v_accvgpr_read_b32 v194, a242
    v_accvgpr_read_b32 v195, a243
    v_accvgpr_read_b32 v196, a244
    v_accvgpr_read_b32 v197, a245
    v_accvgpr_read_b32 v198, a246
    v_accvgpr_read_b32 v199, a247
    v_pk_add_f32 v[192:193], v[192:193], v[232:233]
    v_pk_add_f32 v[194:195], v[194:195], v[234:235]
    v_pk_add_f32 v[196:197], v[196:197], v[236:237]
    v_pk_add_f32 v[198:199], v[198:199], v[238:239]
    v_pk_mul_f32 v[176:177], v[192:193], v[192:193]
    v_pk_mul_f32 v[178:179], v[194:195], v[194:195]
    v_pk_mul_f32 v[180:181], v[196:197], v[196:197]
    v_pk_mul_f32 v[182:183], v[198:199], v[198:199]
    v_pk_fma_f32 v[176:177], v[176:177], s[76:77], v[248:249]
    v_pk_fma_f32 v[178:179], v[178:179], s[76:77], v[248:249]
    v_pk_fma_f32 v[180:181], v[180:181], s[76:77], v[248:249]
    v_pk_fma_f32 v[182:183], v[182:183], s[76:77], v[248:249]
    v_pk_mul_f32 v[176:177], v[176:177], v[192:193]
    v_pk_mul_f32 v[178:179], v[178:179], v[194:195]
    v_pk_mul_f32 v[180:181], v[180:181], v[196:197]
    v_pk_mul_f32 v[182:183], v[182:183], v[198:199]
    v_exp_f32 v176, v176
    v_exp_f32 v177, v177
    v_exp_f32 v178, v178
    v_exp_f32 v179, v179
    v_exp_f32 v180, v180
    v_exp_f32 v181, v181
    v_exp_f32 v182, v182
    v_exp_f32 v183, v183
    v_pk_add_f32 v[176:177], v[176:177], 1.0 op_sel_hi:[1,0]
    v_pk_add_f32 v[178:179], v[178:179], 1.0 op_sel_hi:[1,0]
    v_pk_add_f32 v[180:181], v[180:181], 1.0 op_sel_hi:[1,0]
    v_pk_add_f32 v[182:183], v[182:183], 1.0 op_sel_hi:[1,0]
    v_rcp_f32 v176, v176
    v_rcp_f32 v177, v177
    v_rcp_f32 v178, v178
    v_rcp_f32 v179, v179
    v_rcp_f32 v180, v180
    v_rcp_f32 v181, v181
    v_rcp_f32 v182, v182
    v_rcp_f32 v183, v183
    v_pk_mul_f32 v[192:193], v[192:193], v[176:177]
    v_pk_mul_f32 v[194:195], v[194:195], v[178:179]
    v_pk_mul_f32 v[196:197], v[196:197], v[180:181]
    v_pk_mul_f32 v[198:199], v[198:199], v[182:183]
    v_cvt_pk_bf16_f32 v208, v192, v193
    v_cvt_pk_bf16_f32 v209, v194, v195
    v_cvt_pk_bf16_f32 v210, v196, v197
    v_cvt_pk_bf16_f32 v211, v198, v199
    buffer_store_dwordx4 v[208:211], v1, s[4:7], s73 offen offset:2048 sc1
    v_accvgpr_read_b32 v192, a248
    v_accvgpr_read_b32 v193, a249
    v_accvgpr_read_b32 v194, a250
    v_accvgpr_read_b32 v195, a251
    v_accvgpr_read_b32 v196, a252
    v_accvgpr_read_b32 v197, a253
    v_accvgpr_read_b32 v198, a254
    v_accvgpr_read_b32 v199, a255
    v_pk_add_f32 v[192:193], v[192:193], v[240:241]
    v_pk_add_f32 v[194:195], v[194:195], v[242:243]
    v_pk_add_f32 v[196:197], v[196:197], v[244:245]
    v_pk_add_f32 v[198:199], v[198:199], v[246:247]
    v_pk_mul_f32 v[176:177], v[192:193], v[192:193]
    v_pk_mul_f32 v[178:179], v[194:195], v[194:195]
    v_pk_mul_f32 v[180:181], v[196:197], v[196:197]
    v_pk_mul_f32 v[182:183], v[198:199], v[198:199]
    v_pk_fma_f32 v[176:177], v[176:177], s[76:77], v[248:249]
    v_pk_fma_f32 v[178:179], v[178:179], s[76:77], v[248:249]
    v_pk_fma_f32 v[180:181], v[180:181], s[76:77], v[248:249]
    v_pk_fma_f32 v[182:183], v[182:183], s[76:77], v[248:249]
    v_pk_mul_f32 v[176:177], v[176:177], v[192:193]
    v_pk_mul_f32 v[178:179], v[178:179], v[194:195]
    v_pk_mul_f32 v[180:181], v[180:181], v[196:197]
    v_pk_mul_f32 v[182:183], v[182:183], v[198:199]
    v_exp_f32 v176, v176
    v_exp_f32 v177, v177
    v_exp_f32 v178, v178
    v_exp_f32 v179, v179
    v_exp_f32 v180, v180
    v_exp_f32 v181, v181
    v_exp_f32 v182, v182
    v_exp_f32 v183, v183
    v_pk_add_f32 v[176:177], v[176:177], 1.0 op_sel_hi:[1,0]
    v_pk_add_f32 v[178:179], v[178:179], 1.0 op_sel_hi:[1,0]
    v_pk_add_f32 v[180:181], v[180:181], 1.0 op_sel_hi:[1,0]
    v_pk_add_f32 v[182:183], v[182:183], 1.0 op_sel_hi:[1,0]
    v_rcp_f32 v176, v176
    v_rcp_f32 v177, v177
    v_rcp_f32 v178, v178
    v_rcp_f32 v179, v179
    v_rcp_f32 v180, v180
    v_rcp_f32 v181, v181
    v_rcp_f32 v182, v182
    v_rcp_f32 v183, v183
    v_pk_mul_f32 v[192:193], v[192:193], v[176:177]
    v_pk_mul_f32 v[194:195], v[194:195], v[178:179]
    v_pk_mul_f32 v[196:197], v[196:197], v[180:181]
    v_pk_mul_f32 v[198:199], v[198:199], v[182:183]
    v_cvt_pk_bf16_f32 v212, v192, v193
    v_cvt_pk_bf16_f32 v213, v194, v195
    v_cvt_pk_bf16_f32 v214, v196, v197
    v_cvt_pk_bf16_f32 v215, v198, v199
    buffer_store_dwordx4 v[212:215], v1, s[4:7], s73 offen offset:3072 sc1
    s_add_u32 s73, s73, 147456
Lg1_epi_done:
    s_sub_u32 s31, s52, 1
    s_max_i32 s31, s31, 0
    s_lshl_b32 s31, s31, 7
    s_lshl_b32 s32, s54, 2
    s_add_u32 s31, s31, s32
    s_add_u32 s78, s31, 65536
    s_mov_b32 s32, 0
    s_waitcnt vmcnt(32)
Lg1fw_3:
    v_readfirstlane_b32 s31, v252
    s_and_b32 s31, s31, 0xffff
    s_cmp_ge_u32 s31, 128
    s_cbranch_scc1 Lg1fok_4
    s_add_u32 s32, s32, 1
    s_cmp_gt_u32 s32, 1048576
    s_cbranch_scc1 Lexit
    buffer_load_dword v252, v253, s[20:23], 0 offen sc1
    s_waitcnt vmcnt(0)
    s_branch Lg1fw_3
Lg1fok_4:
    s_cmp_ge_u32 s48, 528
    s_cbranch_scc1 Lg1_done
    s_waitcnt vmcnt(48)
    s_branch Lg1_task
Lg1_done:
    s_waitcnt vmcnt(0)
    s_barrier
    s_cmp_lg_u32 s29, 0
    s_cbranch_scc1 Lw_ffn2
    v_mov_b32 v254, 4
    v_mov_b32 v253, 0
    s_mov_b64 exec, 1
    buffer_atomic_add v254, v253, s[4:7], s78 offen
    s_mov_b64 exec, -1
    s_branch Lw_ffn2
Lw_ffn2:
    s_cmp_ge_u32 s85, 192
    s_cbranch_scc1 Lexit
    s_barrier
    s_load_dwordx2 s[8:9], s[0:1], 0
    s_load_dwordx4 s[12:15], s[0:1], 80
    s_load_dwordx2 s[24:25], s[0:1], 96
    v_lshrrev_b32 v1, 6, v0
    s_nop 0
    v_readfirstlane_b32 s29, v1
    v_and_b32 v1, 63, v0
    s_mul_i32 s30, s85, 171
    s_lshr_b32 s30, s30, 10
    s_mul_i32 s31, s30, 6
    s_sub_u32 s31, s85, s31
    s_waitcnt lgkmcnt(0)
    s_mov_b32 s16, s14
    s_mov_b32 s17, s15
    s_mov_b32 s18, 1152
    s_mov_b32 s19, 0x00020000
    s_mov_b32 s14, 5308416
    s_mov_b32 s15, 0x00020000
    s_mov_b32 s10, 2359296
    s_mov_b32 s11, 0x00020000
    s_mov_b32 s26, 1152
    s_mov_b32 s27, 0x00020000
    v_add_u32 v8, 0, v1
    v_mul_u32_u24 v9, 171, v8
    v_lshrrev_b32 v9, 11, v9
    v_mul_u32_u24 v10, 12, v9
    v_sub_u32 v10, v8, v10
    v_mul_u32_u24 v9, 1152, v9
    v_lshl_add_u32 v2, v10, 4, v9
    v_add_u32 v8, 64, v1
    v_mul_u32_u24 v9, 171, v8
    v_lshrrev_b32 v9, 11, v9
    v_mul_u32_u24 v10, 12, v9
    v_sub_u32 v10, v8, v10
    v_mul_u32_u24 v9, 1152, v9
    v_lshl_add_u32 v3, v10, 4, v9
    v_add_u32 v8, 128, v1
    v_mul_u32_u24 v9, 171, v8
    v_lshrrev_b32 v9, 11, v9
    v_mul_u32_u24 v10, 12, v9
    v_sub_u32 v10, v8, v10
    v_mul_u32_u24 v9, 1152, v9
    v_lshl_add_u32 v4, v10, 4, v9
    v_add_u32 v8, 192, v1
    v_mul_u32_u24 v9, 171, v8
    v_lshrrev_b32 v9, 11, v9
    v_mul_u32_u24 v10, 12, v9
    v_sub_u32 v10, v8, v10
    v_mul_u32_u24 v9, 1152, v9
    v_lshl_add_u32 v5, v10, 4, v9
    v_add_u32 v8, 256, v1
    v_mul_u32_u24 v9, 171, v8
    v_lshrrev_b32 v9, 11, v9
    v_mul_u32_u24 v10, 12, v9
    v_sub_u32 v10, v8, v10
    v_mul_u32_u24 v9, 1152, v9
    v_lshl_add_u32 v6, v10, 4, v9
    v_add_u32 v8, 320, v1
    v_mul_u32_u24 v9, 171, v8
    v_lshrrev_b32 v9, 11, v9
    v_mul_u32_u24 v10, 12, v9
    v_sub_u32 v10, v8, v10
    v_mul_u32_u24 v9, 1152, v9
    v_lshl_add_u32 v7, v10, 4, v9
    v_lshrrev_b32 v9, 4, v1
    v_bfe_u32 v10, v1, 2, 2
    v_lshl_add_u32 v10, v9, 3, v10
    v_mul_u32_u24 v10, 192, v10
    v_and_b32 v11, 3, v1
    v_lshl_add_u32 v10, v11, 4, v10
    s_mul_i32 s32, s29, 36864
    v_add_u32 v8, s32, v10
    v_lshlrev_b32 v9, 4, v9
    v_and_b32 v10, 15, v1
    v_mul_u32_u24 v10, 1152, v10
    v_add_u32 v10, v10, v9
    v_lshlrev_b32 v1, 4, v1
    s_mul_i32 s33, s30, 589824
    s_lshl_b32 s34, s29, 10
    s_add_u32 s33, s33, s34
    s_add_u32 s33, s33, 90177536
    s_mul_i32 s34, s29, 36864
    s_mul_i32 s35, s31, 192
    s_add_u32 s34, s34, s35
    s_lshl_b32 s35, s30, 2
    s_add_u32 s35, s35, s29
    s_mov_b32 s40, s35
    s_mul_i32 s35, s35, 18432
    buffer_load_dwordx4 v[64:67], v10, s[8:11], s35 offen offset:0
    buffer_load_dwordx4 v[160:163], v9, s[24:27], 0 offen offset:0
    buffer_load_dwordx4 v[68:71], v10, s[8:11], s35 offen offset:64
    buffer_load_dwordx4 v[164:167], v9, s[24:27], 0 offen offset:64
    buffer_load_dwordx4 v[72:75], v10, s[8:11], s35 offen offset:128
    buffer_load_dwordx4 v[168:171], v9, s[24:27], 0 offen offset:128
    buffer_load_dwordx4 v[76:79], v10, s[8:11], s35 offen offset:192
    buffer_load_dwordx4 v[172:175], v9, s[24:27], 0 offen offset:192
    buffer_load_dwordx4 v[80:83], v10, s[8:11], s35 offen offset:256
    buffer_load_dwordx4 v[176:179], v9, s[24:27], 0 offen offset:256
    buffer_load_dwordx4 v[84:87], v10, s[8:11], s35 offen offset:320
    buffer_load_dwordx4 v[180:183], v9, s[24:27], 0 offen offset:320
    buffer_load_dwordx4 v[88:91], v10, s[8:11], s35 offen offset:384
    buffer_load_dwordx4 v[184:187], v9, s[24:27], 0 offen offset:384
    buffer_load_dwordx4 v[92:95], v10, s[8:11], s35 offen offset:448
    buffer_load_dwordx4 v[188:191], v9, s[24:27], 0 offen offset:448
    buffer_load_dwordx4 v[96:99], v10, s[8:11], s35 offen offset:512
    buffer_load_dwordx4 v[192:195], v9, s[24:27], 0 offen offset:512
    buffer_load_dwordx4 v[100:103], v10, s[8:11], s35 offen offset:576
    buffer_load_dwordx4 v[196:199], v9, s[24:27], 0 offen offset:576
    buffer_load_dwordx4 v[104:107], v10, s[8:11], s35 offen offset:640
    buffer_load_dwordx4 v[200:203], v9, s[24:27], 0 offen offset:640
    buffer_load_dwordx4 v[108:111], v10, s[8:11], s35 offen offset:704
    buffer_load_dwordx4 v[204:207], v9, s[24:27], 0 offen offset:704
    buffer_load_dwordx4 v[112:115], v10, s[8:11], s35 offen offset:768
    buffer_load_dwordx4 v[208:211], v9, s[24:27], 0 offen offset:768
    buffer_load_dwordx4 v[116:119], v10, s[8:11], s35 offen offset:832
    buffer_load_dwordx4 v[212:215], v9, s[24:27], 0 offen offset:832
    buffer_load_dwordx4 v[120:123], v10, s[8:11], s35 offen offset:896
    buffer_load_dwordx4 v[216:219], v9, s[24:27], 0 offen offset:896
    buffer_load_dwordx4 v[124:127], v10, s[8:11], s35 offen offset:960
    buffer_load_dwordx4 v[220:223], v9, s[24:27], 0 offen offset:960
    buffer_load_dwordx4 v[128:131], v10, s[8:11], s35 offen offset:1024
    buffer_load_dwordx4 v[224:227], v9, s[24:27], 0 offen offset:1024
    buffer_load_dwordx4 v[132:135], v10, s[8:11], s35 offen offset:1088
    buffer_load_dwordx4 v[228:231], v9, s[24:27], 0 offen offset:1088
    s_mul_i32 s35, s31, 192
    buffer_load_dwordx4 v[16:19], v9, s[16:19], s35 offen offset:0
    buffer_load_dwordx4 v[20:23], v9, s[16:19], s35 offen offset:64
    buffer_load_dwordx4 v[24:27], v9, s[16:19], s35 offen offset:128
    s_waitcnt vmcnt(0)
    v_mfma_f32_16x16x32_bf16 v[12:15], v[160:163], v[64:67], 0
    v_mfma_f32_16x16x32_bf16 v[12:15], v[164:167], v[68:71], v[12:15]
    v_mfma_f32_16x16x32_bf16 v[12:15], v[168:171], v[72:75], v[12:15]
    v_mfma_f32_16x16x32_bf16 v[12:15], v[172:175], v[76:79], v[12:15]
    v_mfma_f32_16x16x32_bf16 v[12:15], v[176:179], v[80:83], v[12:15]
    v_mfma_f32_16x16x32_bf16 v[12:15], v[180:183], v[84:87], v[12:15]
    v_mfma_f32_16x16x32_bf16 v[12:15], v[184:187], v[88:91], v[12:15]
    v_mfma_f32_16x16x32_bf16 v[12:15], v[188:191], v[92:95], v[12:15]
    v_mfma_f32_16x16x32_bf16 v[12:15], v[192:195], v[96:99], v[12:15]
    v_mfma_f32_16x16x32_bf16 v[12:15], v[196:199], v[100:103], v[12:15]
    v_mfma_f32_16x16x32_bf16 v[12:15], v[200:203], v[104:107], v[12:15]
    v_mfma_f32_16x16x32_bf16 v[12:15], v[204:207], v[108:111], v[12:15]
    v_mfma_f32_16x16x32_bf16 v[12:15], v[208:211], v[112:115], v[12:15]
    v_mfma_f32_16x16x32_bf16 v[12:15], v[212:215], v[116:119], v[12:15]
    v_mfma_f32_16x16x32_bf16 v[12:15], v[216:219], v[120:123], v[12:15]
    v_mfma_f32_16x16x32_bf16 v[12:15], v[220:223], v[124:127], v[12:15]
    v_mfma_f32_16x16x32_bf16 v[12:15], v[224:227], v[128:131], v[12:15]
    v_mfma_f32_16x16x32_bf16 v[12:15], v[228:231], v[132:135], v[12:15]
    s_lshr_b32 s35, s30, 2
    s_lshl_b32 s35, s35, 2
    s_add_u32 s35, s35, 65792
    v_mov_b32 v250, 0
    s_mov_b32 s49, 0
Lww_5:
    buffer_load_dword v251, v250, s[4:7], s35 offen sc1
    s_add_u32 s49, s49, 1
    s_cmp_gt_u32 s49, 1048576
    s_cbranch_scc1 Lexit
    s_waitcnt vmcnt(0)
    v_cmp_gt_u32 vcc, 72, v251
    s_cbranch_vccz Lwok_6
    s_sleep 1
    s_branch Lww_5
Lwok_6:
    s_add_u32 s35, s33, 0
    buffer_load_dwordx4 v[64:67], v1, s[4:7], s35 offen sc1
    s_add_u32 s35, s33, 147456
    buffer_load_dwordx4 v[68:71], v1, s[4:7], s35 offen sc1
    s_add_u32 s35, s33, 294912
    buffer_load_dwordx4 v[72:75], v1, s[4:7], s35 offen sc1
    s_add_u32 s35, s33, 442368
    buffer_load_dwordx4 v[76:79], v1, s[4:7], s35 offen sc1
    s_add_u32 m0, s32, 0
    s_nop 0
    buffer_load_dwordx4 v2, s[12:15], s34 offen lds
    s_add_u32 m0, s32, 1024
    s_nop 0
    buffer_load_dwordx4 v3, s[12:15], s34 offen lds
    s_add_u32 m0, s32, 2048
    s_nop 0
    buffer_load_dwordx4 v4, s[12:15], s34 offen lds
    s_add_u32 m0, s32, 3072
    s_nop 0
    buffer_load_dwordx4 v5, s[12:15], s34 offen lds
    s_add_u32 m0, s32, 4096
    s_nop 0
    buffer_load_dwordx4 v6, s[12:15], s34 offen lds
    s_add_u32 m0, s32, 5120
    s_nop 0
    buffer_load_dwordx4 v7, s[12:15], s34 offen lds
    s_add_u32 s33, s33, 4096
    s_add_u32 s34, s34, 147456
    s_add_u32 s35, s33, 0
    buffer_load_dwordx4 v[80:83], v1, s[4:7], s35 offen sc1
    s_add_u32 s35, s33, 147456
    buffer_load_dwordx4 v[84:87], v1, s[4:7], s35 offen sc1
    s_add_u32 s35, s33, 294912
    buffer_load_dwordx4 v[88:91], v1, s[4:7], s35 offen sc1
    s_add_u32 s35, s33, 442368
    buffer_load_dwordx4 v[92:95], v1, s[4:7], s35 offen sc1
    s_add_u32 m0, s32, 6144
    s_nop 0
    buffer_load_dwordx4 v2, s[12:15], s34 offen lds
    s_add_u32 m0, s32, 7168
    s_nop 0
    buffer_load_dwordx4 v3, s[12:15], s34 offen lds
    s_add_u32 m0, s32, 8192
    s_nop 0
    buffer_load_dwordx4 v4, s[12:15], s34 offen lds
    s_add_u32 m0, s32, 9216
    s_nop 0
    buffer_load_dwordx4 v5, s[12:15], s34 offen lds
    s_add_u32 m0, s32, 10240
    s_nop 0
    buffer_load_dwordx4 v6, s[12:15], s34 offen lds
    s_add_u32 m0, s32, 11264
    s_nop 0
    buffer_load_dwordx4 v7, s[12:15], s34 offen lds
    s_add_u32 s33, s33, 4096
    s_add_u32 s34, s34, 147456
    s_add_u32 s35, s33, 0
    buffer_load_dwordx4 v[96:99], v1, s[4:7], s35 offen sc1
    s_add_u32 s35, s33, 147456
    buffer_load_dwordx4 v[100:103], v1, s[4:7], s35 offen sc1
    s_add_u32 s35, s33, 294912
    buffer_load_dwordx4 v[104:107], v1, s[4:7], s35 offen sc1
    s_add_u32 s35, s33, 442368
    buffer_load_dwordx4 v[108:111], v1, s[4:7], s35 offen sc1
    s_add_u32 m0, s32, 12288
    s_nop 0
    buffer_load_dwordx4 v2, s[12:15], s34 offen lds
    s_add_u32 m0, s32, 13312
    s_nop 0
    buffer_load_dwordx4 v3, s[12:15], s34 offen lds
    s_add_u32 m0, s32, 14336
    s_nop 0
    buffer_load_dwordx4 v4, s[12:15], s34 offen lds
    s_add_u32 m0, s32, 15360
    s_nop 0
    buffer_load_dwordx4 v5, s[12:15], s34 offen lds
    s_add_u32 m0, s32, 16384
    s_nop 0
    buffer_load_dwordx4 v6, s[12:15], s34 offen lds
    s_add_u32 m0, s32, 17408
    s_nop 0
    buffer_load_dwordx4 v7, s[12:15], s34 offen lds
    s_add_u32 s33, s33, 4096
    s_add_u32 s34, s34, 147456
    s_add_u32 s35, s33, 0
    buffer_load_dwordx4 v[112:115], v1, s[4:7], s35 offen sc1
    s_add_u32 s35, s33, 147456
    buffer_load_dwordx4 v[116:119], v1, s[4:7], s35 offen sc1
    s_add_u32 s35, s33, 294912
    buffer_load_dwordx4 v[120:123], v1, s[4:7], s35 offen sc1
    s_add_u32 s35, s33, 442368
    buffer_load_dwordx4 v[124:127], v1, s[4:7], s35 offen sc1
    s_add_u32 m0, s32, 18432
    s_nop 0
    buffer_load_dwordx4 v2, s[12:15], s34 offen lds
    s_add_u32 m0, s32, 19456
    s_nop 0
    buffer_load_dwordx4 v3, s[12:15], s34 offen lds
    s_add_u32 m0, s32, 20480
    s_nop 0
    buffer_load_dwordx4 v4, s[12:15], s34 offen lds
    s_add_u32 m0, s32, 21504
    s_nop 0
    buffer_load_dwordx4 v5, s[12:15], s34 offen lds
    s_add_u32 m0, s32, 22528
    s_nop 0
    buffer_load_dwordx4 v6, s[12:15], s34 offen lds
    s_add_u32 m0, s32, 23552
    s_nop 0
    buffer_load_dwordx4 v7, s[12:15], s34 offen lds
    s_add_u32 s33, s33, 4096
    s_add_u32 s34, s34, 147456
    s_add_u32 s35, s33, 0
    buffer_load_dwordx4 v[128:131], v1, s[4:7], s35 offen sc1
    s_add_u32 s35, s33, 147456
    buffer_load_dwordx4 v[132:135], v1, s[4:7], s35 offen sc1
    s_add_u32 s35, s33, 294912
    buffer_load_dwordx4 v[136:139], v1, s[4:7], s35 offen sc1
    s_add_u32 s35, s33, 442368
    buffer_load_dwordx4 v[140:143], v1, s[4:7], s35 offen sc1
    s_add_u32 m0, s32, 24576
    s_nop 0
    buffer_load_dwordx4 v2, s[12:15], s34 offen lds
    s_add_u32 m0, s32, 25600
    s_nop 0
    buffer_load_dwordx4 v3, s[12:15], s34 offen lds
    s_add_u32 m0, s32, 26624
    s_nop 0
    buffer_load_dwordx4 v4, s[12:15], s34 offen lds
    s_add_u32 m0, s32, 27648
    s_nop 0
    buffer_load_dwordx4 v5, s[12:15], s34 offen lds
    s_add_u32 m0, s32, 28672
    s_nop 0
    buffer_load_dwordx4 v6, s[12:15], s34 offen lds
    s_add_u32 m0, s32, 29696
    s_nop 0
    buffer_load_dwordx4 v7, s[12:15], s34 offen lds
    s_add_u32 s33, s33, 4096
    s_add_u32 s34, s34, 147456
    s_add_u32 s35, s33, 0
    buffer_load_dwordx4 v[144:147], v1, s[4:7], s35 offen sc1
    s_add_u32 s35, s33, 147456
    buffer_load_dwordx4 v[148:151], v1, s[4:7], s35 offen sc1
    s_add_u32 s35, s33, 294912
    buffer_load_dwordx4 v[152:155], v1, s[4:7], s35 offen sc1
    s_add_u32 s35, s33, 442368
    buffer_load_dwordx4 v[156:159], v1, s[4:7], s35 offen sc1
    s_add_u32 m0, s32, 30720
    s_nop 0
    buffer_load_dwordx4 v2, s[12:15], s34 offen lds
    s_add_u32 m0, s32, 31744
    s_nop 0
    buffer_load_dwordx4 v3, s[12:15], s34 offen lds
    s_add_u32 m0, s32, 32768
    s_nop 0
    buffer_load_dwordx4 v4, s[12:15], s34 offen lds
    s_add_u32 m0, s32, 33792
    s_nop 0
    buffer_load_dwordx4 v5, s[12:15], s34 offen lds
    s_add_u32 m0, s32, 34816
    s_nop 0
    buffer_load_dwordx4 v6, s[12:15], s34 offen lds
    s_add_u32 m0, s32, 35840
    s_nop 0
    buffer_load_dwordx4 v7, s[12:15], s34 offen lds
    s_add_u32 s33, s33, 4096
    s_add_u32 s34, s34, 147456
    v_mul_f32 v12, 0xbfb8aa3b, v12
    v_exp_f32 v12, v12
    s_nop 0
    v_add_f32 v12, 1.0, v12
    v_rcp_f32 v12, v12
    s_nop 0
    v_sub_f32 v13, 1.0, v12
    v_lshlrev_b32 v32, 16, v16
    v_and_b32 v33, 0xffff0000, v16
    v_lshlrev_b32 v34, 16, v17
    v_and_b32 v35, 0xffff0000, v17
    v_lshlrev_b32 v36, 16, v18
    v_and_b32 v37, 0xffff0000, v18
    v_lshlrev_b32 v38, 16, v19
    v_and_b32 v39, 0xffff0000, v19
    v_lshlrev_b32 v40, 16, v20
    v_and_b32 v41, 0xffff0000, v20
    v_lshlrev_b32 v42, 16, v21
    v_and_b32 v43, 0xffff0000, v21
    v_lshlrev_b32 v44, 16, v22
    v_and_b32 v45, 0xffff0000, v22
    v_lshlrev_b32 v46, 16, v23
    v_and_b32 v47, 0xffff0000, v23
    v_lshlrev_b32 v48, 16, v24
    v_and_b32 v49, 0xffff0000, v24
    v_lshlrev_b32 v50, 16, v25
    v_and_b32 v51, 0xffff0000, v25
    v_lshlrev_b32 v52, 16, v26
    v_and_b32 v53, 0xffff0000, v26
    v_lshlrev_b32 v54, 16, v27
    v_and_b32 v55, 0xffff0000, v27
    v_accvgpr_write_b32 a0, 0
    v_accvgpr_write_b32 a1, 0
    v_accvgpr_write_b32 a2, 0
    v_accvgpr_write_b32 a3, 0
    v_accvgpr_write_b32 a4, 0
    v_accvgpr_write_b32 a5, 0
    v_accvgpr_write_b32 a6, 0
    v_accvgpr_write_b32 a7, 0
    v_accvgpr_write_b32 a8, 0
    v_accvgpr_write_b32 a9, 0
    v_accvgpr_write_b32 a10, 0
    v_accvgpr_write_b32 a11, 0
    v_accvgpr_write_b32 a12, 0
    v_accvgpr_write_b32 a13, 0
    v_accvgpr_write_b32 a14, 0
    v_accvgpr_write_b32 a15, 0
    v_accvgpr_write_b32 a16, 0
    v_accvgpr_write_b32 a17, 0
    v_accvgpr_write_b32 a18, 0
    v_accvgpr_write_b32 a19, 0
    v_accvgpr_write_b32 a20, 0
    v_accvgpr_write_b32 a21, 0
    v_accvgpr_write_b32 a22, 0
    v_accvgpr_write_b32 a23, 0
    v_accvgpr_write_b32 a24, 0
    v_accvgpr_write_b32 a25, 0
    v_accvgpr_write_b32 a26, 0
    v_accvgpr_write_b32 a27, 0
    v_accvgpr_write_b32 a28, 0
    v_accvgpr_write_b32 a29, 0
    v_accvgpr_write_b32 a30, 0
    v_accvgpr_write_b32 a31, 0
    v_accvgpr_write_b32 a32, 0
    v_accvgpr_write_b32 a33, 0
    v_accvgpr_write_b32 a34, 0
    v_accvgpr_write_b32 a35, 0
    v_accvgpr_write_b32 a36, 0
    v_accvgpr_write_b32 a37, 0
    v_accvgpr_write_b32 a38, 0
    v_accvgpr_write_b32 a39, 0
    v_accvgpr_write_b32 a40, 0
    v_accvgpr_write_b32 a41, 0
    v_accvgpr_write_b32 a42, 0
    v_accvgpr_write_b32 a43, 0
    v_accvgpr_write_b32 a44, 0
    v_accvgpr_write_b32 a45, 0
    v_accvgpr_write_b32 a46, 0
    v_accvgpr_write_b32 a47, 0
    v_accvgpr_write_b32 a48, 0
    v_accvgpr_write_b32 a49, 0
    v_accvgpr_write_b32 a50, 0
    v_accvgpr_write_b32 a51, 0
    v_accvgpr_write_b32 a52, 0
    v_accvgpr_write_b32 a53, 0
    v_accvgpr_write_b32 a54, 0
    v_accvgpr_write_b32 a55, 0
    v_accvgpr_write_b32 a56, 0
    v_accvgpr_write_b32 a57, 0
    v_accvgpr_write_b32 a58, 0
    v_accvgpr_write_b32 a59, 0
    v_accvgpr_write_b32 a60, 0
    v_accvgpr_write_b32 a61, 0
    v_accvgpr_write_b32 a62, 0
    v_accvgpr_write_b32 a63, 0
    v_accvgpr_write_b32 a64, 0
    v_accvgpr_write_b32 a65, 0
    v_accvgpr_write_b32 a66, 0
    v_accvgpr_write_b32 a67, 0
    v_accvgpr_write_b32 a68, 0
    v_accvgpr_write_b32 a69, 0
    v_accvgpr_write_b32 a70, 0
    v_accvgpr_write_b32 a71, 0
    v_accvgpr_write_b32 a72, 0
    v_accvgpr_write_b32 a73, 0
    v_accvgpr_write_b32 a74, 0
    v_accvgpr_write_b32 a75, 0
    v_accvgpr_write_b32 a76, 0
    v_accvgpr_write_b32 a77, 0
    v_accvgpr_write_b32 a78, 0
    v_accvgpr_write_b32 a79, 0
    v_accvgpr_write_b32 a80, 0
    v_accvgpr_write_b32 a81, 0
    v_accvgpr_write_b32 a82, 0
    v_accvgpr_write_b32 a83, 0
    v_accvgpr_write_b32 a84, 0
    v_accvgpr_write_b32 a85, 0
    v_accvgpr_write_b32 a86, 0
    v_accvgpr_write_b32 a87, 0
    v_accvgpr_write_b32 a88, 0
    v_accvgpr_write_b32 a89, 0
    v_accvgpr_write_b32 a90, 0
    v_accvgpr_write_b32 a91, 0
    v_accvgpr_write_b32 a92, 0
    v_accvgpr_write_b32 a93, 0
    v_accvgpr_write_b32 a94, 0
    v_accvgpr_write_b32 a95, 0
    s_mov_b32 s36, 0
Lf2_7:
    s_cmp_ge_u32 s36, 5
    s_cselect_b32 s33, 2146435072, s33
    s_cselect_b32 s34, 2146435072, s34
    s_waitcnt vmcnt(50)
    ds_read_b64_tr_b16 v[160:161], v8 offset:0
    ds_read_b64_tr_b16 v[162:163], v8 offset:768
    ds_read_b64_tr_b16 v[164:165], v8 offset:8
    ds_read_b64_tr_b16 v[166:167], v8 offset:776
    ds_read_b64_tr_b16 v[168:169], v8 offset:64
    ds_read_b64_tr_b16 v[170:171], v8 offset:832
    ds_read_b64_tr_b16 v[172:173], v8 offset:72
    ds_read_b64_tr_b16 v[174:175], v8 offset:840
    ds_read_b64_tr_b16 v[176:177], v8 offset:128
    ds_read_b64_tr_b16 v[178:179], v8 offset:896
    ds_read_b64_tr_b16 v[180:181], v8 offset:136
    ds_read_b64_tr_b16 v[182:183], v8 offset:904
    s_waitcnt lgkmcnt(10)
    v_mfma_f32_16x16x32_bf16 a[0:3], v[160:163], v[64:67], a[0:3]
    v_mfma_f32_16x16x32_bf16 a[24:27], v[160:163], v[68:71], a[24:27]
    v_mfma_f32_16x16x32_bf16 a[48:51], v[160:163], v[72:75], a[48:51]
    v_mfma_f32_16x16x32_bf16 a[72:75], v[160:163], v[76:79], a[72:75]
    s_waitcnt lgkmcnt(8)
    v_mfma_f32_16x16x32_bf16 a[4:7], v[164:167], v[64:67], a[4:7]
    v_mfma_f32_16x16x32_bf16 a[28:31], v[164:167], v[68:71], a[28:31]
    v_mfma_f32_16x16x32_bf16 a[52:55], v[164:167], v[72:75], a[52:55]
    v_mfma_f32_16x16x32_bf16 a[76:79], v[164:167], v[76:79], a[76:79]
    s_waitcnt lgkmcnt(6)
    v_mfma_f32_16x16x32_bf16 a[8:11], v[168:171], v[64:67], a[8:11]
    v_mfma_f32_16x16x32_bf16 a[32:35], v[168:171], v[68:71], a[32:35]
    v_mfma_f32_16x16x32_bf16 a[56:59], v[168:171], v[72:75], a[56:59]
    v_mfma_f32_16x16x32_bf16 a[80:83], v[168:171], v[76:79], a[80:83]
    s_waitcnt lgkmcnt(4)
    v_mfma_f32_16x16x32_bf16 a[12:15], v[172:175], v[64:67], a[12:15]
    v_mfma_f32_16x16x32_bf16 a[36:39], v[172:175], v[68:71], a[36:39]
    v_mfma_f32_16x16x32_bf16 a[60:63], v[172:175], v[72:75], a[60:63]
    v_mfma_f32_16x16x32_bf16 a[84:87], v[172:175], v[76:79], a[84:87]
    s_waitcnt lgkmcnt(2)
    v_mfma_f32_16x16x32_bf16 a[16:19], v[176:179], v[64:67], a[16:19]
    v_mfma_f32_16x16x32_bf16 a[40:43], v[176:179], v[68:71], a[40:43]
    v_mfma_f32_16x16x32_bf16 a[64:67], v[176:179], v[72:75], a[64:67]
    v_mfma_f32_16x16x32_bf16 a[88:91], v[176:179], v[76:79], a[88:91]
    s_waitcnt lgkmcnt(0)
    v_mfma_f32_16x16x32_bf16 a[20:23], v[180:183], v[64:67], a[20:23]
    v_mfma_f32_16x16x32_bf16 a[44:47], v[180:183], v[68:71], a[44:47]
    v_mfma_f32_16x16x32_bf16 a[68:71], v[180:183], v[72:75], a[68:71]
    v_mfma_f32_16x16x32_bf16 a[92:95], v[180:183], v[76:79], a[92:95]
    s_add_u32 s35, s33, 0
    buffer_load_dwordx4 v[64:67], v1, s[4:7], s35 offen sc1
    s_add_u32 s35, s33, 147456
    buffer_load_dwordx4 v[68:71], v1, s[4:7], s35 offen sc1
    s_add_u32 s35, s33, 294912
    buffer_load_dwordx4 v[72:75], v1, s[4:7], s35 offen sc1
    s_add_u32 s35, s33, 442368
    buffer_load_dwordx4 v[76:79], v1, s[4:7], s35 offen sc1
    s_add_u32 m0, s32, 0
    s_nop 0
    buffer_load_dwordx4 v2, s[12:15], s34 offen lds
    s_add_u32 m0, s32, 1024
    s_nop 0
    buffer_load_dwordx4 v3, s[12:15], s34 offen lds
    s_add_u32 m0, s32, 2048
    s_nop 0
    buffer_load_dwordx4 v4, s[12:15], s34 offen lds
    s_add_u32 m0, s32, 3072
    s_nop 0
    buffer_load_dwordx4 v5, s[12:15], s34 offen lds
    s_add_u32 m0, s32, 4096
    s_nop 0
    buffer_load_dwordx4 v6, s[12:15], s34 offen lds
    s_add_u32 m0, s32, 5120
    s_nop 0
    buffer_load_dwordx4 v7, s[12:15], s34 offen lds
    s_add_u32 s33, s33, 4096
    s_add_u32 s34, s34, 147456
    s_waitcnt vmcnt(50)
    ds_read_b64_tr_b16 v[160:161], v8 offset:6144
    ds_read_b64_tr_b16 v[162:163], v8 offset:6912
    ds_read_b64_tr_b16 v[164:165], v8 offset:6152
    ds_read_b64_tr_b16 v[166:167], v8 offset:6920
    ds_read_b64_tr_b16 v[168:169], v8 offset:6208
    ds_read_b64_tr_b16 v[170:171], v8 offset:6976
    ds_read_b64_tr_b16 v[172:173], v8 offset:6216
    ds_read_b64_tr_b16 v[174:175], v8 offset:6984
    ds_read_b64_tr_b16 v[176:177], v8 offset:6272
    ds_read_b64_tr_b16 v[178:179], v8 offset:7040
    ds_read_b64_tr_b16 v[180:181], v8 offset:6280
    ds_read_b64_tr_b16 v[182:183], v8 offset:7048
    s_waitcnt lgkmcnt(10)
    v_mfma_f32_16x16x32_bf16 a[0:3], v[160:163], v[80:83], a[0:3]
    v_mfma_f32_16x16x32_bf16 a[24:27], v[160:163], v[84:87], a[24:27]
    v_mfma_f32_16x16x32_bf16 a[48:51], v[160:163], v[88:91], a[48:51]
    v_mfma_f32_16x16x32_bf16 a[72:75], v[160:163], v[92:95], a[72:75]
    s_waitcnt lgkmcnt(8)
    v_mfma_f32_16x16x32_bf16 a[4:7], v[164:167], v[80:83], a[4:7]
    v_mfma_f32_16x16x32_bf16 a[28:31], v[164:167], v[84:87], a[28:31]
    v_mfma_f32_16x16x32_bf16 a[52:55], v[164:167], v[88:91], a[52:55]
    v_mfma_f32_16x16x32_bf16 a[76:79], v[164:167], v[92:95], a[76:79]
    s_waitcnt lgkmcnt(6)
    v_mfma_f32_16x16x32_bf16 a[8:11], v[168:171], v[80:83], a[8:11]
    v_mfma_f32_16x16x32_bf16 a[32:35], v[168:171], v[84:87], a[32:35]
    v_mfma_f32_16x16x32_bf16 a[56:59], v[168:171], v[88:91], a[56:59]
    v_mfma_f32_16x16x32_bf16 a[80:83], v[168:171], v[92:95], a[80:83]
    s_waitcnt lgkmcnt(4)
    v_mfma_f32_16x16x32_bf16 a[12:15], v[172:175], v[80:83], a[12:15]
    v_mfma_f32_16x16x32_bf16 a[36:39], v[172:175], v[84:87], a[36:39]
    v_mfma_f32_16x16x32_bf16 a[60:63], v[172:175], v[88:91], a[60:63]
    v_mfma_f32_16x16x32_bf16 a[84:87], v[172:175], v[92:95], a[84:87]
    s_waitcnt lgkmcnt(2)
    v_mfma_f32_16x16x32_bf16 a[16:19], v[176:179], v[80:83], a[16:19]
    v_mfma_f32_16x16x32_bf16 a[40:43], v[176:179], v[84:87], a[40:43]
    v_mfma_f32_16x16x32_bf16 a[64:67], v[176:179], v[88:91], a[64:67]
    v_mfma_f32_16x16x32_bf16 a[88:91], v[176:179], v[92:95], a[88:91]
    s_waitcnt lgkmcnt(0)
    v_mfma_f32_16x16x32_bf16 a[20:23], v[180:183], v[80:83], a[20:23]
    v_mfma_f32_16x16x32_bf16 a[44:47], v[180:183], v[84:87], a[44:47]
    v_mfma_f32_16x16x32_bf16 a[68:71], v[180:183], v[88:91], a[68:71]
    v_mfma_f32_16x16x32_bf16 a[92:95], v[180:183], v[92:95], a[92:95]
    s_add_u32 s35, s33, 0
    buffer_load_dwordx4 v[80:83], v1, s[4:7], s35 offen sc1
    s_add_u32 s35, s33, 147456
    buffer_load_dwordx4 v[84:87], v1, s[4:7], s35 offen sc1
    s_add_u32 s35, s33, 294912
    buffer_load_dwordx4 v[88:91], v1, s[4:7], s35 offen sc1
    s_add_u32 s35, s33, 442368
    buffer_load_dwordx4 v[92:95], v1, s[4:7], s35 offen sc1
    s_add_u32 m0, s32, 6144
    s_nop 0
    buffer_load_dwordx4 v2, s[12:15], s34 offen lds
    s_add_u32 m0, s32, 7168
    s_nop 0
    buffer_load_dwordx4 v3, s[12:15], s34 offen lds
    s_add_u32 m0, s32, 8192
    s_nop 0
    buffer_load_dwordx4 v4, s[12:15], s34 offen lds
    s_add_u32 m0, s32, 9216
    s_nop 0
    buffer_load_dwordx4 v5, s[12:15], s34 offen lds
    s_add_u32 m0, s32, 10240
    s_nop 0
    buffer_load_dwordx4 v6, s[12:15], s34 offen lds
    s_add_u32 m0, s32, 11264
    s_nop 0
    buffer_load_dwordx4 v7, s[12:15], s34 offen lds
    s_add_u32 s33, s33, 4096
    s_add_u32 s34, s34, 147456
    s_waitcnt vmcnt(50)
    ds_read_b64_tr_b16 v[160:161], v8 offset:12288
    ds_read_b64_tr_b16 v[162:163], v8 offset:13056
    ds_read_b64_tr_b16 v[164:165], v8 offset:12296
    ds_read_b64_tr_b16 v[166:167], v8 offset:13064
    ds_read_b64_tr_b16 v[168:169], v8 offset:12352
    ds_read_b64_tr_b16 v[170:171], v8 offset:13120
    ds_read_b64_tr_b16 v[172:173], v8 offset:12360
    ds_read_b64_tr_b16 v[174:175], v8 offset:13128
    ds_read_b64_tr_b16 v[176:177], v8 offset:12416
    ds_read_b64_tr_b16 v[178:179], v8 offset:13184
    ds_read_b64_tr_b16 v[180:181], v8 offset:12424
    ds_read_b64_tr_b16 v[182:183], v8 offset:13192
    s_waitcnt lgkmcnt(10)
    v_mfma_f32_16x16x32_bf16 a[0:3], v[160:163], v[96:99], a[0:3]
    v_mfma_f32_16x16x32_bf16 a[24:27], v[160:163], v[100:103], a[24:27]
    v_mfma_f32_16x16x32_bf16 a[48:51], v[160:163], v[104:107], a[48:51]
    v_mfma_f32_16x16x32_bf16 a[72:75], v[160:163], v[108:111], a[72:75]
    s_waitcnt lgkmcnt(8)
    v_mfma_f32_16x16x32_bf16 a[4:7], v[164:167], v[96:99], a[4:7]
    v_mfma_f32_16x16x32_bf16 a[28:31], v[164:167], v[100:103], a[28:31]
    v_mfma_f32_16x16x32_bf16 a[52:55], v[164:167], v[104:107], a[52:55]
    v_mfma_f32_16x16x32_bf16 a[76:79], v[164:167], v[108:111], a[76:79]
    s_waitcnt lgkmcnt(6)
    v_mfma_f32_16x16x32_bf16 a[8:11], v[168:171], v[96:99], a[8:11]
    v_mfma_f32_16x16x32_bf16 a[32:35], v[168:171], v[100:103], a[32:35]
    v_mfma_f32_16x16x32_bf16 a[56:59], v[168:171], v[104:107], a[56:59]
    v_mfma_f32_16x16x32_bf16 a[80:83], v[168:171], v[108:111], a[80:83]
    s_waitcnt lgkmcnt(4)
    v_mfma_f32_16x16x32_bf16 a[12:15], v[172:175], v[96:99], a[12:15]
    v_mfma_f32_16x16x32_bf16 a[36:39], v[172:175], v[100:103], a[36:39]
    v_mfma_f32_16x16x32_bf16 a[60:63], v[172:175], v[104:107], a[60:63]
    v_mfma_f32_16x16x32_bf16 a[84:87], v[172:175], v[108:111], a[84:87]
    s_waitcnt lgkmcnt(2)
    v_mfma_f32_16x16x32_bf16 a[16:19], v[176:179], v[96:99], a[16:19]
    v_mfma_f32_16x16x32_bf16 a[40:43], v[176:179], v[100:103], a[40:43]
    v_mfma_f32_16x16x32_bf16 a[64:67], v[176:179], v[104:107], a[64:67]
    v_mfma_f32_16x16x32_bf16 a[88:91], v[176:179], v[108:111], a[88:91]
    s_waitcnt lgkmcnt(0)
    v_mfma_f32_16x16x32_bf16 a[20:23], v[180:183], v[96:99], a[20:23]
    v_mfma_f32_16x16x32_bf16 a[44:47], v[180:183], v[100:103], a[44:47]
    v_mfma_f32_16x16x32_bf16 a[68:71], v[180:183], v[104:107], a[68:71]
    v_mfma_f32_16x16x32_bf16 a[92:95], v[180:183], v[108:111], a[92:95]
    s_add_u32 s35, s33, 0
    buffer_load_dwordx4 v[96:99], v1, s[4:7], s35 offen sc1
    s_add_u32 s35, s33, 147456
    buffer_load_dwordx4 v[100:103], v1, s[4:7], s35 offen sc1
    s_add_u32 s35, s33, 294912
    buffer_load_dwordx4 v[104:107], v1, s[4:7], s35 offen sc1
    s_add_u32 s35, s33, 442368
    buffer_load_dwordx4 v[108:111], v1, s[4:7], s35 offen sc1
    s_add_u32 m0, s32, 12288
    s_nop 0
    buffer_load_dwordx4 v2, s[12:15], s34 offen lds
    s_add_u32 m0, s32, 13312
    s_nop 0
    buffer_load_dwordx4 v3, s[12:15], s34 offen lds
    s_add_u32 m0, s32, 14336
    s_nop 0
    buffer_load_dwordx4 v4, s[12:15], s34 offen lds
    s_add_u32 m0, s32, 15360
    s_nop 0
    buffer_load_dwordx4 v5, s[12:15], s34 offen lds
    s_add_u32 m0, s32, 16384
    s_nop 0
    buffer_load_dwordx4 v6, s[12:15], s34 offen lds
    s_add_u32 m0, s32, 17408
    s_nop 0
    buffer_load_dwordx4 v7, s[12:15], s34 offen lds
    s_add_u32 s33, s33, 4096
    s_add_u32 s34, s34, 147456
    s_waitcnt vmcnt(50)
    ds_read_b64_tr_b16 v[160:161], v8 offset:18432
    ds_read_b64_tr_b16 v[162:163], v8 offset:19200
    ds_read_b64_tr_b16 v[164:165], v8 offset:18440
    ds_read_b64_tr_b16 v[166:167], v8 offset:19208
    ds_read_b64_tr_b16 v[168:169], v8 offset:18496
    ds_read_b64_tr_b16 v[170:171], v8 offset:19264
    ds_read_b64_tr_b16 v[172:173], v8 offset:18504
    ds_read_b64_tr_b16 v[174:175], v8 offset:19272
    ds_read_b64_tr_b16 v[176:177], v8 offset:18560
    ds_read_b64_tr_b16 v[178:179], v8 offset:19328
    ds_read_b64_tr_b16 v[180:181], v8 offset:18568
    ds_read_b64_tr_b16 v[182:183], v8 offset:19336
    s_waitcnt lgkmcnt(10)
    v_mfma_f32_16x16x32_bf16 a[0:3], v[160:163], v[112:115], a[0:3]
    v_mfma_f32_16x16x32_bf16 a[24:27], v[160:163], v[116:119], a[24:27]
    v_mfma_f32_16x16x32_bf16 a[48:51], v[160:163], v[120:123], a[48:51]
    v_mfma_f32_16x16x32_bf16 a[72:75], v[160:163], v[124:127], a[72:75]
    s_waitcnt lgkmcnt(8)
    v_mfma_f32_16x16x32_bf16 a[4:7], v[164:167], v[112:115], a[4:7]
    v_mfma_f32_16x16x32_bf16 a[28:31], v[164:167], v[116:119], a[28:31]
    v_mfma_f32_16x16x32_bf16 a[52:55], v[164:167], v[120:123], a[52:55]
    v_mfma_f32_16x16x32_bf16 a[76:79], v[164:167], v[124:127], a[76:79]
    s_waitcnt lgkmcnt(6)
    v_mfma_f32_16x16x32_bf16 a[8:11], v[168:171], v[112:115], a[8:11]
    v_mfma_f32_16x16x32_bf16 a[32:35], v[168:171], v[116:119], a[32:35]
    v_mfma_f32_16x16x32_bf16 a[56:59], v[168:171], v[120:123], a[56:59]
    v_mfma_f32_16x16x32_bf16 a[80:83], v[168:171], v[124:127], a[80:83]
    s_waitcnt lgkmcnt(4)
    v_mfma_f32_16x16x32_bf16 a[12:15], v[172:175], v[112:115], a[12:15]
    v_mfma_f32_16x16x32_bf16 a[36:39], v[172:175], v[116:119], a[36:39]
    v_mfma_f32_16x16x32_bf16 a[60:63], v[172:175], v[120:123], a[60:63]
    v_mfma_f32_16x16x32_bf16 a[84:87], v[172:175], v[124:127], a[84:87]
    s_waitcnt lgkmcnt(2)
    v_mfma_f32_16x16x32_bf16 a[16:19], v[176:179], v[112:115], a[16:19]
    v_mfma_f32_16x16x32_bf16 a[40:43], v[176:179], v[116:119], a[40:43]
    v_mfma_f32_16x16x32_bf16 a[64:67], v[176:179], v[120:123], a[64:67]
    v_mfma_f32_16x16x32_bf16 a[88:91], v[176:179], v[124:127], a[88:91]
    s_waitcnt lgkmcnt(0)
    v_mfma_f32_16x16x32_bf16 a[20:23], v[180:183], v[112:115], a[20:23]
    v_mfma_f32_16x16x32_bf16 a[44:47], v[180:183], v[116:119], a[44:47]
    v_mfma_f32_16x16x32_bf16 a[68:71], v[180:183], v[120:123], a[68:71]
    v_mfma_f32_16x16x32_bf16 a[92:95], v[180:183], v[124:127], a[92:95]
    s_add_u32 s35, s33, 0
    buffer_load_dwordx4 v[112:115], v1, s[4:7], s35 offen sc1
    s_add_u32 s35, s33, 147456
    buffer_load_dwordx4 v[116:119], v1, s[4:7], s35 offen sc1
    s_add_u32 s35, s33, 294912
    buffer_load_dwordx4 v[120:123], v1, s[4:7], s35 offen sc1
    s_add_u32 s35, s33, 442368
    buffer_load_dwordx4 v[124:127], v1, s[4:7], s35 offen sc1
    s_add_u32 m0, s32, 18432
    s_nop 0
    buffer_load_dwordx4 v2, s[12:15], s34 offen lds
    s_add_u32 m0, s32, 19456
    s_nop 0
    buffer_load_dwordx4 v3, s[12:15], s34 offen lds
    s_add_u32 m0, s32, 20480
    s_nop 0
    buffer_load_dwordx4 v4, s[12:15], s34 offen lds
    s_add_u32 m0, s32, 21504
    s_nop 0
    buffer_load_dwordx4 v5, s[12:15], s34 offen lds
    s_add_u32 m0, s32, 22528
    s_nop 0
    buffer_load_dwordx4 v6, s[12:15], s34 offen lds
    s_add_u32 m0, s32, 23552
    s_nop 0
    buffer_load_dwordx4 v7, s[12:15], s34 offen lds
    s_add_u32 s33, s33, 4096
    s_add_u32 s34, s34, 147456
    s_waitcnt vmcnt(50)
    ds_read_b64_tr_b16 v[160:161], v8 offset:24576
    ds_read_b64_tr_b16 v[162:163], v8 offset:25344
    ds_read_b64_tr_b16 v[164:165], v8 offset:24584
    ds_read_b64_tr_b16 v[166:167], v8 offset:25352
    ds_read_b64_tr_b16 v[168:169], v8 offset:24640
    ds_read_b64_tr_b16 v[170:171], v8 offset:25408
    ds_read_b64_tr_b16 v[172:173], v8 offset:24648
    ds_read_b64_tr_b16 v[174:175], v8 offset:25416
    ds_read_b64_tr_b16 v[176:177], v8 offset:24704
    ds_read_b64_tr_b16 v[178:179], v8 offset:25472
    ds_read_b64_tr_b16 v[180:181], v8 offset:24712
    ds_read_b64_tr_b16 v[182:183], v8 offset:25480
    s_waitcnt lgkmcnt(10)
    v_mfma_f32_16x16x32_bf16 a[0:3], v[160:163], v[128:131], a[0:3]
    v_mfma_f32_16x16x32_bf16 a[24:27], v[160:163], v[132:135], a[24:27]
    v_mfma_f32_16x16x32_bf16 a[48:51], v[160:163], v[136:139], a[48:51]
    v_mfma_f32_16x16x32_bf16 a[72:75], v[160:163], v[140:143], a[72:75]
    s_waitcnt lgkmcnt(8)
    v_mfma_f32_16x16x32_bf16 a[4:7], v[164:167], v[128:131], a[4:7]
    v_mfma_f32_16x16x32_bf16 a[28:31], v[164:167], v[132:135], a[28:31]
    v_mfma_f32_16x16x32_bf16 a[52:55], v[164:167], v[136:139], a[52:55]
    v_mfma_f32_16x16x32_bf16 a[76:79], v[164:167], v[140:143], a[76:79]
    s_waitcnt lgkmcnt(6)
    v_mfma_f32_16x16x32_bf16 a[8:11], v[168:171], v[128:131], a[8:11]
    v_mfma_f32_16x16x32_bf16 a[32:35], v[168:171], v[132:135], a[32:35]
    v_mfma_f32_16x16x32_bf16 a[56:59], v[168:171], v[136:139], a[56:59]
    v_mfma_f32_16x16x32_bf16 a[80:83], v[168:171], v[140:143], a[80:83]
    s_waitcnt lgkmcnt(4)
    v_mfma_f32_16x16x32_bf16 a[12:15], v[172:175], v[128:131], a[12:15]
    v_mfma_f32_16x16x32_bf16 a[36:39], v[172:175], v[132:135], a[36:39]
    v_mfma_f32_16x16x32_bf16 a[60:63], v[172:175], v[136:139], a[60:63]
    v_mfma_f32_16x16x32_bf16 a[84:87], v[172:175], v[140:143], a[84:87]
    s_waitcnt lgkmcnt(2)
    v_mfma_f32_16x16x32_bf16 a[16:19], v[176:179], v[128:131], a[16:19]
    v_mfma_f32_16x16x32_bf16 a[40:43], v[176:179], v[132:135], a[40:43]
    v_mfma_f32_16x16x32_bf16 a[64:67], v[176:179], v[136:139], a[64:67]
    v_mfma_f32_16x16x32_bf16 a[88:91], v[176:179], v[140:143], a[88:91]
    s_waitcnt lgkmcnt(0)
    v_mfma_f32_16x16x32_bf16 a[20:23], v[180:183], v[128:131], a[20:23]
    v_mfma_f32_16x16x32_bf16 a[44:47], v[180:183], v[132:135], a[44:47]
    v_mfma_f32_16x16x32_bf16 a[68:71], v[180:183], v[136:139], a[68:71]
    v_mfma_f32_16x16x32_bf16 a[92:95], v[180:183], v[140:143], a[92:95]
    s_add_u32 s35, s33, 0
    buffer_load_dwordx4 v[128:131], v1, s[4:7], s35 offen sc1
    s_add_u32 s35, s33, 147456
    buffer_load_dwordx4 v[132:135], v1, s[4:7], s35 offen sc1
    s_add_u32 s35, s33, 294912
    buffer_load_dwordx4 v[136:139], v1, s[4:7], s35 offen sc1
    s_add_u32 s35, s33, 442368
    buffer_load_dwordx4 v[140:143], v1, s[4:7], s35 offen sc1
    s_add_u32 m0, s32, 24576
    s_nop 0
    buffer_load_dwordx4 v2, s[12:15], s34 offen lds
    s_add_u32 m0, s32, 25600
    s_nop 0
    buffer_load_dwordx4 v3, s[12:15], s34 offen lds
    s_add_u32 m0, s32, 26624
    s_nop 0
    buffer_load_dwordx4 v4, s[12:15], s34 offen lds
    s_add_u32 m0, s32, 27648
    s_nop 0
    buffer_load_dwordx4 v5, s[12:15], s34 offen lds
    s_add_u32 m0, s32, 28672
    s_nop 0
    buffer_load_dwordx4 v6, s[12:15], s34 offen lds
    s_add_u32 m0, s32, 29696
    s_nop 0
    buffer_load_dwordx4 v7, s[12:15], s34 offen lds
    s_add_u32 s33, s33, 4096
    s_add_u32 s34, s34, 147456
    s_waitcnt vmcnt(50)
    ds_read_b64_tr_b16 v[160:161], v8 offset:30720
    ds_read_b64_tr_b16 v[162:163], v8 offset:31488
    ds_read_b64_tr_b16 v[164:165], v8 offset:30728
    ds_read_b64_tr_b16 v[166:167], v8 offset:31496
    ds_read_b64_tr_b16 v[168:169], v8 offset:30784
    ds_read_b64_tr_b16 v[170:171], v8 offset:31552
    ds_read_b64_tr_b16 v[172:173], v8 offset:30792
    ds_read_b64_tr_b16 v[174:175], v8 offset:31560
    ds_read_b64_tr_b16 v[176:177], v8 offset:30848
    ds_read_b64_tr_b16 v[178:179], v8 offset:31616
    ds_read_b64_tr_b16 v[180:181], v8 offset:30856
    ds_read_b64_tr_b16 v[182:183], v8 offset:31624
    s_waitcnt lgkmcnt(10)
    v_mfma_f32_16x16x32_bf16 a[0:3], v[160:163], v[144:147], a[0:3]
    v_mfma_f32_16x16x32_bf16 a[24:27], v[160:163], v[148:151], a[24:27]
    v_mfma_f32_16x16x32_bf16 a[48:51], v[160:163], v[152:155], a[48:51]
    v_mfma_f32_16x16x32_bf16 a[72:75], v[160:163], v[156:159], a[72:75]
    s_waitcnt lgkmcnt(8)
    v_mfma_f32_16x16x32_bf16 a[4:7], v[164:167], v[144:147], a[4:7]
    v_mfma_f32_16x16x32_bf16 a[28:31], v[164:167], v[148:151], a[28:31]
    v_mfma_f32_16x16x32_bf16 a[52:55], v[164:167], v[152:155], a[52:55]
    v_mfma_f32_16x16x32_bf16 a[76:79], v[164:167], v[156:159], a[76:79]
    s_waitcnt lgkmcnt(6)
    v_mfma_f32_16x16x32_bf16 a[8:11], v[168:171], v[144:147], a[8:11]
    v_mfma_f32_16x16x32_bf16 a[32:35], v[168:171], v[148:151], a[32:35]
    v_mfma_f32_16x16x32_bf16 a[56:59], v[168:171], v[152:155], a[56:59]
    v_mfma_f32_16x16x32_bf16 a[80:83], v[168:171], v[156:159], a[80:83]
    s_waitcnt lgkmcnt(4)
    v_mfma_f32_16x16x32_bf16 a[12:15], v[172:175], v[144:147], a[12:15]
    v_mfma_f32_16x16x32_bf16 a[36:39], v[172:175], v[148:151], a[36:39]
    v_mfma_f32_16x16x32_bf16 a[60:63], v[172:175], v[152:155], a[60:63]
    v_mfma_f32_16x16x32_bf16 a[84:87], v[172:175], v[156:159], a[84:87]
    s_waitcnt lgkmcnt(2)
    v_mfma_f32_16x16x32_bf16 a[16:19], v[176:179], v[144:147], a[16:19]
    v_mfma_f32_16x16x32_bf16 a[40:43], v[176:179], v[148:151], a[40:43]
    v_mfma_f32_16x16x32_bf16 a[64:67], v[176:179], v[152:155], a[64:67]
    v_mfma_f32_16x16x32_bf16 a[88:91], v[176:179], v[156:159], a[88:91]
    s_waitcnt lgkmcnt(0)
    v_mfma_f32_16x16x32_bf16 a[20:23], v[180:183], v[144:147], a[20:23]
    v_mfma_f32_16x16x32_bf16 a[44:47], v[180:183], v[148:151], a[44:47]
    v_mfma_f32_16x16x32_bf16 a[68:71], v[180:183], v[152:155], a[68:71]
    v_mfma_f32_16x16x32_bf16 a[92:95], v[180:183], v[156:159], a[92:95]
    s_add_u32 s35, s33, 0
    buffer_load_dwordx4 v[144:147], v1, s[4:7], s35 offen sc1
    s_add_u32 s35, s33, 147456
    buffer_load_dwordx4 v[148:151], v1, s[4:7], s35 offen sc1
    s_add_u32 s35, s33, 294912
    buffer_load_dwordx4 v[152:155], v1, s[4:7], s35 offen sc1
    s_add_u32 s35, s33, 442368
    buffer_load_dwordx4 v[156:159], v1, s[4:7], s35 offen sc1
    s_add_u32 m0, s32, 30720
    s_nop 0
    buffer_load_dwordx4 v2, s[12:15], s34 offen lds
    s_add_u32 m0, s32, 31744
    s_nop 0
    buffer_load_dwordx4 v3, s[12:15], s34 offen lds
    s_add_u32 m0, s32, 32768
    s_nop 0
    buffer_load_dwordx4 v4, s[12:15], s34 offen lds
    s_add_u32 m0, s32, 33792
    s_nop 0
    buffer_load_dwordx4 v5, s[12:15], s34 offen lds
    s_add_u32 m0, s32, 34816
    s_nop 0
    buffer_load_dwordx4 v6, s[12:15], s34 offen lds
    s_add_u32 m0, s32, 35840
    s_nop 0
    buffer_load_dwordx4 v7, s[12:15], s34 offen lds
    s_add_u32 s33, s33, 4096
    s_add_u32 s34, s34, 147456
    s_add_u32 s36, s36, 1
    s_cmp_lt_u32 s36, 6
    s_cbranch_scc1 Lf2_7
    s_waitcnt vmcnt(0)
    s_barrier
    s_mul_i32 s35, s29, 24576
    v_add_u32 v14, s35, v1
    ds_write_b128 v14, a[0:3] offset:0
    ds_write_b128 v14, a[4:7] offset:1024
    ds_write_b128 v14, a[8:11] offset:2048
    ds_write_b128 v14, a[12:15] offset:3072
    ds_write_b128 v14, a[16:19] offset:4096
    ds_write_b128 v14, a[20:23] offset:5120
    ds_write_b128 v14, a[24:27] offset:6144
    ds_write_b128 v14, a[28:31] offset:7168
    ds_write_b128 v14, a[32:35] offset:8192
    ds_write_b128 v14, a[36:39] offset:9216
    ds_write_b128 v14, a[40:43] offset:10240
    ds_write_b128 v14, a[44:47] offset:11264
    ds_write_b128 v14, a[48:51] offset:12288
    ds_write_b128 v14, a[52:55] offset:13312
    ds_write_b128 v14, a[56:59] offset:14336
    ds_write_b128 v14, a[60:63] offset:15360
    ds_write_b128 v14, a[64:67] offset:16384
    ds_write_b128 v14, a[68:71] offset:17408
    ds_write_b128 v14, a[72:75] offset:18432
    ds_write_b128 v14, a[76:79] offset:19456
    ds_write_b128 v14, a[80:83] offset:20480
    ds_write_b128 v14, a[84:87] offset:21504
    ds_write_b128 v14, a[88:91] offset:22528
    ds_write_b128 v14, a[92:95] offset:23552
    s_mul_i32 s35, s29, 6144
    v_add_u32 v14, s35, v1
    v_add_u32 v15, 49152, v14
    s_waitcnt lgkmcnt(0)
    s_barrier
    ds_read_b128 v[64:67], v14 offset:0
    ds_read_b128 v[68:71], v14 offset:1024
    ds_read_b128 v[72:75], v14 offset:2048
    ds_read_b128 v[76:79], v14 offset:3072
    ds_read_b128 v[80:83], v14 offset:4096
    ds_read_b128 v[84:87], v14 offset:5120
    ds_read_b128 v[88:91], v14 offset:24576
    ds_read_b128 v[92:95], v14 offset:25600
    ds_read_b128 v[96:99], v14 offset:26624
    ds_read_b128 v[100:103], v14 offset:27648
    ds_read_b128 v[104:107], v14 offset:28672
    ds_read_b128 v[108:111], v14 offset:29696
    ds_read_b128 v[112:115], v15 offset:0
    ds_read_b128 v[116:119], v15 offset:1024
    ds_read_b128 v[120:123], v15 offset:2048
    ds_read_b128 v[124:127], v15 offset:3072
    ds_read_b128 v[128:131], v15 offset:4096
    ds_read_b128 v[132:135], v15 offset:5120
    ds_read_b128 v[136:139], v15 offset:24576
    ds_read_b128 v[140:143], v15 offset:25600
    ds_read_b128 v[144:147], v15 offset:26624
    ds_read_b128 v[148:151], v15 offset:27648
    ds_read_b128 v[152:155], v15 offset:28672
    ds_read_b128 v[156:159], v15 offset:29696
    s_mul_i32 s35, s40, 6
    s_add_u32 s35, s35, s31
    s_mul_i32 s35, s35, 6144
    s_add_u32 s35, s35, 121634816
    s_add_u32 s37, s35, 4096
    s_waitcnt lgkmcnt(0)
    v_pk_add_f32 v[64:65], v[64:65], v[88:89]
    v_pk_add_f32 v[112:113], v[112:113], v[136:137]
    v_pk_add_f32 v[64:65], v[64:65], v[32:33]
    v_pk_add_f32 v[64:65], v[64:65], v[112:113]
    v_pk_mul_f32 v[64:65], v[64:65], v[12:13] op_sel:[0,1] op_sel_hi:[1,1]
    v_pk_add_f32 v[66:67], v[66:67], v[90:91]
    v_pk_add_f32 v[114:115], v[114:115], v[138:139]
    v_pk_add_f32 v[66:67], v[66:67], v[34:35]
    v_pk_add_f32 v[66:67], v[66:67], v[114:115]
    v_pk_mul_f32 v[66:67], v[66:67], v[12:13] op_sel:[0,1] op_sel_hi:[1,1]
    v_pk_add_f32 v[68:69], v[68:69], v[92:93]
    v_pk_add_f32 v[116:117], v[116:117], v[140:141]
    v_pk_add_f32 v[68:69], v[68:69], v[36:37]
    v_pk_add_f32 v[68:69], v[68:69], v[116:117]
    v_pk_mul_f32 v[68:69], v[68:69], v[12:13] op_sel:[0,1] op_sel_hi:[1,1]
    v_pk_add_f32 v[70:71], v[70:71], v[94:95]
    v_pk_add_f32 v[118:119], v[118:119], v[142:143]
    v_pk_add_f32 v[70:71], v[70:71], v[38:39]
    v_pk_add_f32 v[70:71], v[70:71], v[118:119]
    v_pk_mul_f32 v[70:71], v[70:71], v[12:13] op_sel:[0,1] op_sel_hi:[1,1]
    v_pk_add_f32 v[72:73], v[72:73], v[96:97]
    v_pk_add_f32 v[120:121], v[120:121], v[144:145]
    v_pk_add_f32 v[72:73], v[72:73], v[40:41]
    v_pk_add_f32 v[72:73], v[72:73], v[120:121]
    v_pk_mul_f32 v[72:73], v[72:73], v[12:13] op_sel:[0,1] op_sel_hi:[1,1]
    v_pk_add_f32 v[74:75], v[74:75], v[98:99]
    v_pk_add_f32 v[122:123], v[122:123], v[146:147]
    v_pk_add_f32 v[74:75], v[74:75], v[42:43]
    v_pk_add_f32 v[74:75], v[74:75], v[122:123]
    v_pk_mul_f32 v[74:75], v[74:75], v[12:13] op_sel:[0,1] op_sel_hi:[1,1]
    v_pk_add_f32 v[76:77], v[76:77], v[100:101]
    v_pk_add_f32 v[124:125], v[124:125], v[148:149]
    v_pk_add_f32 v[76:77], v[76:77], v[44:45]
    v_pk_add_f32 v[76:77], v[76:77], v[124:125]
    v_pk_mul_f32 v[76:77], v[76:77], v[12:13] op_sel:[0,1] op_sel_hi:[1,1]
    v_pk_add_f32 v[78:79], v[78:79], v[102:103]
    v_pk_add_f32 v[126:127], v[126:127], v[150:151]
    v_pk_add_f32 v[78:79], v[78:79], v[46:47]
    v_pk_add_f32 v[78:79], v[78:79], v[126:127]
    v_pk_mul_f32 v[78:79], v[78:79], v[12:13] op_sel:[0,1] op_sel_hi:[1,1]
    v_pk_add_f32 v[80:81], v[80:81], v[104:105]
    v_pk_add_f32 v[128:129], v[128:129], v[152:153]
    v_pk_add_f32 v[80:81], v[80:81], v[48:49]
    v_pk_add_f32 v[80:81], v[80:81], v[128:129]
    v_pk_mul_f32 v[80:81], v[80:81], v[12:13] op_sel:[0,1] op_sel_hi:[1,1]
    v_pk_add_f32 v[82:83], v[82:83], v[106:107]
    v_pk_add_f32 v[130:131], v[130:131], v[154:155]
    v_pk_add_f32 v[82:83], v[82:83], v[50:51]
    v_pk_add_f32 v[82:83], v[82:83], v[130:131]
    v_pk_mul_f32 v[82:83], v[82:83], v[12:13] op_sel:[0,1] op_sel_hi:[1,1]
    v_pk_add_f32 v[84:85], v[84:85], v[108:109]
    v_pk_add_f32 v[132:133], v[132:133], v[156:157]
    v_pk_add_f32 v[84:85], v[84:85], v[52:53]
    v_pk_add_f32 v[84:85], v[84:85], v[132:133]
    v_pk_mul_f32 v[84:85], v[84:85], v[12:13] op_sel:[0,1] op_sel_hi:[1,1]
    v_pk_add_f32 v[86:87], v[86:87], v[110:111]
    v_pk_add_f32 v[134:135], v[134:135], v[158:159]
    v_pk_add_f32 v[86:87], v[86:87], v[54:55]
    v_pk_add_f32 v[86:87], v[86:87], v[134:135]
    v_pk_mul_f32 v[86:87], v[86:87], v[12:13] op_sel:[0,1] op_sel_hi:[1,1]
    buffer_store_dwordx4 v[64:67], v1, s[4:7], s35 offen offset:0 sc1
    buffer_store_dwordx4 v[68:71], v1, s[4:7], s35 offen offset:1024 sc1
    buffer_store_dwordx4 v[72:75], v1, s[4:7], s35 offen offset:2048 sc1
    buffer_store_dwordx4 v[76:79], v1, s[4:7], s35 offen offset:3072 sc1
    buffer_store_dwordx4 v[80:83], v1, s[4:7], s37 offen offset:0 sc1
    buffer_store_dwordx4 v[84:87], v1, s[4:7], s37 offen offset:1024 sc1
    v_lshrrev_b32 v14, 2, v1
    s_lshl_b32 s35, s40, 6
    s_add_u32 s35, s35, 126877696
    s_mov_b64 exec, 0xffff
    buffer_store_dword v12, v14, s[4:7], s35 offen sc1
    s_mov_b64 exec, -1
    s_waitcnt vmcnt(0)
    s_barrier
    s_mov_b32 s78, 131072
    s_cmp_lg_u32 s29, 0
    s_cbranch_scc1 Lw_t2
    v_mov_b32 v254, 1
    v_mov_b32 v253, 0
    s_mov_b64 exec, 1
    buffer_atomic_add v254, v253, s[4:7], s78 offen
    s_mov_b64 exec, -1
Lw_t2:
    s_load_dwordx2 s[12:13], s[0:1], 40
    s_load_dwordx2 s[16:17], s[0:1], 104
    v_lshrrev_b32 v1, 6, v0
    s_nop 0
    v_readfirstlane_b32 s29, v1
    v_and_b32 v1, 63, v0
    s_mul_i32 s30, s85, 171
    s_lshr_b32 s30, s30, 9
    s_mul_i32 s31, s30, 3
    s_sub_u32 s31, s85, s31
    s_lshr_b32 s36, s30, 3
    s_and_b32 s30, s30, 7
    s_lshl_b32 s37, s30, 2
    s_add_u32 s37, s37, s29
    s_waitcnt lgkmcnt(0)
    s_mov_b32 s14, 4718592
    s_mov_b32 s15, 0x00020000
    s_mov_b32 s18, 2359296
    s_mov_b32 s19, 0x00020000
    v_add_u32 v8, 0, v1
    v_mul_u32_u24 v9, 171, v8
    v_lshrrev_b32 v9, 12, v9
    v_mul_u32_u24 v10, 24, v9
    v_sub_u32 v10, v8, v10
    v_mul_u32_u24 v9, 1152, v9
    v_lshl_add_u32 v2, v10, 4, v9
    v_add_u32 v8, 64, v1
    v_mul_u32_u24 v9, 171, v8
    v_lshrrev_b32 v9, 12, v9
    v_mul_u32_u24 v10, 24, v9
    v_sub_u32 v10, v8, v10
    v_mul_u32_u24 v9, 1152, v9
    v_lshl_add_u32 v3, v10, 4, v9
    v_add_u32 v8, 128, v1
    v_mul_u32_u24 v9, 171, v8
    v_lshrrev_b32 v9, 12, v9
    v_mul_u32_u24 v10, 24, v9
    v_sub_u32 v10, v8, v10
    v_mul_u32_u24 v9, 1152, v9
    v_lshl_add_u32 v4, v10, 4, v9
    s_mul_i32 s32, s29, 24576
    s_mul_i32 s33, s37, 147456
    s_mul_i32 s34, s31, 384
    s_add_u32 s33, s33, s34
    v_lshrrev_b32 v9, 4, v1
    v_bfe_u32 v10, v1, 2, 2
    v_and_b32 v11, 3, v1
    v_lshl_add_u32 v12, v9, 2, v10
    v_mul_u32_u24 v12, 384, v12
    v_lshl_add_u32 v12, v11, 4, v12
    v_add_u32 v8, s32, v12
    s_add_u32 m0, s32, 0
    s_add_u32 s34, s33, 0
    buffer_load_dwordx4 v2, s[12:15], s34 offen lds
    s_add_u32 m0, s32, 1024
    s_add_u32 s34, s33, 0
    buffer_load_dwordx4 v3, s[12:15], s34 offen lds
    s_add_u32 m0, s32, 2048
    s_add_u32 s34, s33, 0
    buffer_load_dwordx4 v4, s[12:15], s34 offen lds
    s_add_u32 m0, s32, 3072
    s_add_u32 s34, s33, 9216
    buffer_load_dwordx4 v2, s[12:15], s34 offen lds
    s_add_u32 m0, s32, 4096
    s_add_u32 s34, s33, 9216
    buffer_load_dwordx4 v3, s[12:15], s34 offen lds
    s_add_u32 m0, s32, 5120
    s_add_u32 s34, s33, 9216
    buffer_load_dwordx4 v4, s[12:15], s34 offen lds
    s_add_u32 m0, s32, 6144
    s_add_u32 s34, s33, 18432
    buffer_load_dwordx4 v2, s[12:15], s34 offen lds
    s_add_u32 m0, s32, 7168
    s_add_u32 s34, s33, 18432
    buffer_load_dwordx4 v3, s[12:15], s34 offen lds
    s_add_u32 m0, s32, 8192
    s_add_u32 s34, s33, 18432
    buffer_load_dwordx4 v4, s[12:15], s34 offen lds
    s_add_u32 m0, s32, 9216
    s_add_u32 s34, s33, 27648
    buffer_load_dwordx4 v2, s[12:15], s34 offen lds
    s_add_u32 m0, s32, 10240
    s_add_u32 s34, s33, 27648
    buffer_load_dwordx4 v3, s[12:15], s34 offen lds
    s_add_u32 m0, s32, 11264
    s_add_u32 s34, s33, 27648
    buffer_load_dwordx4 v4, s[12:15], s34 offen lds
    s_add_u32 m0, s32, 12288
    s_add_u32 s34, s33, 36864
    buffer_load_dwordx4 v2, s[12:15], s34 offen lds
    s_add_u32 m0, s32, 13312
    s_add_u32 s34, s33, 36864
    buffer_load_dwordx4 v3, s[12:15], s34 offen lds
    s_add_u32 m0, s32, 14336
    s_add_u32 s34, s33, 36864
    buffer_load_dwordx4 v4, s[12:15], s34 offen lds
    s_add_u32 m0, s32, 15360
    s_add_u32 s34, s33, 46080
    buffer_load_dwordx4 v2, s[12:15], s34 offen lds
    s_add_u32 m0, s32, 16384
    s_add_u32 s34, s33, 46080
    buffer_load_dwordx4 v3, s[12:15], s34 offen lds
    s_add_u32 m0, s32, 17408
    s_add_u32 s34, s33, 46080
    buffer_load_dwordx4 v4, s[12:15], s34 offen lds
    s_add_u32 m0, s32, 18432
    s_add_u32 s34, s33, 55296
    buffer_load_dwordx4 v2, s[12:15], s34 offen lds
    s_add_u32 m0, s32, 19456
    s_add_u32 s34, s33, 55296
    buffer_load_dwordx4 v3, s[12:15], s34 offen lds
    s_add_u32 m0, s32, 20480
    s_add_u32 s34, s33, 55296
    buffer_load_dwordx4 v4, s[12:15], s34 offen lds
    s_add_u32 m0, s32, 21504
    s_add_u32 s34, s33, 64512
    buffer_load_dwordx4 v2, s[12:15], s34 offen lds
    s_add_u32 m0, s32, 22528
    s_add_u32 s34, s33, 64512
    buffer_load_dwordx4 v3, s[12:15], s34 offen lds
    s_add_u32 m0, s32, 23552
    s_add_u32 s34, s33, 64512
    buffer_load_dwordx4 v4, s[12:15], s34 offen lds
    s_waitcnt vmcnt(0)
    ds_read_b64_tr_b16 a[0:1], v8 offset:0
    ds_read_b64_tr_b16 a[2:3], v8 offset:6144
    ds_read_b64_tr_b16 a[4:5], v8 offset:8
    ds_read_b64_tr_b16 a[6:7], v8 offset:6152
    ds_read_b64_tr_b16 a[8:9], v8 offset:64
    ds_read_b64_tr_b16 a[10:11], v8 offset:6208
    ds_read_b64_tr_b16 a[12:13], v8 offset:72
    ds_read_b64_tr_b16 a[14:15], v8 offset:6216
    ds_read_b64_tr_b16 a[16:17], v8 offset:128
    ds_read_b64_tr_b16 a[18:19], v8 offset:6272
    ds_read_b64_tr_b16 a[20:21], v8 offset:136
    ds_read_b64_tr_b16 a[22:23], v8 offset:6280
    ds_read_b64_tr_b16 a[24:25], v8 offset:192
    ds_read_b64_tr_b16 a[26:27], v8 offset:6336
    ds_read_b64_tr_b16 a[28:29], v8 offset:200
    ds_read_b64_tr_b16 a[30:31], v8 offset:6344
    ds_read_b64_tr_b16 a[32:33], v8 offset:256
    ds_read_b64_tr_b16 a[34:35], v8 offset:6400
    ds_read_b64_tr_b16 a[36:37], v8 offset:264
    ds_read_b64_tr_b16 a[38:39], v8 offset:6408
    ds_read_b64_tr_b16 a[40:41], v8 offset:320
    ds_read_b64_tr_b16 a[42:43], v8 offset:6464
    ds_read_b64_tr_b16 a[44:45], v8 offset:328
    ds_read_b64_tr_b16 a[46:47], v8 offset:6472
    s_waitcnt lgkmcnt(0)
    ds_read_b64_tr_b16 a[48:49], v8 offset:12288
    ds_read_b64_tr_b16 a[50:51], v8 offset:18432
    ds_read_b64_tr_b16 a[52:53], v8 offset:12296
    ds_read_b64_tr_b16 a[54:55], v8 offset:18440
    ds_read_b64_tr_b16 a[56:57], v8 offset:12352
    ds_read_b64_tr_b16 a[58:59], v8 offset:18496
    ds_read_b64_tr_b16 a[60:61], v8 offset:12360
    ds_read_b64_tr_b16 a[62:63], v8 offset:18504
    ds_read_b64_tr_b16 a[64:65], v8 offset:12416
    ds_read_b64_tr_b16 a[66:67], v8 offset:18560
    ds_read_b64_tr_b16 a[68:69], v8 offset:12424
    ds_read_b64_tr_b16 a[70:71], v8 offset:18568
    ds_read_b64_tr_b16 a[72:73], v8 offset:12480
    ds_read_b64_tr_b16 a[74:75], v8 offset:18624
    ds_read_b64_tr_b16 a[76:77], v8 offset:12488
    ds_read_b64_tr_b16 a[78:79], v8 offset:18632
    ds_read_b64_tr_b16 a[80:81], v8 offset:12544
    ds_read_b64_tr_b16 a[82:83], v8 offset:18688
    ds_read_b64_tr_b16 a[84:85], v8 offset:12552
    ds_read_b64_tr_b16 a[86:87], v8 offset:18696
    ds_read_b64_tr_b16 a[88:89], v8 offset:12608
    ds_read_b64_tr_b16 a[90:91], v8 offset:18752
    ds_read_b64_tr_b16 a[92:93], v8 offset:12616
    ds_read_b64_tr_b16 a[94:95], v8 offset:18760
    s_waitcnt lgkmcnt(0)
    s_add_u32 m0, s32, 0
    s_add_u32 s34, s33, 73728
    buffer_load_dwordx4 v2, s[12:15], s34 offen lds
    s_add_u32 m0, s32, 1024
    s_add_u32 s34, s33, 73728
    buffer_load_dwordx4 v3, s[12:15], s34 offen lds
    s_add_u32 m0, s32, 2048
    s_add_u32 s34, s33, 73728
    buffer_load_dwordx4 v4, s[12:15], s34 offen lds
    s_add_u32 m0, s32, 3072
    s_add_u32 s34, s33, 82944
    buffer_load_dwordx4 v2, s[12:15], s34 offen lds
    s_add_u32 m0, s32, 4096
    s_add_u32 s34, s33, 82944
    buffer_load_dwordx4 v3, s[12:15], s34 offen lds
    s_add_u32 m0, s32, 5120
    s_add_u32 s34, s33, 82944
    buffer_load_dwordx4 v4, s[12:15], s34 offen lds
    s_add_u32 m0, s32, 6144
    s_add_u32 s34, s33, 92160
    buffer_load_dwordx4 v2, s[12:15], s34 offen lds
    s_add_u32 m0, s32, 7168
    s_add_u32 s34, s33, 92160
    buffer_load_dwordx4 v3, s[12:15], s34 offen lds
    s_add_u32 m0, s32, 8192
    s_add_u32 s34, s33, 92160
    buffer_load_dwordx4 v4, s[12:15], s34 offen lds
    s_add_u32 m0, s32, 9216
    s_add_u32 s34, s33, 101376
    buffer_load_dwordx4 v2, s[12:15], s34 offen lds
    s_add_u32 m0, s32, 10240
    s_add_u32 s34, s33, 101376
    buffer_load_dwordx4 v3, s[12:15], s34 offen lds
    s_add_u32 m0, s32, 11264
    s_add_u32 s34, s33, 101376
    buffer_load_dwordx4 v4, s[12:15], s34 offen lds
    s_add_u32 m0, s32, 12288
    s_add_u32 s34, s33, 110592
    buffer_load_dwordx4 v2, s[12:15], s34 offen lds
    s_add_u32 m0, s32, 13312
    s_add_u32 s34, s33, 110592
    buffer_load_dwordx4 v3, s[12:15], s34 offen lds
    s_add_u32 m0, s32, 14336
    s_add_u32 s34, s33, 110592
    buffer_load_dwordx4 v4, s[12:15], s34 offen lds
    s_add_u32 m0, s32, 15360
    s_add_u32 s34, s33, 119808
    buffer_load_dwordx4 v2, s[12:15], s34 offen lds
    s_add_u32 m0, s32, 16384
    s_add_u32 s34, s33, 119808
    buffer_load_dwordx4 v3, s[12:15], s34 offen lds
    s_add_u32 m0, s32, 17408
    s_add_u32 s34, s33, 119808
    buffer_load_dwordx4 v4, s[12:15], s34 offen lds
    s_add_u32 m0, s32, 18432
    s_add_u32 s34, s33, 129024
    buffer_load_dwordx4 v2, s[12:15], s34 offen lds
    s_add_u32 m0, s32, 19456
    s_add_u32 s34, s33, 129024
    buffer_load_dwordx4 v3, s[12:15], s34 offen lds
    s_add_u32 m0, s32, 20480
    s_add_u32 s34, s33, 129024
    buffer_load_dwordx4 v4, s[12:15], s34 offen lds
    s_add_u32 m0, s32, 21504
    s_add_u32 s34, s33, 138240
    buffer_load_dwordx4 v2, s[12:15], s34 offen lds
    s_add_u32 m0, s32, 22528
    s_add_u32 s34, s33, 138240
    buffer_load_dwordx4 v3, s[12:15], s34 offen lds
    s_add_u32 m0, s32, 23552
    s_add_u32 s34, s33, 138240
    buffer_load_dwordx4 v4, s[12:15], s34 offen lds
    s_waitcnt vmcnt(0)
    ds_read_b64_tr_b16 a[96:97], v8 offset:0
    ds_read_b64_tr_b16 a[98:99], v8 offset:6144
    ds_read_b64_tr_b16 a[100:101], v8 offset:8
    ds_read_b64_tr_b16 a[102:103], v8 offset:6152
    ds_read_b64_tr_b16 a[104:105], v8 offset:64
    ds_read_b64_tr_b16 a[106:107], v8 offset:6208
    ds_read_b64_tr_b16 a[108:109], v8 offset:72
    ds_read_b64_tr_b16 a[110:111], v8 offset:6216
    ds_read_b64_tr_b16 a[112:113], v8 offset:128
    ds_read_b64_tr_b16 a[114:115], v8 offset:6272
    ds_read_b64_tr_b16 a[116:117], v8 offset:136
    ds_read_b64_tr_b16 a[118:119], v8 offset:6280
    ds_read_b64_tr_b16 a[120:121], v8 offset:192
    ds_read_b64_tr_b16 a[122:123], v8 offset:6336
    ds_read_b64_tr_b16 a[124:125], v8 offset:200
    ds_read_b64_tr_b16 a[126:127], v8 offset:6344
    ds_read_b64_tr_b16 a[128:129], v8 offset:256
    ds_read_b64_tr_b16 a[130:131], v8 offset:6400
    ds_read_b64_tr_b16 a[132:133], v8 offset:264
    ds_read_b64_tr_b16 a[134:135], v8 offset:6408
    ds_read_b64_tr_b16 a[136:137], v8 offset:320
    ds_read_b64_tr_b16 a[138:139], v8 offset:6464
    ds_read_b64_tr_b16 a[140:141], v8 offset:328
    ds_read_b64_tr_b16 a[142:143], v8 offset:6472
    s_waitcnt lgkmcnt(0)
    ds_read_b64_tr_b16 a[144:145], v8 offset:12288
    ds_read_b64_tr_b16 a[146:147], v8 offset:18432
    ds_read_b64_tr_b16 a[148:149], v8 offset:12296
    ds_read_b64_tr_b16 a[150:151], v8 offset:18440
    ds_read_b64_tr_b16 a[152:153], v8 offset:12352
    ds_read_b64_tr_b16 a[154:155], v8 offset:18496
    ds_read_b64_tr_b16 a[156:157], v8 offset:12360
    ds_read_b64_tr_b16 a[158:159], v8 offset:18504
    ds_read_b64_tr_b16 a[160:161], v8 offset:12416
    ds_read_b64_tr_b16 a[162:163], v8 offset:18560
    ds_read_b64_tr_b16 a[164:165], v8 offset:12424
    ds_read_b64_tr_b16 a[166:167], v8 offset:18568
    ds_read_b64_tr_b16 a[168:169], v8 offset:12480
    ds_read_b64_tr_b16 a[170:171], v8 offset:18624
    ds_read_b64_tr_b16 a[172:173], v8 offset:12488
    ds_read_b64_tr_b16 a[174:175], v8 offset:18632
    ds_read_b64_tr_b16 a[176:177], v8 offset:12544
    ds_read_b64_tr_b16 a[178:179], v8 offset:18688
    ds_read_b64_tr_b16 a[180:181], v8 offset:12552
    ds_read_b64_tr_b16 a[182:183], v8 offset:18696
    ds_read_b64_tr_b16 a[184:185], v8 offset:12608
    ds_read_b64_tr_b16 a[186:187], v8 offset:18752
    ds_read_b64_tr_b16 a[188:189], v8 offset:12616
    ds_read_b64_tr_b16 a[190:191], v8 offset:18760
    s_waitcnt lgkmcnt(0)
    v_lshl_add_u32 v12, v9, 3, v10
    v_lshlrev_b32 v12, 4, v12
    v_and_b32 v13, 1, v1
    v_lshl_add_u32 v12, v13, 3, v12
    s_lshl_b32 s41, s29, 11
    s_add_u32 s41, s41, 98304
    v_add_u32 v2, s41, v12
    v_and_b32 v12, 15, v1
    v_lshl_add_u32 v13, v9, 2, 0
    v_cmp_le_u32 s[50:51], v13, v12
    v_lshl_add_u32 v13, v9, 2, 1
    v_cmp_le_u32 s[52:53], v13, v12
    v_lshl_add_u32 v13, v9, 2, 2
    v_cmp_le_u32 s[54:55], v13, v12
    v_lshl_add_u32 v13, v9, 2, 3
    v_cmp_le_u32 s[56:57], v13, v12
    v_mul_u32_u24 v3, 1152, v12
    v_lshl_add_u32 v3, v9, 4, v3
    v_lshlrev_b32 v4, 2, v12
    v_lshlrev_b32 v1, 4, v1
    v_mov_b32 v6, 0x3f803f80
    v_mov_b32 v7, 0x3f803f80
    v_mov_b32 v8, 0x3f003f00
    v_mov_b32 v9, 0x3f003f00
    v_mov_b32 v5, 0xff800000
    v_add_u32 v14, s32, v1
    s_mul_i32 s33, s29, 6144
    v_add_u32 v15, s33, v1
    v_add_u32 v13, 49152, v15
    s_mov_b32 s42, 0x3e0293ee
    s_mov_b32 s58, 0
    s_mov_b32 s59, -1
    s_lshr_b32 s46, s29, 1
    s_and_b32 s47, s29, 1
    s_lshl_b32 s33, s31, 1
    s_add_u32 s47, s47, s33
    s_mov_b32 s44, 0
    s_mov_b32 s35, 65536
    v_and_b32 v250, 7, v0
    v_lshlrev_b32 v250, 2, v250
    s_mov_b32 s49, 0
Lww_8:
    buffer_load_dword v251, v250, s[4:7], s35 offen sc1
    s_add_u32 s49, s49, 1
    s_cmp_gt_u32 s49, 1048576
    s_cbranch_scc1 Lexit
    s_waitcnt vmcnt(0)
    v_cmp_gt_u32 vcc, 128, v251
    s_cbranch_vccz Lwok_9
    s_sleep 1
    s_branch Lww_8
Lwok_9:
    s_mov_b32 s35, 65664
    v_and_b32 v250, 7, v0
    v_lshlrev_b32 v250, 2, v250
    s_mov_b32 s49, 0
Lww_10:
    buffer_load_dword v251, v250, s[4:7], s35 offen sc1
    s_add_u32 s49, s49, 1
    s_cmp_gt_u32 s49, 1048576
    s_cbranch_scc1 Lexit
    s_waitcnt vmcnt(0)
    v_cmp_gt_u32 vcc, 64, v251
    s_cbranch_vccz Lwok_11
    s_sleep 1
    s_branch Lww_10
Lwok_11:
    s_mov_b32 s33, 131072
    v_mov_b32 v250, 0
    s_mov_b32 s49, 0
Lww_12:
    buffer_load_dword v251, v250, s[4:7], s33 offen sc1
    s_add_u32 s49, s49, 1
    s_cmp_gt_u32 s49, 1048576
    s_cbranch_scc1 Lexit
    s_waitcnt vmcnt(0)
    v_cmp_gt_u32 vcc, 192, v251
    s_cbranch_vccz Lwok_13
    s_sleep 1
    s_branch Lww_12
Lwok_13:
    s_barrier
    s_mul_i32 s33, s37, 65
    s_add_u32 s33, s33, s36
    s_lshl_b32 s34, s33, 13
    s_add_u32 s34, s34, 52428800
    s_lshl_b32 s33, s33, 14
    s_add_u32 s33, s33, 16777216
    buffer_load_dwordx4 v[64:67], v1, s[4:7], s34 offen offset:0 sc1
    buffer_load_dwordx4 v[68:71], v1, s[4:7], s34 offen offset:1024 sc1
    buffer_load_dwordx4 v[72:75], v1, s[4:7], s34 offen offset:2048 sc1
    buffer_load_dwordx4 v[76:79], v1, s[4:7], s34 offen offset:3072 sc1
    s_add_u32 s34, s34, 4096
    buffer_load_dwordx4 v[80:83], v1, s[4:7], s34 offen offset:0 sc1
    buffer_load_dwordx4 v[84:87], v1, s[4:7], s34 offen offset:1024 sc1
    buffer_load_dwordx4 v[88:91], v1, s[4:7], s34 offen offset:2048 sc1
    buffer_load_dwordx4 v[92:95], v1, s[4:7], s34 offen offset:3072 sc1
    buffer_load_dwordx4 v[96:99], v1, s[4:7], s33 offen offset:0 sc1
    buffer_load_dwordx4 v[100:103], v1, s[4:7], s33 offen offset:1024 sc1
    buffer_load_dwordx4 v[104:107], v1, s[4:7], s33 offen offset:2048 sc1
    buffer_load_dwordx4 v[108:111], v1, s[4:7], s33 offen offset:3072 sc1
    s_add_u32 s33, s33, 4096
    buffer_load_dwordx4 v[112:115], v1, s[4:7], s33 offen offset:0 sc1
    buffer_load_dwordx4 v[116:119], v1, s[4:7], s33 offen offset:1024 sc1
    buffer_load_dwordx4 v[120:123], v1, s[4:7], s33 offen offset:2048 sc1
    buffer_load_dwordx4 v[124:127], v1, s[4:7], s33 offen offset:3072 sc1
    s_add_u32 s33, s33, 4096
    buffer_load_dwordx4 v[128:131], v1, s[4:7], s33 offen offset:0 sc1
    buffer_load_dwordx4 v[132:135], v1, s[4:7], s33 offen offset:1024 sc1
    buffer_load_dwordx4 v[136:139], v1, s[4:7], s33 offen offset:2048 sc1
    buffer_load_dwordx4 v[140:143], v1, s[4:7], s33 offen offset:3072 sc1
    s_add_u32 s33, s33, 4096
    buffer_load_dwordx4 v[144:147], v1, s[4:7], s33 offen offset:0 sc1
    buffer_load_dwordx4 v[148:151], v1, s[4:7], s33 offen offset:1024 sc1
    buffer_load_dwordx4 v[152:155], v1, s[4:7], s33 offen offset:2048 sc1
    buffer_load_dwordx4 v[156:159], v1, s[4:7], s33 offen offset:3072 sc1
    s_mov_b32 s45, 0
Lt2_seg:
    s_cmp_eq_u32 s45, 1
    s_cbranch_scc1 Lt2have_14
    s_cmp_gt_u32 s44, s36
    s_cbranch_scc1 Lchok_15
    s_lshl_b32 s33, s37, 7
    s_add_u32 s33, s33, 66560
    s_add_u32 s34, s36, 1
    v_mov_b32 v250, 0
    s_mov_b32 s49, 0
Lww_16:
    buffer_load_dword v251, v250, s[4:7], s33 offen sc1
    s_add_u32 s49, s49, 1
    s_cmp_gt_u32 s49, 1048576
    s_cbranch_scc1 Lexit
    s_waitcnt vmcnt(0)
    v_cmp_gt_u32 vcc, s34, v251
    s_cbranch_vccz Lwok_17
    s_branch Lww_16
Lwok_17:
    v_readfirstlane_b32 s44, v251
Lchok_15:
    s_mul_i32 s35, s37, 65
    s_add_u32 s35, s35, s36
    s_lshl_b32 s35, s35, 13
    s_add_u32 s35, s35, 71303168
    buffer_load_dwordx4 a[240:243], v1, s[4:7], s35 offen offset:0 sc1
    buffer_load_dwordx4 a[244:247], v1, s[4:7], s35 offen offset:1024 sc1
    buffer_load_dwordx4 a[248:251], v1, s[4:7], s35 offen offset:2048 sc1
    buffer_load_dwordx4 a[252:255], v1, s[4:7], s35 offen offset:3072 sc1
Lt2have_14:
    v_lshrrev_b32 v10, 1, v1
    v_add_u32 v10, s41, v10
    s_waitcnt vmcnt(0)
    ds_write_b64 v10, a[240:241] offset:0
    ds_write_b64 v10, a[244:245] offset:512
    ds_write_b64 v10, a[248:249] offset:1024
    ds_write_b64 v10, a[252:253] offset:1536
    s_waitcnt lgkmcnt(0)
    ds_read_b64_tr_b16 v[160:161], v2 offset:0
    ds_read_b64_tr_b16 v[162:163], v2 offset:64
    ds_read_b64_tr_b16 v[164:165], v2 offset:512
    ds_read_b64_tr_b16 v[166:167], v2 offset:576
    ds_read_b64_tr_b16 v[168:169], v2 offset:1024
    ds_read_b64_tr_b16 v[170:171], v2 offset:1088
    ds_read_b64_tr_b16 v[172:173], v2 offset:1536
    ds_read_b64_tr_b16 v[174:175], v2 offset:1600
    s_waitcnt vmcnt(0) lgkmcnt(0)
    v_mfma_f32_16x16x32_bf16 v[192:195], v[160:163], v[64:67], 0
    v_mfma_f32_16x16x32_bf16 v[196:199], v[96:99], v[64:67], 0
    v_mfma_f32_16x16x32_bf16 v[192:195], v[164:167], v[68:71], v[192:195]
    v_mfma_f32_16x16x32_bf16 v[196:199], v[100:103], v[68:71], v[196:199]
    v_mfma_f32_16x16x32_bf16 v[192:195], v[168:171], v[72:75], v[192:195]
    v_mfma_f32_16x16x32_bf16 v[196:199], v[104:107], v[72:75], v[196:199]
    v_mfma_f32_16x16x32_bf16 v[192:195], v[172:175], v[76:79], v[192:195]
    v_mfma_f32_16x16x32_bf16 v[196:199], v[108:111], v[76:79], v[196:199]
    s_nop 7
    v_cndmask_b32 v196, v5, v196, s[50:51]
    v_cndmask_b32 v197, v5, v197, s[52:53]
    v_cndmask_b32 v198, v5, v198, s[54:55]
    v_cndmask_b32 v199, v5, v199, s[56:57]
    v_max3_f32 v10, v192, v193, v194
    v_max3_f32 v10, v10, v195, v196
    v_max3_f32 v10, v10, v197, v198
    v_max_f32 v10, v10, v199
    v_mov_b32 v11, v10
    s_nop 1
    v_permlane32_swap_b32 v10, v11
    v_max_f32 v10, v10, v11
    v_mov_b32 v11, v10
    s_nop 1
    v_permlane16_swap_b32 v10, v11
    v_max_f32 v10, v10, v11
    v_mul_f32 v10, s42, v10
    v_pk_fma_f32 v[192:193], v[192:193], s[42:43], v[10:11] op_sel_hi:[1,0,0] neg_lo:[0,0,1] neg_hi:[0,0,1]
    v_pk_fma_f32 v[194:195], v[194:195], s[42:43], v[10:11] op_sel_hi:[1,0,0] neg_lo:[0,0,1] neg_hi:[0,0,1]
    v_pk_fma_f32 v[196:197], v[196:197], s[42:43], v[10:11] op_sel_hi:[1,0,0] neg_lo:[0,0,1] neg_hi:[0,0,1]
    v_pk_fma_f32 v[198:199], v[198:199], s[42:43], v[10:11] op_sel_hi:[1,0,0] neg_lo:[0,0,1] neg_hi:[0,0,1]
    v_exp_f32 v192, v192
    v_exp_f32 v193, v193
    v_exp_f32 v194, v194
    v_exp_f32 v195, v195
    v_exp_f32 v196, v196
    v_exp_f32 v197, v197
    v_exp_f32 v198, v198
    v_exp_f32 v199, v199
    v_cvt_pk_bf16_f32 v208, v192, v193
    v_cvt_pk_bf16_f32 v209, v194, v195
    v_cvt_pk_bf16_f32 v204, v196, v197
    v_cvt_pk_bf16_f32 v205, v198, v199
    v_cndmask_b32 v52, v208, 0, s[58:59]
    v_cndmask_b32 v54, 0, v208, s[58:59]
    v_cndmask_b32 v53, v209, 0, s[58:59]
    v_cndmask_b32 v55, 0, v209, s[58:59]
    v_mfma_f32_16x16x16_bf16 v[244:247], v[8:9], v[208:209], 0
    v_mfma_f32_16x16x16_bf16 v[244:247], v[6:7], v[204:205], v[244:247]
    v_mfma_f32_16x16x16_bf16 v[212:215], a[242:243], v[52:53], 0
    v_mfma_f32_16x16x16_bf16 v[216:219], a[242:243], v[54:55], 0
    v_mfma_f32_16x16x16_bf16 v[220:223], a[246:247], v[52:53], 0
    v_mfma_f32_16x16x16_bf16 v[224:227], a[246:247], v[54:55], 0
    v_mfma_f32_16x16x16_bf16 v[228:231], a[250:251], v[52:53], 0
    v_mfma_f32_16x16x16_bf16 v[232:235], a[250:251], v[54:55], 0
    v_mfma_f32_16x16x16_bf16 v[236:239], a[254:255], v[52:53], 0
    v_mfma_f32_16x16x16_bf16 v[240:243], a[254:255], v[54:55], 0
    v_mfma_f32_16x16x16_bf16 v[212:215], v[128:129], v[204:205], v[212:215]
    v_mfma_f32_16x16x16_bf16 v[216:219], v[132:133], v[204:205], v[216:219]
    v_mfma_f32_16x16x16_bf16 v[220:223], v[136:137], v[204:205], v[220:223]
    v_mfma_f32_16x16x16_bf16 v[224:227], v[140:141], v[204:205], v[224:227]
    v_mfma_f32_16x16x16_bf16 v[228:231], v[144:145], v[204:205], v[228:231]
    v_mfma_f32_16x16x16_bf16 v[232:235], v[148:149], v[204:205], v[232:235]
    v_mfma_f32_16x16x16_bf16 v[236:239], v[152:153], v[204:205], v[236:239]
    v_mfma_f32_16x16x16_bf16 v[240:243], v[156:157], v[204:205], v[240:243]
    v_rcp_f32 v244, v244
    s_nop 4
    v_pk_mul_f32 v[212:213], v[212:213], v[244:245] op_sel_hi:[1,0]
    v_pk_mul_f32 v[214:215], v[214:215], v[244:245] op_sel_hi:[1,0]
    v_pk_mul_f32 v[216:217], v[216:217], v[244:245] op_sel_hi:[1,0]
    v_pk_mul_f32 v[218:219], v[218:219], v[244:245] op_sel_hi:[1,0]
    v_pk_mul_f32 v[220:221], v[220:221], v[244:245] op_sel_hi:[1,0]
    v_pk_mul_f32 v[222:223], v[222:223], v[244:245] op_sel_hi:[1,0]
    v_pk_mul_f32 v[224:225], v[224:225], v[244:245] op_sel_hi:[1,0]
    v_pk_mul_f32 v[226:227], v[226:227], v[244:245] op_sel_hi:[1,0]
    v_pk_mul_f32 v[228:229], v[228:229], v[244:245] op_sel_hi:[1,0]
    v_pk_mul_f32 v[230:231], v[230:231], v[244:245] op_sel_hi:[1,0]
    v_pk_mul_f32 v[232:233], v[232:233], v[244:245] op_sel_hi:[1,0]
    v_pk_mul_f32 v[234:235], v[234:235], v[244:245] op_sel_hi:[1,0]
    v_pk_mul_f32 v[236:237], v[236:237], v[244:245] op_sel_hi:[1,0]
    v_pk_mul_f32 v[238:239], v[238:239], v[244:245] op_sel_hi:[1,0]
    v_pk_mul_f32 v[240:241], v[240:241], v[244:245] op_sel_hi:[1,0]
    v_pk_mul_f32 v[242:243], v[242:243], v[244:245] op_sel_hi:[1,0]
    v_cvt_pk_bf16_f32 v16, v212, v213
    v_cvt_pk_bf16_f32 v17, v214, v215
    v_cvt_pk_bf16_f32 v18, v216, v217
    v_cvt_pk_bf16_f32 v19, v218, v219
    v_cvt_pk_bf16_f32 v20, v220, v221
    v_cvt_pk_bf16_f32 v21, v222, v223
    v_cvt_pk_bf16_f32 v22, v224, v225
    v_cvt_pk_bf16_f32 v23, v226, v227
    v_cvt_pk_bf16_f32 v24, v228, v229
    v_cvt_pk_bf16_f32 v25, v230, v231
    v_cvt_pk_bf16_f32 v26, v232, v233
    v_cvt_pk_bf16_f32 v27, v234, v235
    v_cvt_pk_bf16_f32 v28, v236, v237
    v_cvt_pk_bf16_f32 v29, v238, v239
    v_cvt_pk_bf16_f32 v30, v240, v241
    v_cvt_pk_bf16_f32 v31, v242, v243
    s_waitcnt lgkmcnt(0)
    s_nop 0
    v_mfma_f32_16x16x32_bf16 a[192:195], a[0:3], v[16:19], 0
    v_mfma_f32_16x16x32_bf16 a[196:199], a[4:7], v[16:19], 0
    v_mfma_f32_16x16x32_bf16 a[200:203], a[8:11], v[16:19], 0
    v_mfma_f32_16x16x32_bf16 a[204:207], a[12:15], v[16:19], 0
    v_mfma_f32_16x16x32_bf16 a[208:211], a[16:19], v[16:19], 0
    v_mfma_f32_16x16x32_bf16 a[212:215], a[20:23], v[16:19], 0
    v_mfma_f32_16x16x32_bf16 a[216:219], a[24:27], v[16:19], 0
    v_mfma_f32_16x16x32_bf16 a[220:223], a[28:31], v[16:19], 0
    v_mfma_f32_16x16x32_bf16 a[224:227], a[32:35], v[16:19], 0
    v_mfma_f32_16x16x32_bf16 a[228:231], a[36:39], v[16:19], 0
    v_mfma_f32_16x16x32_bf16 a[232:235], a[40:43], v[16:19], 0
    v_mfma_f32_16x16x32_bf16 a[236:239], a[44:47], v[16:19], 0
    v_mfma_f32_16x16x32_bf16 a[192:195], a[48:51], v[20:23], a[192:195]
    v_mfma_f32_16x16x32_bf16 a[196:199], a[52:55], v[20:23], a[196:199]
    v_mfma_f32_16x16x32_bf16 a[200:203], a[56:59], v[20:23], a[200:203]
    v_mfma_f32_16x16x32_bf16 a[204:207], a[60:63], v[20:23], a[204:207]
    v_mfma_f32_16x16x32_bf16 a[208:211], a[64:67], v[20:23], a[208:211]
    v_mfma_f32_16x16x32_bf16 a[212:215], a[68:71], v[20:23], a[212:215]
    v_mfma_f32_16x16x32_bf16 a[216:219], a[72:75], v[20:23], a[216:219]
    v_mfma_f32_16x16x32_bf16 a[220:223], a[76:79], v[20:23], a[220:223]
    v_mfma_f32_16x16x32_bf16 a[224:227], a[80:83], v[20:23], a[224:227]
    v_mfma_f32_16x16x32_bf16 a[228:231], a[84:87], v[20:23], a[228:231]
    v_mfma_f32_16x16x32_bf16 a[232:235], a[88:91], v[20:23], a[232:235]
    v_mfma_f32_16x16x32_bf16 a[236:239], a[92:95], v[20:23], a[236:239]
    v_mfma_f32_16x16x32_bf16 a[192:195], a[96:99], v[24:27], a[192:195]
    v_mfma_f32_16x16x32_bf16 a[196:199], a[100:103], v[24:27], a[196:199]
    v_mfma_f32_16x16x32_bf16 a[200:203], a[104:107], v[24:27], a[200:203]
    v_mfma_f32_16x16x32_bf16 a[204:207], a[108:111], v[24:27], a[204:207]
    v_mfma_f32_16x16x32_bf16 a[208:211], a[112:115], v[24:27], a[208:211]
    v_mfma_f32_16x16x32_bf16 a[212:215], a[116:119], v[24:27], a[212:215]
    v_mfma_f32_16x16x32_bf16 a[216:219], a[120:123], v[24:27], a[216:219]
    v_mfma_f32_16x16x32_bf16 a[220:223], a[124:127], v[24:27], a[220:223]
    v_mfma_f32_16x16x32_bf16 a[224:227], a[128:131], v[24:27], a[224:227]
    v_mfma_f32_16x16x32_bf16 a[228:231], a[132:135], v[24:27], a[228:231]
    v_mfma_f32_16x16x32_bf16 a[232:235], a[136:139], v[24:27], a[232:235]
    v_mfma_f32_16x16x32_bf16 a[236:239], a[140:143], v[24:27], a[236:239]
    v_mfma_f32_16x16x32_bf16 a[192:195], a[144:147], v[28:31], a[192:195]
    v_mfma_f32_16x16x32_bf16 a[196:199], a[148:151], v[28:31], a[196:199]
    v_mfma_f32_16x16x32_bf16 a[200:203], a[152:155], v[28:31], a[200:203]
    v_mfma_f32_16x16x32_bf16 a[204:207], a[156:159], v[28:31], a[204:207]
    v_mfma_f32_16x16x32_bf16 a[208:211], a[160:163], v[28:31], a[208:211]
    v_mfma_f32_16x16x32_bf16 a[212:215], a[164:167], v[28:31], a[212:215]
    v_mfma_f32_16x16x32_bf16 a[216:219], a[168:171], v[28:31], a[216:219]
    v_mfma_f32_16x16x32_bf16 a[220:223], a[172:175], v[28:31], a[220:223]
    v_mfma_f32_16x16x32_bf16 a[224:227], a[176:179], v[28:31], a[224:227]
    v_mfma_f32_16x16x32_bf16 a[228:231], a[180:183], v[28:31], a[228:231]
    v_mfma_f32_16x16x32_bf16 a[232:235], a[184:187], v[28:31], a[232:235]
    v_mfma_f32_16x16x32_bf16 a[236:239], a[188:191], v[28:31], a[236:239]
    v_mfma_f32_16x16x32_bf16 v[192:195], v[160:163], v[80:83], 0
    v_mfma_f32_16x16x32_bf16 v[196:199], v[96:99], v[80:83], 0
    v_mfma_f32_16x16x32_bf16 v[200:203], v[112:115], v[80:83], 0
    v_mfma_f32_16x16x32_bf16 v[192:195], v[164:167], v[84:87], v[192:195]
    v_mfma_f32_16x16x32_bf16 v[196:199], v[100:103], v[84:87], v[196:199]
    v_mfma_f32_16x16x32_bf16 v[200:203], v[116:119], v[84:87], v[200:203]
    v_mfma_f32_16x16x32_bf16 v[192:195], v[168:171], v[88:91], v[192:195]
    v_mfma_f32_16x16x32_bf16 v[196:199], v[104:107], v[88:91], v[196:199]
    v_mfma_f32_16x16x32_bf16 v[200:203], v[120:123], v[88:91], v[200:203]
    v_mfma_f32_16x16x32_bf16 v[192:195], v[172:175], v[92:95], v[192:195]
    v_mfma_f32_16x16x32_bf16 v[196:199], v[108:111], v[92:95], v[196:199]
    v_mfma_f32_16x16x32_bf16 v[200:203], v[124:127], v[92:95], v[200:203]
    ds_write_b128 v14, a[192:195] offset:0
    ds_write_b128 v14, a[196:199] offset:1024
    ds_write_b128 v14, a[200:203] offset:2048
    ds_write_b128 v14, a[204:207] offset:3072
    ds_write_b128 v14, a[208:211] offset:4096
    ds_write_b128 v14, a[212:215] offset:5120
    ds_write_b128 v14, a[216:219] offset:6144
    ds_write_b128 v14, a[220:223] offset:7168
    ds_write_b128 v14, a[224:227] offset:8192
    ds_write_b128 v14, a[228:231] offset:9216
    ds_write_b128 v14, a[232:235] offset:10240
    ds_write_b128 v14, a[236:239] offset:11264
    v_cndmask_b32 v200, v5, v200, s[50:51]
    v_cndmask_b32 v201, v5, v201, s[52:53]
    v_cndmask_b32 v202, v5, v202, s[54:55]
    v_cndmask_b32 v203, v5, v203, s[56:57]
    v_max3_f32 v10, v192, v193, v194
    v_max3_f32 v10, v10, v195, v196
    v_max3_f32 v10, v10, v197, v198
    v_max3_f32 v10, v10, v200, v201
    v_max3_f32 v10, v10, v202, v203
    v_max_f32 v10, v10, v199
    v_mov_b32 v11, v10
    s_nop 1
    v_permlane32_swap_b32 v10, v11
    v_max_f32 v10, v10, v11
    v_mov_b32 v11, v10
    s_nop 1
    v_permlane16_swap_b32 v10, v11
    v_max_f32 v10, v10, v11
    v_mul_f32 v10, s42, v10
    v_pk_fma_f32 v[192:193], v[192:193], s[42:43], v[10:11] op_sel_hi:[1,0,0] neg_lo:[0,0,1] neg_hi:[0,0,1]
    v_pk_fma_f32 v[194:195], v[194:195], s[42:43], v[10:11] op_sel_hi:[1,0,0] neg_lo:[0,0,1] neg_hi:[0,0,1]
    v_pk_fma_f32 v[196:197], v[196:197], s[42:43], v[10:11] op_sel_hi:[1,0,0] neg_lo:[0,0,1] neg_hi:[0,0,1]
    v_pk_fma_f32 v[198:199], v[198:199], s[42:43], v[10:11] op_sel_hi:[1,0,0] neg_lo:[0,0,1] neg_hi:[0,0,1]
    v_pk_fma_f32 v[200:201], v[200:201], s[42:43], v[10:11] op_sel_hi:[1,0,0] neg_lo:[0,0,1] neg_hi:[0,0,1]
    v_pk_fma_f32 v[202:203], v[202:203], s[42:43], v[10:11] op_sel_hi:[1,0,0] neg_lo:[0,0,1] neg_hi:[0,0,1]
    v_exp_f32 v192, v192
    v_exp_f32 v193, v193
    v_exp_f32 v194, v194
    v_exp_f32 v195, v195
    v_exp_f32 v196, v196
    v_exp_f32 v197, v197
    v_exp_f32 v198, v198
    v_exp_f32 v199, v199
    v_exp_f32 v200, v200
    v_exp_f32 v201, v201
    v_exp_f32 v202, v202
    v_exp_f32 v203, v203
    v_cvt_pk_bf16_f32 v208, v192, v193
    v_cvt_pk_bf16_f32 v209, v194, v195
    v_cvt_pk_bf16_f32 v204, v196, v197
    v_cvt_pk_bf16_f32 v205, v198, v199
    v_cvt_pk_bf16_f32 v206, v200, v201
    v_cvt_pk_bf16_f32 v207, v202, v203
    v_cndmask_b32 v52, v208, 0, s[58:59]
    v_cndmask_b32 v54, 0, v208, s[58:59]
    v_cndmask_b32 v53, v209, 0, s[58:59]
    v_cndmask_b32 v55, 0, v209, s[58:59]
    v_mfma_f32_16x16x16_bf16 v[244:247], v[8:9], v[208:209], 0
    v_mfma_f32_16x16x16_bf16 v[244:247], v[6:7], v[204:205], v[244:247]
    v_mfma_f32_16x16x16_bf16 v[244:247], v[6:7], v[206:207], v[244:247]
    v_mfma_f32_16x16x16_bf16 v[212:215], a[242:243], v[52:53], 0
    v_mfma_f32_16x16x16_bf16 v[216:219], a[242:243], v[54:55], 0
    v_mfma_f32_16x16x16_bf16 v[220:223], a[246:247], v[52:53], 0
    v_mfma_f32_16x16x16_bf16 v[224:227], a[246:247], v[54:55], 0
    v_mfma_f32_16x16x16_bf16 v[228:231], a[250:251], v[52:53], 0
    v_mfma_f32_16x16x16_bf16 v[232:235], a[250:251], v[54:55], 0
    v_mfma_f32_16x16x16_bf16 v[236:239], a[254:255], v[52:53], 0
    v_mfma_f32_16x16x16_bf16 v[240:243], a[254:255], v[54:55], 0
    v_mfma_f32_16x16x32_bf16 v[212:215], v[128:131], v[204:207], v[212:215]
    v_mfma_f32_16x16x32_bf16 v[216:219], v[132:135], v[204:207], v[216:219]
    v_mfma_f32_16x16x32_bf16 v[220:223], v[136:139], v[204:207], v[220:223]
    v_mfma_f32_16x16x32_bf16 v[224:227], v[140:143], v[204:207], v[224:227]
    v_mfma_f32_16x16x32_bf16 v[228:231], v[144:147], v[204:207], v[228:231]
    v_mfma_f32_16x16x32_bf16 v[232:235], v[148:151], v[204:207], v[232:235]
    v_mfma_f32_16x16x32_bf16 v[236:239], v[152:155], v[204:207], v[236:239]
    v_mfma_f32_16x16x32_bf16 v[240:243], v[156:159], v[204:207], v[240:243]
    v_rcp_f32 v244, v244
    s_add_u32 s40, s36, 8
    s_mov_b32 s45, 0
    s_cmp_ge_u32 s40, 64
    s_cbranch_scc1 Lt2np_18
    s_mul_i32 s33, s37, 65
    s_add_u32 s33, s33, s40
    s_lshl_b32 s34, s33, 13
    s_add_u32 s34, s34, 52428800
    s_lshl_b32 s33, s33, 14
    s_add_u32 s33, s33, 16777216
    buffer_load_dwordx4 v[64:67], v1, s[4:7], s34 offen offset:0 sc1
    buffer_load_dwordx4 v[68:71], v1, s[4:7], s34 offen offset:1024 sc1
    buffer_load_dwordx4 v[72:75], v1, s[4:7], s34 offen offset:2048 sc1
    buffer_load_dwordx4 v[76:79], v1, s[4:7], s34 offen offset:3072 sc1
    s_add_u32 s34, s34, 4096
    buffer_load_dwordx4 v[80:83], v1, s[4:7], s34 offen offset:0 sc1
    buffer_load_dwordx4 v[84:87], v1, s[4:7], s34 offen offset:1024 sc1
    buffer_load_dwordx4 v[88:91], v1, s[4:7], s34 offen offset:2048 sc1
    buffer_load_dwordx4 v[92:95], v1, s[4:7], s34 offen offset:3072 sc1
    buffer_load_dwordx4 v[96:99], v1, s[4:7], s33 offen offset:0 sc1
    buffer_load_dwordx4 v[100:103], v1, s[4:7], s33 offen offset:1024 sc1
    buffer_load_dwordx4 v[104:107], v1, s[4:7], s33 offen offset:2048 sc1
    buffer_load_dwordx4 v[108:111], v1, s[4:7], s33 offen offset:3072 sc1
    s_add_u32 s33, s33, 4096
    buffer_load_dwordx4 v[112:115], v1, s[4:7], s33 offen offset:0 sc1
    buffer_load_dwordx4 v[116:119], v1, s[4:7], s33 offen offset:1024 sc1
    buffer_load_dwordx4 v[120:123], v1, s[4:7], s33 offen offset:2048 sc1
    buffer_load_dwordx4 v[124:127], v1, s[4:7], s33 offen offset:3072 sc1
    s_add_u32 s33, s33, 4096
    buffer_load_dwordx4 v[128:131], v1, s[4:7], s33 offen offset:0 sc1
    buffer_load_dwordx4 v[132:135], v1, s[4:7], s33 offen offset:1024 sc1
    buffer_load_dwordx4 v[136:139], v1, s[4:7], s33 offen offset:2048 sc1
    buffer_load_dwordx4 v[140:143], v1, s[4:7], s33 offen offset:3072 sc1
    s_add_u32 s33, s33, 4096
    buffer_load_dwordx4 v[144:147], v1, s[4:7], s33 offen offset:0 sc1
    buffer_load_dwordx4 v[148:151], v1, s[4:7], s33 offen offset:1024 sc1
    buffer_load_dwordx4 v[152:155], v1, s[4:7], s33 offen offset:2048 sc1
    buffer_load_dwordx4 v[156:159], v1, s[4:7], s33 offen offset:3072 sc1
    s_cmp_gt_u32 s44, s40
    s_cbranch_scc0 Lt2np_18
    s_mov_b32 s45, 1
    s_mul_i32 s35, s37, 65
    s_add_u32 s35, s35, s40
    s_lshl_b32 s35, s35, 13
    s_add_u32 s35, s35, 71303168
    buffer_load_dwordx4 a[240:243], v1, s[4:7], s35 offen offset:0 sc1
    buffer_load_dwordx4 a[244:247], v1, s[4:7], s35 offen offset:1024 sc1
    buffer_load_dwordx4 a[248:251], v1, s[4:7], s35 offen offset:2048 sc1
    buffer_load_dwordx4 a[252:255], v1, s[4:7], s35 offen offset:3072 sc1
Lt2np_18:
    s_nop 1
    v_pk_mul_f32 v[212:213], v[212:213], v[244:245] op_sel_hi:[1,0]
    v_pk_mul_f32 v[214:215], v[214:215], v[244:245] op_sel_hi:[1,0]
    v_pk_mul_f32 v[216:217], v[216:217], v[244:245] op_sel_hi:[1,0]
    v_pk_mul_f32 v[218:219], v[218:219], v[244:245] op_sel_hi:[1,0]
    v_pk_mul_f32 v[220:221], v[220:221], v[244:245] op_sel_hi:[1,0]
    v_pk_mul_f32 v[222:223], v[222:223], v[244:245] op_sel_hi:[1,0]
    v_pk_mul_f32 v[224:225], v[224:225], v[244:245] op_sel_hi:[1,0]
    v_pk_mul_f32 v[226:227], v[226:227], v[244:245] op_sel_hi:[1,0]
    v_pk_mul_f32 v[228:229], v[228:229], v[244:245] op_sel_hi:[1,0]
    v_pk_mul_f32 v[230:231], v[230:231], v[244:245] op_sel_hi:[1,0]
    v_pk_mul_f32 v[232:233], v[232:233], v[244:245] op_sel_hi:[1,0]
    v_pk_mul_f32 v[234:235], v[234:235], v[244:245] op_sel_hi:[1,0]
    v_pk_mul_f32 v[236:237], v[236:237], v[244:245] op_sel_hi:[1,0]
    v_pk_mul_f32 v[238:239], v[238:239], v[244:245] op_sel_hi:[1,0]
    v_pk_mul_f32 v[240:241], v[240:241], v[244:245] op_sel_hi:[1,0]
    v_pk_mul_f32 v[242:243], v[242:243], v[244:245] op_sel_hi:[1,0]
    v_cvt_pk_bf16_f32 v16, v212, v213
    v_cvt_pk_bf16_f32 v17, v214, v215
    v_cvt_pk_bf16_f32 v18, v216, v217
    v_cvt_pk_bf16_f32 v19, v218, v219
    v_cvt_pk_bf16_f32 v20, v220, v221
    v_cvt_pk_bf16_f32 v21, v222, v223
    v_cvt_pk_bf16_f32 v22, v224, v225
    v_cvt_pk_bf16_f32 v23, v226, v227
    v_cvt_pk_bf16_f32 v24, v228, v229
    v_cvt_pk_bf16_f32 v25, v230, v231
    v_cvt_pk_bf16_f32 v26, v232, v233
    v_cvt_pk_bf16_f32 v27, v234, v235
    v_cvt_pk_bf16_f32 v28, v236, v237
    v_cvt_pk_bf16_f32 v29, v238, v239
    v_cvt_pk_bf16_f32 v30, v240, v241
    v_cvt_pk_bf16_f32 v31, v242, v243
    s_waitcnt lgkmcnt(0)
    s_nop 0
    v_mfma_f32_16x16x32_bf16 a[192:195], a[0:3], v[16:19], 0
    v_mfma_f32_16x16x32_bf16 a[196:199], a[4:7], v[16:19], 0
    v_mfma_f32_16x16x32_bf16 a[200:203], a[8:11], v[16:19], 0
    v_mfma_f32_16x16x32_bf16 a[204:207], a[12:15], v[16:19], 0
    v_mfma_f32_16x16x32_bf16 a[208:211], a[16:19], v[16:19], 0
    v_mfma_f32_16x16x32_bf16 a[212:215], a[20:23], v[16:19], 0
    v_mfma_f32_16x16x32_bf16 a[216:219], a[24:27], v[16:19], 0
    v_mfma_f32_16x16x32_bf16 a[220:223], a[28:31], v[16:19], 0
    v_mfma_f32_16x16x32_bf16 a[224:227], a[32:35], v[16:19], 0
    v_mfma_f32_16x16x32_bf16 a[228:231], a[36:39], v[16:19], 0
    v_mfma_f32_16x16x32_bf16 a[232:235], a[40:43], v[16:19], 0
    v_mfma_f32_16x16x32_bf16 a[236:239], a[44:47], v[16:19], 0
    v_mfma_f32_16x16x32_bf16 a[192:195], a[48:51], v[20:23], a[192:195]
    v_mfma_f32_16x16x32_bf16 a[196:199], a[52:55], v[20:23], a[196:199]
    v_mfma_f32_16x16x32_bf16 a[200:203], a[56:59], v[20:23], a[200:203]
    v_mfma_f32_16x16x32_bf16 a[204:207], a[60:63], v[20:23], a[204:207]
    v_mfma_f32_16x16x32_bf16 a[208:211], a[64:67], v[20:23], a[208:211]
    v_mfma_f32_16x16x32_bf16 a[212:215], a[68:71], v[20:23], a[212:215]
    v_mfma_f32_16x16x32_bf16 a[216:219], a[72:75], v[20:23], a[216:219]
    v_mfma_f32_16x16x32_bf16 a[220:223], a[76:79], v[20:23], a[220:223]
    v_mfma_f32_16x16x32_bf16 a[224:227], a[80:83], v[20:23], a[224:227]
    v_mfma_f32_16x16x32_bf16 a[228:231], a[84:87], v[20:23], a[228:231]
    v_mfma_f32_16x16x32_bf16 a[232:235], a[88:91], v[20:23], a[232:235]
    v_mfma_f32_16x16x32_bf16 a[236:239], a[92:95], v[20:23], a[236:239]
    v_mfma_f32_16x16x32_bf16 a[192:195], a[96:99], v[24:27], a[192:195]
    v_mfma_f32_16x16x32_bf16 a[196:199], a[100:103], v[24:27], a[196:199]
    v_mfma_f32_16x16x32_bf16 a[200:203], a[104:107], v[24:27], a[200:203]
    v_mfma_f32_16x16x32_bf16 a[204:207], a[108:111], v[24:27], a[204:207]
    v_mfma_f32_16x16x32_bf16 a[208:211], a[112:115], v[24:27], a[208:211]
    v_mfma_f32_16x16x32_bf16 a[212:215], a[116:119], v[24:27], a[212:215]
    v_mfma_f32_16x16x32_bf16 a[216:219], a[120:123], v[24:27], a[216:219]
    v_mfma_f32_16x16x32_bf16 a[220:223], a[124:127], v[24:27], a[220:223]
    v_mfma_f32_16x16x32_bf16 a[224:227], a[128:131], v[24:27], a[224:227]
    v_mfma_f32_16x16x32_bf16 a[228:231], a[132:135], v[24:27], a[228:231]
    v_mfma_f32_16x16x32_bf16 a[232:235], a[136:139], v[24:27], a[232:235]
    v_mfma_f32_16x16x32_bf16 a[236:239], a[140:143], v[24:27], a[236:239]
    v_mfma_f32_16x16x32_bf16 a[192:195], a[144:147], v[28:31], a[192:195]
    v_mfma_f32_16x16x32_bf16 a[196:199], a[148:151], v[28:31], a[196:199]
    v_mfma_f32_16x16x32_bf16 a[200:203], a[152:155], v[28:31], a[200:203]
    v_mfma_f32_16x16x32_bf16 a[204:207], a[156:159], v[28:31], a[204:207]
    v_mfma_f32_16x16x32_bf16 a[208:211], a[160:163], v[28:31], a[208:211]
    v_mfma_f32_16x16x32_bf16 a[212:215], a[164:167], v[28:31], a[212:215]
    v_mfma_f32_16x16x32_bf16 a[216:219], a[168:171], v[28:31], a[216:219]
    v_mfma_f32_16x16x32_bf16 a[220:223], a[172:175], v[28:31], a[220:223]
    v_mfma_f32_16x16x32_bf16 a[224:227], a[176:179], v[28:31], a[224:227]
    v_mfma_f32_16x16x32_bf16 a[228:231], a[180:183], v[28:31], a[228:231]
    v_mfma_f32_16x16x32_bf16 a[232:235], a[184:187], v[28:31], a[232:235]
    v_mfma_f32_16x16x32_bf16 a[236:239], a[188:191], v[28:31], a[236:239]
    s_mul_i32 s34, s36, 6
    s_add_u32 s34, s34, s47
    s_mul_i32 s35, s34, 98304
    s_mul_i32 s33, s46, 6144
    s_add_u32 s35, s35, s33
    s_add_u32 s35, s35, 134217728
    s_mul_i32 s38, s30, 12288
    s_add_u32 s38, s38, s35
    s_add_u32 s39, s38, 4096
    ds_write_b128 v14, a[192:195] offset:12288
    ds_write_b128 v14, a[196:199] offset:13312
    ds_write_b128 v14, a[200:203] offset:14336
    ds_write_b128 v14, a[204:207] offset:15360
    ds_write_b128 v14, a[208:211] offset:16384
    ds_write_b128 v14, a[212:215] offset:17408
    ds_write_b128 v14, a[216:219] offset:18432
    ds_write_b128 v14, a[220:223] offset:19456
    ds_write_b128 v14, a[224:227] offset:20480
    ds_write_b128 v14, a[228:231] offset:21504
    ds_write_b128 v14, a[232:235] offset:22528
    ds_write_b128 v14, a[236:239] offset:23552
    s_waitcnt lgkmcnt(0)
    s_barrier
    ds_read_b128 v[160:163], v15 offset:0
    ds_read_b128 v[164:167], v15 offset:1024
    ds_read_b128 v[168:171], v15 offset:2048
    ds_read_b128 v[172:175], v15 offset:3072
    ds_read_b128 v[176:179], v15 offset:4096
    ds_read_b128 v[180:183], v15 offset:5120
    ds_read_b128 v[184:187], v15 offset:24576
    ds_read_b128 v[188:191], v15 offset:25600
    ds_read_b128 v[192:195], v15 offset:26624
    ds_read_b128 v[196:199], v15 offset:27648
    ds_read_b128 v[200:203], v15 offset:28672
    ds_read_b128 v[204:207], v15 offset:29696
    ds_read_b128 v[208:211], v13 offset:0
    ds_read_b128 v[212:215], v13 offset:1024
    ds_read_b128 v[216:219], v13 offset:2048
    ds_read_b128 v[220:223], v13 offset:3072
    ds_read_b128 v[224:227], v13 offset:4096
    ds_read_b128 v[228:231], v13 offset:5120
    ds_read_b128 v[232:235], v13 offset:24576
    ds_read_b128 v[236:239], v13 offset:25600
    ds_read_b128 v[240:243], v13 offset:26624
    ds_read_b128 v[244:247], v13 offset:27648
    ds_read_b128 v[248:251], v13 offset:28672
    ds_read_b128 v[252:255], v13 offset:29696
    s_waitcnt lgkmcnt(0)
    v_pk_add_f32 v[160:161], v[160:161], v[184:185]
    v_pk_add_f32 v[208:209], v[208:209], v[232:233]
    v_pk_add_f32 v[160:161], v[160:161], v[208:209]
    v_pk_add_f32 v[162:163], v[162:163], v[186:187]
    v_pk_add_f32 v[210:211], v[210:211], v[234:235]
    v_pk_add_f32 v[162:163], v[162:163], v[210:211]
    v_pk_add_f32 v[164:165], v[164:165], v[188:189]
    v_pk_add_f32 v[212:213], v[212:213], v[236:237]
    v_pk_add_f32 v[164:165], v[164:165], v[212:213]
    v_pk_add_f32 v[166:167], v[166:167], v[190:191]
    v_pk_add_f32 v[214:215], v[214:215], v[238:239]
    v_pk_add_f32 v[166:167], v[166:167], v[214:215]
    v_pk_add_f32 v[168:169], v[168:169], v[192:193]
    v_pk_add_f32 v[216:217], v[216:217], v[240:241]
    v_pk_add_f32 v[168:169], v[168:169], v[216:217]
    v_pk_add_f32 v[170:171], v[170:171], v[194:195]
    v_pk_add_f32 v[218:219], v[218:219], v[242:243]
    v_pk_add_f32 v[170:171], v[170:171], v[218:219]
    v_pk_add_f32 v[172:173], v[172:173], v[196:197]
    v_pk_add_f32 v[220:221], v[220:221], v[244:245]
    v_pk_add_f32 v[172:173], v[172:173], v[220:221]
    v_pk_add_f32 v[174:175], v[174:175], v[198:199]
    v_pk_add_f32 v[222:223], v[222:223], v[246:247]
    v_pk_add_f32 v[174:175], v[174:175], v[222:223]
    v_pk_add_f32 v[176:177], v[176:177], v[200:201]
    v_pk_add_f32 v[224:225], v[224:225], v[248:249]
    v_pk_add_f32 v[176:177], v[176:177], v[224:225]
    v_pk_add_f32 v[178:179], v[178:179], v[202:203]
    v_pk_add_f32 v[226:227], v[226:227], v[250:251]
    v_pk_add_f32 v[178:179], v[178:179], v[226:227]
    v_pk_add_f32 v[180:181], v[180:181], v[204:205]
    v_pk_add_f32 v[228:229], v[228:229], v[252:253]
    v_pk_add_f32 v[180:181], v[180:181], v[228:229]
    v_pk_add_f32 v[182:183], v[182:183], v[206:207]
    v_pk_add_f32 v[230:231], v[230:231], v[254:255]
    v_pk_add_f32 v[182:183], v[182:183], v[230:231]
    buffer_store_dwordx4 v[160:163], v1, s[4:7], s38 offen offset:0 sc1
    buffer_store_dwordx4 v[164:167], v1, s[4:7], s38 offen offset:1024 sc1
    buffer_store_dwordx4 v[168:171], v1, s[4:7], s38 offen offset:2048 sc1
    buffer_store_dwordx4 v[172:175], v1, s[4:7], s38 offen offset:3072 sc1
    buffer_store_dwordx4 v[176:179], v1, s[4:7], s39 offen offset:0 sc1
    buffer_store_dwordx4 v[180:183], v1, s[4:7], s39 offen offset:1024 sc1
    s_waitcnt vmcnt(0)
    s_barrier
    s_lshl_b32 s33, s36, 1
    s_add_u32 s33, s33, s46
    s_lshl_b32 s34, s33, 6
    s_add_u32 s34, s34, 126877696
    buffer_load_dword v40, v4, s[4:7], s34 offen sc1
    s_mul_i32 s38, s33, 18432
    s_mul_i32 s33, s33, 6
    s_add_u32 s33, s33, s47
    s_mul_i32 s33, s33, 6144
    s_add_u32 s33, s33, 121634816
    s_add_u32 s34, s33, 4096
    buffer_load_dwordx4 v[16:19], v1, s[4:7], s33 offen offset:0 sc1
    buffer_load_dwordx4 v[20:23], v1, s[4:7], s33 offen offset:1024 sc1
    buffer_load_dwordx4 v[24:27], v1, s[4:7], s33 offen offset:2048 sc1
    buffer_load_dwordx4 v[28:31], v1, s[4:7], s33 offen offset:3072 sc1
    buffer_load_dwordx4 v[32:35], v1, s[4:7], s34 offen offset:0 sc1
    buffer_load_dwordx4 v[36:39], v1, s[4:7], s34 offen offset:1024 sc1
    s_mul_i32 s34, s36, 3
    s_add_u32 s34, s34, s31
    s_lshl_b32 s34, s34, 7
    s_add_u32 s34, s34, 73728
    v_mov_b32 v10, 1
    v_mov_b32 v11, 0
    v_mov_b32 v12, 106496
    s_cmp_lg_u32 s29, 0
    s_cbranch_scc1 Lt2sk_19
    s_mov_b64 exec, 1
    buffer_atomic_add v10, v11, s[4:7], s34 offen sc0
    s_waitcnt vmcnt(0)
    ds_write_b32 v12, v10
    s_waitcnt lgkmcnt(0)
    s_mov_b64 exec, -1
Lt2sk_19:
    s_barrier
    ds_read_b32 v10, v12
    s_waitcnt lgkmcnt(0)
    v_readfirstlane_b32 s39, v10
    s_cmp_lg_u32 s39, 7
    s_cbranch_scc1 Lt2next_20
    s_add_u32 s33, s35, 0
    s_add_u32 s34, s35, 4096
    buffer_load_dwordx4 v[160:163], v1, s[4:7], s33 offen offset:0 sc1
    buffer_load_dwordx4 v[164:167], v1, s[4:7], s33 offen offset:1024 sc1
    buffer_load_dwordx4 v[168:171], v1, s[4:7], s33 offen offset:2048 sc1
    buffer_load_dwordx4 v[172:175], v1, s[4:7], s33 offen offset:3072 sc1
    buffer_load_dwordx4 v[176:179], v1, s[4:7], s34 offen offset:0 sc1
    buffer_load_dwordx4 v[180:183], v1, s[4:7], s34 offen offset:1024 sc1
    s_add_u32 s33, s35, 12288
    s_add_u32 s34, s35, 16384
    buffer_load_dwordx4 v[184:187], v1, s[4:7], s33 offen offset:0 sc1
    buffer_load_dwordx4 v[188:191], v1, s[4:7], s33 offen offset:1024 sc1
    buffer_load_dwordx4 v[192:195], v1, s[4:7], s33 offen offset:2048 sc1
    buffer_load_dwordx4 v[196:199], v1, s[4:7], s33 offen offset:3072 sc1
    buffer_load_dwordx4 v[200:203], v1, s[4:7], s34 offen offset:0 sc1
    buffer_load_dwordx4 v[204:207], v1, s[4:7], s34 offen offset:1024 sc1
    s_add_u32 s33, s35, 24576
    s_add_u32 s34, s35, 28672
    buffer_load_dwordx4 v[208:211], v1, s[4:7], s33 offen offset:0 sc1
    buffer_load_dwordx4 v[212:215], v1, s[4:7], s33 offen offset:1024 sc1
    buffer_load_dwordx4 v[216:219], v1, s[4:7], s33 offen offset:2048 sc1
    buffer_load_dwordx4 v[220:223], v1, s[4:7], s33 offen offset:3072 sc1
    buffer_load_dwordx4 v[224:227], v1, s[4:7], s34 offen offset:0 sc1
    buffer_load_dwordx4 v[228:231], v1, s[4:7], s34 offen offset:1024 sc1
    s_add_u32 s33, s35, 36864
    s_add_u32 s34, s35, 40960
    buffer_load_dwordx4 v[232:235], v1, s[4:7], s33 offen offset:0 sc1
    buffer_load_dwordx4 v[236:239], v1, s[4:7], s33 offen offset:1024 sc1
    buffer_load_dwordx4 v[240:243], v1, s[4:7], s33 offen offset:2048 sc1
    buffer_load_dwordx4 v[244:247], v1, s[4:7], s33 offen offset:3072 sc1
    buffer_load_dwordx4 v[248:251], v1, s[4:7], s34 offen offset:0 sc1
    buffer_load_dwordx4 v[252:255], v1, s[4:7], s34 offen offset:1024 sc1
    s_add_u32 s33, s35, 49152
    s_add_u32 s34, s35, 53248
    buffer_load_dwordx4 a[192:195], v1, s[4:7], s33 offen offset:0 sc1
    buffer_load_dwordx4 a[196:199], v1, s[4:7], s33 offen offset:1024 sc1
    buffer_load_dwordx4 a[200:203], v1, s[4:7], s33 offen offset:2048 sc1
    buffer_load_dwordx4 a[204:207], v1, s[4:7], s33 offen offset:3072 sc1
    buffer_load_dwordx4 a[208:211], v1, s[4:7], s34 offen offset:0 sc1
    buffer_load_dwordx4 a[212:215], v1, s[4:7], s34 offen offset:1024 sc1
    s_add_u32 s33, s35, 61440
    s_add_u32 s34, s35, 65536
    buffer_load_dwordx4 a[216:219], v1, s[4:7], s33 offen offset:0 sc1
    buffer_load_dwordx4 a[220:223], v1, s[4:7], s33 offen offset:1024 sc1
    buffer_load_dwordx4 a[224:227], v1, s[4:7], s33 offen offset:2048 sc1
    buffer_load_dwordx4 a[228:231], v1, s[4:7], s33 offen offset:3072 sc1
    buffer_load_dwordx4 a[232:235], v1, s[4:7], s34 offen offset:0 sc1
    buffer_load_dwordx4 a[236:239], v1, s[4:7], s34 offen offset:1024 sc1
    s_waitcnt vmcnt(18)
    v_pk_add_f32 v[160:161], v[160:161], v[184:185]
    v_pk_add_f32 v[162:163], v[162:163], v[186:187]
    v_pk_add_f32 v[164:165], v[164:165], v[188:189]
    v_pk_add_f32 v[166:167], v[166:167], v[190:191]
    v_pk_add_f32 v[168:169], v[168:169], v[192:193]
    v_pk_add_f32 v[170:171], v[170:171], v[194:195]
    v_pk_add_f32 v[172:173], v[172:173], v[196:197]
    v_pk_add_f32 v[174:175], v[174:175], v[198:199]
    v_pk_add_f32 v[176:177], v[176:177], v[200:201]
    v_pk_add_f32 v[178:179], v[178:179], v[202:203]
    v_pk_add_f32 v[180:181], v[180:181], v[204:205]
    v_pk_add_f32 v[182:183], v[182:183], v[206:207]
    v_pk_add_f32 v[160:161], v[160:161], v[208:209]
    v_pk_add_f32 v[162:163], v[162:163], v[210:211]
    v_pk_add_f32 v[164:165], v[164:165], v[212:213]
    v_pk_add_f32 v[166:167], v[166:167], v[214:215]
    v_pk_add_f32 v[168:169], v[168:169], v[216:217]
    v_pk_add_f32 v[170:171], v[170:171], v[218:219]
    v_pk_add_f32 v[172:173], v[172:173], v[220:221]
    v_pk_add_f32 v[174:175], v[174:175], v[222:223]
    v_pk_add_f32 v[176:177], v[176:177], v[224:225]
    v_pk_add_f32 v[178:179], v[178:179], v[226:227]
    v_pk_add_f32 v[180:181], v[180:181], v[228:229]
    v_pk_add_f32 v[182:183], v[182:183], v[230:231]
    s_add_u32 s33, s35, 73728
    s_add_u32 s34, s35, 77824
    buffer_load_dwordx4 v[184:187], v1, s[4:7], s33 offen offset:0 sc1
    buffer_load_dwordx4 v[188:191], v1, s[4:7], s33 offen offset:1024 sc1
    buffer_load_dwordx4 v[192:195], v1, s[4:7], s33 offen offset:2048 sc1
    buffer_load_dwordx4 v[196:199], v1, s[4:7], s33 offen offset:3072 sc1
    buffer_load_dwordx4 v[200:203], v1, s[4:7], s34 offen offset:0 sc1
    buffer_load_dwordx4 v[204:207], v1, s[4:7], s34 offen offset:1024 sc1
    s_add_u32 s33, s35, 86016
    s_add_u32 s34, s35, 90112
    buffer_load_dwordx4 v[208:211], v1, s[4:7], s33 offen offset:0 sc1
    buffer_load_dwordx4 v[212:215], v1, s[4:7], s33 offen offset:1024 sc1
    buffer_load_dwordx4 v[216:219], v1, s[4:7], s33 offen offset:2048 sc1
    buffer_load_dwordx4 v[220:223], v1, s[4:7], s33 offen offset:3072 sc1
    buffer_load_dwordx4 v[224:227], v1, s[4:7], s34 offen offset:0 sc1
    buffer_load_dwordx4 v[228:231], v1, s[4:7], s34 offen offset:1024 sc1
    s_waitcnt vmcnt(12)
    v_pk_add_f32 v[160:161], v[160:161], v[232:233]
    v_pk_add_f32 v[162:163], v[162:163], v[234:235]
    v_pk_add_f32 v[164:165], v[164:165], v[236:237]
    v_pk_add_f32 v[166:167], v[166:167], v[238:239]
    v_pk_add_f32 v[168:169], v[168:169], v[240:241]
    v_pk_add_f32 v[170:171], v[170:171], v[242:243]
    v_pk_add_f32 v[172:173], v[172:173], v[244:245]
    v_pk_add_f32 v[174:175], v[174:175], v[246:247]
    v_pk_add_f32 v[176:177], v[176:177], v[248:249]
    v_pk_add_f32 v[178:179], v[178:179], v[250:251]
    v_pk_add_f32 v[180:181], v[180:181], v[252:253]
    v_pk_add_f32 v[182:183], v[182:183], v[254:255]
    v_accvgpr_read_b32 v232, a192
    v_accvgpr_read_b32 v233, a193
    v_accvgpr_read_b32 v234, a194
    v_accvgpr_read_b32 v235, a195
    v_accvgpr_read_b32 v236, a196
    v_accvgpr_read_b32 v237, a197
    v_accvgpr_read_b32 v238, a198
    v_accvgpr_read_b32 v239, a199
    v_accvgpr_read_b32 v240, a200
    v_accvgpr_read_b32 v241, a201
    v_accvgpr_read_b32 v242, a202
    v_accvgpr_read_b32 v243, a203
    v_accvgpr_read_b32 v244, a204
    v_accvgpr_read_b32 v245, a205
    v_accvgpr_read_b32 v246, a206
    v_accvgpr_read_b32 v247, a207
    v_accvgpr_read_b32 v248, a208
    v_accvgpr_read_b32 v249, a209
    v_accvgpr_read_b32 v250, a210
    v_accvgpr_read_b32 v251, a211
    v_accvgpr_read_b32 v252, a212
    v_accvgpr_read_b32 v253, a213
    v_accvgpr_read_b32 v254, a214
    v_accvgpr_read_b32 v255, a215
    v_pk_add_f32 v[160:161], v[160:161], v[232:233]
    v_pk_add_f32 v[162:163], v[162:163], v[234:235]
    v_pk_add_f32 v[164:165], v[164:165], v[236:237]
    v_pk_add_f32 v[166:167], v[166:167], v[238:239]
    v_pk_add_f32 v[168:169], v[168:169], v[240:241]
    v_pk_add_f32 v[170:171], v[170:171], v[242:243]
    v_pk_add_f32 v[172:173], v[172:173], v[244:245]
    v_pk_add_f32 v[174:175], v[174:175], v[246:247]
    v_pk_add_f32 v[176:177], v[176:177], v[248:249]
    v_pk_add_f32 v[178:179], v[178:179], v[250:251]
    v_pk_add_f32 v[180:181], v[180:181], v[252:253]
    v_pk_add_f32 v[182:183], v[182:183], v[254:255]
    v_accvgpr_read_b32 v232, a216
    v_accvgpr_read_b32 v233, a217
    v_accvgpr_read_b32 v234, a218
    v_accvgpr_read_b32 v235, a219
    v_accvgpr_read_b32 v236, a220
    v_accvgpr_read_b32 v237, a221
    v_accvgpr_read_b32 v238, a222
    v_accvgpr_read_b32 v239, a223
    v_accvgpr_read_b32 v240, a224
    v_accvgpr_read_b32 v241, a225
    v_accvgpr_read_b32 v242, a226
    v_accvgpr_read_b32 v243, a227
    v_accvgpr_read_b32 v244, a228
    v_accvgpr_read_b32 v245, a229
    v_accvgpr_read_b32 v246, a230
    v_accvgpr_read_b32 v247, a231
    v_accvgpr_read_b32 v248, a232
    v_accvgpr_read_b32 v249, a233
    v_accvgpr_read_b32 v250, a234
    v_accvgpr_read_b32 v251, a235
    v_accvgpr_read_b32 v252, a236
    v_accvgpr_read_b32 v253, a237
    v_accvgpr_read_b32 v254, a238
    v_accvgpr_read_b32 v255, a239
    v_pk_add_f32 v[160:161], v[160:161], v[232:233]
    v_pk_add_f32 v[162:163], v[162:163], v[234:235]
    v_pk_add_f32 v[164:165], v[164:165], v[236:237]
    v_pk_add_f32 v[166:167], v[166:167], v[238:239]
    v_pk_add_f32 v[168:169], v[168:169], v[240:241]
    v_pk_add_f32 v[170:171], v[170:171], v[242:243]
    v_pk_add_f32 v[172:173], v[172:173], v[244:245]
    v_pk_add_f32 v[174:175], v[174:175], v[246:247]
    v_pk_add_f32 v[176:177], v[176:177], v[248:249]
    v_pk_add_f32 v[178:179], v[178:179], v[250:251]
    v_pk_add_f32 v[180:181], v[180:181], v[252:253]
    v_pk_add_f32 v[182:183], v[182:183], v[254:255]
    s_mul_i32 s34, s47, 192
    s_add_u32 s38, s38, s34
    s_waitcnt vmcnt(0)
    v_pk_add_f32 v[160:161], v[160:161], v[184:185]
    v_pk_add_f32 v[162:163], v[162:163], v[186:187]
    v_pk_add_f32 v[164:165], v[164:165], v[188:189]
    v_pk_add_f32 v[166:167], v[166:167], v[190:191]
    v_pk_add_f32 v[168:169], v[168:169], v[192:193]
    v_pk_add_f32 v[170:171], v[170:171], v[194:195]
    v_pk_add_f32 v[172:173], v[172:173], v[196:197]
    v_pk_add_f32 v[174:175], v[174:175], v[198:199]
    v_pk_add_f32 v[176:177], v[176:177], v[200:201]
    v_pk_add_f32 v[178:179], v[178:179], v[202:203]
    v_pk_add_f32 v[180:181], v[180:181], v[204:205]
    v_pk_add_f32 v[182:183], v[182:183], v[206:207]
    v_pk_add_f32 v[160:161], v[160:161], v[208:209]
    v_pk_add_f32 v[162:163], v[162:163], v[210:211]
    v_pk_add_f32 v[164:165], v[164:165], v[212:213]
    v_pk_add_f32 v[166:167], v[166:167], v[214:215]
    v_pk_add_f32 v[168:169], v[168:169], v[216:217]
    v_pk_add_f32 v[170:171], v[170:171], v[218:219]
    v_pk_add_f32 v[172:173], v[172:173], v[220:221]
    v_pk_add_f32 v[174:175], v[174:175], v[222:223]
    v_pk_add_f32 v[176:177], v[176:177], v[224:225]
    v_pk_add_f32 v[178:179], v[178:179], v[226:227]
    v_pk_add_f32 v[180:181], v[180:181], v[228:229]
    v_pk_add_f32 v[182:183], v[182:183], v[230:231]
    v_pk_fma_f32 v[160:161], v[160:161], v[40:41], v[16:17] op_sel_hi:[1,0,1]
    v_pk_fma_f32 v[162:163], v[162:163], v[40:41], v[18:19] op_sel_hi:[1,0,1]
    v_pk_fma_f32 v[164:165], v[164:165], v[40:41], v[20:21] op_sel_hi:[1,0,1]
    v_pk_fma_f32 v[166:167], v[166:167], v[40:41], v[22:23] op_sel_hi:[1,0,1]
    v_pk_fma_f32 v[168:169], v[168:169], v[40:41], v[24:25] op_sel_hi:[1,0,1]
    v_pk_fma_f32 v[170:171], v[170:171], v[40:41], v[26:27] op_sel_hi:[1,0,1]
    v_pk_fma_f32 v[172:173], v[172:173], v[40:41], v[28:29] op_sel_hi:[1,0,1]
    v_pk_fma_f32 v[174:175], v[174:175], v[40:41], v[30:31] op_sel_hi:[1,0,1]
    v_pk_fma_f32 v[176:177], v[176:177], v[40:41], v[32:33] op_sel_hi:[1,0,1]
    v_pk_fma_f32 v[178:179], v[178:179], v[40:41], v[34:35] op_sel_hi:[1,0,1]
    v_pk_fma_f32 v[180:181], v[180:181], v[40:41], v[36:37] op_sel_hi:[1,0,1]
    v_pk_fma_f32 v[182:183], v[182:183], v[40:41], v[38:39] op_sel_hi:[1,0,1]
    v_cvt_pk_bf16_f32 v232, v160, v161
    v_cvt_pk_bf16_f32 v233, v162, v163
    v_cvt_pk_bf16_f32 v234, v164, v165
    v_cvt_pk_bf16_f32 v235, v166, v167
    v_cvt_pk_bf16_f32 v236, v168, v169
    v_cvt_pk_bf16_f32 v237, v170, v171
    v_cvt_pk_bf16_f32 v238, v172, v173
    v_cvt_pk_bf16_f32 v239, v174, v175
    v_cvt_pk_bf16_f32 v240, v176, v177
    v_cvt_pk_bf16_f32 v241, v178, v179
    v_cvt_pk_bf16_f32 v242, v180, v181
    v_cvt_pk_bf16_f32 v243, v182, v183
    buffer_store_dwordx4 v[232:235], v3, s[16:19], s38 offen offset:0
    buffer_store_dwordx4 v[236:239], v3, s[16:19], s38 offen offset:64
    buffer_store_dwordx4 v[240:243], v3, s[16:19], s38 offen offset:128
    s_nop 1
Lt2next_20:
    s_add_u32 s36, s36, 8
    s_cmp_lt_u32 s36, 64
    s_cbranch_scc1 Lt2_seg
Lexit:
    s_endpgm
Lchain:
    s_mov_b32 s94, s27
    s_load_dwordx2 s[24:25], s[0:1], 8
    s_load_dwordx4 s[44:47], s[0:1], 16
    s_load_dwordx2 s[12:13], s[0:1], 32
    s_load_dwordx2 s[16:17], s[0:1], 40
    v_lshrrev_b32 v1, 6, v0
    s_nop 0
    v_readfirstlane_b32 s29, v1
    v_and_b32 v27, 63, v0
    s_waitcnt lgkmcnt(0)
    s_cmp_lt_u32 s29, 2
    s_cselect_b32 s8, s44, s46
    s_cselect_b32 s9, s45, s47
    s_mov_b32 s10, 4718592
    s_mov_b32 s11, 0x00020000
    s_mov_b32 s14, 4718592
    s_mov_b32 s15, 0x00020000
    s_mov_b32 s18, 4718592
    s_mov_b32 s19, 0x00020000
    s_mov_b32 s26, 9216
    s_mov_b32 s27, 0x00020000
    v_and_b32 v16, 15, v27
    v_lshrrev_b32 v17, 4, v27
    v_and_b32 v18, 8, v27
    v_mov_b32 v0, 0x4444
    v_mov_b32 v19, 0xeeee
    v_cmp_ne_u32 vcc, 0, v18
    s_nop 1
    v_cndmask_b32 v0, v0, v19, vcc
    v_lshlrev_b32 v18, 4, v27
    v_add_u32 v1, 65536, v18
    s_lshl_b32 s31, s29, 12
    v_add_u32 v2, s31, v18
    v_add_u32 v3, 98304, v2
    v_and_b32 v18, 7, v27
    v_lshl_add_u32 v18, v17, 3, v18
    v_lshlrev_b32 v18, 4, v18
    v_add_u32 v8, 81920, v18
    v_bfe_u32 v19, v27, 3, 1
    v_lshl_add_u32 v6, v19, 9, v8
    v_lshrrev_b32 v18, 1, v17
    v_lshl_add_u32 v18, v18, 4, v16
    v_lshlrev_b32 v18, 4, v18
    v_and_b32 v19, 1, v17
    v_lshl_add_u32 v18, v19, 3, v18
    s_lshl_b32 s31, s29, 10
    s_add_u32 s31, s31, 65536
    v_add_u32 v4, s31, v18
    v_lshrrev_b32 v18, 2, v16
    v_lshl_add_u32 v18, v17, 3, v18
    v_lshlrev_b32 v18, 4, v18
    v_and_b32 v19, 1, v27
    v_lshl_add_u32 v18, v19, 3, v18
    v_add_u32 v5, 91136, v18
    v_lshlrev_b32 v18, 12, v17
    v_lshl_add_u32 v18, v16, 3, v18
    s_mul_i32 s31, s29, 73728
    s_lshl_b32 s32, s28, 7
    s_add_u32 s31, s31, s32
    v_add_u32 v7, s31, v18
    s_lshl_b32 s40, s29, 5
    s_add_u32 s40, s40, s28
    v_and_b32 v18, 3, v16
    v_lshlrev_b32 v18, 4, v18
    v_lshrrev_b32 v19, 2, v16
    v_lshl_add_u32 v18, v19, 7, v18
    v_and_b32 v19, 1, v17
    v_lshl_add_u32 v18, v19, 3, v18
    v_lshrrev_b32 v19, 1, v17
    v_lshl_add_u32 v18, v19, 2, v18
    s_lshr_b32 s31, s40, 1
    s_lshl_b32 s31, s31, 8
    s_and_b32 s32, s40, 1
    s_lshl_b32 s32, s32, 6
    s_add_u32 s31, s31, s32
    s_lshl_b32 s69, s40, 12
    s_sub_u32 s69, s69, 65536
    s_cmp_lt_u32 s40, 72
    s_cselect_b32 s43, s31, 2146435072
    s_cselect_b32 s69, s69, 2146435072
    v_mov_b32 v19, 2146435072
    v_cmp_gt_u32 vcc, 8, v16
    s_nop 1
    v_cndmask_b32 v31, v19, v18, vcc
    s_mov_b32 s42, 0x3e0293ee
    s_lshl_b32 s68, s29, 11
    s_add_u32 s31, s29, 0
    s_sub_u32 s32, s31, 3
    s_cmp_ge_u32 s31, 3
    s_cselect_b32 s31, s32, s31
    s_mul_i32 s31, s31, 3072
    s_add_u32 s54, s31, 0
    s_add_u32 s31, s29, 0
    s_sub_u32 s32, s31, 3
    s_cmp_ge_u32 s31, 3
    s_cselect_b32 s31, s32, s31
    s_mul_i32 s31, s31, 3072
    s_add_u32 s55, s31, 1024
    s_add_u32 s31, s29, 0
    s_sub_u32 s32, s31, 3
    s_cmp_ge_u32 s31, 3
    s_cselect_b32 s31, s32, s31
    s_mul_i32 s31, s31, 3072
    s_add_u32 s56, s31, 2048
    s_add_u32 s31, s29, 1
    s_sub_u32 s32, s31, 3
    s_cmp_ge_u32 s31, 3
    s_cselect_b32 s31, s32, s31
    s_mul_i32 s31, s31, 3072
    s_add_u32 s57, s31, 0
    s_add_u32 s31, s29, 1
    s_sub_u32 s32, s31, 3
    s_cmp_ge_u32 s31, 3
    s_cselect_b32 s31, s32, s31
    s_mul_i32 s31, s31, 3072
    s_add_u32 s58, s31, 1024
    s_add_u32 s31, s29, 1
    s_sub_u32 s32, s31, 3
    s_cmp_ge_u32 s31, 3
    s_cselect_b32 s31, s32, s31
    s_mul_i32 s31, s31, 3072
    s_add_u32 s59, s31, 2048
    s_add_u32 s31, s29, 2
    s_sub_u32 s32, s31, 3
    s_cmp_ge_u32 s31, 3
    s_cselect_b32 s31, s32, s31
    s_mul_i32 s31, s31, 3072
    s_add_u32 s60, s31, 0
    s_add_u32 s31, s29, 2
    s_sub_u32 s32, s31, 3
    s_cmp_ge_u32 s31, 3
    s_cselect_b32 s31, s32, s31
    s_mul_i32 s31, s31, 3072
    s_add_u32 s61, s31, 1024
    s_add_u32 s31, s29, 2
    s_sub_u32 s32, s31, 3
    s_cmp_ge_u32 s31, 3
    s_cselect_b32 s31, s32, s31
    s_mul_i32 s31, s31, 3072
    s_add_u32 s62, s31, 2048
    s_add_u32 s31, s29, 0
    s_and_b32 s31, s31, 3
    s_lshl_b32 s64, s31, 9
    s_add_u32 s31, s29, 1
    s_and_b32 s31, s31, 3
    s_lshl_b32 s65, s31, 9
    s_add_u32 s31, s29, 2
    s_and_b32 s31, s31, 3
    s_lshl_b32 s66, s31, 9
    s_add_u32 s31, s29, 3
    s_and_b32 s31, s31, 3
    s_lshl_b32 s67, s31, 9
    v_lshrrev_b32 v18, 3, v27
    v_and_b32 v19, 7, v27
    v_lshlrev_b32 v20, 13, v18
    v_lshl_add_u32 v20, v19, 4, v20
    v_mul_u32_u24 v21, 1152, v18
    v_lshl_add_u32 v21, v19, 4, v21
    v_lshrrev_b32 v18, 1, v27
    v_mul_u32_u24 v22, 1152, v18
    v_and_b32 v18, 1, v27
    v_lshl_add_u32 v22, v18, 4, v22
    v_lshrrev_b32 v18, 2, v27
    v_and_b32 v19, 3, v27
    v_lshlrev_b32 v28, 13, v18
    v_lshl_add_u32 v28, v19, 4, v28
    s_lshl_b32 s31, s29, 12
    v_lshlrev_b32 v19, 3, v19
    v_add_u32 v19, s31, v19
    v_lshlrev_b32 v26, 3, v17
    v_bfe_u32 v18, v27, 2, 1
    v_lshl_add_u32 v26, v18, 1, v26
    v_bfe_u32 v18, v27, 3, 1
    v_add_u32 v26, v18, v26
    v_lshl_add_u32 v23, v26, 7, v19
    v_lshl_add_u32 v29, v26, 6, v19
    v_and_b32 v18, 1, v17
    v_lshlrev_b32 v26, 4, v18
    v_lshrrev_b32 v18, 1, v17
    v_lshl_add_u32 v26, v18, 2, v26
    v_bfe_u32 v18, v27, 2, 1
    v_add_u32 v26, v18, v26
    v_bfe_u32 v18, v27, 3, 1
    s_add_u32 s31, s29, 0
    v_add_u32 v52, s31, v18
    v_lshrrev_b32 v53, 2, v52
    v_and_b32 v52, 3, v52
    v_lshl_add_u32 v48, v26, 7, v19
    v_lshl_add_u32 v48, v53, 14, v48
    v_lshl_add_u32 v48, v52, 5, v48
    s_add_u32 s31, s29, 2
    v_add_u32 v52, s31, v18
    v_lshrrev_b32 v53, 2, v52
    v_and_b32 v52, 3, v52
    v_lshl_add_u32 v49, v26, 7, v19
    v_lshl_add_u32 v49, v53, 14, v49
    v_lshl_add_u32 v49, v52, 5, v49
    s_add_u32 s31, s29, 4
    v_add_u32 v52, s31, v18
    v_lshrrev_b32 v53, 2, v52
    v_and_b32 v52, 3, v52
    v_lshl_add_u32 v50, v26, 7, v19
    v_lshl_add_u32 v50, v53, 14, v50
    v_lshl_add_u32 v50, v52, 5, v50
    s_add_u32 s31, s29, 6
    v_add_u32 v52, s31, v18
    v_lshrrev_b32 v53, 2, v52
    v_and_b32 v52, 3, v52
    v_lshl_add_u32 v51, v26, 7, v19
    v_lshl_add_u32 v51, v53, 14, v51
    v_lshl_add_u32 v51, v52, 5, v51
    v_lshl_add_u32 v26, v18, 5, v26
    v_lshl_add_u32 v25, v26, 5, v19
    v_lshlrev_b32 v55, 13, v27
    s_lshl_b32 s44, s28, 8
    s_lshl_b32 s31, s29, 6
    s_add_u32 s45, s44, s31
    s_and_b32 s31, s29, 1
    s_lshl_b32 s31, s31, 7
    s_add_u32 s44, s44, s31
    s_mul_i32 s46, s28, 147456
    s_lshl_b32 s31, s29, 8
    s_add_u32 s46, s46, s31
    s_lshl_b32 s47, s29, 12
    s_bitcmp1_b32 s29, 0
    s_cbranch_scc1 Lodd_21
    s_mul_i32 s31, s64, 72
    s_add_u32 s31, s31, s46
    s_add_u32 s31, s31, 0
    s_add_u32 m0, s47, 49152
    s_nop 0
    buffer_load_dwordx4 v21, s[16:19], s31 offen lds
    s_mul_i32 s31, s64, 72
    s_add_u32 s31, s31, s46
    s_add_u32 s31, s31, 9216
    s_add_u32 m0, s47, 50176
    s_nop 0
    buffer_load_dwordx4 v21, s[16:19], s31 offen lds
    s_mul_i32 s31, s64, 72
    s_add_u32 s31, s31, s46
    s_add_u32 s31, s31, 18432
    s_add_u32 m0, s47, 51200
    s_nop 0
    buffer_load_dwordx4 v21, s[16:19], s31 offen lds
    s_mul_i32 s31, s64, 72
    s_add_u32 s31, s31, s46
    s_add_u32 s31, s31, 27648
    s_add_u32 m0, s47, 52224
    s_nop 0
    buffer_load_dwordx4 v21, s[16:19], s31 offen lds
    s_mul_i32 s31, s64, 72
    s_add_u32 s31, s31, s46
    s_add_u32 s31, s31, 128
    s_add_u32 m0, s47, 65536
    s_nop 0
    buffer_load_dwordx4 v21, s[16:19], s31 offen lds
    s_mul_i32 s31, s64, 72
    s_add_u32 s31, s31, s46
    s_add_u32 s31, s31, 9344
    s_add_u32 m0, s47, 66560
    s_nop 0
    buffer_load_dwordx4 v21, s[16:19], s31 offen lds
    s_mul_i32 s31, s64, 72
    s_add_u32 s31, s31, s46
    s_add_u32 s31, s31, 18560
    s_add_u32 m0, s47, 67584
    s_nop 0
    buffer_load_dwordx4 v21, s[16:19], s31 offen lds
    s_mul_i32 s31, s64, 72
    s_add_u32 s31, s31, s46
    s_add_u32 s31, s31, 27776
    s_add_u32 m0, s47, 68608
    s_nop 0
    buffer_load_dwordx4 v21, s[16:19], s31 offen lds
    s_mul_i32 s31, s64, 72
    s_add_u32 s31, s31, s46
    s_add_u32 s31, s31, 256
    s_add_u32 m0, s47, 81920
    s_nop 0
    buffer_load_dwordx4 v21, s[16:19], s31 offen lds
    s_mul_i32 s31, s64, 72
    s_add_u32 s31, s31, s46
    s_add_u32 s31, s31, 9472
    s_add_u32 m0, s47, 82944
    s_nop 0
    buffer_load_dwordx4 v21, s[16:19], s31 offen lds
    s_mul_i32 s31, s64, 72
    s_add_u32 s31, s31, s46
    s_add_u32 s31, s31, 18688
    s_add_u32 m0, s47, 83968
    s_nop 0
    buffer_load_dwordx4 v21, s[16:19], s31 offen lds
    s_mul_i32 s31, s64, 72
    s_add_u32 s31, s31, s46
    s_add_u32 s31, s31, 27904
    s_add_u32 m0, s47, 84992
    s_nop 0
    buffer_load_dwordx4 v21, s[16:19], s31 offen lds
    s_mul_i32 s31, s65, 72
    s_add_u32 s31, s31, s46
    s_add_u32 s31, s31, 0
    s_add_u32 m0, s47, 98304
    s_nop 0
    buffer_load_dwordx4 v21, s[16:19], s31 offen lds
    s_mul_i32 s31, s65, 72
    s_add_u32 s31, s31, s46
    s_add_u32 s31, s31, 9216
    s_add_u32 m0, s47, 99328
    s_nop 0
    buffer_load_dwordx4 v21, s[16:19], s31 offen lds
    s_mul_i32 s31, s65, 72
    s_add_u32 s31, s31, s46
    s_add_u32 s31, s31, 18432
    s_add_u32 m0, s47, 100352
    s_nop 0
    buffer_load_dwordx4 v21, s[16:19], s31 offen lds
    s_mul_i32 s31, s65, 72
    s_add_u32 s31, s31, s46
    s_add_u32 s31, s31, 27648
    s_add_u32 m0, s47, 101376
    s_nop 0
    buffer_load_dwordx4 v21, s[16:19], s31 offen lds
    s_mul_i32 s31, s65, 72
    s_add_u32 s31, s31, s46
    s_add_u32 s31, s31, 128
    s_add_u32 m0, s47, 114688
    s_nop 0
    buffer_load_dwordx4 v21, s[16:19], s31 offen lds
    s_mul_i32 s31, s65, 72
    s_add_u32 s31, s31, s46
    s_add_u32 s31, s31, 9344
    s_add_u32 m0, s47, 115712
    s_nop 0
    buffer_load_dwordx4 v21, s[16:19], s31 offen lds
    s_mul_i32 s31, s65, 72
    s_add_u32 s31, s31, s46
    s_add_u32 s31, s31, 18560
    s_add_u32 m0, s47, 116736
    s_nop 0
    buffer_load_dwordx4 v21, s[16:19], s31 offen lds
    s_mul_i32 s31, s65, 72
    s_add_u32 s31, s31, s46
    s_add_u32 s31, s31, 27776
    s_add_u32 m0, s47, 117760
    s_nop 0
    buffer_load_dwordx4 v21, s[16:19], s31 offen lds
    s_mul_i32 s31, s65, 72
    s_add_u32 s31, s31, s46
    s_add_u32 s31, s31, 256
    s_add_u32 m0, s47, 131072
    s_nop 0
    buffer_load_dwordx4 v21, s[16:19], s31 offen lds
    s_mul_i32 s31, s65, 72
    s_add_u32 s31, s31, s46
    s_add_u32 s31, s31, 9472
    s_add_u32 m0, s47, 132096
    s_nop 0
    buffer_load_dwordx4 v21, s[16:19], s31 offen lds
    s_mul_i32 s31, s65, 72
    s_add_u32 s31, s31, s46
    s_add_u32 s31, s31, 18688
    s_add_u32 m0, s47, 133120
    s_nop 0
    buffer_load_dwordx4 v21, s[16:19], s31 offen lds
    s_mul_i32 s31, s65, 72
    s_add_u32 s31, s31, s46
    s_add_u32 s31, s31, 27904
    s_add_u32 m0, s47, 134144
    s_nop 0
    buffer_load_dwordx4 v21, s[16:19], s31 offen lds
    v_mov_b32 v56, -1
    v_mov_b32 v57, -1
    v_mov_b32 v58, -1
    v_mov_b32 v59, -1
    s_add_u32 s31, s69, 1048576
    buffer_store_dwordx4 v[56:59], v1, s[4:7], s31 offen offset:0 sc1
    buffer_store_dwordx4 v[56:59], v1, s[4:7], s31 offen offset:1024 sc1
    buffer_store_dwordx4 v[56:59], v1, s[4:7], s31 offen offset:2048 sc1
    buffer_store_dwordx4 v[56:59], v1, s[4:7], s31 offen offset:3072 sc1
    s_add_u32 s31, s69, 1343488
    buffer_store_dwordx4 v[56:59], v1, s[4:7], s31 offen offset:0 sc1
    buffer_store_dwordx4 v[56:59], v1, s[4:7], s31 offen offset:1024 sc1
    buffer_store_dwordx4 v[56:59], v1, s[4:7], s31 offen offset:2048 sc1
    buffer_store_dwordx4 v[56:59], v1, s[4:7], s31 offen offset:3072 sc1
    s_add_u32 s31, s43, 2097152
    buffer_store_dword v56, v31, s[4:7], s31 offen sc1
    s_add_u32 s31, s43, 2113536
    buffer_store_dword v56, v31, s[4:7], s31 offen sc1
    s_add_u32 s31, s43, 2129920
    buffer_store_dword v56, v31, s[4:7], s31 offen sc1
    s_add_u32 s31, s43, 2146304
    buffer_store_dword v56, v31, s[4:7], s31 offen sc1
    v_mov_b32 v60, 0
    v_mov_b32 v61, 0
    v_mov_b32 v62, 0
    v_mov_b32 v63, 0
    s_lshl_b32 s31, s28, 12
    s_lshl_b32 s32, s29, 10
    s_add_u32 s31, s31, s32
    s_add_u32 s31, s31, 0
    buffer_store_dwordx4 v[60:63], v1, s[4:7], s31 offen sc1
    s_waitcnt vmcnt(25)
    v_add_u32 v26, 49152, v48
    ds_read_b64_tr_b16 v[160:161], v26 offset:0
    ds_read_b64_tr_b16 v[162:163], v26 offset:256
    ds_read_b64_tr_b16 v[164:165], v26 offset:1024
    ds_read_b64_tr_b16 v[166:167], v26 offset:1280
    v_add_u32 v26, 49152, v49
    ds_read_b64_tr_b16 v[32:33], v26 offset:0
    ds_read_b64_tr_b16 v[34:35], v26 offset:256
    ds_read_b64_tr_b16 v[36:37], v26 offset:1024
    ds_read_b64_tr_b16 v[38:39], v26 offset:1280
    v_add_u32 v26, 49152, v50
    ds_read_b64_tr_b16 v[208:209], v26 offset:0
    ds_read_b64_tr_b16 v[210:211], v26 offset:256
    ds_read_b64_tr_b16 v[212:213], v26 offset:1024
    ds_read_b64_tr_b16 v[214:215], v26 offset:1280
    v_add_u32 v26, 49152, v51
    ds_read_b64_tr_b16 v[224:225], v26 offset:0
    ds_read_b64_tr_b16 v[226:227], v26 offset:256
    ds_read_b64_tr_b16 v[228:229], v26 offset:1024
    ds_read_b64_tr_b16 v[230:231], v26 offset:1280
    s_waitcnt lgkmcnt(0)
    ds_write_b128 v2, v[32:35] offset:0
    ds_write_b128 v2, v[36:39] offset:1024
    s_mul_i32 s31, s66, 72
    s_add_u32 s31, s31, s46
    s_add_u32 s31, s31, 0
    s_add_u32 m0, s47, 49152
    s_nop 0
    buffer_load_dwordx4 v21, s[16:19], s31 offen lds
    s_mul_i32 s31, s66, 72
    s_add_u32 s31, s31, s46
    s_add_u32 s31, s31, 9216
    s_add_u32 m0, s47, 50176
    s_nop 0
    buffer_load_dwordx4 v21, s[16:19], s31 offen lds
    s_mul_i32 s31, s66, 72
    s_add_u32 s31, s31, s46
    s_add_u32 s31, s31, 18432
    s_add_u32 m0, s47, 51200
    s_nop 0
    buffer_load_dwordx4 v21, s[16:19], s31 offen lds
    s_mul_i32 s31, s66, 72
    s_add_u32 s31, s31, s46
    s_add_u32 s31, s31, 27648
    s_add_u32 m0, s47, 52224
    s_nop 0
    buffer_load_dwordx4 v21, s[16:19], s31 offen lds
    s_mul_i32 s31, s66, 72
    s_add_u32 s31, s31, s46
    s_add_u32 s31, s31, 128
    s_add_u32 m0, s47, 65536
    s_nop 0
    buffer_load_dwordx4 v21, s[16:19], s31 offen lds
    s_mul_i32 s31, s66, 72
    s_add_u32 s31, s31, s46
    s_add_u32 s31, s31, 9344
    s_add_u32 m0, s47, 66560
    s_nop 0
    buffer_load_dwordx4 v21, s[16:19], s31 offen lds
    s_mul_i32 s31, s66, 72
    s_add_u32 s31, s31, s46
    s_add_u32 s31, s31, 18560
    s_add_u32 m0, s47, 67584
    s_nop 0
    buffer_load_dwordx4 v21, s[16:19], s31 offen lds
    s_mul_i32 s31, s66, 72
    s_add_u32 s31, s31, s46
    s_add_u32 s31, s31, 27776
    s_add_u32 m0, s47, 68608
    s_nop 0
    buffer_load_dwordx4 v21, s[16:19], s31 offen lds
    s_mul_i32 s31, s66, 72
    s_add_u32 s31, s31, s46
    s_add_u32 s31, s31, 256
    s_add_u32 m0, s47, 81920
    s_nop 0
    buffer_load_dwordx4 v21, s[16:19], s31 offen lds
    s_mul_i32 s31, s66, 72
    s_add_u32 s31, s31, s46
    s_add_u32 s31, s31, 9472
    s_add_u32 m0, s47, 82944
    s_nop 0
    buffer_load_dwordx4 v21, s[16:19], s31 offen lds
    s_mul_i32 s31, s66, 72
    s_add_u32 s31, s31, s46
    s_add_u32 s31, s31, 18688
    s_add_u32 m0, s47, 83968
    s_nop 0
    buffer_load_dwordx4 v21, s[16:19], s31 offen lds
    s_mul_i32 s31, s66, 72
    s_add_u32 s31, s31, s46
    s_add_u32 s31, s31, 27904
    s_add_u32 m0, s47, 84992
    s_nop 0
    buffer_load_dwordx4 v21, s[16:19], s31 offen lds
    s_waitcnt vmcnt(25)
    v_add_u32 v26, 98304, v48
    ds_read_b64_tr_b16 v[168:169], v26 offset:0
    ds_read_b64_tr_b16 v[170:171], v26 offset:256
    ds_read_b64_tr_b16 v[172:173], v26 offset:1024
    ds_read_b64_tr_b16 v[174:175], v26 offset:1280
    v_add_u32 v26, 98304, v49
    ds_read_b64_tr_b16 v[32:33], v26 offset:0
    ds_read_b64_tr_b16 v[34:35], v26 offset:256
    ds_read_b64_tr_b16 v[36:37], v26 offset:1024
    ds_read_b64_tr_b16 v[38:39], v26 offset:1280
    v_add_u32 v26, 98304, v50
    ds_read_b64_tr_b16 v[216:217], v26 offset:0
    ds_read_b64_tr_b16 v[218:219], v26 offset:256
    ds_read_b64_tr_b16 v[220:221], v26 offset:1024
    ds_read_b64_tr_b16 v[222:223], v26 offset:1280
    v_add_u32 v26, 98304, v51
    ds_read_b64_tr_b16 v[232:233], v26 offset:0
    ds_read_b64_tr_b16 v[234:235], v26 offset:256
    ds_read_b64_tr_b16 v[236:237], v26 offset:1024
    ds_read_b64_tr_b16 v[238:239], v26 offset:1280
    s_waitcnt lgkmcnt(0)
    ds_write_b128 v2, v[32:35] offset:2048
    ds_write_b128 v2, v[36:39] offset:3072
    s_mul_i32 s31, s67, 72
    s_add_u32 s31, s31, s46
    s_add_u32 s31, s31, 0
    s_add_u32 m0, s47, 98304
    s_nop 0
    buffer_load_dwordx4 v21, s[16:19], s31 offen lds
    s_mul_i32 s31, s67, 72
    s_add_u32 s31, s31, s46
    s_add_u32 s31, s31, 9216
    s_add_u32 m0, s47, 99328
    s_nop 0
    buffer_load_dwordx4 v21, s[16:19], s31 offen lds
    s_mul_i32 s31, s67, 72
    s_add_u32 s31, s31, s46
    s_add_u32 s31, s31, 18432
    s_add_u32 m0, s47, 100352
    s_nop 0
    buffer_load_dwordx4 v21, s[16:19], s31 offen lds
    s_mul_i32 s31, s67, 72
    s_add_u32 s31, s31, s46
    s_add_u32 s31, s31, 27648
    s_add_u32 m0, s47, 101376
    s_nop 0
    buffer_load_dwordx4 v21, s[16:19], s31 offen lds
    s_mul_i32 s31, s67, 72
    s_add_u32 s31, s31, s46
    s_add_u32 s31, s31, 128
    s_add_u32 m0, s47, 114688
    s_nop 0
    buffer_load_dwordx4 v21, s[16:19], s31 offen lds
    s_mul_i32 s31, s67, 72
    s_add_u32 s31, s31, s46
    s_add_u32 s31, s31, 9344
    s_add_u32 m0, s47, 115712
    s_nop 0
    buffer_load_dwordx4 v21, s[16:19], s31 offen lds
    s_mul_i32 s31, s67, 72
    s_add_u32 s31, s31, s46
    s_add_u32 s31, s31, 18560
    s_add_u32 m0, s47, 116736
    s_nop 0
    buffer_load_dwordx4 v21, s[16:19], s31 offen lds
    s_mul_i32 s31, s67, 72
    s_add_u32 s31, s31, s46
    s_add_u32 s31, s31, 27776
    s_add_u32 m0, s47, 117760
    s_nop 0
    buffer_load_dwordx4 v21, s[16:19], s31 offen lds
    s_mul_i32 s31, s67, 72
    s_add_u32 s31, s31, s46
    s_add_u32 s31, s31, 256
    s_add_u32 m0, s47, 131072
    s_nop 0
    buffer_load_dwordx4 v21, s[16:19], s31 offen lds
    s_mul_i32 s31, s67, 72
    s_add_u32 s31, s31, s46
    s_add_u32 s31, s31, 9472
    s_add_u32 m0, s47, 132096
    s_nop 0
    buffer_load_dwordx4 v21, s[16:19], s31 offen lds
    s_mul_i32 s31, s67, 72
    s_add_u32 s31, s31, s46
    s_add_u32 s31, s31, 18688
    s_add_u32 m0, s47, 133120
    s_nop 0
    buffer_load_dwordx4 v21, s[16:19], s31 offen lds
    s_mul_i32 s31, s67, 72
    s_add_u32 s31, s31, s46
    s_add_u32 s31, s31, 27904
    s_add_u32 m0, s47, 134144
    s_nop 0
    buffer_load_dwordx4 v21, s[16:19], s31 offen lds
    s_lshl_b32 s31, s29, 5
    s_add_u32 s31, s31, s46
    s_add_u32 s31, s31, 256
    s_add_u32 m0, s47, 147456
    s_nop 0
    buffer_load_dwordx4 v22, s[16:19], s31 offen lds
    s_lshl_b32 s31, s29, 5
    s_add_u32 s31, s31, s46
    s_add_u32 s31, s31, 37120
    s_add_u32 m0, s47, 148480
    s_nop 0
    buffer_load_dwordx4 v22, s[16:19], s31 offen lds
    s_lshl_b32 s31, s29, 5
    s_add_u32 s31, s31, s46
    s_add_u32 s31, s31, 73984
    s_add_u32 m0, s47, 149504
    s_nop 0
    buffer_load_dwordx4 v22, s[16:19], s31 offen lds
    s_lshl_b32 s31, s29, 5
    s_add_u32 s31, s31, s46
    s_add_u32 s31, s31, 110848
    s_add_u32 m0, s47, 150528
    s_nop 0
    buffer_load_dwordx4 v22, s[16:19], s31 offen lds
    s_waitcnt vmcnt(16)
    s_add_u32 s31, s94, 1
    v_mov_b32 v56, s31
    v_mov_b32 v57, 160
    s_mov_b64 exec, 1
    buffer_atomic_add v56, v57, s[20:23], 0 offen
    s_mov_b64 exec, -1
    v_add_u32 v26, 49152, v48
    ds_read_b64_tr_b16 v[176:177], v26 offset:0
    ds_read_b64_tr_b16 v[178:179], v26 offset:256
    ds_read_b64_tr_b16 v[180:181], v26 offset:1024
    ds_read_b64_tr_b16 v[182:183], v26 offset:1280
    v_add_u32 v26, 49152, v49
    ds_read_b64_tr_b16 v[192:193], v26 offset:0
    ds_read_b64_tr_b16 v[194:195], v26 offset:256
    ds_read_b64_tr_b16 v[196:197], v26 offset:1024
    ds_read_b64_tr_b16 v[198:199], v26 offset:1280
    v_add_u32 v26, 49152, v50
    ds_read_b64_tr_b16 v[32:33], v26 offset:0
    ds_read_b64_tr_b16 v[34:35], v26 offset:256
    ds_read_b64_tr_b16 v[36:37], v26 offset:1024
    ds_read_b64_tr_b16 v[38:39], v26 offset:1280
    v_add_u32 v26, 49152, v51
    ds_read_b64_tr_b16 v[40:41], v26 offset:0
    ds_read_b64_tr_b16 v[42:43], v26 offset:256
    ds_read_b64_tr_b16 v[44:45], v26 offset:1024
    ds_read_b64_tr_b16 v[46:47], v26 offset:1280
    s_waitcnt lgkmcnt(0)
    ds_write_b128 v2, v[32:35] offset:16384
    ds_write_b128 v2, v[36:39] offset:17408
    ds_write_b128 v2, v[40:43] offset:32768
    ds_write_b128 v2, v[44:47] offset:33792
    s_add_u32 s31, s45, 0
    s_add_u32 m0, s47, 65536
    s_nop 0
    buffer_load_dwordx4 v28, s[12:15], s31 offen lds
    s_add_u32 s31, s45, 131072
    s_add_u32 m0, s47, 66560
    s_nop 0
    buffer_load_dwordx4 v28, s[12:15], s31 offen lds
    s_add_u32 s31, s45, 262144
    s_add_u32 m0, s47, 67584
    s_nop 0
    buffer_load_dwordx4 v28, s[12:15], s31 offen lds
    s_add_u32 s31, s45, 393216
    s_add_u32 m0, s47, 68608
    s_nop 0
    buffer_load_dwordx4 v28, s[12:15], s31 offen lds
    s_add_u32 s31, s45, 524288
    s_add_u32 m0, s47, 81920
    s_nop 0
    buffer_load_dwordx4 v28, s[12:15], s31 offen lds
    s_add_u32 s31, s45, 655360
    s_add_u32 m0, s47, 82944
    s_nop 0
    buffer_load_dwordx4 v28, s[12:15], s31 offen lds
    s_add_u32 s31, s45, 786432
    s_add_u32 m0, s47, 83968
    s_nop 0
    buffer_load_dwordx4 v28, s[12:15], s31 offen lds
    s_add_u32 s31, s45, 917504
    s_add_u32 m0, s47, 84992
    s_nop 0
    buffer_load_dwordx4 v28, s[12:15], s31 offen lds
    s_add_u32 s31, s45, 1048576
    s_add_u32 m0, s47, 49152
    s_nop 0
    buffer_load_dwordx4 v28, s[12:15], s31 offen lds
    s_add_u32 s31, s45, 1179648
    s_add_u32 m0, s47, 50176
    s_nop 0
    buffer_load_dwordx4 v28, s[12:15], s31 offen lds
    s_add_u32 s31, s45, 1310720
    s_add_u32 m0, s47, 51200
    s_nop 0
    buffer_load_dwordx4 v28, s[12:15], s31 offen lds
    s_add_u32 s31, s45, 1441792
    s_add_u32 m0, s47, 52224
    s_nop 0
    buffer_load_dwordx4 v28, s[12:15], s31 offen lds
    s_waitcnt vmcnt(17)
    v_add_u32 v26, 98304, v48
    ds_read_b64_tr_b16 v[184:185], v26 offset:0
    ds_read_b64_tr_b16 v[186:187], v26 offset:256
    ds_read_b64_tr_b16 v[188:189], v26 offset:1024
    ds_read_b64_tr_b16 v[190:191], v26 offset:1280
    v_add_u32 v26, 98304, v49
    ds_read_b64_tr_b16 v[200:201], v26 offset:0
    ds_read_b64_tr_b16 v[202:203], v26 offset:256
    ds_read_b64_tr_b16 v[204:205], v26 offset:1024
    ds_read_b64_tr_b16 v[206:207], v26 offset:1280
    v_add_u32 v26, 98304, v50
    ds_read_b64_tr_b16 v[32:33], v26 offset:0
    ds_read_b64_tr_b16 v[34:35], v26 offset:256
    ds_read_b64_tr_b16 v[36:37], v26 offset:1024
    ds_read_b64_tr_b16 v[38:39], v26 offset:1280
    v_add_u32 v26, 98304, v51
    ds_read_b64_tr_b16 v[40:41], v26 offset:0
    ds_read_b64_tr_b16 v[42:43], v26 offset:256
    ds_read_b64_tr_b16 v[44:45], v26 offset:1024
    ds_read_b64_tr_b16 v[46:47], v26 offset:1280
    s_waitcnt lgkmcnt(0)
    ds_write_b128 v2, v[32:35] offset:18432
    ds_write_b128 v2, v[36:39] offset:19456
    ds_write_b128 v2, v[40:43] offset:34816
    ds_write_b128 v2, v[44:47] offset:35840
    s_add_u32 s31, s45, 1572864
    s_add_u32 m0, s47, 131072
    s_nop 0
    buffer_load_dwordx4 v28, s[12:15], s31 offen lds
    s_add_u32 s31, s45, 1703936
    s_add_u32 m0, s47, 132096
    s_nop 0
    buffer_load_dwordx4 v28, s[12:15], s31 offen lds
    s_add_u32 s31, s45, 1835008
    s_add_u32 m0, s47, 133120
    s_nop 0
    buffer_load_dwordx4 v28, s[12:15], s31 offen lds
    s_add_u32 s31, s45, 1966080
    s_add_u32 m0, s47, 134144
    s_nop 0
    buffer_load_dwordx4 v28, s[12:15], s31 offen lds
    s_add_u32 s31, s45, 2097152
    s_add_u32 m0, s47, 114688
    s_nop 0
    buffer_load_dwordx4 v28, s[12:15], s31 offen lds
    s_add_u32 s31, s45, 2228224
    s_add_u32 m0, s47, 115712
    s_nop 0
    buffer_load_dwordx4 v28, s[12:15], s31 offen lds
    s_add_u32 s31, s45, 2359296
    s_add_u32 m0, s47, 116736
    s_nop 0
    buffer_load_dwordx4 v28, s[12:15], s31 offen lds
    s_add_u32 s31, s45, 2490368
    s_add_u32 m0, s47, 117760
    s_nop 0
    buffer_load_dwordx4 v28, s[12:15], s31 offen lds
    s_add_u32 s31, s45, 2621440
    s_add_u32 m0, s47, 98304
    s_nop 0
    buffer_load_dwordx4 v28, s[12:15], s31 offen lds
    s_add_u32 s31, s45, 2752512
    s_add_u32 m0, s47, 99328
    s_nop 0
    buffer_load_dwordx4 v28, s[12:15], s31 offen lds
    s_add_u32 s31, s45, 2883584
    s_add_u32 m0, s47, 100352
    s_nop 0
    buffer_load_dwordx4 v28, s[12:15], s31 offen lds
    s_add_u32 s31, s45, 3014656
    s_add_u32 m0, s47, 101376
    s_nop 0
    buffer_load_dwordx4 v28, s[12:15], s31 offen lds
    s_waitcnt vmcnt(25)
    v_add_u32 v26, 147456, v25
    ds_read_b64_tr_b16 v[240:241], v26 offset:0
    ds_read_b64_tr_b16 v[242:243], v26 offset:64
    ds_read_b64_tr_b16 v[244:245], v26 offset:256
    ds_read_b64_tr_b16 v[246:247], v26 offset:320
    ds_read_b64_tr_b16 v[248:249], v26 offset:2048
    ds_read_b64_tr_b16 v[250:251], v26 offset:2112
    ds_read_b64_tr_b16 v[252:253], v26 offset:2304
    ds_read_b64_tr_b16 v[254:255], v26 offset:2368
    s_waitcnt lgkmcnt(0)
    s_add_u32 s31, s45, 3145728
    s_add_u32 m0, s47, 147456
    s_nop 0
    buffer_load_dwordx4 v28, s[12:15], s31 offen lds
    s_add_u32 s31, s45, 3276800
    s_add_u32 m0, s47, 148480
    s_nop 0
    buffer_load_dwordx4 v28, s[12:15], s31 offen lds
    s_add_u32 s31, s45, 3407872
    s_add_u32 m0, s47, 149504
    s_nop 0
    buffer_load_dwordx4 v28, s[12:15], s31 offen lds
    s_add_u32 s31, s45, 3538944
    s_add_u32 m0, s47, 150528
    s_nop 0
    buffer_load_dwordx4 v28, s[12:15], s31 offen lds
    s_waitcnt vmcnt(24)
    v_add_u32 v26, 65536, v29
    ds_read_b64_tr_b16 a[208:209], v26 offset:0
    ds_read_b64_tr_b16 a[210:211], v26 offset:256
    ds_read_b64_tr_b16 a[212:213], v26 offset:2048
    ds_read_b64_tr_b16 a[214:215], v26 offset:2304
    ds_read_b64_tr_b16 a[216:217], v26 offset:32
    ds_read_b64_tr_b16 a[218:219], v26 offset:288
    ds_read_b64_tr_b16 a[220:221], v26 offset:2080
    ds_read_b64_tr_b16 a[222:223], v26 offset:2336
    s_waitcnt lgkmcnt(0)
    s_add_u32 s31, s45, 3670016
    s_add_u32 m0, s47, 65536
    s_nop 0
    buffer_load_dwordx4 v28, s[12:15], s31 offen lds
    s_add_u32 s31, s45, 3801088
    s_add_u32 m0, s47, 66560
    s_nop 0
    buffer_load_dwordx4 v28, s[12:15], s31 offen lds
    s_add_u32 s31, s45, 3932160
    s_add_u32 m0, s47, 67584
    s_nop 0
    buffer_load_dwordx4 v28, s[12:15], s31 offen lds
    s_add_u32 s31, s45, 4063232
    s_add_u32 m0, s47, 68608
    s_nop 0
    buffer_load_dwordx4 v28, s[12:15], s31 offen lds
    s_waitcnt vmcnt(24)
    v_and_b32 v30, 7, v27
    v_mul_u32_u24 v30, 1152, v30
    v_lshl_add_u32 v30, v17, 5, v30
    s_lshr_b32 s31, s54, 3
    buffer_load_dwordx4 v[32:35], v30, s[24:27], s31 offen offset:0
    buffer_load_dwordx4 v[36:39], v30, s[24:27], s31 offen offset:16
    buffer_load_dwordx4 v[40:43], v30, s[24:27], s31 offen offset:128
    buffer_load_dwordx4 v[44:47], v30, s[24:27], s31 offen offset:144
    buffer_load_dwordx4 v[48:51], v30, s[24:27], s31 offen offset:256
    buffer_load_dwordx4 v[52:55], v30, s[24:27], s31 offen offset:272
    v_mov_b32 v30, 160
    buffer_load_dword v24, v30, s[20:23], 0 offen sc1
    v_add_u32 v26, 81920, v29
    ds_read_b64_tr_b16 a[224:225], v26 offset:0
    ds_read_b64_tr_b16 a[226:227], v26 offset:256
    ds_read_b64_tr_b16 a[228:229], v26 offset:2048
    ds_read_b64_tr_b16 a[230:231], v26 offset:2304
    ds_read_b64_tr_b16 a[232:233], v26 offset:32
    ds_read_b64_tr_b16 a[234:235], v26 offset:288
    ds_read_b64_tr_b16 a[236:237], v26 offset:2080
    ds_read_b64_tr_b16 a[238:239], v26 offset:2336
    s_waitcnt lgkmcnt(0)
    s_add_u32 s31, s45, 4194304
    s_add_u32 m0, s47, 81920
    s_nop 0
    buffer_load_dwordx4 v28, s[12:15], s31 offen lds
    s_add_u32 s31, s45, 4325376
    s_add_u32 m0, s47, 82944
    s_nop 0
    buffer_load_dwordx4 v28, s[12:15], s31 offen lds
    s_add_u32 s31, s45, 4456448
    s_add_u32 m0, s47, 83968
    s_nop 0
    buffer_load_dwordx4 v28, s[12:15], s31 offen lds
    s_add_u32 s31, s45, 4587520
    s_add_u32 m0, s47, 84992
    s_nop 0
    buffer_load_dwordx4 v28, s[12:15], s31 offen lds
    s_waitcnt vmcnt(31)
    v_add_u32 v26, 49152, v29
    ds_read_b64_tr_b16 a[240:241], v26 offset:0
    ds_read_b64_tr_b16 a[242:243], v26 offset:256
    ds_read_b64_tr_b16 a[244:245], v26 offset:2048
    ds_read_b64_tr_b16 a[246:247], v26 offset:2304
    ds_read_b64_tr_b16 a[248:249], v26 offset:32
    ds_read_b64_tr_b16 a[250:251], v26 offset:288
    ds_read_b64_tr_b16 a[252:253], v26 offset:2080
    ds_read_b64_tr_b16 a[254:255], v26 offset:2336
    s_waitcnt lgkmcnt(0)
    s_waitcnt vmcnt(27)
    v_add_u32 v26, 131072, v29
    ds_read_b64_tr_b16 v[64:65], v26 offset:0
    ds_read_b64_tr_b16 v[66:67], v26 offset:256
    ds_read_b64_tr_b16 v[68:69], v26 offset:2048
    ds_read_b64_tr_b16 v[70:71], v26 offset:2304
    ds_read_b64_tr_b16 v[72:73], v26 offset:32
    ds_read_b64_tr_b16 v[74:75], v26 offset:288
    ds_read_b64_tr_b16 v[76:77], v26 offset:2080
    ds_read_b64_tr_b16 v[78:79], v26 offset:2336
    s_waitcnt lgkmcnt(0)
    s_lshl_b32 s31, s55, 9
    s_add_u32 s31, s31, s44
    s_add_u32 s31, s31, 0
    s_add_u32 m0, s47, 131072
    s_nop 0
    buffer_load_dwordx4 v20, s[8:11], s31 offen lds
    s_lshl_b32 s31, s55, 9
    s_add_u32 s31, s31, s44
    s_add_u32 s31, s31, 65536
    s_add_u32 m0, s47, 132096
    s_nop 0
    buffer_load_dwordx4 v20, s[8:11], s31 offen lds
    s_lshl_b32 s31, s55, 9
    s_add_u32 s31, s31, s44
    s_add_u32 s31, s31, 131072
    s_add_u32 m0, s47, 133120
    s_nop 0
    buffer_load_dwordx4 v20, s[8:11], s31 offen lds
    s_lshl_b32 s31, s55, 9
    s_add_u32 s31, s31, s44
    s_add_u32 s31, s31, 196608
    s_add_u32 m0, s47, 134144
    s_nop 0
    buffer_load_dwordx4 v20, s[8:11], s31 offen lds
    s_lshl_b32 s31, s55, 9
    s_add_u32 s31, s31, s44
    s_add_u32 s31, s31, 262144
    s_add_u32 m0, s47, 49152
    s_nop 0
    buffer_load_dwordx4 v20, s[8:11], s31 offen lds
    s_lshl_b32 s31, s55, 9
    s_add_u32 s31, s31, s44
    s_add_u32 s31, s31, 327680
    s_add_u32 m0, s47, 50176
    s_nop 0
    buffer_load_dwordx4 v20, s[8:11], s31 offen lds
    s_lshl_b32 s31, s55, 9
    s_add_u32 s31, s31, s44
    s_add_u32 s31, s31, 393216
    s_add_u32 m0, s47, 51200
    s_nop 0
    buffer_load_dwordx4 v20, s[8:11], s31 offen lds
    s_lshl_b32 s31, s55, 9
    s_add_u32 s31, s31, s44
    s_add_u32 s31, s31, 458752
    s_add_u32 m0, s47, 52224
    s_nop 0
    buffer_load_dwordx4 v20, s[8:11], s31 offen lds
    s_waitcnt vmcnt(31)
    v_add_u32 v26, 114688, v29
    ds_read_b64_tr_b16 v[80:81], v26 offset:0
    ds_read_b64_tr_b16 v[82:83], v26 offset:256
    ds_read_b64_tr_b16 v[84:85], v26 offset:2048
    ds_read_b64_tr_b16 v[86:87], v26 offset:2304
    ds_read_b64_tr_b16 v[88:89], v26 offset:32
    ds_read_b64_tr_b16 v[90:91], v26 offset:288
    ds_read_b64_tr_b16 v[92:93], v26 offset:2080
    ds_read_b64_tr_b16 v[94:95], v26 offset:2336
    s_waitcnt lgkmcnt(0)
    s_waitcnt vmcnt(27)
    v_add_u32 v26, 98304, v29
    ds_read_b64_tr_b16 v[96:97], v26 offset:0
    ds_read_b64_tr_b16 v[98:99], v26 offset:256
    ds_read_b64_tr_b16 v[100:101], v26 offset:2048
    ds_read_b64_tr_b16 v[102:103], v26 offset:2304
    ds_read_b64_tr_b16 v[104:105], v26 offset:32
    ds_read_b64_tr_b16 v[106:107], v26 offset:288
    ds_read_b64_tr_b16 v[108:109], v26 offset:2080
    ds_read_b64_tr_b16 v[110:111], v26 offset:2336
    s_waitcnt lgkmcnt(0)
    s_lshl_b32 s31, s57, 9
    s_add_u32 s31, s31, s44
    s_add_u32 s31, s31, 0
    s_add_u32 m0, s47, 114688
    s_nop 0
    buffer_load_dwordx4 v20, s[8:11], s31 offen lds
    s_lshl_b32 s31, s57, 9
    s_add_u32 s31, s31, s44
    s_add_u32 s31, s31, 65536
    s_add_u32 m0, s47, 115712
    s_nop 0
    buffer_load_dwordx4 v20, s[8:11], s31 offen lds
    s_lshl_b32 s31, s57, 9
    s_add_u32 s31, s31, s44
    s_add_u32 s31, s31, 131072
    s_add_u32 m0, s47, 116736
    s_nop 0
    buffer_load_dwordx4 v20, s[8:11], s31 offen lds
    s_lshl_b32 s31, s57, 9
    s_add_u32 s31, s31, s44
    s_add_u32 s31, s31, 196608
    s_add_u32 m0, s47, 117760
    s_nop 0
    buffer_load_dwordx4 v20, s[8:11], s31 offen lds
    s_lshl_b32 s31, s57, 9
    s_add_u32 s31, s31, s44
    s_add_u32 s31, s31, 262144
    s_add_u32 m0, s47, 98304
    s_nop 0
    buffer_load_dwordx4 v20, s[8:11], s31 offen lds
    s_lshl_b32 s31, s57, 9
    s_add_u32 s31, s31, s44
    s_add_u32 s31, s31, 327680
    s_add_u32 m0, s47, 99328
    s_nop 0
    buffer_load_dwordx4 v20, s[8:11], s31 offen lds
    s_lshl_b32 s31, s57, 9
    s_add_u32 s31, s31, s44
    s_add_u32 s31, s31, 393216
    s_add_u32 m0, s47, 100352
    s_nop 0
    buffer_load_dwordx4 v20, s[8:11], s31 offen lds
    s_lshl_b32 s31, s57, 9
    s_add_u32 s31, s31, s44
    s_add_u32 s31, s31, 458752
    s_add_u32 m0, s47, 101376
    s_nop 0
    buffer_load_dwordx4 v20, s[8:11], s31 offen lds
    s_waitcnt vmcnt(31)
    v_add_u32 v26, 147456, v29
    ds_read_b64_tr_b16 v[112:113], v26 offset:0
    ds_read_b64_tr_b16 v[114:115], v26 offset:256
    ds_read_b64_tr_b16 v[116:117], v26 offset:2048
    ds_read_b64_tr_b16 v[118:119], v26 offset:2304
    ds_read_b64_tr_b16 v[120:121], v26 offset:32
    ds_read_b64_tr_b16 v[122:123], v26 offset:288
    ds_read_b64_tr_b16 v[124:125], v26 offset:2080
    ds_read_b64_tr_b16 v[126:127], v26 offset:2336
    s_waitcnt lgkmcnt(0)
    s_waitcnt vmcnt(27)
    v_add_u32 v26, 65536, v29
    ds_read_b64_tr_b16 v[128:129], v26 offset:0
    ds_read_b64_tr_b16 v[130:131], v26 offset:256
    ds_read_b64_tr_b16 v[132:133], v26 offset:2048
    ds_read_b64_tr_b16 v[134:135], v26 offset:2304
    ds_read_b64_tr_b16 v[136:137], v26 offset:32
    ds_read_b64_tr_b16 v[138:139], v26 offset:288
    ds_read_b64_tr_b16 v[140:141], v26 offset:2080
    ds_read_b64_tr_b16 v[142:143], v26 offset:2336
    s_waitcnt lgkmcnt(0)
    s_lshl_b32 s31, s59, 9
    s_add_u32 s31, s31, s44
    s_add_u32 s31, s31, 0
    s_add_u32 m0, s47, 65536
    s_nop 0
    buffer_load_dwordx4 v20, s[8:11], s31 offen lds
    s_lshl_b32 s31, s59, 9
    s_add_u32 s31, s31, s44
    s_add_u32 s31, s31, 65536
    s_add_u32 m0, s47, 66560
    s_nop 0
    buffer_load_dwordx4 v20, s[8:11], s31 offen lds
    s_lshl_b32 s31, s59, 9
    s_add_u32 s31, s31, s44
    s_add_u32 s31, s31, 131072
    s_add_u32 m0, s47, 67584
    s_nop 0
    buffer_load_dwordx4 v20, s[8:11], s31 offen lds
    s_lshl_b32 s31, s59, 9
    s_add_u32 s31, s31, s44
    s_add_u32 s31, s31, 196608
    s_add_u32 m0, s47, 68608
    s_nop 0
    buffer_load_dwordx4 v20, s[8:11], s31 offen lds
    s_lshl_b32 s31, s59, 9
    s_add_u32 s31, s31, s44
    s_add_u32 s31, s31, 262144
    s_add_u32 m0, s47, 147456
    s_nop 0
    buffer_load_dwordx4 v20, s[8:11], s31 offen lds
    s_lshl_b32 s31, s59, 9
    s_add_u32 s31, s31, s44
    s_add_u32 s31, s31, 327680
    s_add_u32 m0, s47, 148480
    s_nop 0
    buffer_load_dwordx4 v20, s[8:11], s31 offen lds
    s_lshl_b32 s31, s59, 9
    s_add_u32 s31, s31, s44
    s_add_u32 s31, s31, 393216
    s_add_u32 m0, s47, 149504
    s_nop 0
    buffer_load_dwordx4 v20, s[8:11], s31 offen lds
    s_lshl_b32 s31, s59, 9
    s_add_u32 s31, s31, s44
    s_add_u32 s31, s31, 458752
    s_add_u32 m0, s47, 150528
    s_nop 0
    buffer_load_dwordx4 v20, s[8:11], s31 offen lds
    s_waitcnt vmcnt(24)
    v_mov_b32 v30, 0x05040100
    v_mov_b32 v26, 0x07060302
    v_cmp_ne_u32 vcc, 0x4444, v0
    v_readfirstlane_b32 s86, v24
    s_nop 1
    v_cndmask_b32 v30, v30, v26, vcc
    v_perm_b32 v56, v33, v32, v30
    v_min_u32 v56, -2, v56
    v_perm_b32 v57, v35, v34, v30
    v_min_u32 v57, -2, v57
    v_perm_b32 v58, v37, v36, v30
    v_min_u32 v58, -2, v58
    v_perm_b32 v59, v39, v38, v30
    v_min_u32 v59, -2, v59
    v_perm_b32 v60, v41, v40, v30
    v_min_u32 v60, -2, v60
    v_perm_b32 v61, v43, v42, v30
    v_min_u32 v61, -2, v61
    v_perm_b32 v62, v45, v44, v30
    v_min_u32 v62, -2, v62
    v_perm_b32 v63, v47, v46, v30
    v_min_u32 v63, -2, v63
    v_perm_b32 v12, v49, v48, v30
    v_min_u32 v12, -2, v12
    v_perm_b32 v13, v51, v50, v30
    v_min_u32 v13, -2, v13
    v_perm_b32 v14, v53, v52, v30
    v_min_u32 v14, -2, v14
    v_perm_b32 v15, v55, v54, v30
    v_min_u32 v15, -2, v15
    v_add_u32 v26, 81920, v29
    ds_read_b64_tr_b16 v[144:145], v26 offset:0
    ds_read_b64_tr_b16 v[146:147], v26 offset:256
    ds_read_b64_tr_b16 v[148:149], v26 offset:2048
    ds_read_b64_tr_b16 v[150:151], v26 offset:2304
    ds_read_b64_tr_b16 v[152:153], v26 offset:32
    ds_read_b64_tr_b16 v[154:155], v26 offset:288
    ds_read_b64_tr_b16 v[156:157], v26 offset:2080
    ds_read_b64_tr_b16 v[158:159], v26 offset:2336
    s_waitcnt lgkmcnt(0)
    s_waitcnt vmcnt(16)
    v_add_u32 v26, 131072, v23
    ds_read_b64_tr_b16 a[16:17], v26 offset:0
    ds_read_b64_tr_b16 a[18:19], v26 offset:512
    ds_read_b64_tr_b16 a[24:25], v26 offset:32
    ds_read_b64_tr_b16 a[26:27], v26 offset:544
    ds_read_b64_tr_b16 a[32:33], v26 offset:64
    ds_read_b64_tr_b16 a[34:35], v26 offset:576
    ds_read_b64_tr_b16 a[40:41], v26 offset:96
    ds_read_b64_tr_b16 a[42:43], v26 offset:608
    v_add_u32 v26, 49152, v23
    ds_read_b64_tr_b16 a[20:21], v26 offset:0
    ds_read_b64_tr_b16 a[22:23], v26 offset:512
    ds_read_b64_tr_b16 a[28:29], v26 offset:32
    ds_read_b64_tr_b16 a[30:31], v26 offset:544
    ds_read_b64_tr_b16 a[36:37], v26 offset:64
    ds_read_b64_tr_b16 a[38:39], v26 offset:576
    ds_read_b64_tr_b16 a[44:45], v26 offset:96
    ds_read_b64_tr_b16 a[46:47], v26 offset:608
    s_waitcnt lgkmcnt(0)
    s_lshl_b32 s31, s61, 9
    s_add_u32 s31, s31, s44
    s_add_u32 s31, s31, 0
    s_add_u32 m0, s47, 81920
    s_nop 0
    buffer_load_dwordx4 v20, s[8:11], s31 offen lds
    s_lshl_b32 s31, s61, 9
    s_add_u32 s31, s31, s44
    s_add_u32 s31, s31, 65536
    s_add_u32 m0, s47, 82944
    s_nop 0
    buffer_load_dwordx4 v20, s[8:11], s31 offen lds
    s_lshl_b32 s31, s61, 9
    s_add_u32 s31, s31, s44
    s_add_u32 s31, s31, 131072
    s_add_u32 m0, s47, 83968
    s_nop 0
    buffer_load_dwordx4 v20, s[8:11], s31 offen lds
    s_lshl_b32 s31, s61, 9
    s_add_u32 s31, s31, s44
    s_add_u32 s31, s31, 196608
    s_add_u32 m0, s47, 84992
    s_nop 0
    buffer_load_dwordx4 v20, s[8:11], s31 offen lds
    s_lshl_b32 s31, s61, 9
    s_add_u32 s31, s31, s44
    s_add_u32 s31, s31, 262144
    s_add_u32 m0, s47, 131072
    s_nop 0
    buffer_load_dwordx4 v20, s[8:11], s31 offen lds
    s_lshl_b32 s31, s61, 9
    s_add_u32 s31, s31, s44
    s_add_u32 s31, s31, 327680
    s_add_u32 m0, s47, 132096
    s_nop 0
    buffer_load_dwordx4 v20, s[8:11], s31 offen lds
    s_lshl_b32 s31, s61, 9
    s_add_u32 s31, s31, s44
    s_add_u32 s31, s31, 393216
    s_add_u32 m0, s47, 133120
    s_nop 0
    buffer_load_dwordx4 v20, s[8:11], s31 offen lds
    s_lshl_b32 s31, s61, 9
    s_add_u32 s31, s31, s44
    s_add_u32 s31, s31, 458752
    s_add_u32 m0, s47, 134144
    s_nop 0
    buffer_load_dwordx4 v20, s[8:11], s31 offen lds
    s_waitcnt vmcnt(16)
    v_add_u32 v26, 114688, v23
    ds_read_b64_tr_b16 a[64:65], v26 offset:0
    ds_read_b64_tr_b16 a[66:67], v26 offset:512
    ds_read_b64_tr_b16 a[72:73], v26 offset:32
    ds_read_b64_tr_b16 a[74:75], v26 offset:544
    ds_read_b64_tr_b16 a[80:81], v26 offset:64
    ds_read_b64_tr_b16 a[82:83], v26 offset:576
    ds_read_b64_tr_b16 a[88:89], v26 offset:96
    ds_read_b64_tr_b16 a[90:91], v26 offset:608
    v_add_u32 v26, 98304, v23
    ds_read_b64_tr_b16 a[68:69], v26 offset:0
    ds_read_b64_tr_b16 a[70:71], v26 offset:512
    ds_read_b64_tr_b16 a[76:77], v26 offset:32
    ds_read_b64_tr_b16 a[78:79], v26 offset:544
    ds_read_b64_tr_b16 a[84:85], v26 offset:64
    ds_read_b64_tr_b16 a[86:87], v26 offset:576
    ds_read_b64_tr_b16 a[92:93], v26 offset:96
    ds_read_b64_tr_b16 a[94:95], v26 offset:608
    s_waitcnt lgkmcnt(0)
    s_lshl_b32 s31, s54, 9
    s_add_u32 s31, s31, s44
    s_add_u32 s31, s31, 0
    s_add_u32 m0, s47, 49152
    s_nop 0
    buffer_load_dwordx4 v20, s[8:11], s31 offen lds
    s_lshl_b32 s31, s54, 9
    s_add_u32 s31, s31, s44
    s_add_u32 s31, s31, 65536
    s_add_u32 m0, s47, 50176
    s_nop 0
    buffer_load_dwordx4 v20, s[8:11], s31 offen lds
    s_lshl_b32 s31, s54, 9
    s_add_u32 s31, s31, s44
    s_add_u32 s31, s31, 131072
    s_add_u32 m0, s47, 51200
    s_nop 0
    buffer_load_dwordx4 v20, s[8:11], s31 offen lds
    s_lshl_b32 s31, s54, 9
    s_add_u32 s31, s31, s44
    s_add_u32 s31, s31, 196608
    s_add_u32 m0, s47, 52224
    s_nop 0
    buffer_load_dwordx4 v20, s[8:11], s31 offen lds
    s_lshl_b32 s31, s54, 9
    s_add_u32 s31, s31, s44
    s_add_u32 s31, s31, 262144
    s_add_u32 m0, s47, 114688
    s_nop 0
    buffer_load_dwordx4 v20, s[8:11], s31 offen lds
    s_lshl_b32 s31, s54, 9
    s_add_u32 s31, s31, s44
    s_add_u32 s31, s31, 327680
    s_add_u32 m0, s47, 115712
    s_nop 0
    buffer_load_dwordx4 v20, s[8:11], s31 offen lds
    s_lshl_b32 s31, s54, 9
    s_add_u32 s31, s31, s44
    s_add_u32 s31, s31, 393216
    s_add_u32 m0, s47, 116736
    s_nop 0
    buffer_load_dwordx4 v20, s[8:11], s31 offen lds
    s_lshl_b32 s31, s54, 9
    s_add_u32 s31, s31, s44
    s_add_u32 s31, s31, 458752
    s_add_u32 m0, s47, 117760
    s_nop 0
    buffer_load_dwordx4 v20, s[8:11], s31 offen lds
    s_waitcnt vmcnt(16)
    v_add_u32 v26, 65536, v23
    ds_read_b64_tr_b16 a[112:113], v26 offset:0
    ds_read_b64_tr_b16 a[114:115], v26 offset:512
    ds_read_b64_tr_b16 a[120:121], v26 offset:32
    ds_read_b64_tr_b16 a[122:123], v26 offset:544
    ds_read_b64_tr_b16 a[128:129], v26 offset:64
    ds_read_b64_tr_b16 a[130:131], v26 offset:576
    ds_read_b64_tr_b16 a[136:137], v26 offset:96
    ds_read_b64_tr_b16 a[138:139], v26 offset:608
    v_add_u32 v26, 147456, v23
    ds_read_b64_tr_b16 a[116:117], v26 offset:0
    ds_read_b64_tr_b16 a[118:119], v26 offset:512
    ds_read_b64_tr_b16 a[124:125], v26 offset:32
    ds_read_b64_tr_b16 a[126:127], v26 offset:544
    ds_read_b64_tr_b16 a[132:133], v26 offset:64
    ds_read_b64_tr_b16 a[134:135], v26 offset:576
    ds_read_b64_tr_b16 a[140:141], v26 offset:96
    ds_read_b64_tr_b16 a[142:143], v26 offset:608
    s_waitcnt lgkmcnt(0)
    s_lshl_b32 s31, s56, 9
    s_add_u32 s31, s31, s44
    s_add_u32 s31, s31, 0
    s_add_u32 m0, s47, 98304
    s_nop 0
    buffer_load_dwordx4 v20, s[8:11], s31 offen lds
    s_lshl_b32 s31, s56, 9
    s_add_u32 s31, s31, s44
    s_add_u32 s31, s31, 65536
    s_add_u32 m0, s47, 99328
    s_nop 0
    buffer_load_dwordx4 v20, s[8:11], s31 offen lds
    s_lshl_b32 s31, s56, 9
    s_add_u32 s31, s31, s44
    s_add_u32 s31, s31, 131072
    s_add_u32 m0, s47, 100352
    s_nop 0
    buffer_load_dwordx4 v20, s[8:11], s31 offen lds
    s_lshl_b32 s31, s56, 9
    s_add_u32 s31, s31, s44
    s_add_u32 s31, s31, 196608
    s_add_u32 m0, s47, 101376
    s_nop 0
    buffer_load_dwordx4 v20, s[8:11], s31 offen lds
    s_lshl_b32 s31, s56, 9
    s_add_u32 s31, s31, s44
    s_add_u32 s31, s31, 262144
    s_add_u32 m0, s47, 65536
    s_nop 0
    buffer_load_dwordx4 v20, s[8:11], s31 offen lds
    s_lshl_b32 s31, s56, 9
    s_add_u32 s31, s31, s44
    s_add_u32 s31, s31, 327680
    s_add_u32 m0, s47, 66560
    s_nop 0
    buffer_load_dwordx4 v20, s[8:11], s31 offen lds
    s_lshl_b32 s31, s56, 9
    s_add_u32 s31, s31, s44
    s_add_u32 s31, s31, 393216
    s_add_u32 m0, s47, 67584
    s_nop 0
    buffer_load_dwordx4 v20, s[8:11], s31 offen lds
    s_lshl_b32 s31, s56, 9
    s_add_u32 s31, s31, s44
    s_add_u32 s31, s31, 458752
    s_add_u32 m0, s47, 68608
    s_nop 0
    buffer_load_dwordx4 v20, s[8:11], s31 offen lds
    s_waitcnt vmcnt(16)
    v_add_u32 v26, 81920, v23
    ds_read_b64_tr_b16 a[160:161], v26 offset:0
    ds_read_b64_tr_b16 a[162:163], v26 offset:512
    ds_read_b64_tr_b16 a[168:169], v26 offset:32
    ds_read_b64_tr_b16 a[170:171], v26 offset:544
    ds_read_b64_tr_b16 a[176:177], v26 offset:64
    ds_read_b64_tr_b16 a[178:179], v26 offset:576
    ds_read_b64_tr_b16 a[184:185], v26 offset:96
    ds_read_b64_tr_b16 a[186:187], v26 offset:608
    v_add_u32 v26, 131072, v23
    ds_read_b64_tr_b16 a[164:165], v26 offset:0
    ds_read_b64_tr_b16 a[166:167], v26 offset:512
    ds_read_b64_tr_b16 a[172:173], v26 offset:32
    ds_read_b64_tr_b16 a[174:175], v26 offset:544
    ds_read_b64_tr_b16 a[180:181], v26 offset:64
    ds_read_b64_tr_b16 a[182:183], v26 offset:576
    ds_read_b64_tr_b16 a[188:189], v26 offset:96
    ds_read_b64_tr_b16 a[190:191], v26 offset:608
    s_waitcnt lgkmcnt(0)
    s_waitcnt vmcnt(8)
    v_add_u32 v26, 49152, v23
    ds_read_b64_tr_b16 a[0:1], v26 offset:0
    ds_read_b64_tr_b16 a[2:3], v26 offset:512
    ds_read_b64_tr_b16 a[8:9], v26 offset:32
    ds_read_b64_tr_b16 a[10:11], v26 offset:544
    ds_read_b64_tr_b16 v[32:33], v26 offset:64
    ds_read_b64_tr_b16 v[34:35], v26 offset:576
    ds_read_b64_tr_b16 v[40:41], v26 offset:96
    ds_read_b64_tr_b16 v[42:43], v26 offset:608
    v_add_u32 v26, 114688, v23
    ds_read_b64_tr_b16 a[4:5], v26 offset:0
    ds_read_b64_tr_b16 a[6:7], v26 offset:512
    ds_read_b64_tr_b16 a[12:13], v26 offset:32
    ds_read_b64_tr_b16 a[14:15], v26 offset:544
    ds_read_b64_tr_b16 v[36:37], v26 offset:64
    ds_read_b64_tr_b16 v[38:39], v26 offset:576
    ds_read_b64_tr_b16 v[44:45], v26 offset:96
    ds_read_b64_tr_b16 v[46:47], v26 offset:608
    s_waitcnt lgkmcnt(0)
    ds_write_b128 v2, v[32:35] offset:49152
    ds_write_b128 v2, v[36:39] offset:50176
    ds_write_b128 v2, v[40:43] offset:51200
    ds_write_b128 v2, v[44:47] offset:52224
    s_lshl_b32 s31, s58, 9
    s_add_u32 s31, s31, s44
    s_add_u32 s31, s31, 0
    s_add_u32 m0, s47, 114688
    s_nop 0
    buffer_load_dwordx4 v20, s[8:11], s31 offen lds
    s_lshl_b32 s31, s58, 9
    s_add_u32 s31, s31, s44
    s_add_u32 s31, s31, 65536
    s_add_u32 m0, s47, 115712
    s_nop 0
    buffer_load_dwordx4 v20, s[8:11], s31 offen lds
    s_lshl_b32 s31, s58, 9
    s_add_u32 s31, s31, s44
    s_add_u32 s31, s31, 131072
    s_add_u32 m0, s47, 116736
    s_nop 0
    buffer_load_dwordx4 v20, s[8:11], s31 offen lds
    s_lshl_b32 s31, s58, 9
    s_add_u32 s31, s31, s44
    s_add_u32 s31, s31, 196608
    s_add_u32 m0, s47, 117760
    s_nop 0
    buffer_load_dwordx4 v20, s[8:11], s31 offen lds
    s_lshl_b32 s31, s58, 9
    s_add_u32 s31, s31, s44
    s_add_u32 s31, s31, 262144
    s_add_u32 m0, s47, 81920
    s_nop 0
    buffer_load_dwordx4 v20, s[8:11], s31 offen lds
    s_lshl_b32 s31, s58, 9
    s_add_u32 s31, s31, s44
    s_add_u32 s31, s31, 327680
    s_add_u32 m0, s47, 82944
    s_nop 0
    buffer_load_dwordx4 v20, s[8:11], s31 offen lds
    s_lshl_b32 s31, s58, 9
    s_add_u32 s31, s31, s44
    s_add_u32 s31, s31, 393216
    s_add_u32 m0, s47, 83968
    s_nop 0
    buffer_load_dwordx4 v20, s[8:11], s31 offen lds
    s_lshl_b32 s31, s58, 9
    s_add_u32 s31, s31, s44
    s_add_u32 s31, s31, 458752
    s_add_u32 m0, s47, 84992
    s_nop 0
    buffer_load_dwordx4 v20, s[8:11], s31 offen lds
    s_lshl_b32 s31, s60, 9
    s_add_u32 s31, s31, s44
    s_add_u32 s31, s31, 0
    s_add_u32 m0, s47, 131072
    s_nop 0
    buffer_load_dwordx4 v20, s[8:11], s31 offen lds
    s_lshl_b32 s31, s60, 9
    s_add_u32 s31, s31, s44
    s_add_u32 s31, s31, 65536
    s_add_u32 m0, s47, 132096
    s_nop 0
    buffer_load_dwordx4 v20, s[8:11], s31 offen lds
    s_lshl_b32 s31, s60, 9
    s_add_u32 s31, s31, s44
    s_add_u32 s31, s31, 131072
    s_add_u32 m0, s47, 133120
    s_nop 0
    buffer_load_dwordx4 v20, s[8:11], s31 offen lds
    s_lshl_b32 s31, s60, 9
    s_add_u32 s31, s31, s44
    s_add_u32 s31, s31, 196608
    s_add_u32 m0, s47, 134144
    s_nop 0
    buffer_load_dwordx4 v20, s[8:11], s31 offen lds
    s_lshl_b32 s31, s60, 9
    s_add_u32 s31, s31, s44
    s_add_u32 s31, s31, 262144
    s_add_u32 m0, s47, 147456
    s_nop 0
    buffer_load_dwordx4 v20, s[8:11], s31 offen lds
    s_lshl_b32 s31, s60, 9
    s_add_u32 s31, s31, s44
    s_add_u32 s31, s31, 327680
    s_add_u32 m0, s47, 148480
    s_nop 0
    buffer_load_dwordx4 v20, s[8:11], s31 offen lds
    s_lshl_b32 s31, s60, 9
    s_add_u32 s31, s31, s44
    s_add_u32 s31, s31, 393216
    s_add_u32 m0, s47, 149504
    s_nop 0
    buffer_load_dwordx4 v20, s[8:11], s31 offen lds
    s_lshl_b32 s31, s60, 9
    s_add_u32 s31, s31, s44
    s_add_u32 s31, s31, 458752
    s_add_u32 m0, s47, 150528
    s_nop 0
    buffer_load_dwordx4 v20, s[8:11], s31 offen lds
    s_waitcnt vmcnt(16)
    v_add_u32 v26, 98304, v23
    ds_read_b64_tr_b16 a[48:49], v26 offset:0
    ds_read_b64_tr_b16 a[50:51], v26 offset:512
    ds_read_b64_tr_b16 a[56:57], v26 offset:32
    ds_read_b64_tr_b16 a[58:59], v26 offset:544
    ds_read_b64_tr_b16 v[32:33], v26 offset:64
    ds_read_b64_tr_b16 v[34:35], v26 offset:576
    ds_read_b64_tr_b16 v[40:41], v26 offset:96
    ds_read_b64_tr_b16 v[42:43], v26 offset:608
    v_add_u32 v26, 65536, v23
    ds_read_b64_tr_b16 a[52:53], v26 offset:0
    ds_read_b64_tr_b16 a[54:55], v26 offset:512
    ds_read_b64_tr_b16 a[60:61], v26 offset:32
    ds_read_b64_tr_b16 a[62:63], v26 offset:544
    ds_read_b64_tr_b16 v[36:37], v26 offset:64
    ds_read_b64_tr_b16 v[38:39], v26 offset:576
    ds_read_b64_tr_b16 v[44:45], v26 offset:96
    ds_read_b64_tr_b16 v[46:47], v26 offset:608
    s_waitcnt lgkmcnt(0)
    ds_write_b128 v3, v[32:35] offset:0
    ds_write_b128 v3, v[36:39] offset:1024
    ds_write_b128 v3, v[40:43] offset:2048
    ds_write_b128 v3, v[44:47] offset:3072
    s_waitcnt vmcnt(8)
    v_mov_b32 v30, 0
    s_mov_b32 s31, 65536
    buffer_load_dword v24, v30, s[4:7], s31 offen sc1
    s_getpc_b64 s[82:83]
Lpc_23:
    s_add_u32 s82, s82, Lstep-Lpc_23
    s_addc_u32 s83, s83, 0
    v_lshlrev_b32 v30, 2, v2
    v_and_b32 v30, 0xfff, v30
    s_and_b32 s31, s29, 1
    s_lshl_b32 s31, s31, 12
    v_add_u32 v30, s31, v30
    global_load_dword v52, v30, s[82:83]
    v_add_u32 v26, 114688, v23
    ds_read_b64_tr_b16 a[96:97], v26 offset:0
    ds_read_b64_tr_b16 a[98:99], v26 offset:512
    ds_read_b64_tr_b16 a[104:105], v26 offset:32
    ds_read_b64_tr_b16 a[106:107], v26 offset:544
    ds_read_b64_tr_b16 v[32:33], v26 offset:64
    ds_read_b64_tr_b16 v[34:35], v26 offset:576
    ds_read_b64_tr_b16 v[40:41], v26 offset:96
    ds_read_b64_tr_b16 v[42:43], v26 offset:608
    v_add_u32 v26, 81920, v23
    ds_read_b64_tr_b16 a[100:101], v26 offset:0
    ds_read_b64_tr_b16 a[102:103], v26 offset:512
    ds_read_b64_tr_b16 a[108:109], v26 offset:32
    ds_read_b64_tr_b16 a[110:111], v26 offset:544
    ds_read_b64_tr_b16 v[36:37], v26 offset:64
    ds_read_b64_tr_b16 v[38:39], v26 offset:576
    ds_read_b64_tr_b16 v[44:45], v26 offset:96
    ds_read_b64_tr_b16 v[46:47], v26 offset:608
    s_waitcnt lgkmcnt(0)
    ds_write_b128 v3, v[32:35] offset:16384
    ds_write_b128 v3, v[36:39] offset:17408
    ds_write_b128 v3, v[40:43] offset:18432
    ds_write_b128 v3, v[44:47] offset:19456
    s_waitcnt vmcnt(2)
    v_add_u32 v26, 131072, v23
    ds_read_b64_tr_b16 a[144:145], v26 offset:0
    ds_read_b64_tr_b16 a[146:147], v26 offset:512
    ds_read_b64_tr_b16 a[152:153], v26 offset:32
    ds_read_b64_tr_b16 a[154:155], v26 offset:544
    ds_read_b64_tr_b16 v[32:33], v26 offset:64
    ds_read_b64_tr_b16 v[34:35], v26 offset:576
    ds_read_b64_tr_b16 v[40:41], v26 offset:96
    ds_read_b64_tr_b16 v[42:43], v26 offset:608
    v_add_u32 v26, 147456, v23
    ds_read_b64_tr_b16 a[148:149], v26 offset:0
    ds_read_b64_tr_b16 a[150:151], v26 offset:512
    ds_read_b64_tr_b16 a[156:157], v26 offset:32
    ds_read_b64_tr_b16 a[158:159], v26 offset:544
    ds_read_b64_tr_b16 v[36:37], v26 offset:64
    ds_read_b64_tr_b16 v[38:39], v26 offset:576
    ds_read_b64_tr_b16 v[44:45], v26 offset:96
    ds_read_b64_tr_b16 v[46:47], v26 offset:608
    s_waitcnt lgkmcnt(0)
    ds_write_b128 v3, v[32:35] offset:32768
    ds_write_b128 v3, v[36:39] offset:33792
    ds_write_b128 v3, v[40:43] offset:34816
    ds_write_b128 v3, v[44:47] offset:35840
    s_lshl_b32 s31, s62, 9
    s_add_u32 s31, s31, s44
    s_add_u32 s31, s31, 0
    s_add_u32 m0, s47, 147456
    s_nop 0
    buffer_load_dwordx4 v20, s[8:11], s31 offen lds
    s_lshl_b32 s31, s62, 9
    s_add_u32 s31, s31, s44
    s_add_u32 s31, s31, 65536
    s_add_u32 m0, s47, 148480
    s_nop 0
    buffer_load_dwordx4 v20, s[8:11], s31 offen lds
    s_lshl_b32 s31, s62, 9
    s_add_u32 s31, s31, s44
    s_add_u32 s31, s31, 131072
    s_add_u32 m0, s47, 149504
    s_nop 0
    buffer_load_dwordx4 v20, s[8:11], s31 offen lds
    s_lshl_b32 s31, s62, 9
    s_add_u32 s31, s31, s44
    s_add_u32 s31, s31, 196608
    s_add_u32 m0, s47, 150528
    s_nop 0
    buffer_load_dwordx4 v20, s[8:11], s31 offen lds
    s_lshl_b32 s31, s62, 9
    s_add_u32 s31, s31, s44
    s_add_u32 s31, s31, 262144
    s_add_u32 m0, s47, 65536
    s_nop 0
    buffer_load_dwordx4 v20, s[8:11], s31 offen lds
    s_lshl_b32 s31, s62, 9
    s_add_u32 s31, s31, s44
    s_add_u32 s31, s31, 327680
    s_add_u32 m0, s47, 66560
    s_nop 0
    buffer_load_dwordx4 v20, s[8:11], s31 offen lds
    s_lshl_b32 s31, s62, 9
    s_add_u32 s31, s31, s44
    s_add_u32 s31, s31, 393216
    s_add_u32 m0, s47, 67584
    s_nop 0
    buffer_load_dwordx4 v20, s[8:11], s31 offen lds
    s_lshl_b32 s31, s62, 9
    s_add_u32 s31, s31, s44
    s_add_u32 s31, s31, 458752
    s_add_u32 m0, s47, 68608
    s_nop 0
    buffer_load_dwordx4 v20, s[8:11], s31 offen lds
    s_waitcnt vmcnt(0)
    v_add_u32 v26, 147456, v23
    ds_read_b64_tr_b16 a[192:193], v26 offset:0
    ds_read_b64_tr_b16 a[194:195], v26 offset:512
    ds_read_b64_tr_b16 a[200:201], v26 offset:32
    ds_read_b64_tr_b16 a[202:203], v26 offset:544
    ds_read_b64_tr_b16 v[32:33], v26 offset:64
    ds_read_b64_tr_b16 v[34:35], v26 offset:576
    ds_read_b64_tr_b16 v[40:41], v26 offset:96
    ds_read_b64_tr_b16 v[42:43], v26 offset:608
    v_add_u32 v26, 65536, v23
    ds_read_b64_tr_b16 a[196:197], v26 offset:0
    ds_read_b64_tr_b16 a[198:199], v26 offset:512
    ds_read_b64_tr_b16 a[204:205], v26 offset:32
    ds_read_b64_tr_b16 a[206:207], v26 offset:544
    ds_read_b64_tr_b16 v[36:37], v26 offset:64
    ds_read_b64_tr_b16 v[38:39], v26 offset:576
    ds_read_b64_tr_b16 v[44:45], v26 offset:96
    ds_read_b64_tr_b16 v[46:47], v26 offset:608
    s_waitcnt lgkmcnt(0)
    ds_write_b128 v3, v[32:35] offset:49152
    ds_write_b128 v3, v[36:39] offset:50176
    ds_write_b128 v3, v[40:43] offset:51200
    ds_write_b128 v3, v[44:47] offset:52224
    s_branch Lwdone_22
Lodd_21:
    s_mul_i32 s31, s64, 72
    s_add_u32 s31, s31, s46
    s_add_u32 s31, s31, 0
    s_add_u32 m0, s47, 49152
    s_nop 0
    buffer_load_dwordx4 v21, s[16:19], s31 offen lds
    s_mul_i32 s31, s64, 72
    s_add_u32 s31, s31, s46
    s_add_u32 s31, s31, 9216
    s_add_u32 m0, s47, 50176
    s_nop 0
    buffer_load_dwordx4 v21, s[16:19], s31 offen lds
    s_mul_i32 s31, s64, 72
    s_add_u32 s31, s31, s46
    s_add_u32 s31, s31, 18432
    s_add_u32 m0, s47, 51200
    s_nop 0
    buffer_load_dwordx4 v21, s[16:19], s31 offen lds
    s_mul_i32 s31, s64, 72
    s_add_u32 s31, s31, s46
    s_add_u32 s31, s31, 27648
    s_add_u32 m0, s47, 52224
    s_nop 0
    buffer_load_dwordx4 v21, s[16:19], s31 offen lds
    s_mul_i32 s31, s64, 72
    s_add_u32 s31, s31, s46
    s_add_u32 s31, s31, 128
    s_add_u32 m0, s47, 65536
    s_nop 0
    buffer_load_dwordx4 v21, s[16:19], s31 offen lds
    s_mul_i32 s31, s64, 72
    s_add_u32 s31, s31, s46
    s_add_u32 s31, s31, 9344
    s_add_u32 m0, s47, 66560
    s_nop 0
    buffer_load_dwordx4 v21, s[16:19], s31 offen lds
    s_mul_i32 s31, s64, 72
    s_add_u32 s31, s31, s46
    s_add_u32 s31, s31, 18560
    s_add_u32 m0, s47, 67584
    s_nop 0
    buffer_load_dwordx4 v21, s[16:19], s31 offen lds
    s_mul_i32 s31, s64, 72
    s_add_u32 s31, s31, s46
    s_add_u32 s31, s31, 27776
    s_add_u32 m0, s47, 68608
    s_nop 0
    buffer_load_dwordx4 v21, s[16:19], s31 offen lds
    s_mul_i32 s31, s64, 72
    s_add_u32 s31, s31, s46
    s_add_u32 s31, s31, 256
    s_add_u32 m0, s47, 81920
    s_nop 0
    buffer_load_dwordx4 v21, s[16:19], s31 offen lds
    s_mul_i32 s31, s64, 72
    s_add_u32 s31, s31, s46
    s_add_u32 s31, s31, 9472
    s_add_u32 m0, s47, 82944
    s_nop 0
    buffer_load_dwordx4 v21, s[16:19], s31 offen lds
    s_mul_i32 s31, s64, 72
    s_add_u32 s31, s31, s46
    s_add_u32 s31, s31, 18688
    s_add_u32 m0, s47, 83968
    s_nop 0
    buffer_load_dwordx4 v21, s[16:19], s31 offen lds
    s_mul_i32 s31, s64, 72
    s_add_u32 s31, s31, s46
    s_add_u32 s31, s31, 27904
    s_add_u32 m0, s47, 84992
    s_nop 0
    buffer_load_dwordx4 v21, s[16:19], s31 offen lds
    s_mul_i32 s31, s65, 72
    s_add_u32 s31, s31, s46
    s_add_u32 s31, s31, 0
    s_add_u32 m0, s47, 98304
    s_nop 0
    buffer_load_dwordx4 v21, s[16:19], s31 offen lds
    s_mul_i32 s31, s65, 72
    s_add_u32 s31, s31, s46
    s_add_u32 s31, s31, 9216
    s_add_u32 m0, s47, 99328
    s_nop 0
    buffer_load_dwordx4 v21, s[16:19], s31 offen lds
    s_mul_i32 s31, s65, 72
    s_add_u32 s31, s31, s46
    s_add_u32 s31, s31, 18432
    s_add_u32 m0, s47, 100352
    s_nop 0
    buffer_load_dwordx4 v21, s[16:19], s31 offen lds
    s_mul_i32 s31, s65, 72
    s_add_u32 s31, s31, s46
    s_add_u32 s31, s31, 27648
    s_add_u32 m0, s47, 101376
    s_nop 0
    buffer_load_dwordx4 v21, s[16:19], s31 offen lds
    s_mul_i32 s31, s65, 72
    s_add_u32 s31, s31, s46
    s_add_u32 s31, s31, 128
    s_add_u32 m0, s47, 114688
    s_nop 0
    buffer_load_dwordx4 v21, s[16:19], s31 offen lds
    s_mul_i32 s31, s65, 72
    s_add_u32 s31, s31, s46
    s_add_u32 s31, s31, 9344
    s_add_u32 m0, s47, 115712
    s_nop 0
    buffer_load_dwordx4 v21, s[16:19], s31 offen lds
    s_mul_i32 s31, s65, 72
    s_add_u32 s31, s31, s46
    s_add_u32 s31, s31, 18560
    s_add_u32 m0, s47, 116736
    s_nop 0
    buffer_load_dwordx4 v21, s[16:19], s31 offen lds
    s_mul_i32 s31, s65, 72
    s_add_u32 s31, s31, s46
    s_add_u32 s31, s31, 27776
    s_add_u32 m0, s47, 117760
    s_nop 0
    buffer_load_dwordx4 v21, s[16:19], s31 offen lds
    s_mul_i32 s31, s65, 72
    s_add_u32 s31, s31, s46
    s_add_u32 s31, s31, 256
    s_add_u32 m0, s47, 131072
    s_nop 0
    buffer_load_dwordx4 v21, s[16:19], s31 offen lds
    s_mul_i32 s31, s65, 72
    s_add_u32 s31, s31, s46
    s_add_u32 s31, s31, 9472
    s_add_u32 m0, s47, 132096
    s_nop 0
    buffer_load_dwordx4 v21, s[16:19], s31 offen lds
    s_mul_i32 s31, s65, 72
    s_add_u32 s31, s31, s46
    s_add_u32 s31, s31, 18688
    s_add_u32 m0, s47, 133120
    s_nop 0
    buffer_load_dwordx4 v21, s[16:19], s31 offen lds
    s_mul_i32 s31, s65, 72
    s_add_u32 s31, s31, s46
    s_add_u32 s31, s31, 27904
    s_add_u32 m0, s47, 134144
    s_nop 0
    buffer_load_dwordx4 v21, s[16:19], s31 offen lds
    v_mov_b32 v56, -1
    v_mov_b32 v57, -1
    v_mov_b32 v58, -1
    v_mov_b32 v59, -1
    s_add_u32 s31, s69, 1048576
    buffer_store_dwordx4 v[56:59], v1, s[4:7], s31 offen offset:0 sc1
    buffer_store_dwordx4 v[56:59], v1, s[4:7], s31 offen offset:1024 sc1
    buffer_store_dwordx4 v[56:59], v1, s[4:7], s31 offen offset:2048 sc1
    buffer_store_dwordx4 v[56:59], v1, s[4:7], s31 offen offset:3072 sc1
    s_add_u32 s31, s69, 1343488
    buffer_store_dwordx4 v[56:59], v1, s[4:7], s31 offen offset:0 sc1
    buffer_store_dwordx4 v[56:59], v1, s[4:7], s31 offen offset:1024 sc1
    buffer_store_dwordx4 v[56:59], v1, s[4:7], s31 offen offset:2048 sc1
    buffer_store_dwordx4 v[56:59], v1, s[4:7], s31 offen offset:3072 sc1
    s_add_u32 s31, s43, 2097152
    buffer_store_dword v56, v31, s[4:7], s31 offen sc1
    s_add_u32 s31, s43, 2113536
    buffer_store_dword v56, v31, s[4:7], s31 offen sc1
    s_add_u32 s31, s43, 2129920
    buffer_store_dword v56, v31, s[4:7], s31 offen sc1
    s_add_u32 s31, s43, 2146304
    buffer_store_dword v56, v31, s[4:7], s31 offen sc1
    v_mov_b32 v60, 0
    v_mov_b32 v61, 0
    v_mov_b32 v62, 0
    v_mov_b32 v63, 0
    s_lshl_b32 s31, s28, 12
    s_lshl_b32 s32, s29, 10
    s_add_u32 s31, s31, s32
    s_add_u32 s31, s31, 0
    buffer_store_dwordx4 v[60:63], v1, s[4:7], s31 offen sc1
    s_waitcnt vmcnt(25)
    v_add_u32 v26, 49152, v48
    ds_read_b64_tr_b16 v[160:161], v26 offset:0
    ds_read_b64_tr_b16 v[162:163], v26 offset:256
    ds_read_b64_tr_b16 v[164:165], v26 offset:1024
    ds_read_b64_tr_b16 v[166:167], v26 offset:1280
    v_add_u32 v26, 49152, v49
    ds_read_b64_tr_b16 v[32:33], v26 offset:0
    ds_read_b64_tr_b16 v[34:35], v26 offset:256
    ds_read_b64_tr_b16 v[36:37], v26 offset:1024
    ds_read_b64_tr_b16 v[38:39], v26 offset:1280
    v_add_u32 v26, 49152, v50
    ds_read_b64_tr_b16 v[208:209], v26 offset:0
    ds_read_b64_tr_b16 v[210:211], v26 offset:256
    ds_read_b64_tr_b16 v[212:213], v26 offset:1024
    ds_read_b64_tr_b16 v[214:215], v26 offset:1280
    v_add_u32 v26, 49152, v51
    ds_read_b64_tr_b16 v[224:225], v26 offset:0
    ds_read_b64_tr_b16 v[226:227], v26 offset:256
    ds_read_b64_tr_b16 v[228:229], v26 offset:1024
    ds_read_b64_tr_b16 v[230:231], v26 offset:1280
    s_waitcnt lgkmcnt(0)
    ds_write_b128 v2, v[32:35] offset:0
    ds_write_b128 v2, v[36:39] offset:1024
    s_mul_i32 s31, s66, 72
    s_add_u32 s31, s31, s46
    s_add_u32 s31, s31, 0
    s_add_u32 m0, s47, 49152
    s_nop 0
    buffer_load_dwordx4 v21, s[16:19], s31 offen lds
    s_mul_i32 s31, s66, 72
    s_add_u32 s31, s31, s46
    s_add_u32 s31, s31, 9216
    s_add_u32 m0, s47, 50176
    s_nop 0
    buffer_load_dwordx4 v21, s[16:19], s31 offen lds
    s_mul_i32 s31, s66, 72
    s_add_u32 s31, s31, s46
    s_add_u32 s31, s31, 18432
    s_add_u32 m0, s47, 51200
    s_nop 0
    buffer_load_dwordx4 v21, s[16:19], s31 offen lds
    s_mul_i32 s31, s66, 72
    s_add_u32 s31, s31, s46
    s_add_u32 s31, s31, 27648
    s_add_u32 m0, s47, 52224
    s_nop 0
    buffer_load_dwordx4 v21, s[16:19], s31 offen lds
    s_mul_i32 s31, s66, 72
    s_add_u32 s31, s31, s46
    s_add_u32 s31, s31, 128
    s_add_u32 m0, s47, 65536
    s_nop 0
    buffer_load_dwordx4 v21, s[16:19], s31 offen lds
    s_mul_i32 s31, s66, 72
    s_add_u32 s31, s31, s46
    s_add_u32 s31, s31, 9344
    s_add_u32 m0, s47, 66560
    s_nop 0
    buffer_load_dwordx4 v21, s[16:19], s31 offen lds
    s_mul_i32 s31, s66, 72
    s_add_u32 s31, s31, s46
    s_add_u32 s31, s31, 18560
    s_add_u32 m0, s47, 67584
    s_nop 0
    buffer_load_dwordx4 v21, s[16:19], s31 offen lds
    s_mul_i32 s31, s66, 72
    s_add_u32 s31, s31, s46
    s_add_u32 s31, s31, 27776
    s_add_u32 m0, s47, 68608
    s_nop 0
    buffer_load_dwordx4 v21, s[16:19], s31 offen lds
    s_mul_i32 s31, s66, 72
    s_add_u32 s31, s31, s46
    s_add_u32 s31, s31, 256
    s_add_u32 m0, s47, 81920
    s_nop 0
    buffer_load_dwordx4 v21, s[16:19], s31 offen lds
    s_mul_i32 s31, s66, 72
    s_add_u32 s31, s31, s46
    s_add_u32 s31, s31, 9472
    s_add_u32 m0, s47, 82944
    s_nop 0
    buffer_load_dwordx4 v21, s[16:19], s31 offen lds
    s_mul_i32 s31, s66, 72
    s_add_u32 s31, s31, s46
    s_add_u32 s31, s31, 18688
    s_add_u32 m0, s47, 83968
    s_nop 0
    buffer_load_dwordx4 v21, s[16:19], s31 offen lds
    s_mul_i32 s31, s66, 72
    s_add_u32 s31, s31, s46
    s_add_u32 s31, s31, 27904
    s_add_u32 m0, s47, 84992
    s_nop 0
    buffer_load_dwordx4 v21, s[16:19], s31 offen lds
    s_waitcnt vmcnt(25)
    v_add_u32 v26, 98304, v48
    ds_read_b64_tr_b16 v[168:169], v26 offset:0
    ds_read_b64_tr_b16 v[170:171], v26 offset:256
    ds_read_b64_tr_b16 v[172:173], v26 offset:1024
    ds_read_b64_tr_b16 v[174:175], v26 offset:1280
    v_add_u32 v26, 98304, v49
    ds_read_b64_tr_b16 v[32:33], v26 offset:0
    ds_read_b64_tr_b16 v[34:35], v26 offset:256
    ds_read_b64_tr_b16 v[36:37], v26 offset:1024
    ds_read_b64_tr_b16 v[38:39], v26 offset:1280
    v_add_u32 v26, 98304, v50
    ds_read_b64_tr_b16 v[216:217], v26 offset:0
    ds_read_b64_tr_b16 v[218:219], v26 offset:256
    ds_read_b64_tr_b16 v[220:221], v26 offset:1024
    ds_read_b64_tr_b16 v[222:223], v26 offset:1280
    v_add_u32 v26, 98304, v51
    ds_read_b64_tr_b16 v[232:233], v26 offset:0
    ds_read_b64_tr_b16 v[234:235], v26 offset:256
    ds_read_b64_tr_b16 v[236:237], v26 offset:1024
    ds_read_b64_tr_b16 v[238:239], v26 offset:1280
    s_waitcnt lgkmcnt(0)
    ds_write_b128 v2, v[32:35] offset:2048
    ds_write_b128 v2, v[36:39] offset:3072
    s_mul_i32 s31, s67, 72
    s_add_u32 s31, s31, s46
    s_add_u32 s31, s31, 0
    s_add_u32 m0, s47, 98304
    s_nop 0
    buffer_load_dwordx4 v21, s[16:19], s31 offen lds
    s_mul_i32 s31, s67, 72
    s_add_u32 s31, s31, s46
    s_add_u32 s31, s31, 9216
    s_add_u32 m0, s47, 99328
    s_nop 0
    buffer_load_dwordx4 v21, s[16:19], s31 offen lds
    s_mul_i32 s31, s67, 72
    s_add_u32 s31, s31, s46
    s_add_u32 s31, s31, 18432
    s_add_u32 m0, s47, 100352
    s_nop 0
    buffer_load_dwordx4 v21, s[16:19], s31 offen lds
    s_mul_i32 s31, s67, 72
    s_add_u32 s31, s31, s46
    s_add_u32 s31, s31, 27648
    s_add_u32 m0, s47, 101376
    s_nop 0
    buffer_load_dwordx4 v21, s[16:19], s31 offen lds
    s_mul_i32 s31, s67, 72
    s_add_u32 s31, s31, s46
    s_add_u32 s31, s31, 128
    s_add_u32 m0, s47, 114688
    s_nop 0
    buffer_load_dwordx4 v21, s[16:19], s31 offen lds
    s_mul_i32 s31, s67, 72
    s_add_u32 s31, s31, s46
    s_add_u32 s31, s31, 9344
    s_add_u32 m0, s47, 115712
    s_nop 0
    buffer_load_dwordx4 v21, s[16:19], s31 offen lds
    s_mul_i32 s31, s67, 72
    s_add_u32 s31, s31, s46
    s_add_u32 s31, s31, 18560
    s_add_u32 m0, s47, 116736
    s_nop 0
    buffer_load_dwordx4 v21, s[16:19], s31 offen lds
    s_mul_i32 s31, s67, 72
    s_add_u32 s31, s31, s46
    s_add_u32 s31, s31, 27776
    s_add_u32 m0, s47, 117760
    s_nop 0
    buffer_load_dwordx4 v21, s[16:19], s31 offen lds
    s_mul_i32 s31, s67, 72
    s_add_u32 s31, s31, s46
    s_add_u32 s31, s31, 256
    s_add_u32 m0, s47, 131072
    s_nop 0
    buffer_load_dwordx4 v21, s[16:19], s31 offen lds
    s_mul_i32 s31, s67, 72
    s_add_u32 s31, s31, s46
    s_add_u32 s31, s31, 9472
    s_add_u32 m0, s47, 132096
    s_nop 0
    buffer_load_dwordx4 v21, s[16:19], s31 offen lds
    s_mul_i32 s31, s67, 72
    s_add_u32 s31, s31, s46
    s_add_u32 s31, s31, 18688
    s_add_u32 m0, s47, 133120
    s_nop 0
    buffer_load_dwordx4 v21, s[16:19], s31 offen lds
    s_mul_i32 s31, s67, 72
    s_add_u32 s31, s31, s46
    s_add_u32 s31, s31, 27904
    s_add_u32 m0, s47, 134144
    s_nop 0
    buffer_load_dwordx4 v21, s[16:19], s31 offen lds
    s_lshl_b32 s31, s29, 5
    s_add_u32 s31, s31, s46
    s_add_u32 s31, s31, 256
    s_add_u32 m0, s47, 147456
    s_nop 0
    buffer_load_dwordx4 v22, s[16:19], s31 offen lds
    s_lshl_b32 s31, s29, 5
    s_add_u32 s31, s31, s46
    s_add_u32 s31, s31, 37120
    s_add_u32 m0, s47, 148480
    s_nop 0
    buffer_load_dwordx4 v22, s[16:19], s31 offen lds
    s_lshl_b32 s31, s29, 5
    s_add_u32 s31, s31, s46
    s_add_u32 s31, s31, 73984
    s_add_u32 m0, s47, 149504
    s_nop 0
    buffer_load_dwordx4 v22, s[16:19], s31 offen lds
    s_lshl_b32 s31, s29, 5
    s_add_u32 s31, s31, s46
    s_add_u32 s31, s31, 110848
    s_add_u32 m0, s47, 150528
    s_nop 0
    buffer_load_dwordx4 v22, s[16:19], s31 offen lds
    s_waitcnt vmcnt(16)
    s_add_u32 s31, s94, 1
    v_mov_b32 v56, s31
    v_mov_b32 v57, 160
    s_mov_b64 exec, 1
    buffer_atomic_add v56, v57, s[20:23], 0 offen
    s_mov_b64 exec, -1
    v_add_u32 v26, 49152, v48
    ds_read_b64_tr_b16 v[176:177], v26 offset:0
    ds_read_b64_tr_b16 v[178:179], v26 offset:256
    ds_read_b64_tr_b16 v[180:181], v26 offset:1024
    ds_read_b64_tr_b16 v[182:183], v26 offset:1280
    v_add_u32 v26, 49152, v49
    ds_read_b64_tr_b16 v[192:193], v26 offset:0
    ds_read_b64_tr_b16 v[194:195], v26 offset:256
    ds_read_b64_tr_b16 v[196:197], v26 offset:1024
    ds_read_b64_tr_b16 v[198:199], v26 offset:1280
    v_add_u32 v26, 49152, v50
    ds_read_b64_tr_b16 v[32:33], v26 offset:0
    ds_read_b64_tr_b16 v[34:35], v26 offset:256
    ds_read_b64_tr_b16 v[36:37], v26 offset:1024
    ds_read_b64_tr_b16 v[38:39], v26 offset:1280
    v_add_u32 v26, 49152, v51
    ds_read_b64_tr_b16 v[40:41], v26 offset:0
    ds_read_b64_tr_b16 v[42:43], v26 offset:256
    ds_read_b64_tr_b16 v[44:45], v26 offset:1024
    ds_read_b64_tr_b16 v[46:47], v26 offset:1280
    s_waitcnt lgkmcnt(0)
    ds_write_b128 v2, v[32:35] offset:16384
    ds_write_b128 v2, v[36:39] offset:17408
    ds_write_b128 v2, v[40:43] offset:32768
    ds_write_b128 v2, v[44:47] offset:33792
    s_lshl_b32 s31, s55, 9
    s_add_u32 s31, s31, s44
    s_add_u32 s31, s31, 0
    s_add_u32 m0, s47, 65536
    s_nop 0
    buffer_load_dwordx4 v20, s[8:11], s31 offen lds
    s_lshl_b32 s31, s55, 9
    s_add_u32 s31, s31, s44
    s_add_u32 s31, s31, 65536
    s_add_u32 m0, s47, 66560
    s_nop 0
    buffer_load_dwordx4 v20, s[8:11], s31 offen lds
    s_lshl_b32 s31, s55, 9
    s_add_u32 s31, s31, s44
    s_add_u32 s31, s31, 131072
    s_add_u32 m0, s47, 67584
    s_nop 0
    buffer_load_dwordx4 v20, s[8:11], s31 offen lds
    s_lshl_b32 s31, s55, 9
    s_add_u32 s31, s31, s44
    s_add_u32 s31, s31, 196608
    s_add_u32 m0, s47, 68608
    s_nop 0
    buffer_load_dwordx4 v20, s[8:11], s31 offen lds
    s_lshl_b32 s31, s55, 9
    s_add_u32 s31, s31, s44
    s_add_u32 s31, s31, 262144
    s_add_u32 m0, s47, 81920
    s_nop 0
    buffer_load_dwordx4 v20, s[8:11], s31 offen lds
    s_lshl_b32 s31, s55, 9
    s_add_u32 s31, s31, s44
    s_add_u32 s31, s31, 327680
    s_add_u32 m0, s47, 82944
    s_nop 0
    buffer_load_dwordx4 v20, s[8:11], s31 offen lds
    s_lshl_b32 s31, s55, 9
    s_add_u32 s31, s31, s44
    s_add_u32 s31, s31, 393216
    s_add_u32 m0, s47, 83968
    s_nop 0
    buffer_load_dwordx4 v20, s[8:11], s31 offen lds
    s_lshl_b32 s31, s55, 9
    s_add_u32 s31, s31, s44
    s_add_u32 s31, s31, 458752
    s_add_u32 m0, s47, 84992
    s_nop 0
    buffer_load_dwordx4 v20, s[8:11], s31 offen lds
    s_add_u32 s31, s45, 0
    s_add_u32 m0, s47, 49152
    s_nop 0
    buffer_load_dwordx4 v28, s[12:15], s31 offen lds
    s_add_u32 s31, s45, 131072
    s_add_u32 m0, s47, 50176
    s_nop 0
    buffer_load_dwordx4 v28, s[12:15], s31 offen lds
    s_add_u32 s31, s45, 262144
    s_add_u32 m0, s47, 51200
    s_nop 0
    buffer_load_dwordx4 v28, s[12:15], s31 offen lds
    s_add_u32 s31, s45, 393216
    s_add_u32 m0, s47, 52224
    s_nop 0
    buffer_load_dwordx4 v28, s[12:15], s31 offen lds
    s_waitcnt vmcnt(17)
    v_add_u32 v26, 98304, v48
    ds_read_b64_tr_b16 v[184:185], v26 offset:0
    ds_read_b64_tr_b16 v[186:187], v26 offset:256
    ds_read_b64_tr_b16 v[188:189], v26 offset:1024
    ds_read_b64_tr_b16 v[190:191], v26 offset:1280
    v_add_u32 v26, 98304, v49
    ds_read_b64_tr_b16 v[200:201], v26 offset:0
    ds_read_b64_tr_b16 v[202:203], v26 offset:256
    ds_read_b64_tr_b16 v[204:205], v26 offset:1024
    ds_read_b64_tr_b16 v[206:207], v26 offset:1280
    v_add_u32 v26, 98304, v50
    ds_read_b64_tr_b16 v[32:33], v26 offset:0
    ds_read_b64_tr_b16 v[34:35], v26 offset:256
    ds_read_b64_tr_b16 v[36:37], v26 offset:1024
    ds_read_b64_tr_b16 v[38:39], v26 offset:1280
    v_add_u32 v26, 98304, v51
    ds_read_b64_tr_b16 v[40:41], v26 offset:0
    ds_read_b64_tr_b16 v[42:43], v26 offset:256
    ds_read_b64_tr_b16 v[44:45], v26 offset:1024
    ds_read_b64_tr_b16 v[46:47], v26 offset:1280
    s_waitcnt lgkmcnt(0)
    ds_write_b128 v2, v[32:35] offset:18432
    ds_write_b128 v2, v[36:39] offset:19456
    ds_write_b128 v2, v[40:43] offset:34816
    ds_write_b128 v2, v[44:47] offset:35840
    s_add_u32 s31, s45, 524288
    s_add_u32 m0, s47, 131072
    s_nop 0
    buffer_load_dwordx4 v28, s[12:15], s31 offen lds
    s_add_u32 s31, s45, 655360
    s_add_u32 m0, s47, 132096
    s_nop 0
    buffer_load_dwordx4 v28, s[12:15], s31 offen lds
    s_add_u32 s31, s45, 786432
    s_add_u32 m0, s47, 133120
    s_nop 0
    buffer_load_dwordx4 v28, s[12:15], s31 offen lds
    s_add_u32 s31, s45, 917504
    s_add_u32 m0, s47, 134144
    s_nop 0
    buffer_load_dwordx4 v28, s[12:15], s31 offen lds
    s_add_u32 s31, s45, 1048576
    s_add_u32 m0, s47, 114688
    s_nop 0
    buffer_load_dwordx4 v28, s[12:15], s31 offen lds
    s_add_u32 s31, s45, 1179648
    s_add_u32 m0, s47, 115712
    s_nop 0
    buffer_load_dwordx4 v28, s[12:15], s31 offen lds
    s_add_u32 s31, s45, 1310720
    s_add_u32 m0, s47, 116736
    s_nop 0
    buffer_load_dwordx4 v28, s[12:15], s31 offen lds
    s_add_u32 s31, s45, 1441792
    s_add_u32 m0, s47, 117760
    s_nop 0
    buffer_load_dwordx4 v28, s[12:15], s31 offen lds
    s_add_u32 s31, s45, 1572864
    s_add_u32 m0, s47, 98304
    s_nop 0
    buffer_load_dwordx4 v28, s[12:15], s31 offen lds
    s_add_u32 s31, s45, 1703936
    s_add_u32 m0, s47, 99328
    s_nop 0
    buffer_load_dwordx4 v28, s[12:15], s31 offen lds
    s_add_u32 s31, s45, 1835008
    s_add_u32 m0, s47, 100352
    s_nop 0
    buffer_load_dwordx4 v28, s[12:15], s31 offen lds
    s_add_u32 s31, s45, 1966080
    s_add_u32 m0, s47, 101376
    s_nop 0
    buffer_load_dwordx4 v28, s[12:15], s31 offen lds
    s_waitcnt vmcnt(25)
    v_add_u32 v26, 147456, v25
    ds_read_b64_tr_b16 v[240:241], v26 offset:0
    ds_read_b64_tr_b16 v[242:243], v26 offset:64
    ds_read_b64_tr_b16 v[244:245], v26 offset:256
    ds_read_b64_tr_b16 v[246:247], v26 offset:320
    ds_read_b64_tr_b16 v[248:249], v26 offset:2048
    ds_read_b64_tr_b16 v[250:251], v26 offset:2112
    ds_read_b64_tr_b16 v[252:253], v26 offset:2304
    ds_read_b64_tr_b16 v[254:255], v26 offset:2368
    s_waitcnt lgkmcnt(0)
    s_add_u32 s31, s45, 2097152
    s_add_u32 m0, s47, 147456
    s_nop 0
    buffer_load_dwordx4 v28, s[12:15], s31 offen lds
    s_add_u32 s31, s45, 2228224
    s_add_u32 m0, s47, 148480
    s_nop 0
    buffer_load_dwordx4 v28, s[12:15], s31 offen lds
    s_add_u32 s31, s45, 2359296
    s_add_u32 m0, s47, 149504
    s_nop 0
    buffer_load_dwordx4 v28, s[12:15], s31 offen lds
    s_add_u32 s31, s45, 2490368
    s_add_u32 m0, s47, 150528
    s_nop 0
    buffer_load_dwordx4 v28, s[12:15], s31 offen lds
    s_waitcnt vmcnt(20)
    v_add_u32 v26, 65536, v23
    ds_read_b64_tr_b16 a[16:17], v26 offset:0
    ds_read_b64_tr_b16 a[18:19], v26 offset:512
    ds_read_b64_tr_b16 a[24:25], v26 offset:32
    ds_read_b64_tr_b16 a[26:27], v26 offset:544
    ds_read_b64_tr_b16 a[32:33], v26 offset:64
    ds_read_b64_tr_b16 a[34:35], v26 offset:576
    ds_read_b64_tr_b16 a[40:41], v26 offset:96
    ds_read_b64_tr_b16 a[42:43], v26 offset:608
    v_add_u32 v26, 81920, v23
    ds_read_b64_tr_b16 a[20:21], v26 offset:0
    ds_read_b64_tr_b16 a[22:23], v26 offset:512
    ds_read_b64_tr_b16 a[28:29], v26 offset:32
    ds_read_b64_tr_b16 a[30:31], v26 offset:544
    ds_read_b64_tr_b16 a[36:37], v26 offset:64
    ds_read_b64_tr_b16 a[38:39], v26 offset:576
    ds_read_b64_tr_b16 a[44:45], v26 offset:96
    ds_read_b64_tr_b16 a[46:47], v26 offset:608
    s_waitcnt lgkmcnt(0)
    s_add_u32 s31, s45, 2621440
    s_add_u32 m0, s47, 65536
    s_nop 0
    buffer_load_dwordx4 v28, s[12:15], s31 offen lds
    s_add_u32 s31, s45, 2752512
    s_add_u32 m0, s47, 66560
    s_nop 0
    buffer_load_dwordx4 v28, s[12:15], s31 offen lds
    s_add_u32 s31, s45, 2883584
    s_add_u32 m0, s47, 67584
    s_nop 0
    buffer_load_dwordx4 v28, s[12:15], s31 offen lds
    s_add_u32 s31, s45, 3014656
    s_add_u32 m0, s47, 68608
    s_nop 0
    buffer_load_dwordx4 v28, s[12:15], s31 offen lds
    s_add_u32 s31, s45, 3145728
    s_add_u32 m0, s47, 81920
    s_nop 0
    buffer_load_dwordx4 v28, s[12:15], s31 offen lds
    s_add_u32 s31, s45, 3276800
    s_add_u32 m0, s47, 82944
    s_nop 0
    buffer_load_dwordx4 v28, s[12:15], s31 offen lds
    s_add_u32 s31, s45, 3407872
    s_add_u32 m0, s47, 83968
    s_nop 0
    buffer_load_dwordx4 v28, s[12:15], s31 offen lds
    s_add_u32 s31, s45, 3538944
    s_add_u32 m0, s47, 84992
    s_nop 0
    buffer_load_dwordx4 v28, s[12:15], s31 offen lds
    s_waitcnt vmcnt(24)
    v_and_b32 v30, 7, v27
    v_mul_u32_u24 v30, 1152, v30
    v_lshl_add_u32 v30, v17, 5, v30
    s_lshr_b32 s31, s54, 3
    buffer_load_dwordx4 v[32:35], v30, s[24:27], s31 offen offset:0
    buffer_load_dwordx4 v[36:39], v30, s[24:27], s31 offen offset:16
    buffer_load_dwordx4 v[40:43], v30, s[24:27], s31 offen offset:128
    buffer_load_dwordx4 v[44:47], v30, s[24:27], s31 offen offset:144
    buffer_load_dwordx4 v[48:51], v30, s[24:27], s31 offen offset:256
    buffer_load_dwordx4 v[52:55], v30, s[24:27], s31 offen offset:272
    v_mov_b32 v30, 160
    buffer_load_dword v24, v30, s[20:23], 0 offen sc1
    v_add_u32 v26, 49152, v29
    ds_read_b64_tr_b16 a[208:209], v26 offset:0
    ds_read_b64_tr_b16 a[210:211], v26 offset:256
    ds_read_b64_tr_b16 a[212:213], v26 offset:2048
    ds_read_b64_tr_b16 a[214:215], v26 offset:2304
    ds_read_b64_tr_b16 a[216:217], v26 offset:32
    ds_read_b64_tr_b16 a[218:219], v26 offset:288
    ds_read_b64_tr_b16 a[220:221], v26 offset:2080
    ds_read_b64_tr_b16 a[222:223], v26 offset:2336
    s_waitcnt lgkmcnt(0)
    s_add_u32 s31, s45, 3670016
    s_add_u32 m0, s47, 49152
    s_nop 0
    buffer_load_dwordx4 v28, s[12:15], s31 offen lds
    s_add_u32 s31, s45, 3801088
    s_add_u32 m0, s47, 50176
    s_nop 0
    buffer_load_dwordx4 v28, s[12:15], s31 offen lds
    s_add_u32 s31, s45, 3932160
    s_add_u32 m0, s47, 51200
    s_nop 0
    buffer_load_dwordx4 v28, s[12:15], s31 offen lds
    s_add_u32 s31, s45, 4063232
    s_add_u32 m0, s47, 52224
    s_nop 0
    buffer_load_dwordx4 v28, s[12:15], s31 offen lds
    s_waitcnt vmcnt(31)
    v_add_u32 v26, 131072, v29
    ds_read_b64_tr_b16 a[224:225], v26 offset:0
    ds_read_b64_tr_b16 a[226:227], v26 offset:256
    ds_read_b64_tr_b16 a[228:229], v26 offset:2048
    ds_read_b64_tr_b16 a[230:231], v26 offset:2304
    ds_read_b64_tr_b16 a[232:233], v26 offset:32
    ds_read_b64_tr_b16 a[234:235], v26 offset:288
    ds_read_b64_tr_b16 a[236:237], v26 offset:2080
    ds_read_b64_tr_b16 a[238:239], v26 offset:2336
    s_waitcnt lgkmcnt(0)
    s_add_u32 s31, s45, 4194304
    s_add_u32 m0, s47, 131072
    s_nop 0
    buffer_load_dwordx4 v28, s[12:15], s31 offen lds
    s_add_u32 s31, s45, 4325376
    s_add_u32 m0, s47, 132096
    s_nop 0
    buffer_load_dwordx4 v28, s[12:15], s31 offen lds
    s_add_u32 s31, s45, 4456448
    s_add_u32 m0, s47, 133120
    s_nop 0
    buffer_load_dwordx4 v28, s[12:15], s31 offen lds
    s_add_u32 s31, s45, 4587520
    s_add_u32 m0, s47, 134144
    s_nop 0
    buffer_load_dwordx4 v28, s[12:15], s31 offen lds
    s_waitcnt vmcnt(31)
    v_add_u32 v26, 114688, v29
    ds_read_b64_tr_b16 a[240:241], v26 offset:0
    ds_read_b64_tr_b16 a[242:243], v26 offset:256
    ds_read_b64_tr_b16 a[244:245], v26 offset:2048
    ds_read_b64_tr_b16 a[246:247], v26 offset:2304
    ds_read_b64_tr_b16 a[248:249], v26 offset:32
    ds_read_b64_tr_b16 a[250:251], v26 offset:288
    ds_read_b64_tr_b16 a[252:253], v26 offset:2080
    ds_read_b64_tr_b16 a[254:255], v26 offset:2336
    s_waitcnt lgkmcnt(0)
    s_waitcnt vmcnt(27)
    v_add_u32 v26, 98304, v29
    ds_read_b64_tr_b16 v[64:65], v26 offset:0
    ds_read_b64_tr_b16 v[66:67], v26 offset:256
    ds_read_b64_tr_b16 v[68:69], v26 offset:2048
    ds_read_b64_tr_b16 v[70:71], v26 offset:2304
    ds_read_b64_tr_b16 v[72:73], v26 offset:32
    ds_read_b64_tr_b16 v[74:75], v26 offset:288
    ds_read_b64_tr_b16 v[76:77], v26 offset:2080
    ds_read_b64_tr_b16 v[78:79], v26 offset:2336
    s_waitcnt lgkmcnt(0)
    s_lshl_b32 s31, s57, 9
    s_add_u32 s31, s31, s44
    s_add_u32 s31, s31, 0
    s_add_u32 m0, s47, 114688
    s_nop 0
    buffer_load_dwordx4 v20, s[8:11], s31 offen lds
    s_lshl_b32 s31, s57, 9
    s_add_u32 s31, s31, s44
    s_add_u32 s31, s31, 65536
    s_add_u32 m0, s47, 115712
    s_nop 0
    buffer_load_dwordx4 v20, s[8:11], s31 offen lds
    s_lshl_b32 s31, s57, 9
    s_add_u32 s31, s31, s44
    s_add_u32 s31, s31, 131072
    s_add_u32 m0, s47, 116736
    s_nop 0
    buffer_load_dwordx4 v20, s[8:11], s31 offen lds
    s_lshl_b32 s31, s57, 9
    s_add_u32 s31, s31, s44
    s_add_u32 s31, s31, 196608
    s_add_u32 m0, s47, 117760
    s_nop 0
    buffer_load_dwordx4 v20, s[8:11], s31 offen lds
    s_lshl_b32 s31, s57, 9
    s_add_u32 s31, s31, s44
    s_add_u32 s31, s31, 262144
    s_add_u32 m0, s47, 98304
    s_nop 0
    buffer_load_dwordx4 v20, s[8:11], s31 offen lds
    s_lshl_b32 s31, s57, 9
    s_add_u32 s31, s31, s44
    s_add_u32 s31, s31, 327680
    s_add_u32 m0, s47, 99328
    s_nop 0
    buffer_load_dwordx4 v20, s[8:11], s31 offen lds
    s_lshl_b32 s31, s57, 9
    s_add_u32 s31, s31, s44
    s_add_u32 s31, s31, 393216
    s_add_u32 m0, s47, 100352
    s_nop 0
    buffer_load_dwordx4 v20, s[8:11], s31 offen lds
    s_lshl_b32 s31, s57, 9
    s_add_u32 s31, s31, s44
    s_add_u32 s31, s31, 458752
    s_add_u32 m0, s47, 101376
    s_nop 0
    buffer_load_dwordx4 v20, s[8:11], s31 offen lds
    s_waitcnt vmcnt(31)
    v_add_u32 v26, 147456, v29
    ds_read_b64_tr_b16 v[80:81], v26 offset:0
    ds_read_b64_tr_b16 v[82:83], v26 offset:256
    ds_read_b64_tr_b16 v[84:85], v26 offset:2048
    ds_read_b64_tr_b16 v[86:87], v26 offset:2304
    ds_read_b64_tr_b16 v[88:89], v26 offset:32
    ds_read_b64_tr_b16 v[90:91], v26 offset:288
    ds_read_b64_tr_b16 v[92:93], v26 offset:2080
    ds_read_b64_tr_b16 v[94:95], v26 offset:2336
    s_waitcnt lgkmcnt(0)
    s_waitcnt vmcnt(27)
    v_add_u32 v26, 65536, v29
    ds_read_b64_tr_b16 v[96:97], v26 offset:0
    ds_read_b64_tr_b16 v[98:99], v26 offset:256
    ds_read_b64_tr_b16 v[100:101], v26 offset:2048
    ds_read_b64_tr_b16 v[102:103], v26 offset:2304
    ds_read_b64_tr_b16 v[104:105], v26 offset:32
    ds_read_b64_tr_b16 v[106:107], v26 offset:288
    ds_read_b64_tr_b16 v[108:109], v26 offset:2080
    ds_read_b64_tr_b16 v[110:111], v26 offset:2336
    s_waitcnt lgkmcnt(0)
    s_lshl_b32 s31, s59, 9
    s_add_u32 s31, s31, s44
    s_add_u32 s31, s31, 0
    s_add_u32 m0, s47, 65536
    s_nop 0
    buffer_load_dwordx4 v20, s[8:11], s31 offen lds
    s_lshl_b32 s31, s59, 9
    s_add_u32 s31, s31, s44
    s_add_u32 s31, s31, 65536
    s_add_u32 m0, s47, 66560
    s_nop 0
    buffer_load_dwordx4 v20, s[8:11], s31 offen lds
    s_lshl_b32 s31, s59, 9
    s_add_u32 s31, s31, s44
    s_add_u32 s31, s31, 131072
    s_add_u32 m0, s47, 67584
    s_nop 0
    buffer_load_dwordx4 v20, s[8:11], s31 offen lds
    s_lshl_b32 s31, s59, 9
    s_add_u32 s31, s31, s44
    s_add_u32 s31, s31, 196608
    s_add_u32 m0, s47, 68608
    s_nop 0
    buffer_load_dwordx4 v20, s[8:11], s31 offen lds
    s_lshl_b32 s31, s59, 9
    s_add_u32 s31, s31, s44
    s_add_u32 s31, s31, 262144
    s_add_u32 m0, s47, 147456
    s_nop 0
    buffer_load_dwordx4 v20, s[8:11], s31 offen lds
    s_lshl_b32 s31, s59, 9
    s_add_u32 s31, s31, s44
    s_add_u32 s31, s31, 327680
    s_add_u32 m0, s47, 148480
    s_nop 0
    buffer_load_dwordx4 v20, s[8:11], s31 offen lds
    s_lshl_b32 s31, s59, 9
    s_add_u32 s31, s31, s44
    s_add_u32 s31, s31, 393216
    s_add_u32 m0, s47, 149504
    s_nop 0
    buffer_load_dwordx4 v20, s[8:11], s31 offen lds
    s_lshl_b32 s31, s59, 9
    s_add_u32 s31, s31, s44
    s_add_u32 s31, s31, 458752
    s_add_u32 m0, s47, 150528
    s_nop 0
    buffer_load_dwordx4 v20, s[8:11], s31 offen lds
    s_waitcnt vmcnt(31)
    v_add_u32 v26, 81920, v29
    ds_read_b64_tr_b16 v[112:113], v26 offset:0
    ds_read_b64_tr_b16 v[114:115], v26 offset:256
    ds_read_b64_tr_b16 v[116:117], v26 offset:2048
    ds_read_b64_tr_b16 v[118:119], v26 offset:2304
    ds_read_b64_tr_b16 v[120:121], v26 offset:32
    ds_read_b64_tr_b16 v[122:123], v26 offset:288
    ds_read_b64_tr_b16 v[124:125], v26 offset:2080
    ds_read_b64_tr_b16 v[126:127], v26 offset:2336
    s_waitcnt lgkmcnt(0)
    s_waitcnt vmcnt(20)
    v_mov_b32 v30, 0x05040100
    v_mov_b32 v26, 0x07060302
    v_cmp_ne_u32 vcc, 0x4444, v0
    v_readfirstlane_b32 s86, v24
    s_nop 1
    v_cndmask_b32 v30, v30, v26, vcc
    v_perm_b32 v56, v33, v32, v30
    v_min_u32 v56, -2, v56
    v_perm_b32 v57, v35, v34, v30
    v_min_u32 v57, -2, v57
    v_perm_b32 v58, v37, v36, v30
    v_min_u32 v58, -2, v58
    v_perm_b32 v59, v39, v38, v30
    v_min_u32 v59, -2, v59
    v_perm_b32 v60, v41, v40, v30
    v_min_u32 v60, -2, v60
    v_perm_b32 v61, v43, v42, v30
    v_min_u32 v61, -2, v61
    v_perm_b32 v62, v45, v44, v30
    v_min_u32 v62, -2, v62
    v_perm_b32 v63, v47, v46, v30
    v_min_u32 v63, -2, v63
    v_perm_b32 v12, v49, v48, v30
    v_min_u32 v12, -2, v12
    v_perm_b32 v13, v51, v50, v30
    v_min_u32 v13, -2, v13
    v_perm_b32 v14, v53, v52, v30
    v_min_u32 v14, -2, v14
    v_perm_b32 v15, v55, v54, v30
    v_min_u32 v15, -2, v15
    v_add_u32 v26, 49152, v29
    ds_read_b64_tr_b16 v[128:129], v26 offset:0
    ds_read_b64_tr_b16 v[130:131], v26 offset:256
    ds_read_b64_tr_b16 v[132:133], v26 offset:2048
    ds_read_b64_tr_b16 v[134:135], v26 offset:2304
    ds_read_b64_tr_b16 v[136:137], v26 offset:32
    ds_read_b64_tr_b16 v[138:139], v26 offset:288
    ds_read_b64_tr_b16 v[140:141], v26 offset:2080
    ds_read_b64_tr_b16 v[142:143], v26 offset:2336
    s_waitcnt lgkmcnt(0)
    s_lshl_b32 s31, s61, 9
    s_add_u32 s31, s31, s44
    s_add_u32 s31, s31, 0
    s_add_u32 m0, s47, 81920
    s_nop 0
    buffer_load_dwordx4 v20, s[8:11], s31 offen lds
    s_lshl_b32 s31, s61, 9
    s_add_u32 s31, s31, s44
    s_add_u32 s31, s31, 65536
    s_add_u32 m0, s47, 82944
    s_nop 0
    buffer_load_dwordx4 v20, s[8:11], s31 offen lds
    s_lshl_b32 s31, s61, 9
    s_add_u32 s31, s31, s44
    s_add_u32 s31, s31, 131072
    s_add_u32 m0, s47, 83968
    s_nop 0
    buffer_load_dwordx4 v20, s[8:11], s31 offen lds
    s_lshl_b32 s31, s61, 9
    s_add_u32 s31, s31, s44
    s_add_u32 s31, s31, 196608
    s_add_u32 m0, s47, 84992
    s_nop 0
    buffer_load_dwordx4 v20, s[8:11], s31 offen lds
    s_lshl_b32 s31, s61, 9
    s_add_u32 s31, s31, s44
    s_add_u32 s31, s31, 262144
    s_add_u32 m0, s47, 49152
    s_nop 0
    buffer_load_dwordx4 v20, s[8:11], s31 offen lds
    s_lshl_b32 s31, s61, 9
    s_add_u32 s31, s31, s44
    s_add_u32 s31, s31, 327680
    s_add_u32 m0, s47, 50176
    s_nop 0
    buffer_load_dwordx4 v20, s[8:11], s31 offen lds
    s_lshl_b32 s31, s61, 9
    s_add_u32 s31, s31, s44
    s_add_u32 s31, s31, 393216
    s_add_u32 m0, s47, 51200
    s_nop 0
    buffer_load_dwordx4 v20, s[8:11], s31 offen lds
    s_lshl_b32 s31, s61, 9
    s_add_u32 s31, s31, s44
    s_add_u32 s31, s31, 458752
    s_add_u32 m0, s47, 52224
    s_nop 0
    buffer_load_dwordx4 v20, s[8:11], s31 offen lds
    s_waitcnt vmcnt(24)
    v_add_u32 v26, 131072, v29
    ds_read_b64_tr_b16 v[144:145], v26 offset:0
    ds_read_b64_tr_b16 v[146:147], v26 offset:256
    ds_read_b64_tr_b16 v[148:149], v26 offset:2048
    ds_read_b64_tr_b16 v[150:151], v26 offset:2304
    ds_read_b64_tr_b16 v[152:153], v26 offset:32
    ds_read_b64_tr_b16 v[154:155], v26 offset:288
    ds_read_b64_tr_b16 v[156:157], v26 offset:2080
    ds_read_b64_tr_b16 v[158:159], v26 offset:2336
    s_waitcnt lgkmcnt(0)
    s_waitcnt vmcnt(16)
    v_add_u32 v26, 114688, v23
    ds_read_b64_tr_b16 a[64:65], v26 offset:0
    ds_read_b64_tr_b16 a[66:67], v26 offset:512
    ds_read_b64_tr_b16 a[72:73], v26 offset:32
    ds_read_b64_tr_b16 a[74:75], v26 offset:544
    ds_read_b64_tr_b16 a[80:81], v26 offset:64
    ds_read_b64_tr_b16 a[82:83], v26 offset:576
    ds_read_b64_tr_b16 a[88:89], v26 offset:96
    ds_read_b64_tr_b16 a[90:91], v26 offset:608
    v_add_u32 v26, 98304, v23
    ds_read_b64_tr_b16 a[68:69], v26 offset:0
    ds_read_b64_tr_b16 a[70:71], v26 offset:512
    ds_read_b64_tr_b16 a[76:77], v26 offset:32
    ds_read_b64_tr_b16 a[78:79], v26 offset:544
    ds_read_b64_tr_b16 a[84:85], v26 offset:64
    ds_read_b64_tr_b16 a[86:87], v26 offset:576
    ds_read_b64_tr_b16 a[92:93], v26 offset:96
    ds_read_b64_tr_b16 a[94:95], v26 offset:608
    s_waitcnt lgkmcnt(0)
    s_waitcnt vmcnt(8)
    v_add_u32 v26, 65536, v23
    ds_read_b64_tr_b16 a[112:113], v26 offset:0
    ds_read_b64_tr_b16 a[114:115], v26 offset:512
    ds_read_b64_tr_b16 a[120:121], v26 offset:32
    ds_read_b64_tr_b16 a[122:123], v26 offset:544
    ds_read_b64_tr_b16 a[128:129], v26 offset:64
    ds_read_b64_tr_b16 a[130:131], v26 offset:576
    ds_read_b64_tr_b16 a[136:137], v26 offset:96
    ds_read_b64_tr_b16 a[138:139], v26 offset:608
    v_add_u32 v26, 147456, v23
    ds_read_b64_tr_b16 a[116:117], v26 offset:0
    ds_read_b64_tr_b16 a[118:119], v26 offset:512
    ds_read_b64_tr_b16 a[124:125], v26 offset:32
    ds_read_b64_tr_b16 a[126:127], v26 offset:544
    ds_read_b64_tr_b16 a[132:133], v26 offset:64
    ds_read_b64_tr_b16 a[134:135], v26 offset:576
    ds_read_b64_tr_b16 a[140:141], v26 offset:96
    ds_read_b64_tr_b16 a[142:143], v26 offset:608
    s_waitcnt lgkmcnt(0)
    s_waitcnt vmcnt(0)
    v_add_u32 v26, 81920, v23
    ds_read_b64_tr_b16 a[160:161], v26 offset:0
    ds_read_b64_tr_b16 a[162:163], v26 offset:512
    ds_read_b64_tr_b16 a[168:169], v26 offset:32
    ds_read_b64_tr_b16 a[170:171], v26 offset:544
    ds_read_b64_tr_b16 a[176:177], v26 offset:64
    ds_read_b64_tr_b16 a[178:179], v26 offset:576
    ds_read_b64_tr_b16 a[184:185], v26 offset:96
    ds_read_b64_tr_b16 a[186:187], v26 offset:608
    v_add_u32 v26, 49152, v23
    ds_read_b64_tr_b16 a[164:165], v26 offset:0
    ds_read_b64_tr_b16 a[166:167], v26 offset:512
    ds_read_b64_tr_b16 a[172:173], v26 offset:32
    ds_read_b64_tr_b16 a[174:175], v26 offset:544
    ds_read_b64_tr_b16 a[180:181], v26 offset:64
    ds_read_b64_tr_b16 a[182:183], v26 offset:576
    ds_read_b64_tr_b16 a[188:189], v26 offset:96
    ds_read_b64_tr_b16 a[190:191], v26 offset:608
    s_waitcnt lgkmcnt(0)
    s_lshl_b32 s31, s54, 9
    s_add_u32 s31, s31, s44
    s_add_u32 s31, s31, 0
    s_add_u32 m0, s47, 49152
    s_nop 0
    buffer_load_dwordx4 v20, s[8:11], s31 offen lds
    s_lshl_b32 s31, s54, 9
    s_add_u32 s31, s31, s44
    s_add_u32 s31, s31, 65536
    s_add_u32 m0, s47, 50176
    s_nop 0
    buffer_load_dwordx4 v20, s[8:11], s31 offen lds
    s_lshl_b32 s31, s54, 9
    s_add_u32 s31, s31, s44
    s_add_u32 s31, s31, 131072
    s_add_u32 m0, s47, 51200
    s_nop 0
    buffer_load_dwordx4 v20, s[8:11], s31 offen lds
    s_lshl_b32 s31, s54, 9
    s_add_u32 s31, s31, s44
    s_add_u32 s31, s31, 196608
    s_add_u32 m0, s47, 52224
    s_nop 0
    buffer_load_dwordx4 v20, s[8:11], s31 offen lds
    s_lshl_b32 s31, s54, 9
    s_add_u32 s31, s31, s44
    s_add_u32 s31, s31, 262144
    s_add_u32 m0, s47, 65536
    s_nop 0
    buffer_load_dwordx4 v20, s[8:11], s31 offen lds
    s_lshl_b32 s31, s54, 9
    s_add_u32 s31, s31, s44
    s_add_u32 s31, s31, 327680
    s_add_u32 m0, s47, 66560
    s_nop 0
    buffer_load_dwordx4 v20, s[8:11], s31 offen lds
    s_lshl_b32 s31, s54, 9
    s_add_u32 s31, s31, s44
    s_add_u32 s31, s31, 393216
    s_add_u32 m0, s47, 67584
    s_nop 0
    buffer_load_dwordx4 v20, s[8:11], s31 offen lds
    s_lshl_b32 s31, s54, 9
    s_add_u32 s31, s31, s44
    s_add_u32 s31, s31, 458752
    s_add_u32 m0, s47, 68608
    s_nop 0
    buffer_load_dwordx4 v20, s[8:11], s31 offen lds
    s_lshl_b32 s31, s56, 9
    s_add_u32 s31, s31, s44
    s_add_u32 s31, s31, 0
    s_add_u32 m0, s47, 98304
    s_nop 0
    buffer_load_dwordx4 v20, s[8:11], s31 offen lds
    s_lshl_b32 s31, s56, 9
    s_add_u32 s31, s31, s44
    s_add_u32 s31, s31, 65536
    s_add_u32 m0, s47, 99328
    s_nop 0
    buffer_load_dwordx4 v20, s[8:11], s31 offen lds
    s_lshl_b32 s31, s56, 9
    s_add_u32 s31, s31, s44
    s_add_u32 s31, s31, 131072
    s_add_u32 m0, s47, 100352
    s_nop 0
    buffer_load_dwordx4 v20, s[8:11], s31 offen lds
    s_lshl_b32 s31, s56, 9
    s_add_u32 s31, s31, s44
    s_add_u32 s31, s31, 196608
    s_add_u32 m0, s47, 101376
    s_nop 0
    buffer_load_dwordx4 v20, s[8:11], s31 offen lds
    s_lshl_b32 s31, s56, 9
    s_add_u32 s31, s31, s44
    s_add_u32 s31, s31, 262144
    s_add_u32 m0, s47, 81920
    s_nop 0
    buffer_load_dwordx4 v20, s[8:11], s31 offen lds
    s_lshl_b32 s31, s56, 9
    s_add_u32 s31, s31, s44
    s_add_u32 s31, s31, 327680
    s_add_u32 m0, s47, 82944
    s_nop 0
    buffer_load_dwordx4 v20, s[8:11], s31 offen lds
    s_lshl_b32 s31, s56, 9
    s_add_u32 s31, s31, s44
    s_add_u32 s31, s31, 393216
    s_add_u32 m0, s47, 83968
    s_nop 0
    buffer_load_dwordx4 v20, s[8:11], s31 offen lds
    s_lshl_b32 s31, s56, 9
    s_add_u32 s31, s31, s44
    s_add_u32 s31, s31, 458752
    s_add_u32 m0, s47, 84992
    s_nop 0
    buffer_load_dwordx4 v20, s[8:11], s31 offen lds
    s_lshl_b32 s31, s58, 9
    s_add_u32 s31, s31, s44
    s_add_u32 s31, s31, 0
    s_add_u32 m0, s47, 114688
    s_nop 0
    buffer_load_dwordx4 v20, s[8:11], s31 offen lds
    s_lshl_b32 s31, s58, 9
    s_add_u32 s31, s31, s44
    s_add_u32 s31, s31, 65536
    s_add_u32 m0, s47, 115712
    s_nop 0
    buffer_load_dwordx4 v20, s[8:11], s31 offen lds
    s_lshl_b32 s31, s58, 9
    s_add_u32 s31, s31, s44
    s_add_u32 s31, s31, 131072
    s_add_u32 m0, s47, 116736
    s_nop 0
    buffer_load_dwordx4 v20, s[8:11], s31 offen lds
    s_lshl_b32 s31, s58, 9
    s_add_u32 s31, s31, s44
    s_add_u32 s31, s31, 196608
    s_add_u32 m0, s47, 117760
    s_nop 0
    buffer_load_dwordx4 v20, s[8:11], s31 offen lds
    s_lshl_b32 s31, s58, 9
    s_add_u32 s31, s31, s44
    s_add_u32 s31, s31, 262144
    s_add_u32 m0, s47, 147456
    s_nop 0
    buffer_load_dwordx4 v20, s[8:11], s31 offen lds
    s_lshl_b32 s31, s58, 9
    s_add_u32 s31, s31, s44
    s_add_u32 s31, s31, 327680
    s_add_u32 m0, s47, 148480
    s_nop 0
    buffer_load_dwordx4 v20, s[8:11], s31 offen lds
    s_lshl_b32 s31, s58, 9
    s_add_u32 s31, s31, s44
    s_add_u32 s31, s31, 393216
    s_add_u32 m0, s47, 149504
    s_nop 0
    buffer_load_dwordx4 v20, s[8:11], s31 offen lds
    s_lshl_b32 s31, s58, 9
    s_add_u32 s31, s31, s44
    s_add_u32 s31, s31, 458752
    s_add_u32 m0, s47, 150528
    s_nop 0
    buffer_load_dwordx4 v20, s[8:11], s31 offen lds
    s_waitcnt vmcnt(16)
    v_add_u32 v26, 49152, v23
    ds_read_b64_tr_b16 a[0:1], v26 offset:0
    ds_read_b64_tr_b16 a[2:3], v26 offset:512
    ds_read_b64_tr_b16 a[8:9], v26 offset:32
    ds_read_b64_tr_b16 a[10:11], v26 offset:544
    ds_read_b64_tr_b16 v[32:33], v26 offset:64
    ds_read_b64_tr_b16 v[34:35], v26 offset:576
    ds_read_b64_tr_b16 v[40:41], v26 offset:96
    ds_read_b64_tr_b16 v[42:43], v26 offset:608
    v_add_u32 v26, 65536, v23
    ds_read_b64_tr_b16 a[4:5], v26 offset:0
    ds_read_b64_tr_b16 a[6:7], v26 offset:512
    ds_read_b64_tr_b16 a[12:13], v26 offset:32
    ds_read_b64_tr_b16 a[14:15], v26 offset:544
    ds_read_b64_tr_b16 v[36:37], v26 offset:64
    ds_read_b64_tr_b16 v[38:39], v26 offset:576
    ds_read_b64_tr_b16 v[44:45], v26 offset:96
    ds_read_b64_tr_b16 v[46:47], v26 offset:608
    s_waitcnt lgkmcnt(0)
    ds_write_b128 v2, v[32:35] offset:49152
    ds_write_b128 v2, v[36:39] offset:50176
    ds_write_b128 v2, v[40:43] offset:51200
    ds_write_b128 v2, v[44:47] offset:52224
    s_lshl_b32 s31, s60, 9
    s_add_u32 s31, s31, s44
    s_add_u32 s31, s31, 0
    s_add_u32 m0, s47, 131072
    s_nop 0
    buffer_load_dwordx4 v20, s[8:11], s31 offen lds
    s_lshl_b32 s31, s60, 9
    s_add_u32 s31, s31, s44
    s_add_u32 s31, s31, 65536
    s_add_u32 m0, s47, 132096
    s_nop 0
    buffer_load_dwordx4 v20, s[8:11], s31 offen lds
    s_lshl_b32 s31, s60, 9
    s_add_u32 s31, s31, s44
    s_add_u32 s31, s31, 131072
    s_add_u32 m0, s47, 133120
    s_nop 0
    buffer_load_dwordx4 v20, s[8:11], s31 offen lds
    s_lshl_b32 s31, s60, 9
    s_add_u32 s31, s31, s44
    s_add_u32 s31, s31, 196608
    s_add_u32 m0, s47, 134144
    s_nop 0
    buffer_load_dwordx4 v20, s[8:11], s31 offen lds
    s_lshl_b32 s31, s60, 9
    s_add_u32 s31, s31, s44
    s_add_u32 s31, s31, 262144
    s_add_u32 m0, s47, 65536
    s_nop 0
    buffer_load_dwordx4 v20, s[8:11], s31 offen lds
    s_lshl_b32 s31, s60, 9
    s_add_u32 s31, s31, s44
    s_add_u32 s31, s31, 327680
    s_add_u32 m0, s47, 66560
    s_nop 0
    buffer_load_dwordx4 v20, s[8:11], s31 offen lds
    s_lshl_b32 s31, s60, 9
    s_add_u32 s31, s31, s44
    s_add_u32 s31, s31, 393216
    s_add_u32 m0, s47, 67584
    s_nop 0
    buffer_load_dwordx4 v20, s[8:11], s31 offen lds
    s_lshl_b32 s31, s60, 9
    s_add_u32 s31, s31, s44
    s_add_u32 s31, s31, 458752
    s_add_u32 m0, s47, 68608
    s_nop 0
    buffer_load_dwordx4 v20, s[8:11], s31 offen lds
    s_waitcnt vmcnt(16)
    v_add_u32 v26, 98304, v23
    ds_read_b64_tr_b16 a[48:49], v26 offset:0
    ds_read_b64_tr_b16 a[50:51], v26 offset:512
    ds_read_b64_tr_b16 a[56:57], v26 offset:32
    ds_read_b64_tr_b16 a[58:59], v26 offset:544
    ds_read_b64_tr_b16 v[32:33], v26 offset:64
    ds_read_b64_tr_b16 v[34:35], v26 offset:576
    ds_read_b64_tr_b16 v[40:41], v26 offset:96
    ds_read_b64_tr_b16 v[42:43], v26 offset:608
    v_add_u32 v26, 81920, v23
    ds_read_b64_tr_b16 a[52:53], v26 offset:0
    ds_read_b64_tr_b16 a[54:55], v26 offset:512
    ds_read_b64_tr_b16 a[60:61], v26 offset:32
    ds_read_b64_tr_b16 a[62:63], v26 offset:544
    ds_read_b64_tr_b16 v[36:37], v26 offset:64
    ds_read_b64_tr_b16 v[38:39], v26 offset:576
    ds_read_b64_tr_b16 v[44:45], v26 offset:96
    ds_read_b64_tr_b16 v[46:47], v26 offset:608
    s_waitcnt lgkmcnt(0)
    ds_write_b128 v3, v[32:35] offset:0
    ds_write_b128 v3, v[36:39] offset:1024
    ds_write_b128 v3, v[40:43] offset:2048
    ds_write_b128 v3, v[44:47] offset:3072
    s_waitcnt vmcnt(8)
    v_mov_b32 v30, 0
    s_mov_b32 s31, 65536
    buffer_load_dword v24, v30, s[4:7], s31 offen sc1
    s_getpc_b64 s[82:83]
Lpc_24:
    s_add_u32 s82, s82, Lstep-Lpc_24
    s_addc_u32 s83, s83, 0
    v_lshlrev_b32 v30, 2, v2
    v_and_b32 v30, 0xfff, v30
    s_and_b32 s31, s29, 1
    s_lshl_b32 s31, s31, 12
    v_add_u32 v30, s31, v30
    global_load_dword v52, v30, s[82:83]
    v_add_u32 v26, 114688, v23
    ds_read_b64_tr_b16 a[96:97], v26 offset:0
    ds_read_b64_tr_b16 a[98:99], v26 offset:512
    ds_read_b64_tr_b16 a[104:105], v26 offset:32
    ds_read_b64_tr_b16 a[106:107], v26 offset:544
    ds_read_b64_tr_b16 v[32:33], v26 offset:64
    ds_read_b64_tr_b16 v[34:35], v26 offset:576
    ds_read_b64_tr_b16 v[40:41], v26 offset:96
    ds_read_b64_tr_b16 v[42:43], v26 offset:608
    v_add_u32 v26, 147456, v23
    ds_read_b64_tr_b16 a[100:101], v26 offset:0
    ds_read_b64_tr_b16 a[102:103], v26 offset:512
    ds_read_b64_tr_b16 a[108:109], v26 offset:32
    ds_read_b64_tr_b16 a[110:111], v26 offset:544
    ds_read_b64_tr_b16 v[36:37], v26 offset:64
    ds_read_b64_tr_b16 v[38:39], v26 offset:576
    ds_read_b64_tr_b16 v[44:45], v26 offset:96
    ds_read_b64_tr_b16 v[46:47], v26 offset:608
    s_waitcnt lgkmcnt(0)
    ds_write_b128 v3, v[32:35] offset:16384
    ds_write_b128 v3, v[36:39] offset:17408
    ds_write_b128 v3, v[40:43] offset:18432
    ds_write_b128 v3, v[44:47] offset:19456
    s_lshl_b32 s31, s62, 9
    s_add_u32 s31, s31, s44
    s_add_u32 s31, s31, 0
    s_add_u32 m0, s47, 147456
    s_nop 0
    buffer_load_dwordx4 v20, s[8:11], s31 offen lds
    s_lshl_b32 s31, s62, 9
    s_add_u32 s31, s31, s44
    s_add_u32 s31, s31, 65536
    s_add_u32 m0, s47, 148480
    s_nop 0
    buffer_load_dwordx4 v20, s[8:11], s31 offen lds
    s_lshl_b32 s31, s62, 9
    s_add_u32 s31, s31, s44
    s_add_u32 s31, s31, 131072
    s_add_u32 m0, s47, 149504
    s_nop 0
    buffer_load_dwordx4 v20, s[8:11], s31 offen lds
    s_lshl_b32 s31, s62, 9
    s_add_u32 s31, s31, s44
    s_add_u32 s31, s31, 196608
    s_add_u32 m0, s47, 150528
    s_nop 0
    buffer_load_dwordx4 v20, s[8:11], s31 offen lds
    s_lshl_b32 s31, s62, 9
    s_add_u32 s31, s31, s44
    s_add_u32 s31, s31, 262144
    s_add_u32 m0, s47, 81920
    s_nop 0
    buffer_load_dwordx4 v20, s[8:11], s31 offen lds
    s_lshl_b32 s31, s62, 9
    s_add_u32 s31, s31, s44
    s_add_u32 s31, s31, 327680
    s_add_u32 m0, s47, 82944
    s_nop 0
    buffer_load_dwordx4 v20, s[8:11], s31 offen lds
    s_lshl_b32 s31, s62, 9
    s_add_u32 s31, s31, s44
    s_add_u32 s31, s31, 393216
    s_add_u32 m0, s47, 83968
    s_nop 0
    buffer_load_dwordx4 v20, s[8:11], s31 offen lds
    s_lshl_b32 s31, s62, 9
    s_add_u32 s31, s31, s44
    s_add_u32 s31, s31, 458752
    s_add_u32 m0, s47, 84992
    s_nop 0
    buffer_load_dwordx4 v20, s[8:11], s31 offen lds
    s_waitcnt vmcnt(10)
    v_add_u32 v26, 131072, v23
    ds_read_b64_tr_b16 a[144:145], v26 offset:0
    ds_read_b64_tr_b16 a[146:147], v26 offset:512
    ds_read_b64_tr_b16 a[152:153], v26 offset:32
    ds_read_b64_tr_b16 a[154:155], v26 offset:544
    ds_read_b64_tr_b16 v[32:33], v26 offset:64
    ds_read_b64_tr_b16 v[34:35], v26 offset:576
    ds_read_b64_tr_b16 v[40:41], v26 offset:96
    ds_read_b64_tr_b16 v[42:43], v26 offset:608
    v_add_u32 v26, 65536, v23
    ds_read_b64_tr_b16 a[148:149], v26 offset:0
    ds_read_b64_tr_b16 a[150:151], v26 offset:512
    ds_read_b64_tr_b16 a[156:157], v26 offset:32
    ds_read_b64_tr_b16 a[158:159], v26 offset:544
    ds_read_b64_tr_b16 v[36:37], v26 offset:64
    ds_read_b64_tr_b16 v[38:39], v26 offset:576
    ds_read_b64_tr_b16 v[44:45], v26 offset:96
    ds_read_b64_tr_b16 v[46:47], v26 offset:608
    s_waitcnt lgkmcnt(0)
    ds_write_b128 v3, v[32:35] offset:32768
    ds_write_b128 v3, v[36:39] offset:33792
    ds_write_b128 v3, v[40:43] offset:34816
    ds_write_b128 v3, v[44:47] offset:35840
    s_waitcnt vmcnt(0)
    v_add_u32 v26, 147456, v23
    ds_read_b64_tr_b16 a[192:193], v26 offset:0
    ds_read_b64_tr_b16 a[194:195], v26 offset:512
    ds_read_b64_tr_b16 a[200:201], v26 offset:32
    ds_read_b64_tr_b16 a[202:203], v26 offset:544
    ds_read_b64_tr_b16 v[32:33], v26 offset:64
    ds_read_b64_tr_b16 v[34:35], v26 offset:576
    ds_read_b64_tr_b16 v[40:41], v26 offset:96
    ds_read_b64_tr_b16 v[42:43], v26 offset:608
    v_add_u32 v26, 81920, v23
    ds_read_b64_tr_b16 a[196:197], v26 offset:0
    ds_read_b64_tr_b16 a[198:199], v26 offset:512
    ds_read_b64_tr_b16 a[204:205], v26 offset:32
    ds_read_b64_tr_b16 a[206:207], v26 offset:544
    ds_read_b64_tr_b16 v[36:37], v26 offset:64
    ds_read_b64_tr_b16 v[38:39], v26 offset:576
    ds_read_b64_tr_b16 v[44:45], v26 offset:96
    ds_read_b64_tr_b16 v[46:47], v26 offset:608
    s_waitcnt lgkmcnt(0)
    ds_write_b128 v3, v[32:35] offset:49152
    ds_write_b128 v3, v[36:39] offset:50176
    ds_write_b128 v3, v[40:43] offset:51200
    ds_write_b128 v3, v[44:47] offset:52224
Lwdone_22:
    s_waitcnt vmcnt(0) lgkmcnt(0)
    s_barrier
    v_and_b32 v18, 1, v27
    v_lshlrev_b32 v18, 4, v18
    v_mov_b32 v19, 0x3f80
    v_lshlrev_b32 v19, v18, v19
    v_lshrrev_b32 v18, 1, v16
    v_cmp_eq_u32 vcc, 0, v18
    s_nop 1
    v_cndmask_b32 v32, 0, v19, vcc
    v_cmp_eq_u32 vcc, 1, v18
    s_nop 1
    v_cndmask_b32 v33, 0, v19, vcc
    v_cmp_eq_u32 vcc, 2, v18
    s_nop 1
    v_cndmask_b32 v34, 0, v19, vcc
    v_cmp_eq_u32 vcc, 3, v18
    s_nop 1
    v_cndmask_b32 v35, 0, v19, vcc
    ds_write_b128 v1, v[32:35] offset:29696
    v_lshrrev_b32 v18, 2, v1
    v_add_u32 v18, 79872, v18
    ds_write_b32 v18, v31
    s_mov_b32 s88, 0x3f803f80
    s_mov_b32 s89, 0x3f803f80
    s_mov_b32 s90, 0x3f003f00
    s_mov_b32 s91, 0x3f003f00
    s_mul_i32 s38, s28, 1064960
    s_add_u32 s38, s38, 16711680
    s_add_u32 s38, s38, s68
    s_add_u32 s87, s68, 65536
    s_add_u32 s71, s54, 81920
    s_lshl_b32 s93, s28, 7
    s_add_u32 s93, s93, 66560
    s_mov_b32 s95, 0
    s_lshl_b32 s84, s28, 12
    s_lshl_b32 s31, s29, 10
    s_add_u32 s84, s84, s31
    s_sub_u32 s84, s84, 65536
    s_mov_b32 s85, 2146435072
    s_cmp_lt_u32 s28, 8
    s_cselect_b32 s85, 262144, s85
    s_mov_b32 s44, 2146435072
    s_mov_b32 s45, 2146435072
    s_mov_b32 s46, 2146435072
    s_mov_b32 s47, 2146435072
    s_mov_b32 s81, 2146435072
    v_readfirstlane_b32 s32, v24
    s_mov_b32 s94, s86
    s_and_b32 s31, s94, 0xffff
    s_cmp_ge_u32 s31, 128
    s_cbranch_scc1 Larr_26
    s_mov_b32 s33, 0
    v_mov_b32 v33, 160
Lpinit_25:
    buffer_load_dword v32, v33, s[20:23], 0 offen sc1
    s_add_u32 s33, s33, 1
    s_cmp_gt_u32 s33, 1048576
    s_cbranch_scc1 Lchain_exit
    s_waitcnt vmcnt(0)
    v_readfirstlane_b32 s94, v32
    s_and_b32 s31, s94, 0xffff
    s_cmp_lt_u32 s31, 128
    s_cbranch_scc1 Lpinit_25
    s_mov_b32 s32, 0
Larr_26:
    s_mov_b32 s86, s32
    v_mov_b64 v[16:17], v[56:57]
    v_mov_b64 v[18:19], v[58:59]
    v_mov_b64 v[20:21], v[60:61]
    v_mov_b64 v[22:23], v[62:63]
    v_mov_b64 v[24:25], v[12:13]
    v_mov_b64 v[26:27], v[14:15]
    v_mov_b32 v61, 0
    v_add_u32 v32, s54, v1
    ds_write_b128 v32, v[16:19] offset:16384
    ds_write_b128 v32, v[20:23] offset:17408
    ds_write_b128 v32, v[24:27] offset:18432
    s_mov_b32 s30, 0
    s_mov_b32 s41, 2146435072
    s_mov_b32 s37, 2146435072
    v_mov_b32 v9, 0
    s_cmp_ge_u32 s86, 128
    s_cbranch_scc1 Lkv0_27
    v_lshrrev_b32 v34, 2, v1
    v_and_b32 v34, 31, v34
    s_mov_b32 s32, 65536
    s_mov_b32 s33, 0
Lkvw_28:
    buffer_load_dword v35, v34, s[4:7], s32 offen sc1
    s_add_u32 s33, s33, 1
    s_cmp_gt_u32 s33, 1048576
    s_cbranch_scc1 Lchain_exit
    s_add_u32 s31, s30, 2
    s_lshr_b32 s31, s31, 3
    s_min_u32 s31, s31, 7
    s_waitcnt vmcnt(0)
    v_cmp_le_u32 vcc, 128, v35
    s_bitcmp1_b32 vcc_lo, s31
    s_cbranch_scc0 Lkvw_28
    s_cmp_eq_u64 vcc, exec
    s_cselect_b32 s95, 1, 0
Lkv0_27:
    s_mov_b32 m0, s87
    s_nop 0
    buffer_load_dwordx4 v1, s[4:7], s38 offen offset:0 sc1 lds
    buffer_load_dwordx4 v1, s[4:7], s38 offen offset:1024 sc1 lds
    s_add_u32 m0, s87, 8192
    s_add_u32 s92, s38, 8192
    buffer_load_dwordx4 v1, s[4:7], s92 offen offset:0 sc1 lds
    buffer_load_dwordx4 v1, s[4:7], s92 offen offset:1024 sc1 lds
    ds_read_b128 v[44:47], v2 offset:49152
    ds_read_b128 v[48:51], v2 offset:50176
    ds_read_b128 v[52:55], v2 offset:51200
    ds_read_b128 v[56:59], v2 offset:52224
    v_add_u32 v10, s57, v1
    v_add_u32 v11, s60, v1
    s_and_b32 s31, s30, 1
    s_mul_i32 s31, s31, 294912
    s_add_u32 s48, s31, 1048576
    s_add_u32 s49, s48, 16384
    s_add_u32 s50, s48, 32768
    s_add_u32 s51, s48, 49152
    s_add_u32 s52, s48, 65536
    s_add_u32 s34, s48, s69
    s_and_b32 s31, s30, 3
    s_lshl_b32 s31, s31, 14
    s_add_u32 s35, s31, 2097152
    s_add_u32 s38, s38, 16384
    s_add_u32 s53, s38, s68
    s_add_u32 s53, s53, -180224
    s_mul_i32 s31, s28, 65
    s_add_u32 s31, s31, s30
    s_lshl_b32 s31, s31, 13
    s_add_u32 s39, s31, 71237632
    s_lshl_b32 s32, s29, 10
    s_add_u32 s63, s39, s32
    s_and_b32 s32, s30, 3
    s_xor_b32 s32, s32, 1
    s_cmp_ge_u32 s30, 60
    s_cselect_b32 s32, 0, s32
    s_or_b32 s32, s32, s29
    v_mov_b64 v[28:29], 0
    v_mov_b64 v[30:31], 0
    v_mov_b64 v[32:33], 0
    v_mov_b64 v[34:35], 0
    v_mov_b64 v[36:37], 0
    v_mov_b64 v[38:39], 0
    v_mov_b64 v[40:41], 0
    v_mov_b64 v[42:43], 0
    v_mov_b64 v[12:13], 0
    v_mov_b64 v[14:15], 0
    v_lshlrev_b32 v60, 2, v1
    s_mov_b32 m0, 96512
    s_sub_u32 s31, s53, 16384
    buffer_load_dword v60, s[4:7], s31 offen sc1 lds
    s_waitcnt lgkmcnt(0)
    s_cmp_ge_u32 s94, 0x10000
    s_cbranch_scc1 Lstep_s
    .p2align 6
Lstep:
    s_cmp_eq_u32 s32, 0
    v_smfmac_f32_16x16x64_bf16 v[36:39], v[16:19], v[44:51], v0
    ds_read_b128 v[44:47], v3 offset:0
    ds_read_b128 v[48:51], v3 offset:1024
    v_smfmac_f32_16x16x64_bf16 v[40:43], v[16:19], v[52:59], v0
    ds_read_b128 v[52:55], v3 offset:2048
    ds_read_b128 v[56:59], v3 offset:3072
    v_smfmac_f32_16x16x64_bf16 v[28:31], v[16:19], a[0:7], v0
    v_smfmac_f32_16x16x64_bf16 v[32:35], v[16:19], a[8:15], v0
    v_smfmac_f32_16x16x64_bf16 v[36:39], v[20:23], a[32:39], v0
    v_smfmac_f32_16x16x64_bf16 v[40:43], v[20:23], a[40:47], v0
    v_smfmac_f32_16x16x64_bf16 v[28:31], v[20:23], a[16:23], v0
    v_smfmac_f32_16x16x64_bf16 v[32:35], v[20:23], a[24:31], v0
    s_waitcnt vmcnt(1)
    s_barrier
    ds_read_b128 v[16:19], v10 offset:16384
    ds_read_b128 v[20:23], v10 offset:17408
    buffer_store_dwordx4 v[12:15], v1, s[4:7], s81 offen sc1
    s_waitcnt lgkmcnt(2)
    v_smfmac_f32_16x16x64_bf16 v[36:39], v[24:27], v[44:51], v0
    ds_read_b128 v[44:47], v3 offset:16384
    ds_read_b128 v[48:51], v3 offset:17408
    v_smfmac_f32_16x16x64_bf16 v[40:43], v[24:27], v[52:59], v0
    ds_read_b128 v[52:55], v3 offset:18432
    ds_read_b128 v[56:59], v3 offset:19456
    v_smfmac_f32_16x16x64_bf16 v[28:31], v[24:27], a[48:55], v0
    v_smfmac_f32_16x16x64_bf16 v[32:35], v[24:27], a[56:63], v0
    ds_read_b128 v[24:27], v10 offset:18432
    v_mov_b64 v[12:13], -1
    s_waitcnt lgkmcnt(6)
    v_smfmac_f32_16x16x64_bf16 v[36:39], v[16:19], a[80:87], v0
    v_smfmac_f32_16x16x64_bf16 v[40:43], v[16:19], a[88:95], v0
    v_smfmac_f32_16x16x64_bf16 v[28:31], v[16:19], a[64:71], v0
    v_smfmac_f32_16x16x64_bf16 v[32:35], v[16:19], a[72:79], v0
    ds_read_b128 v[16:19], v11 offset:16384
    buffer_load_dword v60, s[4:7], s53 offen sc1 lds
    v_mov_b64 v[14:15], -1
    s_cbranch_scc1 Lflag_29
Lflagr_30:
    s_waitcnt lgkmcnt(2)
    v_smfmac_f32_16x16x64_bf16 v[36:39], v[20:23], v[44:51], v0
    ds_read_b128 v[44:47], v3 offset:32768
    ds_read_b128 v[48:51], v3 offset:33792
    v_smfmac_f32_16x16x64_bf16 v[40:43], v[20:23], v[52:59], v0
    ds_read_b128 v[52:55], v3 offset:34816
    ds_read_b128 v[56:59], v3 offset:35840
    v_smfmac_f32_16x16x64_bf16 v[28:31], v[20:23], a[96:103], v0
    v_smfmac_f32_16x16x64_bf16 v[32:35], v[20:23], a[104:111], v0
    ds_read_b128 v[20:23], v11 offset:17408
    buffer_store_dword v12, v9, s[4:7], s37 offen
    v_mov_b64 v[60:61], 0
    v_mov_b64 v[62:63], 0
    s_waitcnt lgkmcnt(6)
    v_smfmac_f32_16x16x64_bf16 v[36:39], v[24:27], a[128:135], v0
    v_smfmac_f32_16x16x64_bf16 v[40:43], v[24:27], a[136:143], v0
    v_smfmac_f32_16x16x64_bf16 v[28:31], v[24:27], a[112:119], v0
    v_smfmac_f32_16x16x64_bf16 v[32:35], v[24:27], a[120:127], v0
    ds_read_b128 v[24:27], v11 offset:18432
    buffer_store_dwordx4 v[12:15], v1, s[4:7], s44 offen
    s_waitcnt lgkmcnt(2)
    v_smfmac_f32_16x16x64_bf16 v[36:39], v[16:19], v[44:51], v0
    ds_read_b128 v[44:47], v3 offset:49152
    ds_read_b128 v[48:51], v3 offset:50176
    v_smfmac_f32_16x16x64_bf16 v[40:43], v[16:19], v[52:59], v0
    ds_read_b128 v[52:55], v3 offset:51200
    ds_read_b128 v[56:59], v3 offset:52224
    v_smfmac_f32_16x16x64_bf16 v[28:31], v[16:19], a[144:151], v0
    v_smfmac_f32_16x16x64_bf16 v[32:35], v[16:19], a[152:159], v0
    ds_read_b128 v[16:19], v1 offset:16384
    buffer_store_dwordx4 v[12:15], v1, s[4:7], s45 offen
    s_waitcnt lgkmcnt(6)
    v_smfmac_f32_16x16x64_bf16 v[36:39], v[20:23], a[176:183], v0
    v_smfmac_f32_16x16x64_bf16 v[40:43], v[20:23], a[184:191], v0
    v_smfmac_f32_16x16x64_bf16 v[28:31], v[20:23], a[160:167], v0
    v_smfmac_f32_16x16x64_bf16 v[32:35], v[20:23], a[168:175], v0
    ds_read_b128 v[20:23], v1 offset:17408
    buffer_store_dwordx4 v[12:15], v1, s[4:7], s46 offen
    s_waitcnt lgkmcnt(2)
    v_smfmac_f32_16x16x64_bf16 v[36:39], v[24:27], v[44:51], v0
    v_smfmac_f32_16x16x64_bf16 v[40:43], v[24:27], v[52:59], v0
    v_smfmac_f32_16x16x64_bf16 v[28:31], v[24:27], a[192:199], v0
    v_smfmac_f32_16x16x64_bf16 v[32:35], v[24:27], a[200:207], v0
    ds_read_b128 v[24:27], v1 offset:18432
    v_mov_b64 v[12:13], 0
    v_mov_b64 v[14:15], 0
    ds_read_b128 v[44:47], v1 offset:0
    ds_read_b128 v[48:51], v1 offset:4096
    ds_read_b128 v[52:55], v1 offset:1024
    ds_read_b128 v[56:59], v1 offset:5120
    s_nop 0
    v_permlane32_swap_b32 v36, v40
    v_permlane32_swap_b32 v37, v41
    v_permlane32_swap_b32 v38, v42
    v_permlane32_swap_b32 v39, v43
    v_pk_add_f32 v[36:37], v[36:37], v[40:41]
    v_pk_add_f32 v[38:39], v[38:39], v[42:43]
    v_cvt_pk_bf16_f32 v40, v36, v37
    v_cvt_pk_bf16_f32 v41, v38, v39
    ds_write_b64 v4, v[40:41] offset:26112
    v_permlane32_swap_b32 v28, v32
    v_permlane32_swap_b32 v29, v33
    v_permlane32_swap_b32 v30, v34
    v_permlane32_swap_b32 v31, v35
    v_pk_add_f32 v[28:29], v[28:29], v[32:33]
    v_pk_add_f32 v[30:31], v[30:31], v[34:35]
    v_cvt_pk_bf16_f32 v32, v28, v29
    v_cvt_pk_bf16_f32 v33, v30, v31
    ds_write_b64 v4, v[32:33] offset:25600
    s_waitcnt lgkmcnt(8)
    v_smfmac_f32_16x16x64_bf16 v[60:63], v[16:19], a[208:215], v0
    ds_read_b128 v[28:31], v1 offset:2048
    v_smfmac_f32_16x16x64_bf16 v[12:15], v[16:19], a[216:223], v0
    s_waitcnt lgkmcnt(8)
    v_smfmac_f32_16x16x64_bf16 v[60:63], v[20:23], a[224:231], v0
    v_smfmac_f32_16x16x64_bf16 v[12:15], v[20:23], a[232:239], v0
    s_cmp_eq_u32 s30, 63
    s_waitcnt lgkmcnt(1)
    s_barrier
    s_cbranch_scc1 Llast
    ds_read_b64_tr_b16 v[36:37], v5 offset:0
    ds_read_b64_tr_b16 v[38:39], v5 offset:64
    ds_read_b64_tr_b16 v[16:17], v5 offset:512
    ds_read_b64_tr_b16 v[18:19], v5 offset:576
    v_smfmac_f32_16x16x64_bf16 v[60:63], v[24:27], a[240:247], v0
    ds_read_b64_tr_b16 v[20:21], v5 offset:1024
    ds_read_b64_tr_b16 v[22:23], v5 offset:1088
    v_smfmac_f32_16x16x64_bf16 v[12:15], v[24:27], a[248:255], v0
    ds_read_b64_tr_b16 v[24:25], v5 offset:1536
    ds_read_b64_tr_b16 v[26:27], v5 offset:1600
    v_add_u32 v9, s68, v1
    s_waitcnt lgkmcnt(6)
    v_mfma_f32_16x16x32_bf16 v[32:35], v[44:47], v[36:39], 0
    ds_read_b128 v[44:47], v1 offset:6144
    v_mfma_f32_16x16x32_bf16 v[40:43], v[48:51], v[36:39], 0
    ds_read_b128 v[48:51], v1 offset:3072
    s_waitcnt lgkmcnt(6)
    v_mfma_f32_16x16x32_bf16 v[32:35], v[52:55], v[16:19], v[32:35]
    ds_read_b128 v[52:55], v1 offset:7168
    v_mfma_f32_16x16x32_bf16 v[40:43], v[56:59], v[16:19], v[40:43]
    ds_read_b64_tr_b16 v[56:57], v5 offset:2048
    ds_read_b64_tr_b16 v[58:59], v5 offset:2112
    s_waitcnt lgkmcnt(4)
    v_mfma_f32_16x16x32_bf16 v[32:35], v[28:31], v[20:23], v[32:35]
    v_mfma_f32_16x16x32_bf16 v[40:43], v[44:47], v[20:23], v[40:43]
    ds_read_b64_tr_b16 v[44:45], v5 offset:2560
    ds_read_b64_tr_b16 v[46:47], v5 offset:2624
    s_waitcnt lgkmcnt(4)
    v_mfma_f32_16x16x32_bf16 v[32:35], v[48:51], v[24:27], v[32:35]
    ds_read_b64_tr_b16 v[48:49], v5 offset:3072
    ds_read_b64_tr_b16 v[50:51], v5 offset:3136
    v_mfma_f32_16x16x32_bf16 v[40:43], v[52:55], v[24:27], v[40:43]
    ds_read_b64_tr_b16 v[52:53], v5 offset:3584
    ds_read_b64_tr_b16 v[54:55], v5 offset:3648
    s_waitcnt lgkmcnt(4)
    v_mfma_f32_16x16x32_bf16 v[28:31], v[56:59], v[36:39], 0
    v_mfma_f32_16x16x32_bf16 v[28:31], v[44:47], v[16:19], v[28:31]
    ds_read_b128 v[16:19], v1 offset:19456
    s_waitcnt lgkmcnt(1)
    v_mfma_f32_16x16x32_bf16 v[28:31], v[48:51], v[20:23], v[28:31]
    ds_read_b128 v[20:23], v1 offset:20480
    v_max3_f32 v11, v32, v33, v34
    v_mfma_f32_16x16x32_bf16 v[28:31], v[52:55], v[24:27], v[28:31]
    ds_read_b128 v[24:27], v1 offset:21504
    v_max3_f32 v11, v11, v35, v40
    v_max3_f32 v11, v11, v41, v42
    ds_read_b128 v[56:59], v9 offset:8192
    ds_read_b128 v[36:39], v9 offset:9216
    v_max_f32 v11, v11, v43
    s_waitcnt lgkmcnt(4)
    v_smfmac_f32_16x16x64_bf16 v[60:63], v[16:19], v[64:71], v0
    v_smfmac_f32_16x16x64_bf16 v[12:15], v[16:19], v[72:79], v0
    ds_read_b128 v[16:19], v1 offset:22528
    v_max3_f32 v11, v11, v28, v29
    v_max3_f32 v10, v11, v30, v31
    v_max3_f32 v11, v11, v30, v31
    s_waitcnt lgkmcnt(4)
    v_smfmac_f32_16x16x64_bf16 v[60:63], v[20:23], v[80:87], v0
    v_permlane32_swap_b32 v10, v11
    v_max_f32 v9, v10, v11
    v_max_f32 v11, v10, v11
    v_smfmac_f32_16x16x64_bf16 v[12:15], v[20:23], v[88:95], v0
    ds_read_b128 v[20:23], v1 offset:23552
    v_permlane16_swap_b32 v9, v11
    v_max_f32 v10, v9, v11
    v_mul_f32 v10, s42, v10
    v_pk_fma_f32 v[32:33], v[32:33], s[42:43], v[10:11] op_sel_hi:[1,0,0] neg_lo:[0,0,1] neg_hi:[0,0,1]
    v_pk_fma_f32 v[34:35], v[34:35], s[42:43], v[10:11] op_sel_hi:[1,0,0] neg_lo:[0,0,1] neg_hi:[0,0,1]
    v_pk_fma_f32 v[40:41], v[40:41], s[42:43], v[10:11] op_sel_hi:[1,0,0] neg_lo:[0,0,1] neg_hi:[0,0,1]
    v_pk_fma_f32 v[42:43], v[42:43], s[42:43], v[10:11] op_sel_hi:[1,0,0] neg_lo:[0,0,1] neg_hi:[0,0,1]
    v_pk_fma_f32 v[28:29], v[28:29], s[42:43], v[10:11] op_sel_hi:[1,0,0] neg_lo:[0,0,1] neg_hi:[0,0,1]
    v_pk_fma_f32 v[30:31], v[30:31], s[42:43], v[10:11] op_sel_hi:[1,0,0] neg_lo:[0,0,1] neg_hi:[0,0,1]
    v_exp_f32 v32, v32
    s_waitcnt lgkmcnt(4)
    v_smfmac_f32_16x16x64_bf16 v[60:63], v[24:27], v[96:103], v0
    v_exp_f32 v33, v33
    v_smfmac_f32_16x16x64_bf16 v[12:15], v[24:27], v[104:111], v0
    ds_read_b128 v[24:27], v1 offset:24576
    v_exp_f32 v34, v34
    s_waitcnt lgkmcnt(2)
    v_smfmac_f32_16x16x64_bf16 v[60:63], v[16:19], v[112:119], v0
    v_exp_f32 v35, v35
    v_smfmac_f32_16x16x64_bf16 v[12:15], v[16:19], v[120:127], v0
    v_exp_f32 v40, v40
    s_waitcnt lgkmcnt(1)
    v_smfmac_f32_16x16x64_bf16 v[60:63], v[20:23], v[128:135], v0
    v_exp_f32 v41, v41
    v_smfmac_f32_16x16x64_bf16 v[12:15], v[20:23], v[136:143], v0
    v_exp_f32 v42, v42
    s_waitcnt lgkmcnt(0)
    v_smfmac_f32_16x16x64_bf16 v[60:63], v[24:27], v[144:151], v0
    v_exp_f32 v43, v43
    v_smfmac_f32_16x16x64_bf16 v[12:15], v[24:27], v[152:159], v0
    s_add_u32 m0, s87, 8192
    s_add_u32 s92, s38, 8192
    buffer_load_dwordx4 v1, s[4:7], s92 offen offset:0 sc1 lds
    v_cvt_pk_bf16_f32 v48, v32, v33
    v_cvt_pk_bf16_f32 v49, v34, v35
    v_cvt_pk_bf16_f32 v50, v40, v41
    v_cvt_pk_bf16_f32 v51, v42, v43
    v_exp_f32 v28, v28
    v_exp_f32 v29, v29
    v_mfma_f32_16x16x32_bf16 v[32:35], v[56:59], v[48:51], 0
    v_exp_f32 v30, v30
    v_mfma_f32_16x16x32_bf16 v[40:43], v[36:39], v[48:51], 0
    v_exp_f32 v31, v31
    v_mov_b64 v[44:45], s[88:89]
    v_mov_b64 v[46:47], s[90:91]
    v_cvt_pk_bf16_f32 v36, v60, v61
    v_cvt_pk_bf16_f32 v37, v62, v63
    v_mfma_f32_16x16x16_bf16 v[16:19], v[44:45], v[48:49], 0
    v_cvt_pk_bf16_f32 v52, v28, v29
    v_cvt_pk_bf16_f32 v53, v30, v31
    v_mfma_f32_16x16x16_bf16 v[16:19], v[44:45], v[50:51], v[16:19]
    v_cvt_pk_bf16_f32 v38, v12, v13
    v_cvt_pk_bf16_f32 v39, v14, v15
    v_mfma_f32_16x16x16_bf16 v[16:19], v[46:47], v[52:53], v[16:19]
    v_mov_b64 v[60:61], 0
    v_mov_b64 v[62:63], 0
    v_mfma_f32_16x16x16_bf16 v[32:35], v[36:37], v[52:53], v[32:35]
    v_mov_b64 v[12:13], 0
    v_mov_b64 v[14:15], 0
    v_mfma_f32_16x16x16_bf16 v[40:43], v[38:39], v[52:53], v[40:43]
    v_mov_b64 v[28:29], 0
    v_mov_b64 v[30:31], 0
    buffer_load_dwordx4 v1, s[4:7], s92 offen offset:1024 sc1 lds
    v_rcp_f32 v16, v16
    v_mov_b64 v[24:25], 0
    v_mov_b64 v[26:27], 0
    v_add_u32 v9, s64, v8
    v_pk_mul_f32 v[32:33], v[32:33], v[16:17] op_sel_hi:[1,0]
    v_pk_mul_f32 v[34:35], v[34:35], v[16:17] op_sel_hi:[1,0]
    v_pk_mul_f32 v[40:41], v[40:41], v[16:17] op_sel_hi:[1,0]
    v_pk_mul_f32 v[42:43], v[42:43], v[16:17] op_sel_hi:[1,0]
    v_cvt_pk_bf16_f32 v20, v32, v33
    v_cvt_pk_bf16_f32 v21, v34, v35
    v_cvt_pk_bf16_f32 v22, v40, v41
    v_cvt_pk_bf16_f32 v23, v42, v43
    ds_write_b128 v9, v[20:23]
    ds_read_b128 v[44:47], v2 offset:0
    ds_read_b128 v[48:51], v2 offset:1024
    v_smfmac_f32_16x16x64_bf16 v[60:63], v[20:23], v[160:167], v0
    ds_read_b128 v[52:55], v2 offset:2048
    v_add_u32 v10, s65, v8
    v_smfmac_f32_16x16x64_bf16 v[28:31], v[20:23], v[208:215], v0
    ds_read_b128 v[56:59], v2 offset:3072
    v_add_u32 v11, s66, v8
    v_smfmac_f32_16x16x64_bf16 v[24:27], v[20:23], v[224:231], v0
    v_add_u32 v9, s67, v8
    s_mov_b32 m0, s87
    s_waitcnt lgkmcnt(2)
    v_smfmac_f32_16x16x64_bf16 v[12:15], v[20:23], v[44:51], v0
    s_waitcnt vmcnt(2)
    s_barrier
    ds_read_b128 v[32:35], v10
    ds_read_b128 v[40:43], v11
    ds_read_b128 v[16:19], v9
    ds_read_b128 v[20:23], v6
    ds_read_b128 v[44:47], v2 offset:16384
    ds_read_b128 v[48:51], v2 offset:17408
    buffer_load_dwordx4 v1, s[4:7], s38 offen offset:0 sc1 lds
    buffer_load_dwordx4 v1, s[4:7], s38 offen offset:1024 sc1 lds
    s_lshl_b32 s31, s29, 10
    v_add_u32 v10, s31, v1
    s_waitcnt lgkmcnt(5)
    v_smfmac_f32_16x16x64_bf16 v[60:63], v[32:35], v[168:175], v0
    ds_write_b128 v10, v[36:39] offset:20480
    s_waitcnt lgkmcnt(5)
    v_smfmac_f32_16x16x64_bf16 v[60:63], v[40:43], v[176:183], v0
    s_waitcnt lgkmcnt(4)
    v_smfmac_f32_16x16x64_bf16 v[60:63], v[16:19], v[184:191], v0
    v_bfe_u32 v9, v1, 9, 1
    v_smfmac_f32_16x16x64_bf16 v[12:15], v[32:35], v[52:59], v0
    ds_read_b128 v[52:55], v2 offset:18432
    ds_read_b128 v[56:59], v2 offset:19456
    v_mul_u32_u24 v9, 8188, v9
    v_smfmac_f32_16x16x64_bf16 v[12:15], v[40:43], v[192:199], v0
    v_sub_u32 v9, v7, v9
    v_smfmac_f32_16x16x64_bf16 v[12:15], v[16:19], v[200:207], v0
    v_cvt_pk_bf16_f32 v60, v60, v61
    v_cvt_pk_bf16_f32 v61, v62, v63
    buffer_store_dwordx2 v[60:61], v7, s[4:7], s48 offen
    v_smfmac_f32_16x16x64_bf16 v[28:31], v[32:35], v[216:223], v0
    v_mov_b64 v[36:37], 0
    v_smfmac_f32_16x16x64_bf16 v[24:27], v[32:35], v[232:239], v0
    v_mov_b64 v[38:39], 0
    ds_read_b128 v[32:35], v6 offset:1024
    s_waitcnt lgkmcnt(4)
    v_smfmac_f32_16x16x64_bf16 v[28:31], v[40:43], v[44:51], v0
    ds_read_b128 v[44:47], v2 offset:32768
    ds_read_b128 v[48:51], v2 offset:33792
    v_cvt_pk_bf16_f32 v12, v12, v13
    v_cvt_pk_bf16_f32 v13, v14, v15
    buffer_store_dwordx2 v[12:13], v7, s[4:7], s49 offen
    s_waitcnt lgkmcnt(3)
    v_smfmac_f32_16x16x64_bf16 v[28:31], v[16:19], v[52:59], v0
    ds_read_b128 v[52:55], v2 offset:34816
    ds_read_b128 v[56:59], v2 offset:35840
    v_smfmac_f32_16x16x64_bf16 v[36:39], v[20:23], v[240:247], v0
    s_waitcnt lgkmcnt(4)
    v_smfmac_f32_16x16x64_bf16 v[36:39], v[32:35], v[248:255], v0
    s_waitcnt lgkmcnt(2)
    v_smfmac_f32_16x16x64_bf16 v[24:27], v[40:43], v[44:51], v0
    s_nop 0
    v_cvt_pk_bf16_f32 v28, v28, v29
    v_cvt_pk_bf16_f32 v29, v30, v31
    buffer_store_dwordx2 v[28:29], v7, s[4:7], s50 offen
    s_waitcnt lgkmcnt(0)
    v_smfmac_f32_16x16x64_bf16 v[24:27], v[16:19], v[52:59], v0
    s_nop 1
    v_permlane32_swap_b32 v36, v38
    v_permlane32_swap_b32 v37, v39
    v_add_f32 v36, v36, v38
    v_add_f32 v37, v37, v39
    v_cvt_pk_bf16_f32 v36, v36, v37
    s_nop 0
    v_cvt_pk_bf16_f32 v24, v24, v25
    v_cvt_pk_bf16_f32 v25, v26, v27
    buffer_store_dwordx2 v[24:25], v7, s[4:7], s51 offen
    buffer_store_dword v36, v9, s[4:7], s52 offen
Lhops:
    ds_read_b128 v[28:31], v10 offset:20480
    v_lshrrev_b32 v61, 1, v10
    ds_read_b64 v[12:13], v61 offset:60416
    s_mov_b32 s81, s63
    ds_read_b128 v[16:19], v1 offset:29696
    v_lshrrev_b32 v9, 2, v1
    v_add_u32 v9, 79872, v9
    ds_read_b32 v9, v9
    ds_read_b128 v[44:47], v2 offset:49152
    ds_read_b128 v[48:51], v2 offset:50176
    ds_read_b128 v[52:55], v2 offset:51200
    ds_read_b128 v[56:59], v2 offset:52224
    v_add_u32 v10, s57, v1
    v_add_u32 v11, s60, v1
    s_mov_b32 s41, s34
    s_add_u32 s44, s48, s84
    s_add_u32 s45, s44, 131072
    s_add_u32 s46, s44, s85
    s_add_u32 s70, s35, s43
    s_xor_b32 s37, s70, 32768
    s_add_u32 s36, s35, s54
    s_sub_u32 s36, s36, 65536
    s_add_u32 s30, s30, 1
    s_and_b32 s31, s30, 1
    s_mul_i32 s31, s31, 294912
    s_add_u32 s48, s31, 1048576
    s_add_u32 s49, s48, 16384
    s_add_u32 s50, s48, 32768
    s_add_u32 s51, s48, 49152
    s_add_u32 s52, s48, 65536
    s_add_u32 s34, s48, s69
    s_and_b32 s31, s30, 3
    s_lshl_b32 s31, s31, 14
    s_add_u32 s35, s31, 2097152
    s_add_u32 s38, s38, 16384
    s_add_u32 s53, s38, s68
    s_add_u32 s53, s53, -180224
    s_mul_i32 s31, s28, 65
    s_add_u32 s31, s31, s30
    s_lshl_b32 s31, s31, 13
    s_add_u32 s39, s31, 71237632
    s_lshl_b32 s32, s29, 10
    s_add_u32 s63, s39, s32
    s_mov_b32 m0, s71
    s_waitcnt lgkmcnt(0)
    v_permlane32_swap_b32 v28, v30
    v_permlane32_swap_b32 v29, v31
    v_lshlrev_b32 v32, 16, v28
    v_and_b32 v33, 0xffff0000, v28
    v_lshlrev_b32 v34, 16, v29
    v_and_b32 v35, 0xffff0000, v29
    v_lshlrev_b32 v36, 16, v30
    v_and_b32 v37, 0xffff0000, v30
    v_lshlrev_b32 v38, 16, v31
    v_and_b32 v39, 0xffff0000, v31
    v_pk_add_f32 v[32:33], v[32:33], v[36:37]
    v_pk_add_f32 v[34:35], v[34:35], v[38:39]
    v_cvt_pk_bf16_f32 v14, v32, v33
    v_cvt_pk_bf16_f32 v15, v34, v35
    s_cmp_ge_u32 s40, 72
    s_cbranch_scc1 Lhop2_31
    s_mov_b32 s33, 0
    s_waitcnt lgkmcnt(0)
Lp1_34:
    buffer_load_dwordx4 v[28:31], v1, s[4:7], s41 offen offset:0 sc1
    buffer_load_dwordx4 v[32:35], v1, s[4:7], s41 offen offset:1024 sc1
    buffer_load_dwordx4 v[36:39], v1, s[4:7], s41 offen offset:2048 sc1
    buffer_load_dwordx4 v[40:43], v1, s[4:7], s41 offen offset:3072 sc1
    s_add_u32 s33, s33, 1
    s_cmp_gt_u32 s33, 1048576
    s_cbranch_scc1 Lchain_exit
    s_waitcnt vmcnt(3)
    v_mfma_f32_16x16x32_bf16 v[20:23], v[28:31], v[16:19], 0
    v_max3_u32 v24, v28, v29, v30
    v_max_u32 v24, v24, v31
    s_waitcnt vmcnt(2)
    v_mfma_f32_16x16x32_bf16 v[20:23], v[32:35], v[16:19], v[20:23]
    v_max3_u32 v24, v24, v32, v33
    v_max3_u32 v24, v24, v34, v35
    s_waitcnt vmcnt(1)
    v_mfma_f32_16x16x32_bf16 v[20:23], v[36:39], v[16:19], v[20:23]
    v_max3_u32 v24, v24, v36, v37
    v_max3_u32 v24, v24, v38, v39
    s_waitcnt vmcnt(0)
    v_mfma_f32_16x16x32_bf16 v[20:23], v[40:43], v[16:19], v[20:23]
    v_max3_u32 v24, v24, v40, v41
    v_max3_u32 v24, v24, v42, v43
    v_cmp_eq_u32 vcc, -1, v24
    s_cbranch_vccnz Lp1_34
    s_nop 3
    v_permlane32_swap_b32 v20, v22
    v_permlane32_swap_b32 v21, v23
    v_pk_add_f32 v[20:21], v[20:21], v[22:23]
    v_cvt_pk_bf16_f32 v20, v20, v21
    buffer_store_dword v20, v9, s[4:7], s70 offen
Lhop2_31:
    v_mov_b64 v[28:29], 0
    v_mov_b64 v[30:31], 0
    v_mov_b64 v[32:33], 0
    v_mov_b64 v[34:35], 0
    v_mov_b64 v[36:37], 0
    v_mov_b64 v[38:39], 0
    v_mov_b64 v[40:41], 0
    v_mov_b64 v[42:43], 0
    s_add_u32 s31, s30, 2
    s_and_b32 s31, s31, 7
    s_or_b32 s31, s31, s95
    s_cbranch_scc1 Lkvok_35
    v_lshrrev_b32 v60, 2, v1
    v_and_b32 v60, 31, v60
    s_mov_b32 s32, 65536
    s_mov_b32 s33, 0
Lkvw_36:
    buffer_load_dword v61, v60, s[4:7], s32 offen sc1
    s_add_u32 s33, s33, 1
    s_cmp_gt_u32 s33, 1048576
    s_cbranch_scc1 Lchain_exit
    s_add_u32 s31, s30, 2
    s_lshr_b32 s31, s31, 3
    s_min_u32 s31, s31, 7
    s_waitcnt vmcnt(0)
    v_cmp_le_u32 vcc, 128, v61
    s_bitcmp1_b32 vcc_lo, s31
    s_cbranch_scc0 Lkvw_36
    s_cmp_eq_u64 vcc, exec
    s_cselect_b32 s95, 1, 0
Lkvok_35:
    s_and_b32 s32, s30, 3
    s_xor_b32 s32, s32, 1
    s_cmp_ge_u32 s30, 60
    s_cselect_b32 s32, 0, s32
    s_or_b32 s32, s32, s29
    s_waitcnt lgkmcnt(0)
    s_barrier
    s_mov_b32 s33, 0
    v_add_u32 v60, s54, v1
Lp2_37:
    buffer_load_dwordx4 v1, s[4:7], s36 offen offset:0 sc1 lds
    buffer_load_dwordx4 v1, s[4:7], s36 offen offset:1024 sc1 lds
    buffer_load_dwordx4 v1, s[4:7], s36 offen offset:2048 sc1 lds
    s_add_u32 s33, s33, 1
    s_cmp_gt_u32 s33, 1048576
    s_cbranch_scc1 Lchain_exit
    s_waitcnt vmcnt(2)
    ds_read_b128 v[16:19], v60 offset:16384
    s_waitcnt vmcnt(1)
    ds_read_b128 v[20:23], v60 offset:17408
    s_waitcnt vmcnt(0)
    ds_read_b128 v[24:27], v60 offset:18432
    s_waitcnt lgkmcnt(2)
    v_max3_u32 v28, v16, v17, v18
    s_waitcnt lgkmcnt(1)
    v_max3_u32 v29, v19, v20, v21
    v_max3_u32 v28, v28, v22, v23
    s_waitcnt lgkmcnt(0)
    v_max3_u32 v29, v29, v24, v25
    v_max3_u32 v28, v28, v26, v27
    v_max_u32 v28, v28, v29
    v_cmp_eq_u32 vcc, -1, v28
    v_mov_b64 v[28:29], 0
    s_cbranch_vccnz Lp2_37
    v_lshlrev_b32 v60, 2, v1
    s_mov_b32 m0, 96512
    s_branch Lstep
Lflag_29:
    s_sub_u32 s31, s30, 1
    s_max_i32 s31, s31, 0
    v_mov_b32 v62, s31
    v_mov_b32 v63, 0
    s_mov_b64 exec, 1
    buffer_store_dword v62, v63, s[4:7], s93 offen sc1
    s_mov_b64 exec, -1
    s_branch Lflagr_30
Llast:
    s_waitcnt lgkmcnt(7)
    v_smfmac_f32_16x16x64_bf16 v[60:63], v[24:27], a[240:247], v0
    v_smfmac_f32_16x16x64_bf16 v[12:15], v[24:27], a[248:255], v0
    ds_read_b128 v[16:19], v1 offset:19456
    s_waitcnt lgkmcnt(0)
    v_smfmac_f32_16x16x64_bf16 v[60:63], v[16:19], v[64:71], v0
    v_smfmac_f32_16x16x64_bf16 v[12:15], v[16:19], v[72:79], v0
    ds_read_b128 v[20:23], v1 offset:20480
    s_waitcnt lgkmcnt(0)
    v_smfmac_f32_16x16x64_bf16 v[60:63], v[20:23], v[80:87], v0
    v_smfmac_f32_16x16x64_bf16 v[12:15], v[20:23], v[88:95], v0
    ds_read_b128 v[24:27], v1 offset:21504
    s_waitcnt lgkmcnt(0)
    v_smfmac_f32_16x16x64_bf16 v[60:63], v[24:27], v[96:103], v0
    v_smfmac_f32_16x16x64_bf16 v[12:15], v[24:27], v[104:111], v0
    ds_read_b128 v[16:19], v1 offset:22528
    s_waitcnt lgkmcnt(0)
    v_smfmac_f32_16x16x64_bf16 v[60:63], v[16:19], v[112:119], v0
    v_smfmac_f32_16x16x64_bf16 v[12:15], v[16:19], v[120:127], v0
    ds_read_b128 v[20:23], v1 offset:23552
    s_waitcnt lgkmcnt(0)
    v_smfmac_f32_16x16x64_bf16 v[60:63], v[20:23], v[128:135], v0
    v_smfmac_f32_16x16x64_bf16 v[12:15], v[20:23], v[136:143], v0
    ds_read_b128 v[24:27], v1 offset:24576
    s_waitcnt lgkmcnt(0)
    v_smfmac_f32_16x16x64_bf16 v[60:63], v[24:27], v[144:151], v0
    v_smfmac_f32_16x16x64_bf16 v[12:15], v[24:27], v[152:159], v0
    s_nop 7
    s_nop 1
    s_lshl_b32 s31, s29, 9
    v_lshrrev_b32 v10, 1, v1
    v_add_u32 v10, s31, v10
    ds_read_b64 v[44:45], v10 offset:60416
    v_permlane32_swap_b32 v60, v12
    v_permlane32_swap_b32 v61, v13
    v_permlane32_swap_b32 v62, v14
    v_permlane32_swap_b32 v63, v15
    v_pk_add_f32 v[60:61], v[60:61], v[12:13]
    v_pk_add_f32 v[62:63], v[62:63], v[14:15]
    v_cvt_pk_bf16_f32 v46, v60, v61
    v_cvt_pk_bf16_f32 v47, v62, v63
    s_waitcnt lgkmcnt(0)
    buffer_store_dwordx4 v[44:47], v1, s[4:7], s63 offen sc1
    s_branch Lfin
    .p2align 6
Lstep_s:
    s_cmp_eq_u32 s32, 0
    v_smfmac_f32_16x16x64_bf16 v[36:39], v[16:19], v[44:51], v0
    ds_read_b128 v[44:47], v3 offset:0
    ds_read_b128 v[48:51], v3 offset:1024
    v_smfmac_f32_16x16x64_bf16 v[40:43], v[16:19], v[52:59], v0
    ds_read_b128 v[52:55], v3 offset:2048
    ds_read_b128 v[56:59], v3 offset:3072
    v_smfmac_f32_16x16x64_bf16 v[28:31], v[16:19], a[0:7], v0
    v_smfmac_f32_16x16x64_bf16 v[32:35], v[16:19], a[8:15], v0
    v_smfmac_f32_16x16x64_bf16 v[36:39], v[20:23], a[32:39], v0
    v_smfmac_f32_16x16x64_bf16 v[40:43], v[20:23], a[40:47], v0
    v_smfmac_f32_16x16x64_bf16 v[28:31], v[20:23], a[16:23], v0
    v_smfmac_f32_16x16x64_bf16 v[32:35], v[20:23], a[24:31], v0
    s_waitcnt vmcnt(1)
    s_barrier
    ds_read_b128 v[16:19], v10 offset:16384
    ds_read_b128 v[20:23], v10 offset:17408
    buffer_store_dwordx4 v[12:15], v1, s[4:7], s81 offen sc1
    s_waitcnt lgkmcnt(2)
    v_smfmac_f32_16x16x64_bf16 v[36:39], v[24:27], v[44:51], v0
    ds_read_b128 v[44:47], v3 offset:16384
    ds_read_b128 v[48:51], v3 offset:17408
    v_smfmac_f32_16x16x64_bf16 v[40:43], v[24:27], v[52:59], v0
    ds_read_b128 v[52:55], v3 offset:18432
    ds_read_b128 v[56:59], v3 offset:19456
    v_smfmac_f32_16x16x64_bf16 v[28:31], v[24:27], a[48:55], v0
    v_smfmac_f32_16x16x64_bf16 v[32:35], v[24:27], a[56:63], v0
    ds_read_b128 v[24:27], v10 offset:18432
    v_mov_b64 v[12:13], -1
    s_waitcnt lgkmcnt(6)
    v_smfmac_f32_16x16x64_bf16 v[36:39], v[16:19], a[80:87], v0
    v_smfmac_f32_16x16x64_bf16 v[40:43], v[16:19], a[88:95], v0
    v_smfmac_f32_16x16x64_bf16 v[28:31], v[16:19], a[64:71], v0
    v_smfmac_f32_16x16x64_bf16 v[32:35], v[16:19], a[72:79], v0
    ds_read_b128 v[16:19], v11 offset:16384
    buffer_load_dword v60, s[4:7], s53 offen sc1 lds
    v_mov_b64 v[14:15], -1
    s_cbranch_scc1 Lflag_38
Lflagr_39:
    s_waitcnt lgkmcnt(2)
    v_smfmac_f32_16x16x64_bf16 v[36:39], v[20:23], v[44:51], v0
    ds_read_b128 v[44:47], v3 offset:32768
    ds_read_b128 v[48:51], v3 offset:33792
    v_smfmac_f32_16x16x64_bf16 v[40:43], v[20:23], v[52:59], v0
    ds_read_b128 v[52:55], v3 offset:34816
    ds_read_b128 v[56:59], v3 offset:35840
    v_smfmac_f32_16x16x64_bf16 v[28:31], v[20:23], a[96:103], v0
    v_smfmac_f32_16x16x64_bf16 v[32:35], v[20:23], a[104:111], v0
    ds_read_b128 v[20:23], v11 offset:17408
    buffer_store_dword v12, v9, s[4:7], s37 offen sc1
    v_mov_b64 v[60:61], 0
    v_mov_b64 v[62:63], 0
    s_waitcnt lgkmcnt(6)
    v_smfmac_f32_16x16x64_bf16 v[36:39], v[24:27], a[128:135], v0
    v_smfmac_f32_16x16x64_bf16 v[40:43], v[24:27], a[136:143], v0
    v_smfmac_f32_16x16x64_bf16 v[28:31], v[24:27], a[112:119], v0
    v_smfmac_f32_16x16x64_bf16 v[32:35], v[24:27], a[120:127], v0
    ds_read_b128 v[24:27], v11 offset:18432
    buffer_store_dwordx4 v[12:15], v1, s[4:7], s44 offen sc1
    s_waitcnt lgkmcnt(2)
    v_smfmac_f32_16x16x64_bf16 v[36:39], v[16:19], v[44:51], v0
    ds_read_b128 v[44:47], v3 offset:49152
    ds_read_b128 v[48:51], v3 offset:50176
    v_smfmac_f32_16x16x64_bf16 v[40:43], v[16:19], v[52:59], v0
    ds_read_b128 v[52:55], v3 offset:51200
    ds_read_b128 v[56:59], v3 offset:52224
    v_smfmac_f32_16x16x64_bf16 v[28:31], v[16:19], a[144:151], v0
    v_smfmac_f32_16x16x64_bf16 v[32:35], v[16:19], a[152:159], v0
    ds_read_b128 v[16:19], v1 offset:16384
    buffer_store_dwordx4 v[12:15], v1, s[4:7], s45 offen sc1
    s_waitcnt lgkmcnt(6)
    v_smfmac_f32_16x16x64_bf16 v[36:39], v[20:23], a[176:183], v0
    v_smfmac_f32_16x16x64_bf16 v[40:43], v[20:23], a[184:191], v0
    v_smfmac_f32_16x16x64_bf16 v[28:31], v[20:23], a[160:167], v0
    v_smfmac_f32_16x16x64_bf16 v[32:35], v[20:23], a[168:175], v0
    ds_read_b128 v[20:23], v1 offset:17408
    buffer_store_dwordx4 v[12:15], v1, s[4:7], s46 offen sc1
    s_waitcnt lgkmcnt(2)
    v_smfmac_f32_16x16x64_bf16 v[36:39], v[24:27], v[44:51], v0
    v_smfmac_f32_16x16x64_bf16 v[40:43], v[24:27], v[52:59], v0
    v_smfmac_f32_16x16x64_bf16 v[28:31], v[24:27], a[192:199], v0
    v_smfmac_f32_16x16x64_bf16 v[32:35], v[24:27], a[200:207], v0
    ds_read_b128 v[24:27], v1 offset:18432
    v_mov_b64 v[12:13], 0
    v_mov_b64 v[14:15], 0
    ds_read_b128 v[44:47], v1 offset:0
    ds_read_b128 v[48:51], v1 offset:4096
    ds_read_b128 v[52:55], v1 offset:1024
    ds_read_b128 v[56:59], v1 offset:5120
    s_nop 0
    v_permlane32_swap_b32 v36, v40
    v_permlane32_swap_b32 v37, v41
    v_permlane32_swap_b32 v38, v42
    v_permlane32_swap_b32 v39, v43
    v_pk_add_f32 v[36:37], v[36:37], v[40:41]
    v_pk_add_f32 v[38:39], v[38:39], v[42:43]
    v_cvt_pk_bf16_f32 v40, v36, v37
    v_cvt_pk_bf16_f32 v41, v38, v39
    ds_write_b64 v4, v[40:41] offset:26112
    v_permlane32_swap_b32 v28, v32
    v_permlane32_swap_b32 v29, v33
    v_permlane32_swap_b32 v30, v34
    v_permlane32_swap_b32 v31, v35
    v_pk_add_f32 v[28:29], v[28:29], v[32:33]
    v_pk_add_f32 v[30:31], v[30:31], v[34:35]
    v_cvt_pk_bf16_f32 v32, v28, v29
    v_cvt_pk_bf16_f32 v33, v30, v31
    ds_write_b64 v4, v[32:33] offset:25600
    s_waitcnt lgkmcnt(8)
    v_smfmac_f32_16x16x64_bf16 v[60:63], v[16:19], a[208:215], v0
    ds_read_b128 v[28:31], v1 offset:2048
    v_smfmac_f32_16x16x64_bf16 v[12:15], v[16:19], a[216:223], v0
    s_waitcnt lgkmcnt(8)
    v_smfmac_f32_16x16x64_bf16 v[60:63], v[20:23], a[224:231], v0
    v_smfmac_f32_16x16x64_bf16 v[12:15], v[20:23], a[232:239], v0
    s_cmp_eq_u32 s30, 63
    s_waitcnt lgkmcnt(1)
    s_barrier
    s_cbranch_scc1 Llast_s
    ds_read_b64_tr_b16 v[36:37], v5 offset:0
    ds_read_b64_tr_b16 v[38:39], v5 offset:64
    ds_read_b64_tr_b16 v[16:17], v5 offset:512
    ds_read_b64_tr_b16 v[18:19], v5 offset:576
    v_smfmac_f32_16x16x64_bf16 v[60:63], v[24:27], a[240:247], v0
    ds_read_b64_tr_b16 v[20:21], v5 offset:1024
    ds_read_b64_tr_b16 v[22:23], v5 offset:1088
    v_smfmac_f32_16x16x64_bf16 v[12:15], v[24:27], a[248:255], v0
    ds_read_b64_tr_b16 v[24:25], v5 offset:1536
    ds_read_b64_tr_b16 v[26:27], v5 offset:1600
    v_add_u32 v9, s68, v1
    s_waitcnt lgkmcnt(6)
    v_mfma_f32_16x16x32_bf16 v[32:35], v[44:47], v[36:39], 0
    ds_read_b128 v[44:47], v1 offset:6144
    v_mfma_f32_16x16x32_bf16 v[40:43], v[48:51], v[36:39], 0
    ds_read_b128 v[48:51], v1 offset:3072
    s_waitcnt lgkmcnt(6)
    v_mfma_f32_16x16x32_bf16 v[32:35], v[52:55], v[16:19], v[32:35]
    ds_read_b128 v[52:55], v1 offset:7168
    v_mfma_f32_16x16x32_bf16 v[40:43], v[56:59], v[16:19], v[40:43]
    ds_read_b64_tr_b16 v[56:57], v5 offset:2048
    ds_read_b64_tr_b16 v[58:59], v5 offset:2112
    s_waitcnt lgkmcnt(4)
    v_mfma_f32_16x16x32_bf16 v[32:35], v[28:31], v[20:23], v[32:35]
    v_mfma_f32_16x16x32_bf16 v[40:43], v[44:47], v[20:23], v[40:43]
    ds_read_b64_tr_b16 v[44:45], v5 offset:2560
    ds_read_b64_tr_b16 v[46:47], v5 offset:2624
    s_waitcnt lgkmcnt(4)
    v_mfma_f32_16x16x32_bf16 v[32:35], v[48:51], v[24:27], v[32:35]
    ds_read_b64_tr_b16 v[48:49], v5 offset:3072
    ds_read_b64_tr_b16 v[50:51], v5 offset:3136
    v_mfma_f32_16x16x32_bf16 v[40:43], v[52:55], v[24:27], v[40:43]
    ds_read_b64_tr_b16 v[52:53], v5 offset:3584
    ds_read_b64_tr_b16 v[54:55], v5 offset:3648
    s_waitcnt lgkmcnt(4)
    v_mfma_f32_16x16x32_bf16 v[28:31], v[56:59], v[36:39], 0
    v_mfma_f32_16x16x32_bf16 v[28:31], v[44:47], v[16:19], v[28:31]
    ds_read_b128 v[16:19], v1 offset:19456
    s_waitcnt lgkmcnt(1)
    v_mfma_f32_16x16x32_bf16 v[28:31], v[48:51], v[20:23], v[28:31]
    ds_read_b128 v[20:23], v1 offset:20480
    v_max3_f32 v11, v32, v33, v34
    v_mfma_f32_16x16x32_bf16 v[28:31], v[52:55], v[24:27], v[28:31]
    ds_read_b128 v[24:27], v1 offset:21504
    v_max3_f32 v11, v11, v35, v40
    v_max3_f32 v11, v11, v41, v42
    ds_read_b128 v[56:59], v9 offset:8192
    ds_read_b128 v[36:39], v9 offset:9216
    v_max_f32 v11, v11, v43
    s_waitcnt lgkmcnt(4)
    v_smfmac_f32_16x16x64_bf16 v[60:63], v[16:19], v[64:71], v0
    v_smfmac_f32_16x16x64_bf16 v[12:15], v[16:19], v[72:79], v0
    ds_read_b128 v[16:19], v1 offset:22528
    v_max3_f32 v11, v11, v28, v29
    v_max3_f32 v10, v11, v30, v31
    v_max3_f32 v11, v11, v30, v31
    s_waitcnt lgkmcnt(4)
    v_smfmac_f32_16x16x64_bf16 v[60:63], v[20:23], v[80:87], v0
    v_permlane32_swap_b32 v10, v11
    v_max_f32 v9, v10, v11
    v_max_f32 v11, v10, v11
    v_smfmac_f32_16x16x64_bf16 v[12:15], v[20:23], v[88:95], v0
    ds_read_b128 v[20:23], v1 offset:23552
    v_permlane16_swap_b32 v9, v11
    v_max_f32 v10, v9, v11
    v_mul_f32 v10, s42, v10
    v_pk_fma_f32 v[32:33], v[32:33], s[42:43], v[10:11] op_sel_hi:[1,0,0] neg_lo:[0,0,1] neg_hi:[0,0,1]
    v_pk_fma_f32 v[34:35], v[34:35], s[42:43], v[10:11] op_sel_hi:[1,0,0] neg_lo:[0,0,1] neg_hi:[0,0,1]
    v_pk_fma_f32 v[40:41], v[40:41], s[42:43], v[10:11] op_sel_hi:[1,0,0] neg_lo:[0,0,1] neg_hi:[0,0,1]
    v_pk_fma_f32 v[42:43], v[42:43], s[42:43], v[10:11] op_sel_hi:[1,0,0] neg_lo:[0,0,1] neg_hi:[0,0,1]
    v_pk_fma_f32 v[28:29], v[28:29], s[42:43], v[10:11] op_sel_hi:[1,0,0] neg_lo:[0,0,1] neg_hi:[0,0,1]
    v_pk_fma_f32 v[30:31], v[30:31], s[42:43], v[10:11] op_sel_hi:[1,0,0] neg_lo:[0,0,1] neg_hi:[0,0,1]
    v_exp_f32 v32, v32
    s_waitcnt lgkmcnt(4)
    v_smfmac_f32_16x16x64_bf16 v[60:63], v[24:27], v[96:103], v0
    v_exp_f32 v33, v33
    v_smfmac_f32_16x16x64_bf16 v[12:15], v[24:27], v[104:111], v0
    ds_read_b128 v[24:27], v1 offset:24576
    v_exp_f32 v34, v34
    s_waitcnt lgkmcnt(2)
    v_smfmac_f32_16x16x64_bf16 v[60:63], v[16:19], v[112:119], v0
    v_exp_f32 v35, v35
    v_smfmac_f32_16x16x64_bf16 v[12:15], v[16:19], v[120:127], v0
    v_exp_f32 v40, v40
    s_waitcnt lgkmcnt(1)
    v_smfmac_f32_16x16x64_bf16 v[60:63], v[20:23], v[128:135], v0
    v_exp_f32 v41, v41
    v_smfmac_f32_16x16x64_bf16 v[12:15], v[20:23], v[136:143], v0
    v_exp_f32 v42, v42
    s_waitcnt lgkmcnt(0)
    v_smfmac_f32_16x16x64_bf16 v[60:63], v[24:27], v[144:151], v0
    v_exp_f32 v43, v43
    v_smfmac_f32_16x16x64_bf16 v[12:15], v[24:27], v[152:159], v0
    s_add_u32 m0, s87, 8192
    s_add_u32 s92, s38, 8192
    buffer_load_dwordx4 v1, s[4:7], s92 offen offset:0 sc1 lds
    v_cvt_pk_bf16_f32 v48, v32, v33
    v_cvt_pk_bf16_f32 v49, v34, v35
    v_cvt_pk_bf16_f32 v50, v40, v41
    v_cvt_pk_bf16_f32 v51, v42, v43
    v_exp_f32 v28, v28
    v_exp_f32 v29, v29
    v_mfma_f32_16x16x32_bf16 v[32:35], v[56:59], v[48:51], 0
    v_exp_f32 v30, v30
    v_mfma_f32_16x16x32_bf16 v[40:43], v[36:39], v[48:51], 0
    v_exp_f32 v31, v31
    v_mov_b64 v[44:45], s[88:89]
    v_mov_b64 v[46:47], s[90:91]
    v_cvt_pk_bf16_f32 v36, v60, v61
    v_cvt_pk_bf16_f32 v37, v62, v63
    v_mfma_f32_16x16x16_bf16 v[16:19], v[44:45], v[48:49], 0
    v_cvt_pk_bf16_f32 v52, v28, v29
    v_cvt_pk_bf16_f32 v53, v30, v31
    v_mfma_f32_16x16x16_bf16 v[16:19], v[44:45], v[50:51], v[16:19]
    v_cvt_pk_bf16_f32 v38, v12, v13
    v_cvt_pk_bf16_f32 v39, v14, v15
    v_mfma_f32_16x16x16_bf16 v[16:19], v[46:47], v[52:53], v[16:19]
    v_mov_b64 v[60:61], 0
    v_mov_b64 v[62:63], 0
    v_mfma_f32_16x16x16_bf16 v[32:35], v[36:37], v[52:53], v[32:35]
    v_mov_b64 v[12:13], 0
    v_mov_b64 v[14:15], 0
    v_mfma_f32_16x16x16_bf16 v[40:43], v[38:39], v[52:53], v[40:43]
    v_mov_b64 v[28:29], 0
    v_mov_b64 v[30:31], 0
    buffer_load_dwordx4 v1, s[4:7], s92 offen offset:1024 sc1 lds
    v_rcp_f32 v16, v16
    v_mov_b64 v[24:25], 0
    v_mov_b64 v[26:27], 0
    v_add_u32 v9, s64, v8
    v_pk_mul_f32 v[32:33], v[32:33], v[16:17] op_sel_hi:[1,0]
    v_pk_mul_f32 v[34:35], v[34:35], v[16:17] op_sel_hi:[1,0]
    v_pk_mul_f32 v[40:41], v[40:41], v[16:17] op_sel_hi:[1,0]
    v_pk_mul_f32 v[42:43], v[42:43], v[16:17] op_sel_hi:[1,0]
    v_cvt_pk_bf16_f32 v20, v32, v33
    v_cvt_pk_bf16_f32 v21, v34, v35
    v_cvt_pk_bf16_f32 v22, v40, v41
    v_cvt_pk_bf16_f32 v23, v42, v43
    ds_write_b128 v9, v[20:23]
    ds_read_b128 v[44:47], v2 offset:0
    ds_read_b128 v[48:51], v2 offset:1024
    v_smfmac_f32_16x16x64_bf16 v[60:63], v[20:23], v[160:167], v0
    ds_read_b128 v[52:55], v2 offset:2048
    v_add_u32 v10, s65, v8
    v_smfmac_f32_16x16x64_bf16 v[28:31], v[20:23], v[208:215], v0
    ds_read_b128 v[56:59], v2 offset:3072
    v_add_u32 v11, s66, v8
    v_smfmac_f32_16x16x64_bf16 v[24:27], v[20:23], v[224:231], v0
    v_add_u32 v9, s67, v8
    s_mov_b32 m0, s87
    s_waitcnt lgkmcnt(2)
    v_smfmac_f32_16x16x64_bf16 v[12:15], v[20:23], v[44:51], v0
    s_waitcnt vmcnt(2)
    s_barrier
    ds_read_b128 v[32:35], v10
    ds_read_b128 v[40:43], v11
    ds_read_b128 v[16:19], v9
    ds_read_b128 v[20:23], v6
    ds_read_b128 v[44:47], v2 offset:16384
    ds_read_b128 v[48:51], v2 offset:17408
    buffer_load_dwordx4 v1, s[4:7], s38 offen offset:0 sc1 lds
    buffer_load_dwordx4 v1, s[4:7], s38 offen offset:1024 sc1 lds
    s_lshl_b32 s31, s29, 10
    v_add_u32 v10, s31, v1
    s_waitcnt lgkmcnt(5)
    v_smfmac_f32_16x16x64_bf16 v[60:63], v[32:35], v[168:175], v0
    ds_write_b128 v10, v[36:39] offset:20480
    s_waitcnt lgkmcnt(5)
    v_smfmac_f32_16x16x64_bf16 v[60:63], v[40:43], v[176:183], v0
    s_waitcnt lgkmcnt(4)
    v_smfmac_f32_16x16x64_bf16 v[60:63], v[16:19], v[184:191], v0
    v_bfe_u32 v9, v1, 9, 1
    v_smfmac_f32_16x16x64_bf16 v[12:15], v[32:35], v[52:59], v0
    ds_read_b128 v[52:55], v2 offset:18432
    ds_read_b128 v[56:59], v2 offset:19456
    v_mul_u32_u24 v9, 8188, v9
    v_smfmac_f32_16x16x64_bf16 v[12:15], v[40:43], v[192:199], v0
    v_sub_u32 v9, v7, v9
    v_smfmac_f32_16x16x64_bf16 v[12:15], v[16:19], v[200:207], v0
    v_cvt_pk_bf16_f32 v60, v60, v61
    v_cvt_pk_bf16_f32 v61, v62, v63
    buffer_store_dwordx2 v[60:61], v7, s[4:7], s48 offen sc1
    v_smfmac_f32_16x16x64_bf16 v[28:31], v[32:35], v[216:223], v0
    v_mov_b64 v[36:37], 0
    v_smfmac_f32_16x16x64_bf16 v[24:27], v[32:35], v[232:239], v0
    v_mov_b64 v[38:39], 0
    ds_read_b128 v[32:35], v6 offset:1024
    s_waitcnt lgkmcnt(4)
    v_smfmac_f32_16x16x64_bf16 v[28:31], v[40:43], v[44:51], v0
    ds_read_b128 v[44:47], v2 offset:32768
    ds_read_b128 v[48:51], v2 offset:33792
    v_cvt_pk_bf16_f32 v12, v12, v13
    v_cvt_pk_bf16_f32 v13, v14, v15
    buffer_store_dwordx2 v[12:13], v7, s[4:7], s49 offen sc1
    s_waitcnt lgkmcnt(3)
    v_smfmac_f32_16x16x64_bf16 v[28:31], v[16:19], v[52:59], v0
    ds_read_b128 v[52:55], v2 offset:34816
    ds_read_b128 v[56:59], v2 offset:35840
    v_smfmac_f32_16x16x64_bf16 v[36:39], v[20:23], v[240:247], v0
    s_waitcnt lgkmcnt(4)
    v_smfmac_f32_16x16x64_bf16 v[36:39], v[32:35], v[248:255], v0
    s_waitcnt lgkmcnt(2)
    v_smfmac_f32_16x16x64_bf16 v[24:27], v[40:43], v[44:51], v0
    s_nop 0
    v_cvt_pk_bf16_f32 v28, v28, v29
    v_cvt_pk_bf16_f32 v29, v30, v31
    buffer_store_dwordx2 v[28:29], v7, s[4:7], s50 offen sc1
    s_waitcnt lgkmcnt(0)
    v_smfmac_f32_16x16x64_bf16 v[24:27], v[16:19], v[52:59], v0
    s_nop 1
    v_permlane32_swap_b32 v36, v38
    v_permlane32_swap_b32 v37, v39
    v_add_f32 v36, v36, v38
    v_add_f32 v37, v37, v39
    v_cvt_pk_bf16_f32 v36, v36, v37
    s_nop 0
    v_cvt_pk_bf16_f32 v24, v24, v25
    v_cvt_pk_bf16_f32 v25, v26, v27
    buffer_store_dwordx2 v[24:25], v7, s[4:7], s51 offen sc1
    buffer_store_dword v36, v9, s[4:7], s52 offen sc1
Lhops_s:
    ds_read_b128 v[28:31], v10 offset:20480
    v_lshrrev_b32 v61, 1, v10
    ds_read_b64 v[12:13], v61 offset:60416
    s_mov_b32 s81, s63
    ds_read_b128 v[16:19], v1 offset:29696
    v_lshrrev_b32 v9, 2, v1
    v_add_u32 v9, 79872, v9
    ds_read_b32 v9, v9
    ds_read_b128 v[44:47], v2 offset:49152
    ds_read_b128 v[48:51], v2 offset:50176
    ds_read_b128 v[52:55], v2 offset:51200
    ds_read_b128 v[56:59], v2 offset:52224
    v_add_u32 v10, s57, v1
    v_add_u32 v11, s60, v1
    s_mov_b32 s41, s34
    s_add_u32 s44, s48, s84
    s_add_u32 s45, s44, 131072
    s_add_u32 s46, s44, s85
    s_add_u32 s70, s35, s43
    s_xor_b32 s37, s70, 32768
    s_add_u32 s36, s35, s54
    s_sub_u32 s36, s36, 65536
    s_add_u32 s30, s30, 1
    s_and_b32 s31, s30, 1
    s_mul_i32 s31, s31, 294912
    s_add_u32 s48, s31, 1048576
    s_add_u32 s49, s48, 16384
    s_add_u32 s50, s48, 32768
    s_add_u32 s51, s48, 49152
    s_add_u32 s52, s48, 65536
    s_add_u32 s34, s48, s69
    s_and_b32 s31, s30, 3
    s_lshl_b32 s31, s31, 14
    s_add_u32 s35, s31, 2097152
    s_add_u32 s38, s38, 16384
    s_add_u32 s53, s38, s68
    s_add_u32 s53, s53, -180224
    s_mul_i32 s31, s28, 65
    s_add_u32 s31, s31, s30
    s_lshl_b32 s31, s31, 13
    s_add_u32 s39, s31, 71237632
    s_lshl_b32 s32, s29, 10
    s_add_u32 s63, s39, s32
    s_mov_b32 m0, s71
    s_waitcnt lgkmcnt(0)
    v_permlane32_swap_b32 v28, v30
    v_permlane32_swap_b32 v29, v31
    v_lshlrev_b32 v32, 16, v28
    v_and_b32 v33, 0xffff0000, v28
    v_lshlrev_b32 v34, 16, v29
    v_and_b32 v35, 0xffff0000, v29
    v_lshlrev_b32 v36, 16, v30
    v_and_b32 v37, 0xffff0000, v30
    v_lshlrev_b32 v38, 16, v31
    v_and_b32 v39, 0xffff0000, v31
    v_pk_add_f32 v[32:33], v[32:33], v[36:37]
    v_pk_add_f32 v[34:35], v[34:35], v[38:39]
    v_cvt_pk_bf16_f32 v14, v32, v33
    v_cvt_pk_bf16_f32 v15, v34, v35
    s_cmp_ge_u32 s40, 72
    s_cbranch_scc1 Lhop2_40
    s_mov_b32 s33, 0
    s_waitcnt lgkmcnt(0)
Lp1_43:
    buffer_load_dwordx4 v[28:31], v1, s[4:7], s41 offen offset:0 sc1
    buffer_load_dwordx4 v[32:35], v1, s[4:7], s41 offen offset:1024 sc1
    buffer_load_dwordx4 v[36:39], v1, s[4:7], s41 offen offset:2048 sc1
    buffer_load_dwordx4 v[40:43], v1, s[4:7], s41 offen offset:3072 sc1
    s_add_u32 s33, s33, 1
    s_cmp_gt_u32 s33, 1048576
    s_cbranch_scc1 Lchain_exit
    s_waitcnt vmcnt(3)
    v_mfma_f32_16x16x32_bf16 v[20:23], v[28:31], v[16:19], 0
    v_max3_u32 v24, v28, v29, v30
    v_max_u32 v24, v24, v31
    s_waitcnt vmcnt(2)
    v_mfma_f32_16x16x32_bf16 v[20:23], v[32:35], v[16:19], v[20:23]
    v_max3_u32 v24, v24, v32, v33
    v_max3_u32 v24, v24, v34, v35
    s_waitcnt vmcnt(1)
    v_mfma_f32_16x16x32_bf16 v[20:23], v[36:39], v[16:19], v[20:23]
    v_max3_u32 v24, v24, v36, v37
    v_max3_u32 v24, v24, v38, v39
    s_waitcnt vmcnt(0)
    v_mfma_f32_16x16x32_bf16 v[20:23], v[40:43], v[16:19], v[20:23]
    v_max3_u32 v24, v24, v40, v41
    v_max3_u32 v24, v24, v42, v43
    v_cmp_eq_u32 vcc, -1, v24
    s_cbranch_vccnz Lp1_43
    s_nop 3
    v_permlane32_swap_b32 v20, v22
    v_permlane32_swap_b32 v21, v23
    v_pk_add_f32 v[20:21], v[20:21], v[22:23]
    v_cvt_pk_bf16_f32 v20, v20, v21
    buffer_store_dword v20, v9, s[4:7], s70 offen sc1
Lhop2_40:
    v_mov_b64 v[28:29], 0
    v_mov_b64 v[30:31], 0
    v_mov_b64 v[32:33], 0
    v_mov_b64 v[34:35], 0
    v_mov_b64 v[36:37], 0
    v_mov_b64 v[38:39], 0
    v_mov_b64 v[40:41], 0
    v_mov_b64 v[42:43], 0
    s_add_u32 s31, s30, 2
    s_and_b32 s31, s31, 7
    s_or_b32 s31, s31, s95
    s_cbranch_scc1 Lkvok_44
    v_lshrrev_b32 v60, 2, v1
    v_and_b32 v60, 31, v60
    s_mov_b32 s32, 65536
    s_mov_b32 s33, 0
Lkvw_45:
    buffer_load_dword v61, v60, s[4:7], s32 offen sc1
    s_add_u32 s33, s33, 1
    s_cmp_gt_u32 s33, 1048576
    s_cbranch_scc1 Lchain_exit
    s_add_u32 s31, s30, 2
    s_lshr_b32 s31, s31, 3
    s_min_u32 s31, s31, 7
    s_waitcnt vmcnt(0)
    v_cmp_le_u32 vcc, 128, v61
    s_bitcmp1_b32 vcc_lo, s31
    s_cbranch_scc0 Lkvw_45
    s_cmp_eq_u64 vcc, exec
    s_cselect_b32 s95, 1, 0
Lkvok_44:
    s_and_b32 s32, s30, 3
    s_xor_b32 s32, s32, 1
    s_cmp_ge_u32 s30, 60
    s_cselect_b32 s32, 0, s32
    s_or_b32 s32, s32, s29
    s_waitcnt lgkmcnt(0)
    s_barrier
    s_mov_b32 s33, 0
    v_add_u32 v60, s54, v1
Lp2_46:
    buffer_load_dwordx4 v1, s[4:7], s36 offen offset:0 sc1 lds
    buffer_load_dwordx4 v1, s[4:7], s36 offen offset:1024 sc1 lds
    buffer_load_dwordx4 v1, s[4:7], s36 offen offset:2048 sc1 lds
    s_add_u32 s33, s33, 1
    s_cmp_gt_u32 s33, 1048576
    s_cbranch_scc1 Lchain_exit
    s_waitcnt vmcnt(2)
    ds_read_b128 v[16:19], v60 offset:16384
    s_waitcnt vmcnt(1)
    ds_read_b128 v[20:23], v60 offset:17408
    s_waitcnt vmcnt(0)
    ds_read_b128 v[24:27], v60 offset:18432
    s_waitcnt lgkmcnt(2)
    v_max3_u32 v28, v16, v17, v18
    s_waitcnt lgkmcnt(1)
    v_max3_u32 v29, v19, v20, v21
    v_max3_u32 v28, v28, v22, v23
    s_waitcnt lgkmcnt(0)
    v_max3_u32 v29, v29, v24, v25
    v_max3_u32 v28, v28, v26, v27
    v_max_u32 v28, v28, v29
    v_cmp_eq_u32 vcc, -1, v28
    v_mov_b64 v[28:29], 0
    s_cbranch_vccnz Lp2_46
    v_lshlrev_b32 v60, 2, v1
    s_mov_b32 m0, 96512
    s_branch Lstep_s
Lflag_38:
    s_sub_u32 s31, s30, 1
    s_max_i32 s31, s31, 0
    v_mov_b32 v62, s31
    v_mov_b32 v63, 0
    s_mov_b64 exec, 1
    buffer_store_dword v62, v63, s[4:7], s93 offen sc1
    s_mov_b64 exec, -1
    s_branch Lflagr_39
Llast_s:
    s_waitcnt lgkmcnt(7)
    v_smfmac_f32_16x16x64_bf16 v[60:63], v[24:27], a[240:247], v0
    v_smfmac_f32_16x16x64_bf16 v[12:15], v[24:27], a[248:255], v0
    ds_read_b128 v[16:19], v1 offset:19456
    s_waitcnt lgkmcnt(0)
    v_smfmac_f32_16x16x64_bf16 v[60:63], v[16:19], v[64:71], v0
    v_smfmac_f32_16x16x64_bf16 v[12:15], v[16:19], v[72:79], v0
    ds_read_b128 v[20:23], v1 offset:20480
    s_waitcnt lgkmcnt(0)
    v_smfmac_f32_16x16x64_bf16 v[60:63], v[20:23], v[80:87], v0
    v_smfmac_f32_16x16x64_bf16 v[12:15], v[20:23], v[88:95], v0
    ds_read_b128 v[24:27], v1 offset:21504
    s_waitcnt lgkmcnt(0)
    v_smfmac_f32_16x16x64_bf16 v[60:63], v[24:27], v[96:103], v0
    v_smfmac_f32_16x16x64_bf16 v[12:15], v[24:27], v[104:111], v0
    ds_read_b128 v[16:19], v1 offset:22528
    s_waitcnt lgkmcnt(0)
    v_smfmac_f32_16x16x64_bf16 v[60:63], v[16:19], v[112:119], v0
    v_smfmac_f32_16x16x64_bf16 v[12:15], v[16:19], v[120:127], v0
    ds_read_b128 v[20:23], v1 offset:23552
    s_waitcnt lgkmcnt(0)
    v_smfmac_f32_16x16x64_bf16 v[60:63], v[20:23], v[128:135], v0
    v_smfmac_f32_16x16x64_bf16 v[12:15], v[20:23], v[136:143], v0
    ds_read_b128 v[24:27], v1 offset:24576
    s_waitcnt lgkmcnt(0)
    v_smfmac_f32_16x16x64_bf16 v[60:63], v[24:27], v[144:151], v0
    v_smfmac_f32_16x16x64_bf16 v[12:15], v[24:27], v[152:159], v0
    s_nop 7
    s_nop 1
    s_lshl_b32 s31, s29, 9
    v_lshrrev_b32 v10, 1, v1
    v_add_u32 v10, s31, v10
    ds_read_b64 v[44:45], v10 offset:60416
    v_permlane32_swap_b32 v60, v12
    v_permlane32_swap_b32 v61, v13
    v_permlane32_swap_b32 v62, v14
    v_permlane32_swap_b32 v63, v15
    v_pk_add_f32 v[60:61], v[60:61], v[12:13]
    v_pk_add_f32 v[62:63], v[62:63], v[14:15]
    v_cvt_pk_bf16_f32 v46, v60, v61
    v_cvt_pk_bf16_f32 v47, v62, v63
    s_waitcnt lgkmcnt(0)
    buffer_store_dwordx4 v[44:47], v1, s[4:7], s63 offen sc1
    s_branch Lfin
Lfin:
    s_waitcnt vmcnt(0)
    s_barrier
    s_cmp_lg_u32 s29, 0
    s_cbranch_scc1 Lchain_exit
    v_mov_b32 v10, 64
    v_mov_b32 v11, 0
    s_mov_b64 exec, 1
    buffer_store_dword v10, v11, s[4:7], s93 offen sc1
Lchain_exit:
    s_endpgm
Lcode_end:
.section .rodata,"a"
.p2align 6
.amdhsa_kernel gated_mix__memory_aug_recurrent_mem_tr__dense_activation_gelu__prompt_kernel
  .amdhsa_next_free_vgpr 512
  .amdhsa_next_free_sgpr 102
  .amdhsa_accum_offset 256
  .amdhsa_group_segment_fixed_size 0
  .amdhsa_kernarg_size 128
  .amdhsa_user_sgpr_count 2
  .amdhsa_user_sgpr_kernarg_segment_ptr 1
  .amdhsa_system_sgpr_workgroup_id_x 1
.end_amdhsa_kernel
```
